```python
import torch

def _softmax(x, axis=-1):
    return torch.softmax(x, dim=axis)
def _gelu(x):
    return torch.nn.functional.gelu(x, approximate="tanh")
def _silu(x):
    return torch.nn.functional.silu(x)
def _sigmoid(x):
    return torch.sigmoid(x)
def _layernorm(x, axis=-1, eps=1e-5):
    m = x.mean(dim=axis, keepdim=True)
    v = x.var(dim=axis, keepdim=True, unbiased=False)
    return (x - m) / torch.sqrt(v + eps)
def _scatter_add(tgt, idx, src, axis=0):
    return tgt.clone().index_add_(axis, idx, src)
def _segment_sum(src, seg, n):
    out = torch.zeros((n,) + src.shape[1:], dtype=src.dtype)
    return out.index_add_(0, seg, src)
def _pad(x, pw):
    flat = tuple(v for pair in reversed(pw) for v in pair)
    return torch.nn.functional.pad(x, flat)

kernel_name = 'sequential_preLN__sliding_block__glu_gated_glu__prompt'

def setup_inputs():

    _w = (lambda a: (lambda t: t.to(torch.bfloat16) if t.is_floating_point() else t)(torch.as_tensor(a)))
    def _A_setup():
        B, S, D = 1, 2048, 576
        return {
            "x": _w((lambda *s: torch.randn(*s, dtype=torch.bfloat16) * 0.05)(B, S, D)),
            "wqkv": _w((lambda *s: torch.randn(*s, dtype=torch.bfloat16) * 0.05)(D, 3 * D)),
            "wo": _w((lambda *s: torch.randn(*s, dtype=torch.bfloat16) * 0.05)(D, D)),
        }
    _A_in = _A_setup()

    def _B_setup():
        B, S, D, F = 1, 2048, 576, 4608
        return {
            "x": _w((lambda *s: torch.randn(*s, dtype=torch.bfloat16) * 0.05)(B, S, D)),
            "w_gate": _w((lambda *s: torch.randn(*s, dtype=torch.bfloat16) * 0.05)(D, F)),
            "w_up": _w((lambda *s: torch.randn(*s, dtype=torch.bfloat16) * 0.05)(D, F)),
            "w_down": _w((lambda *s: torch.randn(*s, dtype=torch.bfloat16) * 0.05)(F, D)),
        }
    _B_in = _B_setup()

    return {
        "A_x": _A_in["x"],
        "A_wqkv": _A_in["wqkv"],
        "A_wo": _A_in["wo"],
        "B_x": _B_in["x"],
        "B_w_gate": _B_in["w_gate"],
        "B_w_up": _B_in["w_up"],
        "B_w_down": _B_in["w_down"],
    }

def reference(A_x, A_wqkv, A_wo, B_x, B_w_gate, B_w_up, B_w_down):
    def _A_ref(x, wqkv, wo):
        B, S, D = x.shape
        H = 32; Dh = D // H; W = 256
        qkv = (lambda x, *d: x.permute(*d))((x @ wqkv).reshape(B, S, 3, H, Dh), 2, 0, 3, 1, 4)
        q, k, v = qkv[0], qkv[1], qkv[2]
        scores = torch.einsum("bhqd,bhkd->bhqk", q, k) * (Dh ** -0.5)
        idx = torch.arange(S)
        mask = (idx[:, None] - idx[None, :] >= 0) & (idx[:, None] - idx[None, :] < W)
        scores = torch.where(mask[None, None], scores, -1e9)
        p = _softmax(scores, axis=-1)
        o = torch.einsum("bhqk,bhkd->bhqd", p, v)
        return (lambda x, *d: x.permute(*d))(o, 0, 2, 1, 3).reshape(B, S, D) @ wo

    def _B_ref(x, w_gate, w_up, w_down):
        g = torch.einsum("bsd,df->bsf", x, w_gate)
        u = torch.einsum("bsd,df->bsf", x, w_up)
        h = _sigmoid(g) * u
        return torch.einsum("bsf,fd->bsd", h, w_down)

    x = A_x
    h = x + _A_ref(_layernorm(x, axis=-1), A_wqkv, A_wo)
    h2 = h + _B_ref(_layernorm(h, axis=-1), B_w_gate, B_w_up, B_w_down)
    return h2
```

```asm
; @launch kernel=sequential_preLN__sliding_block__glu_gated_glu__prompt_kernel grid=(256,1,1) block=(256,1,1) lds=133120
; @launch kernel=k2_kernel grid=(256,1,1) block=(256,1,1) lds=1024
; @launch kernel=k3_kernel grid=(240,1,1) block=(320,1,1) lds=90112
; @launch kernel=k4_kernel grid=(256,1,1) block=(512,1,1) lds=147456
; @launch kernel=k5_kernel grid=(256,1,1) block=(256,1,1) lds=159744
.amdgcn_target "amdgcn-amd-amdhsa--gfx950"
.text
.globl sequential_preLN__sliding_block__glu_gated_glu__prompt_kernel
.p2align 8
.type sequential_preLN__sliding_block__glu_gated_glu__prompt_kernel,@function
sequential_preLN__sliding_block__glu_gated_glu__prompt_kernel:
    s_cmp_ge_u32 s2, 256
    s_cbranch_scc1 L_sequential_preLN__sliding_block__glu_gated_glu__prompt_kernel_x
    v_lshrrev_b32 v180, 6, v0
    v_and_b32 v0, 63, v0
    v_readfirstlane_b32 s24, v180
    s_cmp_ge_u32 s2, 224
    s_cbranch_scc1 L_sequential_preLN__sliding_block__glu_gated_glu__prompt_kernel_pf
    s_load_dwordx4 s[4:7], s[0:1], 0
    s_load_dwordx2 s[8:9], s[0:1], 72
    s_and_b32 s27, s2, 7
    s_lshr_b32 s28, s2, 3
    s_lshl_b32 s25, s27, 1
    s_and_b32 s27, s28, 1
    s_add_u32 s25, s25, s27
    s_lshr_b32 s26, s28, 1
    s_lshr_b32 s29, s24, 1
    s_and_b32 s30, s24, 1
    s_lshl_b32 s31, s26, 1
    s_add_u32 s31, s31, s30
    v_lshrrev_b32 v180, 3, v0
    v_mul_u32_u24 v1, 1152, v180
    v_lshrrev_b32 v181, 4, v0
    s_lshl_b32 s27, s30, 2
    v_add_u32 v182, s27, v181
    v_and_b32 v183, 7, v0
    v_xor_b32 v182, v182, v183
    v_lshl_add_u32 v1, v182, 4, v1
    v_lshrrev_b32 v182, 5, v0
    v_lshlrev_b32 v182, 3, v182
    v_and_b32 v180, 3, v180
    v_add_u32 v182, v182, v180
    v_mul_u32_u24 v2, 3456, v182
    v_lshlrev_b32 v181, 1, v181
    v_xor_b32 v181, v181, v183
    v_lshl_add_u32 v2, v181, 4, v2
    s_lshl_b32 s32, s24, 10
    s_lshl_b32 s27, s25, 7
    s_lshl_b32 s28, s24, 3
    s_add_u32 s27, s27, s28
    s_mul_i32 s33, s27, 1152
    s_lshl_b32 s27, s29, 4
    s_lshl_b32 s28, s30, 2
    s_add_u32 s27, s27, s28
    s_mul_i32 s34, s27, 3456
    s_lshl_b32 s27, s26, 8
    s_add_u32 s34, s34, s27
    s_mov_b32 s36, 0x3f803f80
    s_waitcnt lgkmcnt(0)
    s_mov_b32 s12, s4
    s_mov_b32 s13, s5
    s_mov_b32 s14, 2359296
    s_mov_b32 s15, 0x00020000
    s_mov_b32 s16, s6
    s_mov_b32 s17, s7
    s_mov_b32 s18, 1990656
    s_mov_b32 s19, 0x00020000
    s_mov_b32 s20, s8
    s_mov_b32 s21, s9
    s_mov_b32 s22, 75497472
    s_mov_b32 s23, 0x00020000
    s_add_u32 s62, s25, s26
    s_mul_i32 s27, s62, 7282
    s_lshr_b32 s27, s27, 16
    s_mul_i32 s27, s27, 9
    s_sub_u32 s62, s62, s27
    s_lshl_b32 s60, s62, 7
    s_add_u32 s60, s60, s33
    s_mul_i32 s61, s62, 221184
    s_add_u32 s61, s61, s34
    s_add_u32 s62, s62, 1
    s_cmp_eq_u32 s62, 9
    s_cselect_b32 s62, 0, s62
    s_add_u32 m0, s32, 0
    s_add_u32 s35, s60, 0
    buffer_load_dwordx4 v1, s[12:15], s35 offen lds
    s_add_u32 m0, s32, 16384
    s_add_u32 s35, s61, 0
    buffer_load_dwordx4 v2, s[16:19], s35 offen lds
    s_add_u32 m0, s32, 4096
    s_add_u32 s35, s60, 36864
    buffer_load_dwordx4 v1, s[12:15], s35 offen lds
    s_add_u32 m0, s32, 20480
    s_add_u32 s35, s61, 110592
    buffer_load_dwordx4 v2, s[16:19], s35 offen lds
    s_add_u32 m0, s32, 8192
    s_add_u32 s35, s60, 73728
    buffer_load_dwordx4 v1, s[12:15], s35 offen lds
    s_add_u32 m0, s32, 24576
    s_add_u32 s35, s61, 128
    buffer_load_dwordx4 v2, s[16:19], s35 offen lds
    s_add_u32 m0, s32, 12288
    s_add_u32 s35, s60, 110592
    buffer_load_dwordx4 v1, s[12:15], s35 offen lds
    s_add_u32 m0, s32, 28672
    s_add_u32 s35, s61, 110720
    buffer_load_dwordx4 v2, s[16:19], s35 offen lds
    s_getpc_b64 s[64:65]
L_pfc1:
    s_add_u32 s64, s64, sequential_preLN__sliding_block__glu_gated_glu__prompt_kernel-L_pfc1
    s_addc_u32 s65, s65, (sequential_preLN__sliding_block__glu_gated_glu__prompt_kernel-L_pfc1)>>32
    s_lshl_b32 s27, s24, 6
    v_add_u32 v236, s27, v0
    v_lshlrev_b32 v236, 7, v236
    s_mov_b32 s27, k2_kernel-sequential_preLN__sliding_block__glu_gated_glu__prompt_kernel
    v_cmp_gt_u32 s[66:67], s27, v236
    v_mov_b32 v237, s65
    v_add_co_u32 v236, vcc, s64, v236
    s_nop 1
    v_addc_co_u32 v237, vcc, 0, v237, vcc
    s_mov_b64 exec, s[66:67]
    s_cbranch_execz L_pfc1_s
    global_load_dword v236, v[236:237], off
L_pfc1_s:
    s_mov_b64 exec, -1
    s_lshl_b32 s60, s62, 7
    s_add_u32 s60, s60, s33
    s_mul_i32 s61, s62, 221184
    s_add_u32 s61, s61, s34
    s_add_u32 s62, s62, 1
    s_cmp_eq_u32 s62, 9
    s_cselect_b32 s62, 0, s62
    s_add_u32 m0, s32, 32768
    s_add_u32 s35, s60, 0
    buffer_load_dwordx4 v1, s[12:15], s35 offen lds
    s_add_u32 m0, s32, 49152
    s_add_u32 s35, s61, 0
    buffer_load_dwordx4 v2, s[16:19], s35 offen lds
    s_add_u32 m0, s32, 36864
    s_add_u32 s35, s60, 36864
    buffer_load_dwordx4 v1, s[12:15], s35 offen lds
    s_add_u32 m0, s32, 53248
    s_add_u32 s35, s61, 110592
    buffer_load_dwordx4 v2, s[16:19], s35 offen lds
    s_add_u32 m0, s32, 40960
    s_add_u32 s35, s60, 73728
    buffer_load_dwordx4 v1, s[12:15], s35 offen lds
    s_add_u32 m0, s32, 57344
    s_add_u32 s35, s61, 128
    buffer_load_dwordx4 v2, s[16:19], s35 offen lds
    s_add_u32 m0, s32, 45056
    s_add_u32 s35, s60, 110592
    buffer_load_dwordx4 v1, s[12:15], s35 offen lds
    s_add_u32 m0, s32, 61440
    s_add_u32 s35, s61, 110720
    buffer_load_dwordx4 v2, s[16:19], s35 offen lds
    s_lshr_b32 s28, s2, 3
    s_lshl_b32 s28, s28, 2
    s_add_u32 s28, s28, s24
    s_and_b32 s28, s28, 31
    s_getpc_b64 s[64:65]
L_pfc2:
    s_add_u32 s64, s64, k2_kernel-L_pfc2
    s_addc_u32 s65, s65, (k2_kernel-L_pfc2)>>32
    s_lshl_b32 s27, s28, 6
    v_add_u32 v238, s27, v0
    v_lshlrev_b32 v238, 7, v238
    s_mov_b32 s27, L_code_end-k2_kernel
    v_cmp_gt_u32 s[66:67], s27, v238
    v_mov_b32 v239, s65
    v_add_co_u32 v238, vcc, s64, v238
    s_nop 1
    v_addc_co_u32 v239, vcc, 0, v239, vcc
    s_mov_b64 exec, s[66:67]
    s_cbranch_execz L_pfc2_s
    global_load_dword v238, v[238:239], off
L_pfc2_s:
    s_mov_b64 exec, -1
    v_and_b32 v180, 15, v0
    v_lshrrev_b32 v181, 4, v0
    v_lshrrev_b32 v182, 1, v180
    v_xor_b32 v182, v182, v181
    v_lshlrev_b32 v183, 7, v180
    v_lshl_add_u32 v183, v182, 4, v183
    s_lshl_b32 s27, s29, 13
    v_add_u32 v3, s27, v183
    v_add_u32 v4, 65536, v3
    v_xor_b32 v5, 64, v3
    v_add_u32 v6, 65536, v5
    v_lshrrev_b32 v182, 5, v0
    v_lshlrev_b32 v182, 4, v182
    v_bfe_u32 v183, v0, 2, 3
    v_add_u32 v182, v182, v183
    v_lshlrev_b32 v182, 7, v182
    v_and_b32 v184, 3, v0
    v_lshl_add_u32 v182, v184, 3, v182
    s_lshl_b32 s27, s30, 13
    s_add_u32 s27, s27, 16384
    v_add_u32 v182, s27, v182
    v_bfe_u32 v183, v0, 3, 2
    v_xor_b32 v184, 0, v183
    v_lshl_add_u32 v7, v184, 5, v182
    v_add_u32 v8, 65536, v7
    v_xor_b32 v184, 1, v183
    v_lshl_add_u32 v9, v184, 5, v182
    v_add_u32 v10, 65536, v9
    v_xor_b32 v184, 2, v183
    v_lshl_add_u32 v11, v184, 5, v182
    v_add_u32 v12, 65536, v11
    v_xor_b32 v184, 3, v183
    v_lshl_add_u32 v13, v184, 5, v182
    v_add_u32 v14, 65536, v13
    v_mov_b32 v168, 0x3f803f80
    v_mov_b32 v169, 0x3f803f80
    v_mov_b32 v170, 0x3f803f80
    v_mov_b32 v171, 0x3f803f80
    v_and_b32 v180, 3, v0
    v_cmp_eq_u32 s[52:53], 1, v180
    v_cmp_eq_u32 s[54:55], 2, v180
    v_cmp_eq_u32 s[56:57], 3, v180
    v_bfe_u32 v180, v0, 2, 2
    v_lshrrev_b32 v181, 4, v0
    v_cmp_eq_u32 s[58:59], v180, v181
    s_lshl_b32 s27, s30, 12
    s_sub_u32 s28, 4096, s27
    v_add_u32 v240, s28, v3
    v_add_u32 v3, s27, v3
    v_add_u32 v241, s28, v4
    v_add_u32 v4, s27, v4
    v_add_u32 v242, s28, v5
    v_add_u32 v5, s27, v5
    v_add_u32 v243, s28, v6
    v_add_u32 v6, s27, v6
    s_cmp_eq_u32 s29, 0
    s_cbranch_scc1 L_sequential_preLN__sliding_block__glu_gated_glu__prompt_kernel_nosw
    v_swap_b32 v7, v11
    v_swap_b32 v8, v12
    v_swap_b32 v9, v13
    v_swap_b32 v10, v14
L_sequential_preLN__sliding_block__glu_gated_glu__prompt_kernel_nosw:
    s_cmp_ge_u32 s31, 18
    s_cbranch_scc1 L_sequential_preLN__sliding_block__glu_gated_glu__prompt_kernel_v
    s_cmp_ge_u32 s31, 9
    s_cselect_b32 s38, 9, 0
    s_cselect_b32 s37, 2727936, 0
    s_sub_u32 s38, s31, s38
    s_lshl_b32 s38, s38, 4
    s_lshl_b32 s27, s25, 3
    s_lshl_b32 s28, s29, 2
    s_add_u32 s27, s27, s28
    s_add_u32 s27, s27, 16
    s_mul_i32 s27, s27, 592
    s_add_u32 s37, s37, s27
    v_lshrrev_b32 v220, 4, v0
    v_add_u32 v220, s38, v220
    v_and_b32 v221, 15, v0
    s_lshl_b32 s27, s29, 3
    s_xor_b32 s28, s27, 0
    v_add_u32 v222, s28, v220
    v_mul_u32_u24 v223, 7282, v222
    v_lshrrev_b32 v223, 16, v223
    v_mul_u32_u24 v224, 9, v223
    v_sub_u32 v224, v222, v224
    v_cmp_lt_u32 vcc, 4, v224
    v_cmp_eq_u32 s[40:41], 4, v224
    v_mul_u32_u24 v223, 170496, v223
    v_subrev_u32 v225, 5, v224
    v_cndmask_b32 v224, v224, v225, vcc
    v_add_u32 v225, 85248, v223
    v_cndmask_b32 v226, v223, v225, vcc
    v_lshrrev_b32 v227, 1, v224
    v_lshl_add_u32 v226, v227, 8, v226
    v_and_b32 v227, 1, v224
    v_lshl_add_u32 v226, v227, 3, v226
    v_lshl_add_u32 v226, v221, 4, v226
    v_lshl_add_u32 v223, v221, 2, v223
    v_add_u32 v223, 512, v223
    v_cndmask_b32 v228, v226, v223, s[40:41]
    v_add_u32 v229, 85248, v223
    s_xor_b32 s28, s27, 4
    v_add_u32 v222, s28, v220
    v_mul_u32_u24 v223, 7282, v222
    v_lshrrev_b32 v223, 16, v223
    v_mul_u32_u24 v224, 9, v223
    v_sub_u32 v224, v222, v224
    v_cmp_lt_u32 vcc, 4, v224
    v_cmp_eq_u32 s[42:43], 4, v224
    v_mul_u32_u24 v223, 170496, v223
    v_subrev_u32 v225, 5, v224
    v_cndmask_b32 v224, v224, v225, vcc
    v_add_u32 v225, 85248, v223
    v_cndmask_b32 v226, v223, v225, vcc
    v_lshrrev_b32 v227, 1, v224
    v_lshl_add_u32 v226, v227, 8, v226
    v_and_b32 v227, 1, v224
    v_lshl_add_u32 v226, v227, 3, v226
    v_lshl_add_u32 v226, v221, 4, v226
    v_lshl_add_u32 v223, v221, 2, v223
    v_add_u32 v223, 512, v223
    v_cndmask_b32 v230, v226, v223, s[42:43]
    v_add_u32 v231, 85248, v223
    s_xor_b32 s28, s27, 8
    v_add_u32 v222, s28, v220
    v_mul_u32_u24 v223, 7282, v222
    v_lshrrev_b32 v223, 16, v223
    v_mul_u32_u24 v224, 9, v223
    v_sub_u32 v224, v222, v224
    v_cmp_lt_u32 vcc, 4, v224
    v_cmp_eq_u32 s[44:45], 4, v224
    v_mul_u32_u24 v223, 170496, v223
    v_subrev_u32 v225, 5, v224
    v_cndmask_b32 v224, v224, v225, vcc
    v_add_u32 v225, 85248, v223
    v_cndmask_b32 v226, v223, v225, vcc
    v_lshrrev_b32 v227, 1, v224
    v_lshl_add_u32 v226, v227, 8, v226
    v_and_b32 v227, 1, v224
    v_lshl_add_u32 v226, v227, 3, v226
    v_lshl_add_u32 v226, v221, 4, v226
    v_lshl_add_u32 v223, v221, 2, v223
    v_add_u32 v223, 512, v223
    v_cndmask_b32 v232, v226, v223, s[44:45]
    v_add_u32 v233, 85248, v223
    s_xor_b32 s28, s27, 12
    v_add_u32 v222, s28, v220
    v_mul_u32_u24 v223, 7282, v222
    v_lshrrev_b32 v223, 16, v223
    v_mul_u32_u24 v224, 9, v223
    v_sub_u32 v224, v222, v224
    v_cmp_lt_u32 vcc, 4, v224
    v_cmp_eq_u32 s[46:47], 4, v224
    v_mul_u32_u24 v223, 170496, v223
    v_subrev_u32 v225, 5, v224
    v_cndmask_b32 v224, v224, v225, vcc
    v_add_u32 v225, 85248, v223
    v_cndmask_b32 v226, v223, v225, vcc
    v_lshrrev_b32 v227, 1, v224
    v_lshl_add_u32 v226, v227, 8, v226
    v_and_b32 v227, 1, v224
    v_lshl_add_u32 v226, v227, 3, v226
    v_lshl_add_u32 v226, v221, 4, v226
    v_lshl_add_u32 v223, v221, 2, v223
    v_add_u32 v223, 512, v223
    v_cndmask_b32 v234, v226, v223, s[46:47]
    v_add_u32 v235, 85248, v223
    v_and_b32 v180, 15, v0
    v_lshlrev_b32 v180, 2, v180
    s_lshl_b32 s27, s29, 8
    s_lshl_b32 s28, s30, 7
    s_add_u32 s27, s27, s28
    s_add_u32 s27, s27, 131072
    v_add_u32 v172, s27, v180
    s_lshl_b32 s27, s30, 8
    s_lshl_b32 s28, s29, 7
    s_add_u32 s27, s27, s28
    s_add_u32 s27, s27, 132096
    v_add_u32 v173, s27, v180
    v_and_b32 v180, 15, v0
    v_lshlrev_b32 v180, 2, v180
    s_lshl_b32 s27, s29, 8
    s_lshl_b32 s28, s30, 7
    s_add_u32 s27, s27, 131072
    s_add_u32 s35, s27, s28
    v_add_u32 v174, s35, v180
    s_sub_u32 s28, 128, s28
    s_add_u32 s35, s27, s28
    v_add_u32 v175, s35, v180
    v_lshrrev_b32 v180, 4, v0
    v_lshlrev_b32 v180, 4, v180
    s_lshl_b32 s27, s30, 8
    s_lshl_b32 s28, s29, 7
    s_add_u32 s27, s27, 132096
    s_add_u32 s35, s27, s28
    v_add_u32 v176, s35, v180
    s_sub_u32 s28, 128, s28
    s_add_u32 s35, s27, s28
    v_add_u32 v177, s35, v180
    s_waitcnt vmcnt(8)
    s_barrier
    ds_read_b128 v[80:83], v3 offset:0
    ds_read_b64_tr_b16 v[112:113], v7 offset:0
    ds_read_b64_tr_b16 v[114:115], v7 offset:1024
    ds_read_b128 v[84:87], v3 offset:2048
    ds_read_b64_tr_b16 v[116:117], v9 offset:0
    ds_read_b64_tr_b16 v[118:119], v9 offset:1024
    ds_read_b128 v[88:91], v240 offset:0
    ds_read_b64_tr_b16 v[120:121], v11 offset:0
    ds_read_b64_tr_b16 v[122:123], v11 offset:1024
    ds_read_b128 v[92:95], v240 offset:2048
    ds_read_b64_tr_b16 v[124:125], v13 offset:0
    ds_read_b64_tr_b16 v[126:127], v13 offset:1024
    s_waitcnt lgkmcnt(9)
    v_mfma_f32_16x16x32_bf16 v[16:19], v[112:115], v[80:83], 0
    ds_read_b128 v[96:99], v5 offset:0
    s_waitcnt lgkmcnt(7)
    v_mfma_f32_16x16x32_bf16 v[20:23], v[116:119], v[80:83], 0
    ds_read_b64_tr_b16 v[128:129], v7 offset:4096
    s_lshl_b32 s60, s62, 7
    s_add_u32 s60, s60, s33
    s_mul_i32 s61, s62, 221184
    s_add_u32 s61, s61, s34
    s_add_u32 s62, s62, 1
    s_cmp_eq_u32 s62, 9
    s_cselect_b32 s62, 0, s62
    s_add_u32 m0, s32, 65536
    s_add_u32 s35, s60, 0
    buffer_load_dwordx4 v1, s[12:15], s35 offen lds
    s_waitcnt lgkmcnt(5)
    v_mfma_f32_16x16x32_bf16 v[24:27], v[120:123], v[80:83], 0
    ds_read_b64_tr_b16 v[130:131], v7 offset:5120
    s_waitcnt lgkmcnt(3)
    v_mfma_f32_16x16x32_bf16 v[28:31], v[124:127], v[80:83], 0
    ds_read_b128 v[100:103], v5 offset:2048
    s_add_u32 m0, s32, 81920
    s_add_u32 s35, s61, 0
    buffer_load_dwordx4 v2, s[16:19], s35 offen lds
    v_mfma_f32_16x16x32_bf16 v[32:35], v[112:115], v[84:87], 0
    ds_read_b64_tr_b16 v[132:133], v9 offset:4096
    v_mfma_f32_16x16x32_bf16 v[36:39], v[116:119], v[84:87], 0
    ds_read_b64_tr_b16 v[134:135], v9 offset:5120
    s_add_u32 m0, s32, 69632
    s_add_u32 s35, s60, 36864
    buffer_load_dwordx4 v1, s[12:15], s35 offen lds
    v_mfma_f32_16x16x32_bf16 v[40:43], v[120:123], v[84:87], 0
    ds_read_b128 v[104:107], v242 offset:0
    v_mfma_f32_16x16x32_bf16 v[44:47], v[124:127], v[84:87], 0
    ds_read_b64_tr_b16 v[136:137], v11 offset:4096
    s_add_u32 m0, s32, 86016
    s_add_u32 s35, s61, 110592
    buffer_load_dwordx4 v2, s[16:19], s35 offen lds
    v_mfma_f32_16x16x32_bf16 v[48:51], v[112:115], v[88:91], 0
    ds_read_b64_tr_b16 v[138:139], v11 offset:5120
    v_mfma_f32_16x16x32_bf16 v[52:55], v[116:119], v[88:91], 0
    ds_read_b128 v[108:111], v242 offset:2048
    s_add_u32 m0, s32, 73728
    s_add_u32 s35, s60, 73728
    buffer_load_dwordx4 v1, s[12:15], s35 offen lds
    v_mfma_f32_16x16x32_bf16 v[56:59], v[120:123], v[88:91], 0
    ds_read_b64_tr_b16 v[140:141], v13 offset:4096
    v_mfma_f32_16x16x32_bf16 v[144:147], v[168:171], v[80:83], 0
    v_mfma_f32_16x16x32_bf16 v[60:63], v[124:127], v[88:91], 0
    ds_read_b64_tr_b16 v[142:143], v13 offset:5120
    v_mfma_f32_16x16x32_bf16 v[152:155], v[80:83], v[80:83], 0
    s_add_u32 m0, s32, 90112
    s_add_u32 s35, s61, 128
    buffer_load_dwordx4 v2, s[16:19], s35 offen lds
    v_mfma_f32_16x16x32_bf16 v[64:67], v[112:115], v[92:95], 0
    v_mfma_f32_16x16x32_bf16 v[160:163], v[168:171], v[112:115], 0
    v_mfma_f32_16x16x32_bf16 v[68:71], v[116:119], v[92:95], 0
    v_mfma_f32_16x16x32_bf16 v[148:151], v[168:171], v[84:87], 0
    s_add_u32 m0, s32, 77824
    s_add_u32 s35, s60, 110592
    buffer_load_dwordx4 v1, s[12:15], s35 offen lds
    v_mfma_f32_16x16x32_bf16 v[72:75], v[120:123], v[92:95], 0
    v_mfma_f32_16x16x32_bf16 v[156:159], v[84:87], v[84:87], 0
    v_mfma_f32_16x16x32_bf16 v[76:79], v[124:127], v[92:95], 0
    v_mfma_f32_16x16x32_bf16 v[164:167], v[168:171], v[116:119], 0
    s_add_u32 m0, s32, 94208
    s_add_u32 s35, s61, 110720
    buffer_load_dwordx4 v2, s[16:19], s35 offen lds
    s_waitcnt vmcnt(8)
    s_waitcnt lgkmcnt(0)
    s_barrier
    v_mfma_f32_16x16x32_bf16 v[16:19], v[128:131], v[96:99], v[16:19]
    ds_read_b128 v[80:83], v3 offset:32768
    v_mfma_f32_16x16x32_bf16 v[20:23], v[132:135], v[96:99], v[20:23]
    ds_read_b64_tr_b16 v[112:113], v7 offset:32768
    s_lshl_b32 s60, s62, 7
    s_add_u32 s60, s60, s33
    s_mul_i32 s61, s62, 221184
    s_add_u32 s61, s61, s34
    s_add_u32 s62, s62, 1
    s_cmp_eq_u32 s62, 9
    s_cselect_b32 s62, 0, s62
    s_add_u32 m0, s32, 98304
    s_add_u32 s35, s60, 0
    buffer_load_dwordx4 v1, s[12:15], s35 offen lds
    v_mfma_f32_16x16x32_bf16 v[24:27], v[136:139], v[96:99], v[24:27]
    ds_read_b64_tr_b16 v[114:115], v7 offset:33792
    v_mfma_f32_16x16x32_bf16 v[28:31], v[140:143], v[96:99], v[28:31]
    ds_read_b128 v[84:87], v3 offset:34816
    s_add_u32 m0, s32, 114688
    s_add_u32 s35, s61, 0
    buffer_load_dwordx4 v2, s[16:19], s35 offen lds
    v_mfma_f32_16x16x32_bf16 v[32:35], v[128:131], v[100:103], v[32:35]
    ds_read_b64_tr_b16 v[116:117], v9 offset:32768
    v_mfma_f32_16x16x32_bf16 v[36:39], v[132:135], v[100:103], v[36:39]
    ds_read_b64_tr_b16 v[118:119], v9 offset:33792
    s_add_u32 m0, s32, 102400
    s_add_u32 s35, s60, 36864
    buffer_load_dwordx4 v1, s[12:15], s35 offen lds
    v_mfma_f32_16x16x32_bf16 v[40:43], v[136:139], v[100:103], v[40:43]
    ds_read_b128 v[88:91], v240 offset:32768
    v_mfma_f32_16x16x32_bf16 v[44:47], v[140:143], v[100:103], v[44:47]
    ds_read_b64_tr_b16 v[120:121], v11 offset:32768
    s_add_u32 m0, s32, 118784
    s_add_u32 s35, s61, 110592
    buffer_load_dwordx4 v2, s[16:19], s35 offen lds
    v_mfma_f32_16x16x32_bf16 v[48:51], v[128:131], v[104:107], v[48:51]
    ds_read_b64_tr_b16 v[122:123], v11 offset:33792
    v_mfma_f32_16x16x32_bf16 v[52:55], v[132:135], v[104:107], v[52:55]
    ds_read_b128 v[92:95], v240 offset:34816
    s_add_u32 m0, s32, 106496
    s_add_u32 s35, s60, 73728
    buffer_load_dwordx4 v1, s[12:15], s35 offen lds
    v_mfma_f32_16x16x32_bf16 v[56:59], v[136:139], v[104:107], v[56:59]
    ds_read_b64_tr_b16 v[124:125], v13 offset:32768
    v_mfma_f32_16x16x32_bf16 v[144:147], v[168:171], v[96:99], v[144:147]
    v_mfma_f32_16x16x32_bf16 v[60:63], v[140:143], v[104:107], v[60:63]
    ds_read_b64_tr_b16 v[126:127], v13 offset:33792
    v_mfma_f32_16x16x32_bf16 v[152:155], v[96:99], v[96:99], v[152:155]
    s_add_u32 m0, s32, 122880
    s_add_u32 s35, s61, 128
    buffer_load_dwordx4 v2, s[16:19], s35 offen lds
    v_mfma_f32_16x16x32_bf16 v[64:67], v[128:131], v[108:111], v[64:67]
    v_mfma_f32_16x16x32_bf16 v[160:163], v[168:171], v[128:131], v[160:163]
    v_mfma_f32_16x16x32_bf16 v[68:71], v[132:135], v[108:111], v[68:71]
    v_mfma_f32_16x16x32_bf16 v[148:151], v[168:171], v[100:103], v[148:151]
    s_add_u32 m0, s32, 110592
    s_add_u32 s35, s60, 110592
    buffer_load_dwordx4 v1, s[12:15], s35 offen lds
    v_mfma_f32_16x16x32_bf16 v[72:75], v[136:139], v[108:111], v[72:75]
    v_mfma_f32_16x16x32_bf16 v[156:159], v[100:103], v[100:103], v[156:159]
    v_mfma_f32_16x16x32_bf16 v[76:79], v[140:143], v[108:111], v[76:79]
    v_mfma_f32_16x16x32_bf16 v[164:167], v[168:171], v[132:135], v[164:167]
    s_add_u32 m0, s32, 126976
    s_add_u32 s35, s61, 110720
    buffer_load_dwordx4 v2, s[16:19], s35 offen lds
    s_waitcnt lgkmcnt(9)
    v_mfma_f32_16x16x32_bf16 v[16:19], v[112:115], v[80:83], v[16:19]
    ds_read_b128 v[96:99], v5 offset:32768
    s_waitcnt lgkmcnt(7)
    v_mfma_f32_16x16x32_bf16 v[20:23], v[116:119], v[80:83], v[20:23]
    ds_read_b64_tr_b16 v[128:129], v7 offset:36864
    s_lshl_b32 s60, s62, 7
    s_add_u32 s60, s60, s33
    s_mul_i32 s61, s62, 221184
    s_add_u32 s61, s61, s34
    s_add_u32 s62, s62, 1
    s_cmp_eq_u32 s62, 9
    s_cselect_b32 s62, 0, s62
    s_add_u32 m0, s32, 0
    s_add_u32 s35, s60, 0
    buffer_load_dwordx4 v1, s[12:15], s35 offen lds
    s_waitcnt lgkmcnt(5)
    v_mfma_f32_16x16x32_bf16 v[24:27], v[120:123], v[80:83], v[24:27]
    ds_read_b64_tr_b16 v[130:131], v7 offset:37888
    s_waitcnt lgkmcnt(3)
    v_mfma_f32_16x16x32_bf16 v[28:31], v[124:127], v[80:83], v[28:31]
    ds_read_b128 v[100:103], v5 offset:34816
    s_add_u32 m0, s32, 16384
    s_add_u32 s35, s61, 0
    buffer_load_dwordx4 v2, s[16:19], s35 offen lds
    v_mfma_f32_16x16x32_bf16 v[32:35], v[112:115], v[84:87], v[32:35]
    ds_read_b64_tr_b16 v[132:133], v9 offset:36864
    v_mfma_f32_16x16x32_bf16 v[36:39], v[116:119], v[84:87], v[36:39]
    ds_read_b64_tr_b16 v[134:135], v9 offset:37888
    s_add_u32 m0, s32, 4096
    s_add_u32 s35, s60, 36864
    buffer_load_dwordx4 v1, s[12:15], s35 offen lds
    v_mfma_f32_16x16x32_bf16 v[40:43], v[120:123], v[84:87], v[40:43]
    ds_read_b128 v[104:107], v242 offset:32768
    v_mfma_f32_16x16x32_bf16 v[44:47], v[124:127], v[84:87], v[44:47]
    ds_read_b64_tr_b16 v[136:137], v11 offset:36864
    s_add_u32 m0, s32, 20480
    s_add_u32 s35, s61, 110592
    buffer_load_dwordx4 v2, s[16:19], s35 offen lds
    v_mfma_f32_16x16x32_bf16 v[48:51], v[112:115], v[88:91], v[48:51]
    ds_read_b64_tr_b16 v[138:139], v11 offset:37888
    v_mfma_f32_16x16x32_bf16 v[52:55], v[116:119], v[88:91], v[52:55]
    ds_read_b128 v[108:111], v242 offset:34816
    s_add_u32 m0, s32, 8192
    s_add_u32 s35, s60, 73728
    buffer_load_dwordx4 v1, s[12:15], s35 offen lds
    v_mfma_f32_16x16x32_bf16 v[56:59], v[120:123], v[88:91], v[56:59]
    ds_read_b64_tr_b16 v[140:141], v13 offset:36864
    v_mfma_f32_16x16x32_bf16 v[144:147], v[168:171], v[80:83], v[144:147]
    v_mfma_f32_16x16x32_bf16 v[60:63], v[124:127], v[88:91], v[60:63]
    ds_read_b64_tr_b16 v[142:143], v13 offset:37888
    v_mfma_f32_16x16x32_bf16 v[152:155], v[80:83], v[80:83], v[152:155]
    s_add_u32 m0, s32, 24576
    s_add_u32 s35, s61, 128
    buffer_load_dwordx4 v2, s[16:19], s35 offen lds
    v_mfma_f32_16x16x32_bf16 v[64:67], v[112:115], v[92:95], v[64:67]
    v_mfma_f32_16x16x32_bf16 v[160:163], v[168:171], v[112:115], v[160:163]
    v_mfma_f32_16x16x32_bf16 v[68:71], v[116:119], v[92:95], v[68:71]
    v_mfma_f32_16x16x32_bf16 v[148:151], v[168:171], v[84:87], v[148:151]
    s_add_u32 m0, s32, 12288
    s_add_u32 s35, s60, 110592
    buffer_load_dwordx4 v1, s[12:15], s35 offen lds
    v_mfma_f32_16x16x32_bf16 v[72:75], v[120:123], v[92:95], v[72:75]
    v_mfma_f32_16x16x32_bf16 v[156:159], v[84:87], v[84:87], v[156:159]
    v_mfma_f32_16x16x32_bf16 v[76:79], v[124:127], v[92:95], v[76:79]
    v_mfma_f32_16x16x32_bf16 v[164:167], v[168:171], v[116:119], v[164:167]
    s_add_u32 m0, s32, 28672
    s_add_u32 s35, s61, 110720
    buffer_load_dwordx4 v2, s[16:19], s35 offen lds
    s_waitcnt vmcnt(16)
    s_waitcnt lgkmcnt(0)
    s_barrier
    v_mfma_f32_16x16x32_bf16 v[16:19], v[128:131], v[96:99], v[16:19]
    ds_read_b128 v[80:83], v4 offset:0
    v_mfma_f32_16x16x32_bf16 v[20:23], v[132:135], v[96:99], v[20:23]
    ds_read_b64_tr_b16 v[112:113], v8 offset:0
    s_lshl_b32 s60, s62, 7
    s_add_u32 s60, s60, s33
    s_mul_i32 s61, s62, 221184
    s_add_u32 s61, s61, s34
    s_add_u32 s62, s62, 1
    s_cmp_eq_u32 s62, 9
    s_cselect_b32 s62, 0, s62
    s_add_u32 m0, s32, 32768
    s_add_u32 s35, s60, 0
    buffer_load_dwordx4 v1, s[12:15], s35 offen lds
    v_mfma_f32_16x16x32_bf16 v[24:27], v[136:139], v[96:99], v[24:27]
    ds_read_b64_tr_b16 v[114:115], v8 offset:1024
    v_mfma_f32_16x16x32_bf16 v[28:31], v[140:143], v[96:99], v[28:31]
    ds_read_b128 v[84:87], v4 offset:2048
    s_add_u32 m0, s32, 49152
    s_add_u32 s35, s61, 0
    buffer_load_dwordx4 v2, s[16:19], s35 offen lds
    v_mfma_f32_16x16x32_bf16 v[32:35], v[128:131], v[100:103], v[32:35]
    ds_read_b64_tr_b16 v[116:117], v10 offset:0
    v_mfma_f32_16x16x32_bf16 v[36:39], v[132:135], v[100:103], v[36:39]
    ds_read_b64_tr_b16 v[118:119], v10 offset:1024
    s_add_u32 m0, s32, 36864
    s_add_u32 s35, s60, 36864
    buffer_load_dwordx4 v1, s[12:15], s35 offen lds
    v_mfma_f32_16x16x32_bf16 v[40:43], v[136:139], v[100:103], v[40:43]
    ds_read_b128 v[88:91], v241 offset:0
    v_mfma_f32_16x16x32_bf16 v[44:47], v[140:143], v[100:103], v[44:47]
    ds_read_b64_tr_b16 v[120:121], v12 offset:0
    s_add_u32 m0, s32, 53248
    s_add_u32 s35, s61, 110592
    buffer_load_dwordx4 v2, s[16:19], s35 offen lds
    v_mfma_f32_16x16x32_bf16 v[48:51], v[128:131], v[104:107], v[48:51]
    ds_read_b64_tr_b16 v[122:123], v12 offset:1024
    v_mfma_f32_16x16x32_bf16 v[52:55], v[132:135], v[104:107], v[52:55]
    ds_read_b128 v[92:95], v241 offset:2048
    s_add_u32 m0, s32, 40960
    s_add_u32 s35, s60, 73728
    buffer_load_dwordx4 v1, s[12:15], s35 offen lds
    v_mfma_f32_16x16x32_bf16 v[56:59], v[136:139], v[104:107], v[56:59]
    ds_read_b64_tr_b16 v[124:125], v14 offset:0
    v_mfma_f32_16x16x32_bf16 v[144:147], v[168:171], v[96:99], v[144:147]
    v_mfma_f32_16x16x32_bf16 v[60:63], v[140:143], v[104:107], v[60:63]
    ds_read_b64_tr_b16 v[126:127], v14 offset:1024
    v_mfma_f32_16x16x32_bf16 v[152:155], v[96:99], v[96:99], v[152:155]
    s_add_u32 m0, s32, 57344
    s_add_u32 s35, s61, 128
    buffer_load_dwordx4 v2, s[16:19], s35 offen lds
    v_mfma_f32_16x16x32_bf16 v[64:67], v[128:131], v[108:111], v[64:67]
    v_mfma_f32_16x16x32_bf16 v[160:163], v[168:171], v[128:131], v[160:163]
    v_mfma_f32_16x16x32_bf16 v[68:71], v[132:135], v[108:111], v[68:71]
    v_mfma_f32_16x16x32_bf16 v[148:151], v[168:171], v[100:103], v[148:151]
    s_add_u32 m0, s32, 45056
    s_add_u32 s35, s60, 110592
    buffer_load_dwordx4 v1, s[12:15], s35 offen lds
    v_mfma_f32_16x16x32_bf16 v[72:75], v[136:139], v[108:111], v[72:75]
    v_mfma_f32_16x16x32_bf16 v[156:159], v[100:103], v[100:103], v[156:159]
    v_mfma_f32_16x16x32_bf16 v[76:79], v[140:143], v[108:111], v[76:79]
    v_mfma_f32_16x16x32_bf16 v[164:167], v[168:171], v[132:135], v[164:167]
    s_add_u32 m0, s32, 61440
    s_add_u32 s35, s61, 110720
    buffer_load_dwordx4 v2, s[16:19], s35 offen lds
    s_waitcnt lgkmcnt(9)
    v_mfma_f32_16x16x32_bf16 v[16:19], v[112:115], v[80:83], v[16:19]
    ds_read_b128 v[96:99], v6 offset:0
    s_waitcnt lgkmcnt(7)
    v_mfma_f32_16x16x32_bf16 v[20:23], v[116:119], v[80:83], v[20:23]
    ds_read_b64_tr_b16 v[128:129], v8 offset:4096
    s_waitcnt lgkmcnt(5)
    v_mfma_f32_16x16x32_bf16 v[24:27], v[120:123], v[80:83], v[24:27]
    ds_read_b64_tr_b16 v[130:131], v8 offset:5120
    s_waitcnt lgkmcnt(3)
    v_mfma_f32_16x16x32_bf16 v[28:31], v[124:127], v[80:83], v[28:31]
    ds_read_b128 v[100:103], v6 offset:2048
    v_mfma_f32_16x16x32_bf16 v[32:35], v[112:115], v[84:87], v[32:35]
    ds_read_b64_tr_b16 v[132:133], v10 offset:4096
    v_mfma_f32_16x16x32_bf16 v[36:39], v[116:119], v[84:87], v[36:39]
    ds_read_b64_tr_b16 v[134:135], v10 offset:5120
    v_mfma_f32_16x16x32_bf16 v[40:43], v[120:123], v[84:87], v[40:43]
    ds_read_b128 v[104:107], v243 offset:0
    v_mfma_f32_16x16x32_bf16 v[44:47], v[124:127], v[84:87], v[44:47]
    ds_read_b64_tr_b16 v[136:137], v12 offset:4096
    v_mfma_f32_16x16x32_bf16 v[48:51], v[112:115], v[88:91], v[48:51]
    ds_read_b64_tr_b16 v[138:139], v12 offset:5120
    v_mfma_f32_16x16x32_bf16 v[52:55], v[116:119], v[88:91], v[52:55]
    ds_read_b128 v[108:111], v243 offset:2048
    v_mfma_f32_16x16x32_bf16 v[56:59], v[120:123], v[88:91], v[56:59]
    ds_read_b64_tr_b16 v[140:141], v14 offset:4096
    v_mfma_f32_16x16x32_bf16 v[144:147], v[168:171], v[80:83], v[144:147]
    v_mfma_f32_16x16x32_bf16 v[60:63], v[124:127], v[88:91], v[60:63]
    ds_read_b64_tr_b16 v[142:143], v14 offset:5120
    v_mfma_f32_16x16x32_bf16 v[152:155], v[80:83], v[80:83], v[152:155]
    v_mfma_f32_16x16x32_bf16 v[64:67], v[112:115], v[92:95], v[64:67]
    v_mfma_f32_16x16x32_bf16 v[160:163], v[168:171], v[112:115], v[160:163]
    v_mfma_f32_16x16x32_bf16 v[68:71], v[116:119], v[92:95], v[68:71]
    v_mfma_f32_16x16x32_bf16 v[148:151], v[168:171], v[84:87], v[148:151]
    v_mfma_f32_16x16x32_bf16 v[72:75], v[120:123], v[92:95], v[72:75]
    v_mfma_f32_16x16x32_bf16 v[156:159], v[84:87], v[84:87], v[156:159]
    v_mfma_f32_16x16x32_bf16 v[76:79], v[124:127], v[92:95], v[76:79]
    v_mfma_f32_16x16x32_bf16 v[164:167], v[168:171], v[116:119], v[164:167]
    s_waitcnt vmcnt(16)
    s_waitcnt lgkmcnt(0)
    s_barrier
    v_mfma_f32_16x16x32_bf16 v[16:19], v[128:131], v[96:99], v[16:19]
    ds_read_b128 v[80:83], v4 offset:32768
    v_mfma_f32_16x16x32_bf16 v[20:23], v[132:135], v[96:99], v[20:23]
    ds_read_b64_tr_b16 v[112:113], v8 offset:32768
    s_lshl_b32 s60, s62, 7
    s_add_u32 s60, s60, s33
    s_mul_i32 s61, s62, 221184
    s_add_u32 s61, s61, s34
    s_add_u32 s62, s62, 1
    s_cmp_eq_u32 s62, 9
    s_cselect_b32 s62, 0, s62
    s_add_u32 m0, s32, 65536
    s_add_u32 s35, s60, 0
    buffer_load_dwordx4 v1, s[12:15], s35 offen lds
    v_mfma_f32_16x16x32_bf16 v[24:27], v[136:139], v[96:99], v[24:27]
    ds_read_b64_tr_b16 v[114:115], v8 offset:33792
    v_mfma_f32_16x16x32_bf16 v[28:31], v[140:143], v[96:99], v[28:31]
    ds_read_b128 v[84:87], v4 offset:34816
    s_add_u32 m0, s32, 81920
    s_add_u32 s35, s61, 0
    buffer_load_dwordx4 v2, s[16:19], s35 offen lds
    v_mfma_f32_16x16x32_bf16 v[32:35], v[128:131], v[100:103], v[32:35]
    ds_read_b64_tr_b16 v[116:117], v10 offset:32768
    v_mfma_f32_16x16x32_bf16 v[36:39], v[132:135], v[100:103], v[36:39]
    ds_read_b64_tr_b16 v[118:119], v10 offset:33792
    s_add_u32 m0, s32, 69632
    s_add_u32 s35, s60, 36864
    buffer_load_dwordx4 v1, s[12:15], s35 offen lds
    v_mfma_f32_16x16x32_bf16 v[40:43], v[136:139], v[100:103], v[40:43]
    ds_read_b128 v[88:91], v241 offset:32768
    v_mfma_f32_16x16x32_bf16 v[44:47], v[140:143], v[100:103], v[44:47]
    ds_read_b64_tr_b16 v[120:121], v12 offset:32768
    s_add_u32 m0, s32, 86016
    s_add_u32 s35, s61, 110592
    buffer_load_dwordx4 v2, s[16:19], s35 offen lds
    v_mfma_f32_16x16x32_bf16 v[48:51], v[128:131], v[104:107], v[48:51]
    ds_read_b64_tr_b16 v[122:123], v12 offset:33792
    v_mfma_f32_16x16x32_bf16 v[52:55], v[132:135], v[104:107], v[52:55]
    ds_read_b128 v[92:95], v241 offset:34816
    s_add_u32 m0, s32, 73728
    s_add_u32 s35, s60, 73728
    buffer_load_dwordx4 v1, s[12:15], s35 offen lds
    v_mfma_f32_16x16x32_bf16 v[56:59], v[136:139], v[104:107], v[56:59]
    ds_read_b64_tr_b16 v[124:125], v14 offset:32768
    v_mfma_f32_16x16x32_bf16 v[144:147], v[168:171], v[96:99], v[144:147]
    v_mfma_f32_16x16x32_bf16 v[60:63], v[140:143], v[104:107], v[60:63]
    ds_read_b64_tr_b16 v[126:127], v14 offset:33792
    v_mfma_f32_16x16x32_bf16 v[152:155], v[96:99], v[96:99], v[152:155]
    s_add_u32 m0, s32, 90112
    s_add_u32 s35, s61, 128
    buffer_load_dwordx4 v2, s[16:19], s35 offen lds
    v_mfma_f32_16x16x32_bf16 v[64:67], v[128:131], v[108:111], v[64:67]
    v_mfma_f32_16x16x32_bf16 v[160:163], v[168:171], v[128:131], v[160:163]
    v_mfma_f32_16x16x32_bf16 v[68:71], v[132:135], v[108:111], v[68:71]
    v_mfma_f32_16x16x32_bf16 v[148:151], v[168:171], v[100:103], v[148:151]
    s_add_u32 m0, s32, 77824
    s_add_u32 s35, s60, 110592
    buffer_load_dwordx4 v1, s[12:15], s35 offen lds
    v_mfma_f32_16x16x32_bf16 v[72:75], v[136:139], v[108:111], v[72:75]
    v_mfma_f32_16x16x32_bf16 v[156:159], v[100:103], v[100:103], v[156:159]
    v_mfma_f32_16x16x32_bf16 v[76:79], v[140:143], v[108:111], v[76:79]
    v_mfma_f32_16x16x32_bf16 v[164:167], v[168:171], v[132:135], v[164:167]
    s_add_u32 m0, s32, 94208
    s_add_u32 s35, s61, 110720
    buffer_load_dwordx4 v2, s[16:19], s35 offen lds
    s_waitcnt lgkmcnt(9)
    v_mfma_f32_16x16x32_bf16 v[16:19], v[112:115], v[80:83], v[16:19]
    ds_read_b128 v[96:99], v6 offset:32768
    s_waitcnt lgkmcnt(7)
    v_mfma_f32_16x16x32_bf16 v[20:23], v[116:119], v[80:83], v[20:23]
    ds_read_b64_tr_b16 v[128:129], v8 offset:36864
    s_waitcnt lgkmcnt(5)
    v_mfma_f32_16x16x32_bf16 v[24:27], v[120:123], v[80:83], v[24:27]
    ds_read_b64_tr_b16 v[130:131], v8 offset:37888
    s_waitcnt lgkmcnt(3)
    v_mfma_f32_16x16x32_bf16 v[28:31], v[124:127], v[80:83], v[28:31]
    ds_read_b128 v[100:103], v6 offset:34816
    v_mfma_f32_16x16x32_bf16 v[32:35], v[112:115], v[84:87], v[32:35]
    ds_read_b64_tr_b16 v[132:133], v10 offset:36864
    v_mfma_f32_16x16x32_bf16 v[36:39], v[116:119], v[84:87], v[36:39]
    ds_read_b64_tr_b16 v[134:135], v10 offset:37888
    v_mfma_f32_16x16x32_bf16 v[40:43], v[120:123], v[84:87], v[40:43]
    ds_read_b128 v[104:107], v243 offset:32768
    v_mfma_f32_16x16x32_bf16 v[44:47], v[124:127], v[84:87], v[44:47]
    ds_read_b64_tr_b16 v[136:137], v12 offset:36864
    v_mfma_f32_16x16x32_bf16 v[48:51], v[112:115], v[88:91], v[48:51]
    ds_read_b64_tr_b16 v[138:139], v12 offset:37888
    v_mfma_f32_16x16x32_bf16 v[52:55], v[116:119], v[88:91], v[52:55]
    ds_read_b128 v[108:111], v243 offset:34816
    v_mfma_f32_16x16x32_bf16 v[56:59], v[120:123], v[88:91], v[56:59]
    ds_read_b64_tr_b16 v[140:141], v14 offset:36864
    v_mfma_f32_16x16x32_bf16 v[144:147], v[168:171], v[80:83], v[144:147]
    v_mfma_f32_16x16x32_bf16 v[60:63], v[124:127], v[88:91], v[60:63]
    ds_read_b64_tr_b16 v[142:143], v14 offset:37888
    v_mfma_f32_16x16x32_bf16 v[152:155], v[80:83], v[80:83], v[152:155]
    v_mfma_f32_16x16x32_bf16 v[64:67], v[112:115], v[92:95], v[64:67]
    v_mfma_f32_16x16x32_bf16 v[160:163], v[168:171], v[112:115], v[160:163]
    v_mfma_f32_16x16x32_bf16 v[68:71], v[116:119], v[92:95], v[68:71]
    v_mfma_f32_16x16x32_bf16 v[148:151], v[168:171], v[84:87], v[148:151]
    v_mfma_f32_16x16x32_bf16 v[72:75], v[120:123], v[92:95], v[72:75]
    v_mfma_f32_16x16x32_bf16 v[156:159], v[84:87], v[84:87], v[156:159]
    v_mfma_f32_16x16x32_bf16 v[76:79], v[124:127], v[92:95], v[76:79]
    v_mfma_f32_16x16x32_bf16 v[164:167], v[168:171], v[116:119], v[164:167]
    s_waitcnt vmcnt(16)
    s_waitcnt lgkmcnt(0)
    s_barrier
    v_mfma_f32_16x16x32_bf16 v[16:19], v[128:131], v[96:99], v[16:19]
    ds_read_b128 v[80:83], v3 offset:0
    v_mfma_f32_16x16x32_bf16 v[20:23], v[132:135], v[96:99], v[20:23]
    ds_read_b64_tr_b16 v[112:113], v7 offset:0
    s_lshl_b32 s60, s62, 7
    s_add_u32 s60, s60, s33
    s_mul_i32 s61, s62, 221184
    s_add_u32 s61, s61, s34
    s_add_u32 s62, s62, 1
    s_cmp_eq_u32 s62, 9
    s_cselect_b32 s62, 0, s62
    s_add_u32 m0, s32, 98304
    s_add_u32 s35, s60, 0
    buffer_load_dwordx4 v1, s[12:15], s35 offen lds
    v_mfma_f32_16x16x32_bf16 v[24:27], v[136:139], v[96:99], v[24:27]
    ds_read_b64_tr_b16 v[114:115], v7 offset:1024
    v_mfma_f32_16x16x32_bf16 v[28:31], v[140:143], v[96:99], v[28:31]
    ds_read_b128 v[84:87], v3 offset:2048
    s_add_u32 m0, s32, 114688
    s_add_u32 s35, s61, 0
    buffer_load_dwordx4 v2, s[16:19], s35 offen lds
    v_mfma_f32_16x16x32_bf16 v[32:35], v[128:131], v[100:103], v[32:35]
    ds_read_b64_tr_b16 v[116:117], v9 offset:0
    v_mfma_f32_16x16x32_bf16 v[36:39], v[132:135], v[100:103], v[36:39]
    ds_read_b64_tr_b16 v[118:119], v9 offset:1024
    s_add_u32 m0, s32, 102400
    s_add_u32 s35, s60, 36864
    buffer_load_dwordx4 v1, s[12:15], s35 offen lds
    v_mfma_f32_16x16x32_bf16 v[40:43], v[136:139], v[100:103], v[40:43]
    ds_read_b128 v[88:91], v240 offset:0
    v_mfma_f32_16x16x32_bf16 v[44:47], v[140:143], v[100:103], v[44:47]
    ds_read_b64_tr_b16 v[120:121], v11 offset:0
    s_add_u32 m0, s32, 118784
    s_add_u32 s35, s61, 110592
    buffer_load_dwordx4 v2, s[16:19], s35 offen lds
    v_mfma_f32_16x16x32_bf16 v[48:51], v[128:131], v[104:107], v[48:51]
    ds_read_b64_tr_b16 v[122:123], v11 offset:1024
    v_mfma_f32_16x16x32_bf16 v[52:55], v[132:135], v[104:107], v[52:55]
    ds_read_b128 v[92:95], v240 offset:2048
    s_add_u32 m0, s32, 106496
    s_add_u32 s35, s60, 73728
    buffer_load_dwordx4 v1, s[12:15], s35 offen lds
    v_mfma_f32_16x16x32_bf16 v[56:59], v[136:139], v[104:107], v[56:59]
    ds_read_b64_tr_b16 v[124:125], v13 offset:0
    v_mfma_f32_16x16x32_bf16 v[144:147], v[168:171], v[96:99], v[144:147]
    v_mfma_f32_16x16x32_bf16 v[60:63], v[140:143], v[104:107], v[60:63]
    ds_read_b64_tr_b16 v[126:127], v13 offset:1024
    v_mfma_f32_16x16x32_bf16 v[152:155], v[96:99], v[96:99], v[152:155]
    s_add_u32 m0, s32, 122880
    s_add_u32 s35, s61, 128
    buffer_load_dwordx4 v2, s[16:19], s35 offen lds
    v_mfma_f32_16x16x32_bf16 v[64:67], v[128:131], v[108:111], v[64:67]
    v_mfma_f32_16x16x32_bf16 v[160:163], v[168:171], v[128:131], v[160:163]
    v_mfma_f32_16x16x32_bf16 v[68:71], v[132:135], v[108:111], v[68:71]
    v_mfma_f32_16x16x32_bf16 v[148:151], v[168:171], v[100:103], v[148:151]
    s_add_u32 m0, s32, 110592
    s_add_u32 s35, s60, 110592
    buffer_load_dwordx4 v1, s[12:15], s35 offen lds
    v_mfma_f32_16x16x32_bf16 v[72:75], v[136:139], v[108:111], v[72:75]
    v_mfma_f32_16x16x32_bf16 v[156:159], v[100:103], v[100:103], v[156:159]
    v_mfma_f32_16x16x32_bf16 v[76:79], v[140:143], v[108:111], v[76:79]
    v_mfma_f32_16x16x32_bf16 v[164:167], v[168:171], v[132:135], v[164:167]
    s_add_u32 m0, s32, 126976
    s_add_u32 s35, s61, 110720
    buffer_load_dwordx4 v2, s[16:19], s35 offen lds
    s_waitcnt lgkmcnt(9)
    v_mfma_f32_16x16x32_bf16 v[16:19], v[112:115], v[80:83], v[16:19]
    ds_read_b128 v[96:99], v5 offset:0
    s_waitcnt lgkmcnt(7)
    v_mfma_f32_16x16x32_bf16 v[20:23], v[116:119], v[80:83], v[20:23]
    ds_read_b64_tr_b16 v[128:129], v7 offset:4096
    s_waitcnt lgkmcnt(5)
    v_mfma_f32_16x16x32_bf16 v[24:27], v[120:123], v[80:83], v[24:27]
    ds_read_b64_tr_b16 v[130:131], v7 offset:5120
    s_waitcnt lgkmcnt(3)
    v_mfma_f32_16x16x32_bf16 v[28:31], v[124:127], v[80:83], v[28:31]
    ds_read_b128 v[100:103], v5 offset:2048
    v_mfma_f32_16x16x32_bf16 v[32:35], v[112:115], v[84:87], v[32:35]
    ds_read_b64_tr_b16 v[132:133], v9 offset:4096
    v_mfma_f32_16x16x32_bf16 v[36:39], v[116:119], v[84:87], v[36:39]
    ds_read_b64_tr_b16 v[134:135], v9 offset:5120
    v_mfma_f32_16x16x32_bf16 v[40:43], v[120:123], v[84:87], v[40:43]
    ds_read_b128 v[104:107], v242 offset:0
    v_mfma_f32_16x16x32_bf16 v[44:47], v[124:127], v[84:87], v[44:47]
    ds_read_b64_tr_b16 v[136:137], v11 offset:4096
    v_mfma_f32_16x16x32_bf16 v[48:51], v[112:115], v[88:91], v[48:51]
    ds_read_b64_tr_b16 v[138:139], v11 offset:5120
    v_mfma_f32_16x16x32_bf16 v[52:55], v[116:119], v[88:91], v[52:55]
    ds_read_b128 v[108:111], v242 offset:2048
    v_mfma_f32_16x16x32_bf16 v[56:59], v[120:123], v[88:91], v[56:59]
    ds_read_b64_tr_b16 v[140:141], v13 offset:4096
    v_mfma_f32_16x16x32_bf16 v[144:147], v[168:171], v[80:83], v[144:147]
    v_mfma_f32_16x16x32_bf16 v[60:63], v[124:127], v[88:91], v[60:63]
    ds_read_b64_tr_b16 v[142:143], v13 offset:5120
    v_mfma_f32_16x16x32_bf16 v[152:155], v[80:83], v[80:83], v[152:155]
    v_mfma_f32_16x16x32_bf16 v[64:67], v[112:115], v[92:95], v[64:67]
    v_mfma_f32_16x16x32_bf16 v[160:163], v[168:171], v[112:115], v[160:163]
    v_mfma_f32_16x16x32_bf16 v[68:71], v[116:119], v[92:95], v[68:71]
    v_mfma_f32_16x16x32_bf16 v[148:151], v[168:171], v[84:87], v[148:151]
    v_mfma_f32_16x16x32_bf16 v[72:75], v[120:123], v[92:95], v[72:75]
    v_mfma_f32_16x16x32_bf16 v[156:159], v[84:87], v[84:87], v[156:159]
    v_mfma_f32_16x16x32_bf16 v[76:79], v[124:127], v[92:95], v[76:79]
    v_mfma_f32_16x16x32_bf16 v[164:167], v[168:171], v[116:119], v[164:167]
    s_waitcnt vmcnt(16)
    s_waitcnt lgkmcnt(0)
    s_barrier
    v_mfma_f32_16x16x32_bf16 v[16:19], v[128:131], v[96:99], v[16:19]
    ds_read_b128 v[80:83], v3 offset:32768
    v_mfma_f32_16x16x32_bf16 v[20:23], v[132:135], v[96:99], v[20:23]
    ds_read_b64_tr_b16 v[112:113], v7 offset:32768
    s_lshl_b32 s60, s62, 7
    s_add_u32 s60, s60, s33
    s_mul_i32 s61, s62, 221184
    s_add_u32 s61, s61, s34
    s_add_u32 s62, s62, 1
    s_cmp_eq_u32 s62, 9
    s_cselect_b32 s62, 0, s62
    s_add_u32 m0, s32, 0
    s_add_u32 s35, s60, 0
    buffer_load_dwordx4 v1, s[12:15], s35 offen lds
    v_mfma_f32_16x16x32_bf16 v[24:27], v[136:139], v[96:99], v[24:27]
    ds_read_b64_tr_b16 v[114:115], v7 offset:33792
    v_mfma_f32_16x16x32_bf16 v[28:31], v[140:143], v[96:99], v[28:31]
    ds_read_b128 v[84:87], v3 offset:34816
    s_add_u32 m0, s32, 16384
    s_add_u32 s35, s61, 0
    buffer_load_dwordx4 v2, s[16:19], s35 offen lds
    v_mfma_f32_16x16x32_bf16 v[32:35], v[128:131], v[100:103], v[32:35]
    ds_read_b64_tr_b16 v[116:117], v9 offset:32768
    v_mfma_f32_16x16x32_bf16 v[36:39], v[132:135], v[100:103], v[36:39]
    ds_read_b64_tr_b16 v[118:119], v9 offset:33792
    s_add_u32 m0, s32, 4096
    s_add_u32 s35, s60, 36864
    buffer_load_dwordx4 v1, s[12:15], s35 offen lds
    v_mfma_f32_16x16x32_bf16 v[40:43], v[136:139], v[100:103], v[40:43]
    ds_read_b128 v[88:91], v240 offset:32768
    v_mfma_f32_16x16x32_bf16 v[44:47], v[140:143], v[100:103], v[44:47]
    ds_read_b64_tr_b16 v[120:121], v11 offset:32768
    s_add_u32 m0, s32, 20480
    s_add_u32 s35, s61, 110592
    buffer_load_dwordx4 v2, s[16:19], s35 offen lds
    v_mfma_f32_16x16x32_bf16 v[48:51], v[128:131], v[104:107], v[48:51]
    ds_read_b64_tr_b16 v[122:123], v11 offset:33792
    v_mfma_f32_16x16x32_bf16 v[52:55], v[132:135], v[104:107], v[52:55]
    ds_read_b128 v[92:95], v240 offset:34816
    s_add_u32 m0, s32, 8192
    s_add_u32 s35, s60, 73728
    buffer_load_dwordx4 v1, s[12:15], s35 offen lds
    v_mfma_f32_16x16x32_bf16 v[56:59], v[136:139], v[104:107], v[56:59]
    ds_read_b64_tr_b16 v[124:125], v13 offset:32768
    v_mfma_f32_16x16x32_bf16 v[144:147], v[168:171], v[96:99], v[144:147]
    v_mfma_f32_16x16x32_bf16 v[60:63], v[140:143], v[104:107], v[60:63]
    ds_read_b64_tr_b16 v[126:127], v13 offset:33792
    v_mfma_f32_16x16x32_bf16 v[152:155], v[96:99], v[96:99], v[152:155]
    s_add_u32 m0, s32, 24576
    s_add_u32 s35, s61, 128
    buffer_load_dwordx4 v2, s[16:19], s35 offen lds
    v_mfma_f32_16x16x32_bf16 v[64:67], v[128:131], v[108:111], v[64:67]
    v_mfma_f32_16x16x32_bf16 v[160:163], v[168:171], v[128:131], v[160:163]
    v_mfma_f32_16x16x32_bf16 v[68:71], v[132:135], v[108:111], v[68:71]
    v_mfma_f32_16x16x32_bf16 v[148:151], v[168:171], v[100:103], v[148:151]
    s_add_u32 m0, s32, 12288
    s_add_u32 s35, s60, 110592
    buffer_load_dwordx4 v1, s[12:15], s35 offen lds
    v_mfma_f32_16x16x32_bf16 v[72:75], v[136:139], v[108:111], v[72:75]
    v_mfma_f32_16x16x32_bf16 v[156:159], v[100:103], v[100:103], v[156:159]
    v_mfma_f32_16x16x32_bf16 v[76:79], v[140:143], v[108:111], v[76:79]
    v_mfma_f32_16x16x32_bf16 v[164:167], v[168:171], v[132:135], v[164:167]
    s_add_u32 m0, s32, 28672
    s_add_u32 s35, s61, 110720
    buffer_load_dwordx4 v2, s[16:19], s35 offen lds
    s_waitcnt lgkmcnt(9)
    v_mfma_f32_16x16x32_bf16 v[16:19], v[112:115], v[80:83], v[16:19]
    ds_read_b128 v[96:99], v5 offset:32768
    s_waitcnt lgkmcnt(7)
    v_mfma_f32_16x16x32_bf16 v[20:23], v[116:119], v[80:83], v[20:23]
    ds_read_b64_tr_b16 v[128:129], v7 offset:36864
    s_waitcnt lgkmcnt(5)
    v_mfma_f32_16x16x32_bf16 v[24:27], v[120:123], v[80:83], v[24:27]
    ds_read_b64_tr_b16 v[130:131], v7 offset:37888
    s_waitcnt lgkmcnt(3)
    v_mfma_f32_16x16x32_bf16 v[28:31], v[124:127], v[80:83], v[28:31]
    ds_read_b128 v[100:103], v5 offset:34816
    v_mfma_f32_16x16x32_bf16 v[32:35], v[112:115], v[84:87], v[32:35]
    ds_read_b64_tr_b16 v[132:133], v9 offset:36864
    v_mfma_f32_16x16x32_bf16 v[36:39], v[116:119], v[84:87], v[36:39]
    ds_read_b64_tr_b16 v[134:135], v9 offset:37888
    v_mfma_f32_16x16x32_bf16 v[40:43], v[120:123], v[84:87], v[40:43]
    ds_read_b128 v[104:107], v242 offset:32768
    v_mfma_f32_16x16x32_bf16 v[44:47], v[124:127], v[84:87], v[44:47]
    ds_read_b64_tr_b16 v[136:137], v11 offset:36864
    v_mfma_f32_16x16x32_bf16 v[48:51], v[112:115], v[88:91], v[48:51]
    ds_read_b64_tr_b16 v[138:139], v11 offset:37888
    v_mfma_f32_16x16x32_bf16 v[52:55], v[116:119], v[88:91], v[52:55]
    ds_read_b128 v[108:111], v242 offset:34816
    v_mfma_f32_16x16x32_bf16 v[56:59], v[120:123], v[88:91], v[56:59]
    ds_read_b64_tr_b16 v[140:141], v13 offset:36864
    v_mfma_f32_16x16x32_bf16 v[144:147], v[168:171], v[80:83], v[144:147]
    v_mfma_f32_16x16x32_bf16 v[60:63], v[124:127], v[88:91], v[60:63]
    ds_read_b64_tr_b16 v[142:143], v13 offset:37888
    v_mfma_f32_16x16x32_bf16 v[152:155], v[80:83], v[80:83], v[152:155]
    v_mfma_f32_16x16x32_bf16 v[64:67], v[112:115], v[92:95], v[64:67]
    v_mfma_f32_16x16x32_bf16 v[160:163], v[168:171], v[112:115], v[160:163]
    v_mfma_f32_16x16x32_bf16 v[68:71], v[116:119], v[92:95], v[68:71]
    v_mfma_f32_16x16x32_bf16 v[148:151], v[168:171], v[84:87], v[148:151]
    v_mfma_f32_16x16x32_bf16 v[72:75], v[120:123], v[92:95], v[72:75]
    v_mfma_f32_16x16x32_bf16 v[156:159], v[84:87], v[84:87], v[156:159]
    v_mfma_f32_16x16x32_bf16 v[76:79], v[124:127], v[92:95], v[76:79]
    v_mfma_f32_16x16x32_bf16 v[164:167], v[168:171], v[116:119], v[164:167]
    s_waitcnt vmcnt(16)
    s_waitcnt lgkmcnt(0)
    s_barrier
    v_mfma_f32_16x16x32_bf16 v[16:19], v[128:131], v[96:99], v[16:19]
    ds_read_b128 v[80:83], v4 offset:0
    v_mfma_f32_16x16x32_bf16 v[20:23], v[132:135], v[96:99], v[20:23]
    ds_read_b64_tr_b16 v[112:113], v8 offset:0
    v_mfma_f32_16x16x32_bf16 v[24:27], v[136:139], v[96:99], v[24:27]
    ds_read_b64_tr_b16 v[114:115], v8 offset:1024
    v_mfma_f32_16x16x32_bf16 v[28:31], v[140:143], v[96:99], v[28:31]
    ds_read_b128 v[84:87], v4 offset:2048
    v_mfma_f32_16x16x32_bf16 v[32:35], v[128:131], v[100:103], v[32:35]
    ds_read_b64_tr_b16 v[116:117], v10 offset:0
    v_mfma_f32_16x16x32_bf16 v[36:39], v[132:135], v[100:103], v[36:39]
    ds_read_b64_tr_b16 v[118:119], v10 offset:1024
    v_mfma_f32_16x16x32_bf16 v[40:43], v[136:139], v[100:103], v[40:43]
    ds_read_b128 v[88:91], v241 offset:0
    v_mfma_f32_16x16x32_bf16 v[44:47], v[140:143], v[100:103], v[44:47]
    ds_read_b64_tr_b16 v[120:121], v12 offset:0
    v_mfma_f32_16x16x32_bf16 v[48:51], v[128:131], v[104:107], v[48:51]
    ds_read_b64_tr_b16 v[122:123], v12 offset:1024
    v_mfma_f32_16x16x32_bf16 v[52:55], v[132:135], v[104:107], v[52:55]
    ds_read_b128 v[92:95], v241 offset:2048
    v_mfma_f32_16x16x32_bf16 v[56:59], v[136:139], v[104:107], v[56:59]
    ds_read_b64_tr_b16 v[124:125], v14 offset:0
    v_mfma_f32_16x16x32_bf16 v[144:147], v[168:171], v[96:99], v[144:147]
    v_mfma_f32_16x16x32_bf16 v[60:63], v[140:143], v[104:107], v[60:63]
    ds_read_b64_tr_b16 v[126:127], v14 offset:1024
    v_mfma_f32_16x16x32_bf16 v[152:155], v[96:99], v[96:99], v[152:155]
    v_mfma_f32_16x16x32_bf16 v[64:67], v[128:131], v[108:111], v[64:67]
    v_mfma_f32_16x16x32_bf16 v[160:163], v[168:171], v[128:131], v[160:163]
    v_mfma_f32_16x16x32_bf16 v[68:71], v[132:135], v[108:111], v[68:71]
    v_mfma_f32_16x16x32_bf16 v[148:151], v[168:171], v[100:103], v[148:151]
    v_mfma_f32_16x16x32_bf16 v[72:75], v[136:139], v[108:111], v[72:75]
    v_mfma_f32_16x16x32_bf16 v[156:159], v[100:103], v[100:103], v[156:159]
    v_mfma_f32_16x16x32_bf16 v[76:79], v[140:143], v[108:111], v[76:79]
    v_mfma_f32_16x16x32_bf16 v[164:167], v[168:171], v[132:135], v[164:167]
    s_waitcnt lgkmcnt(9)
    v_mfma_f32_16x16x32_bf16 v[16:19], v[112:115], v[80:83], v[16:19]
    ds_read_b128 v[96:99], v6 offset:0
    s_waitcnt lgkmcnt(7)
    v_mfma_f32_16x16x32_bf16 v[20:23], v[116:119], v[80:83], v[20:23]
    ds_read_b64_tr_b16 v[128:129], v8 offset:4096
    s_waitcnt lgkmcnt(5)
    v_mfma_f32_16x16x32_bf16 v[24:27], v[120:123], v[80:83], v[24:27]
    ds_read_b64_tr_b16 v[130:131], v8 offset:5120
    s_waitcnt lgkmcnt(3)
    v_mfma_f32_16x16x32_bf16 v[28:31], v[124:127], v[80:83], v[28:31]
    ds_read_b128 v[100:103], v6 offset:2048
    v_mfma_f32_16x16x32_bf16 v[32:35], v[112:115], v[84:87], v[32:35]
    ds_read_b64_tr_b16 v[132:133], v10 offset:4096
    v_mfma_f32_16x16x32_bf16 v[36:39], v[116:119], v[84:87], v[36:39]
    ds_read_b64_tr_b16 v[134:135], v10 offset:5120
    v_mfma_f32_16x16x32_bf16 v[40:43], v[120:123], v[84:87], v[40:43]
    ds_read_b128 v[104:107], v243 offset:0
    v_mfma_f32_16x16x32_bf16 v[44:47], v[124:127], v[84:87], v[44:47]
    ds_read_b64_tr_b16 v[136:137], v12 offset:4096
    v_mfma_f32_16x16x32_bf16 v[48:51], v[112:115], v[88:91], v[48:51]
    ds_read_b64_tr_b16 v[138:139], v12 offset:5120
    v_mfma_f32_16x16x32_bf16 v[52:55], v[116:119], v[88:91], v[52:55]
    ds_read_b128 v[108:111], v243 offset:2048
    v_mfma_f32_16x16x32_bf16 v[56:59], v[120:123], v[88:91], v[56:59]
    ds_read_b64_tr_b16 v[140:141], v14 offset:4096
    v_mfma_f32_16x16x32_bf16 v[144:147], v[168:171], v[80:83], v[144:147]
    v_mfma_f32_16x16x32_bf16 v[60:63], v[124:127], v[88:91], v[60:63]
    ds_read_b64_tr_b16 v[142:143], v14 offset:5120
    v_mfma_f32_16x16x32_bf16 v[152:155], v[80:83], v[80:83], v[152:155]
    v_mfma_f32_16x16x32_bf16 v[64:67], v[112:115], v[92:95], v[64:67]
    v_mfma_f32_16x16x32_bf16 v[160:163], v[168:171], v[112:115], v[160:163]
    v_mfma_f32_16x16x32_bf16 v[68:71], v[116:119], v[92:95], v[68:71]
    v_mfma_f32_16x16x32_bf16 v[148:151], v[168:171], v[84:87], v[148:151]
    v_mfma_f32_16x16x32_bf16 v[72:75], v[120:123], v[92:95], v[72:75]
    v_mfma_f32_16x16x32_bf16 v[156:159], v[84:87], v[84:87], v[156:159]
    v_mfma_f32_16x16x32_bf16 v[76:79], v[124:127], v[92:95], v[76:79]
    v_mfma_f32_16x16x32_bf16 v[164:167], v[168:171], v[116:119], v[164:167]
    s_waitcnt vmcnt(8)
    s_waitcnt lgkmcnt(0)
    s_barrier
    v_mfma_f32_16x16x32_bf16 v[16:19], v[128:131], v[96:99], v[16:19]
    ds_read_b128 v[80:83], v4 offset:32768
    v_mfma_f32_16x16x32_bf16 v[20:23], v[132:135], v[96:99], v[20:23]
    ds_read_b64_tr_b16 v[112:113], v8 offset:32768
    v_mfma_f32_16x16x32_bf16 v[24:27], v[136:139], v[96:99], v[24:27]
    ds_read_b64_tr_b16 v[114:115], v8 offset:33792
    v_mfma_f32_16x16x32_bf16 v[28:31], v[140:143], v[96:99], v[28:31]
    ds_read_b128 v[84:87], v4 offset:34816
    v_mfma_f32_16x16x32_bf16 v[32:35], v[128:131], v[100:103], v[32:35]
    ds_read_b64_tr_b16 v[116:117], v10 offset:32768
    v_mfma_f32_16x16x32_bf16 v[36:39], v[132:135], v[100:103], v[36:39]
    ds_read_b64_tr_b16 v[118:119], v10 offset:33792
    v_mfma_f32_16x16x32_bf16 v[40:43], v[136:139], v[100:103], v[40:43]
    ds_read_b128 v[88:91], v241 offset:32768
    v_mfma_f32_16x16x32_bf16 v[44:47], v[140:143], v[100:103], v[44:47]
    ds_read_b64_tr_b16 v[120:121], v12 offset:32768
    v_mfma_f32_16x16x32_bf16 v[48:51], v[128:131], v[104:107], v[48:51]
    ds_read_b64_tr_b16 v[122:123], v12 offset:33792
    v_mfma_f32_16x16x32_bf16 v[52:55], v[132:135], v[104:107], v[52:55]
    ds_read_b128 v[92:95], v241 offset:34816
    v_mfma_f32_16x16x32_bf16 v[56:59], v[136:139], v[104:107], v[56:59]
    ds_read_b64_tr_b16 v[124:125], v14 offset:32768
    v_mfma_f32_16x16x32_bf16 v[144:147], v[168:171], v[96:99], v[144:147]
    v_mfma_f32_16x16x32_bf16 v[60:63], v[140:143], v[104:107], v[60:63]
    ds_read_b64_tr_b16 v[126:127], v14 offset:33792
    v_mfma_f32_16x16x32_bf16 v[152:155], v[96:99], v[96:99], v[152:155]
    v_mfma_f32_16x16x32_bf16 v[64:67], v[128:131], v[108:111], v[64:67]
    v_mfma_f32_16x16x32_bf16 v[160:163], v[168:171], v[128:131], v[160:163]
    v_mfma_f32_16x16x32_bf16 v[68:71], v[132:135], v[108:111], v[68:71]
    v_mfma_f32_16x16x32_bf16 v[148:151], v[168:171], v[100:103], v[148:151]
    v_mfma_f32_16x16x32_bf16 v[72:75], v[136:139], v[108:111], v[72:75]
    v_mfma_f32_16x16x32_bf16 v[156:159], v[100:103], v[100:103], v[156:159]
    v_mfma_f32_16x16x32_bf16 v[76:79], v[140:143], v[108:111], v[76:79]
    v_mfma_f32_16x16x32_bf16 v[164:167], v[168:171], v[132:135], v[164:167]
    s_waitcnt lgkmcnt(9)
    v_mfma_f32_16x16x32_bf16 v[16:19], v[112:115], v[80:83], v[16:19]
    ds_read_b128 v[96:99], v6 offset:32768
    s_waitcnt lgkmcnt(7)
    v_mfma_f32_16x16x32_bf16 v[20:23], v[116:119], v[80:83], v[20:23]
    ds_read_b64_tr_b16 v[128:129], v8 offset:36864
    s_waitcnt lgkmcnt(5)
    v_mfma_f32_16x16x32_bf16 v[24:27], v[120:123], v[80:83], v[24:27]
    ds_read_b64_tr_b16 v[130:131], v8 offset:37888
    s_waitcnt lgkmcnt(3)
    v_mfma_f32_16x16x32_bf16 v[28:31], v[124:127], v[80:83], v[28:31]
    ds_read_b128 v[100:103], v6 offset:34816
    v_mfma_f32_16x16x32_bf16 v[32:35], v[112:115], v[84:87], v[32:35]
    ds_read_b64_tr_b16 v[132:133], v10 offset:36864
    v_mfma_f32_16x16x32_bf16 v[36:39], v[116:119], v[84:87], v[36:39]
    ds_read_b64_tr_b16 v[134:135], v10 offset:37888
    v_mfma_f32_16x16x32_bf16 v[40:43], v[120:123], v[84:87], v[40:43]
    ds_read_b128 v[104:107], v243 offset:32768
    v_mfma_f32_16x16x32_bf16 v[44:47], v[124:127], v[84:87], v[44:47]
    ds_read_b64_tr_b16 v[136:137], v12 offset:36864
    v_mfma_f32_16x16x32_bf16 v[48:51], v[112:115], v[88:91], v[48:51]
    ds_read_b64_tr_b16 v[138:139], v12 offset:37888
    v_mfma_f32_16x16x32_bf16 v[52:55], v[116:119], v[88:91], v[52:55]
    ds_read_b128 v[108:111], v243 offset:34816
    v_mfma_f32_16x16x32_bf16 v[56:59], v[120:123], v[88:91], v[56:59]
    ds_read_b64_tr_b16 v[140:141], v14 offset:36864
    v_mfma_f32_16x16x32_bf16 v[144:147], v[168:171], v[80:83], v[144:147]
    v_mfma_f32_16x16x32_bf16 v[60:63], v[124:127], v[88:91], v[60:63]
    ds_read_b64_tr_b16 v[142:143], v14 offset:37888
    v_mfma_f32_16x16x32_bf16 v[152:155], v[80:83], v[80:83], v[152:155]
    v_mfma_f32_16x16x32_bf16 v[64:67], v[112:115], v[92:95], v[64:67]
    v_mfma_f32_16x16x32_bf16 v[160:163], v[168:171], v[112:115], v[160:163]
    v_mfma_f32_16x16x32_bf16 v[68:71], v[116:119], v[92:95], v[68:71]
    v_mfma_f32_16x16x32_bf16 v[148:151], v[168:171], v[84:87], v[148:151]
    v_mfma_f32_16x16x32_bf16 v[72:75], v[120:123], v[92:95], v[72:75]
    v_mfma_f32_16x16x32_bf16 v[156:159], v[84:87], v[84:87], v[156:159]
    v_mfma_f32_16x16x32_bf16 v[76:79], v[124:127], v[92:95], v[76:79]
    v_mfma_f32_16x16x32_bf16 v[164:167], v[168:171], v[116:119], v[164:167]
    s_waitcnt vmcnt(0)
    s_waitcnt lgkmcnt(0)
    s_barrier
    v_mfma_f32_16x16x32_bf16 v[16:19], v[128:131], v[96:99], v[16:19]
    ds_read_b128 v[80:83], v3 offset:0
    v_mfma_f32_16x16x32_bf16 v[20:23], v[132:135], v[96:99], v[20:23]
    ds_read_b64_tr_b16 v[112:113], v7 offset:0
    v_mfma_f32_16x16x32_bf16 v[24:27], v[136:139], v[96:99], v[24:27]
    ds_read_b64_tr_b16 v[114:115], v7 offset:1024
    v_mfma_f32_16x16x32_bf16 v[28:31], v[140:143], v[96:99], v[28:31]
    ds_read_b128 v[84:87], v3 offset:2048
    v_mfma_f32_16x16x32_bf16 v[32:35], v[128:131], v[100:103], v[32:35]
    ds_read_b64_tr_b16 v[116:117], v9 offset:0
    v_mfma_f32_16x16x32_bf16 v[36:39], v[132:135], v[100:103], v[36:39]
    ds_read_b64_tr_b16 v[118:119], v9 offset:1024
    v_mfma_f32_16x16x32_bf16 v[40:43], v[136:139], v[100:103], v[40:43]
    ds_read_b128 v[88:91], v240 offset:0
    v_mfma_f32_16x16x32_bf16 v[44:47], v[140:143], v[100:103], v[44:47]
    ds_read_b64_tr_b16 v[120:121], v11 offset:0
    v_mfma_f32_16x16x32_bf16 v[48:51], v[128:131], v[104:107], v[48:51]
    ds_read_b64_tr_b16 v[122:123], v11 offset:1024
    v_mfma_f32_16x16x32_bf16 v[52:55], v[132:135], v[104:107], v[52:55]
    ds_read_b128 v[92:95], v240 offset:2048
    v_mfma_f32_16x16x32_bf16 v[56:59], v[136:139], v[104:107], v[56:59]
    ds_read_b64_tr_b16 v[124:125], v13 offset:0
    v_mfma_f32_16x16x32_bf16 v[144:147], v[168:171], v[96:99], v[144:147]
    v_mfma_f32_16x16x32_bf16 v[60:63], v[140:143], v[104:107], v[60:63]
    ds_read_b64_tr_b16 v[126:127], v13 offset:1024
    v_mfma_f32_16x16x32_bf16 v[152:155], v[96:99], v[96:99], v[152:155]
    v_mfma_f32_16x16x32_bf16 v[64:67], v[128:131], v[108:111], v[64:67]
    v_mfma_f32_16x16x32_bf16 v[160:163], v[168:171], v[128:131], v[160:163]
    v_mfma_f32_16x16x32_bf16 v[68:71], v[132:135], v[108:111], v[68:71]
    v_mfma_f32_16x16x32_bf16 v[148:151], v[168:171], v[100:103], v[148:151]
    v_mfma_f32_16x16x32_bf16 v[72:75], v[136:139], v[108:111], v[72:75]
    v_mfma_f32_16x16x32_bf16 v[156:159], v[100:103], v[100:103], v[156:159]
    v_mfma_f32_16x16x32_bf16 v[76:79], v[140:143], v[108:111], v[76:79]
    v_mfma_f32_16x16x32_bf16 v[164:167], v[168:171], v[132:135], v[164:167]
    s_waitcnt lgkmcnt(9)
    v_mfma_f32_16x16x32_bf16 v[16:19], v[112:115], v[80:83], v[16:19]
    ds_read_b128 v[96:99], v5 offset:0
    s_waitcnt lgkmcnt(7)
    v_mfma_f32_16x16x32_bf16 v[20:23], v[116:119], v[80:83], v[20:23]
    ds_read_b64_tr_b16 v[128:129], v7 offset:4096
    s_waitcnt lgkmcnt(5)
    v_mfma_f32_16x16x32_bf16 v[24:27], v[120:123], v[80:83], v[24:27]
    ds_read_b64_tr_b16 v[130:131], v7 offset:5120
    s_waitcnt lgkmcnt(3)
    v_mfma_f32_16x16x32_bf16 v[28:31], v[124:127], v[80:83], v[28:31]
    ds_read_b128 v[100:103], v5 offset:2048
    v_mfma_f32_16x16x32_bf16 v[32:35], v[112:115], v[84:87], v[32:35]
    ds_read_b64_tr_b16 v[132:133], v9 offset:4096
    v_mfma_f32_16x16x32_bf16 v[36:39], v[116:119], v[84:87], v[36:39]
    ds_read_b64_tr_b16 v[134:135], v9 offset:5120
    v_mfma_f32_16x16x32_bf16 v[40:43], v[120:123], v[84:87], v[40:43]
    ds_read_b128 v[104:107], v242 offset:0
    v_mfma_f32_16x16x32_bf16 v[44:47], v[124:127], v[84:87], v[44:47]
    ds_read_b64_tr_b16 v[136:137], v11 offset:4096
    v_mfma_f32_16x16x32_bf16 v[48:51], v[112:115], v[88:91], v[48:51]
    ds_read_b64_tr_b16 v[138:139], v11 offset:5120
    v_mfma_f32_16x16x32_bf16 v[52:55], v[116:119], v[88:91], v[52:55]
    ds_read_b128 v[108:111], v242 offset:2048
    v_mfma_f32_16x16x32_bf16 v[56:59], v[120:123], v[88:91], v[56:59]
    ds_read_b64_tr_b16 v[140:141], v13 offset:4096
    v_mfma_f32_16x16x32_bf16 v[144:147], v[168:171], v[80:83], v[144:147]
    v_mfma_f32_16x16x32_bf16 v[60:63], v[124:127], v[88:91], v[60:63]
    ds_read_b64_tr_b16 v[142:143], v13 offset:5120
    v_mfma_f32_16x16x32_bf16 v[152:155], v[80:83], v[80:83], v[152:155]
    v_mfma_f32_16x16x32_bf16 v[64:67], v[112:115], v[92:95], v[64:67]
    v_mfma_f32_16x16x32_bf16 v[160:163], v[168:171], v[112:115], v[160:163]
    v_mfma_f32_16x16x32_bf16 v[68:71], v[116:119], v[92:95], v[68:71]
    v_mfma_f32_16x16x32_bf16 v[148:151], v[168:171], v[84:87], v[148:151]
    v_mfma_f32_16x16x32_bf16 v[72:75], v[120:123], v[92:95], v[72:75]
    v_mfma_f32_16x16x32_bf16 v[156:159], v[84:87], v[84:87], v[156:159]
    v_mfma_f32_16x16x32_bf16 v[76:79], v[124:127], v[92:95], v[76:79]
    v_mfma_f32_16x16x32_bf16 v[164:167], v[168:171], v[116:119], v[164:167]
    s_waitcnt lgkmcnt(9)
    v_mfma_f32_16x16x32_bf16 v[16:19], v[128:131], v[96:99], v[16:19]
    s_waitcnt lgkmcnt(6)
    v_mfma_f32_16x16x32_bf16 v[20:23], v[132:135], v[96:99], v[20:23]
    s_waitcnt lgkmcnt(3)
    v_mfma_f32_16x16x32_bf16 v[24:27], v[136:139], v[96:99], v[24:27]
    s_waitcnt lgkmcnt(0)
    v_mfma_f32_16x16x32_bf16 v[28:31], v[140:143], v[96:99], v[28:31]
    v_mfma_f32_16x16x32_bf16 v[32:35], v[128:131], v[100:103], v[32:35]
    v_mfma_f32_16x16x32_bf16 v[36:39], v[132:135], v[100:103], v[36:39]
    v_mfma_f32_16x16x32_bf16 v[40:43], v[136:139], v[100:103], v[40:43]
    v_mfma_f32_16x16x32_bf16 v[44:47], v[140:143], v[100:103], v[44:47]
    v_mfma_f32_16x16x32_bf16 v[48:51], v[128:131], v[104:107], v[48:51]
    v_mfma_f32_16x16x32_bf16 v[52:55], v[132:135], v[104:107], v[52:55]
    v_mfma_f32_16x16x32_bf16 v[56:59], v[136:139], v[104:107], v[56:59]
    v_mfma_f32_16x16x32_bf16 v[144:147], v[168:171], v[96:99], v[144:147]
    v_mfma_f32_16x16x32_bf16 v[60:63], v[140:143], v[104:107], v[60:63]
    v_mfma_f32_16x16x32_bf16 v[152:155], v[96:99], v[96:99], v[152:155]
    v_mfma_f32_16x16x32_bf16 v[64:67], v[128:131], v[108:111], v[64:67]
    v_mfma_f32_16x16x32_bf16 v[160:163], v[168:171], v[128:131], v[160:163]
    v_mfma_f32_16x16x32_bf16 v[68:71], v[132:135], v[108:111], v[68:71]
    v_mfma_f32_16x16x32_bf16 v[148:151], v[168:171], v[100:103], v[148:151]
    v_mfma_f32_16x16x32_bf16 v[72:75], v[136:139], v[108:111], v[72:75]
    v_mfma_f32_16x16x32_bf16 v[156:159], v[100:103], v[100:103], v[156:159]
    v_mfma_f32_16x16x32_bf16 v[76:79], v[140:143], v[108:111], v[76:79]
    v_mfma_f32_16x16x32_bf16 v[164:167], v[168:171], v[132:135], v[164:167]
    v_cndmask_b32 v152, v152, v153, s[52:53]
    s_nop 4
    v_cndmask_b32 v156, v156, v157, s[52:53]
    v_cndmask_b32 v152, v152, v154, s[54:55]
    v_cndmask_b32 v156, v156, v158, s[54:55]
    v_cndmask_b32 v152, v152, v155, s[56:57]
    v_cndmask_b32 v156, v156, v159, s[56:57]
    v_mul_f32 v144, 0x3ae38e39, v144
    v_mul_f32 v148, 0x3ae38e39, v148
    v_mov_b32 v145, v144
    v_mov_b32 v149, v148
    v_mul_f32 v152, 0x3ae38e39, v152
    v_mul_f32 v156, 0x3ae38e39, v156
    v_fma_f32 v152, -v144, v144, v152
    v_fma_f32 v156, -v148, v148, v156
    v_max_f32 v152, 0, v152
    v_max_f32 v156, 0, v156
    v_cvt_pk_bf16_f32 v144, v144, v144
    v_cvt_pk_bf16_f32 v148, v148, v148
    v_lshlrev_b32 v144, 16, v144
    v_lshlrev_b32 v148, 16, v148
    v_cvt_pk_bf16_f32 v152, v152, v152
    v_cvt_pk_bf16_f32 v156, v156, v156
    v_lshlrev_b32 v152, 16, v152
    v_lshlrev_b32 v156, 16, v156
    v_add_f32 v152, 0x3727c5ac, v152
    v_add_f32 v156, 0x3727c5ac, v156
    v_cvt_pk_bf16_f32 v152, v152, v152
    v_cvt_pk_bf16_f32 v156, v156, v156
    v_lshlrev_b32 v152, 16, v152
    v_lshlrev_b32 v156, 16, v156
    v_sqrt_f32 v152, v152
    v_sqrt_f32 v156, v156
    v_cvt_pk_bf16_f32 v152, v152, v152
    v_cvt_pk_bf16_f32 v156, v156, v156
    v_lshlrev_b32 v152, 16, v152
    v_lshlrev_b32 v156, 16, v156
    v_rcp_f32 v152, v152
    v_rcp_f32 v156, v156
    v_sub_f32 v144, 0, v144
    v_sub_f32 v148, 0, v148
    s_mov_b64 exec, s[58:59]
    ds_write_b32 v172, v144
    ds_write_b32 v172, v148 offset:64
    ds_write_b32 v172, v152 offset:512
    ds_write_b32 v172, v156 offset:576
    ds_write_b32 v173, v160
    ds_write_b32 v173, v164 offset:64
    s_cmp_lg_u32 s26, 0
    s_cbranch_scc1 L_sequential_preLN__sliding_block__glu_gated_glu__prompt_kernel_nomx
    s_lshl_b32 s27, s25, 9
    s_add_u32 s27, s27, 43384832
    buffer_store_dword v145, v172, s[20:23], s27 offen
    buffer_store_dword v149, v172, s[20:23], s27 offen offset:64
L_sequential_preLN__sliding_block__glu_gated_glu__prompt_kernel_nomx:
    s_mov_b64 exec, -1
    s_waitcnt lgkmcnt(0)
    s_barrier
    ds_read_b32 v180, v174 offset:0
    ds_read_b32 v184, v174 offset:512
    ds_read_b32 v181, v174 offset:64
    ds_read_b32 v185, v174 offset:576
    ds_read_b32 v182, v175 offset:0
    ds_read_b32 v186, v175 offset:512
    ds_read_b32 v183, v175 offset:64
    ds_read_b32 v187, v175 offset:576
    ds_read_b128 v[188:191], v176 offset:0
    ds_read_b128 v[192:195], v176 offset:64
    ds_read_b128 v[196:199], v177 offset:0
    ds_read_b128 v[200:203], v177 offset:64
    s_cmp_ge_u32 s31, 9
    s_cselect_b32 s27, 1.0, 0x3eae1a93
    s_waitcnt lgkmcnt(10)
    v_mul_f32 v184, s27, v184
    s_waitcnt lgkmcnt(8)
    v_mul_f32 v185, s27, v185
    s_waitcnt lgkmcnt(6)
    v_mul_f32 v186, s27, v186
    s_waitcnt lgkmcnt(4)
    v_mul_f32 v187, s27, v187
    s_mul_i32 s27, s30, 1184
    s_add_u32 s48, s37, s27
    s_sub_u32 s27, 1184, s27
    s_add_u32 s49, s37, s27
    s_waitcnt lgkmcnt(3)
    v_fma_f32 v16, v188, v180, v16
    v_fma_f32 v17, v189, v180, v17
    v_fma_f32 v18, v190, v180, v18
    v_fma_f32 v19, v191, v180, v19
    v_mul_f32 v16, v16, v184
    v_mul_f32 v17, v17, v184
    v_mul_f32 v18, v18, v184
    v_mul_f32 v19, v19, v184
    v_cvt_pk_bf16_f32 v16, v16, v17
    v_cvt_pk_bf16_f32 v17, v18, v19
    v_fma_f32 v32, v188, v181, v32
    v_fma_f32 v33, v189, v181, v33
    v_fma_f32 v34, v190, v181, v34
    v_fma_f32 v35, v191, v181, v35
    v_mul_f32 v32, v32, v185
    v_mul_f32 v33, v33, v185
    v_mul_f32 v34, v34, v185
    v_mul_f32 v35, v35, v185
    v_cvt_pk_bf16_f32 v32, v32, v33
    v_cvt_pk_bf16_f32 v33, v34, v35
    v_fma_f32 v48, v188, v182, v48
    v_fma_f32 v49, v189, v182, v49
    v_fma_f32 v50, v190, v182, v50
    v_fma_f32 v51, v191, v182, v51
    v_mul_f32 v48, v48, v186
    v_mul_f32 v49, v49, v186
    v_mul_f32 v50, v50, v186
    v_mul_f32 v51, v51, v186
    v_cvt_pk_bf16_f32 v48, v48, v49
    v_cvt_pk_bf16_f32 v49, v50, v51
    v_fma_f32 v64, v188, v183, v64
    v_fma_f32 v65, v189, v183, v65
    v_fma_f32 v66, v190, v183, v66
    v_fma_f32 v67, v191, v183, v67
    v_mul_f32 v64, v64, v187
    v_mul_f32 v65, v65, v187
    v_mul_f32 v66, v66, v187
    v_mul_f32 v67, v67, v187
    v_cvt_pk_bf16_f32 v64, v64, v65
    v_cvt_pk_bf16_f32 v65, v66, v67
    s_andn2_b64 exec, -1, s[40:41]
    buffer_store_dwordx2 v[16:17], v228, s[20:23], s48 offen offset:0
    buffer_store_dwordx2 v[32:33], v228, s[20:23], s48 offen offset:592
    buffer_store_dwordx2 v[48:49], v228, s[20:23], s49 offen offset:0
    buffer_store_dwordx2 v[64:65], v228, s[20:23], s49 offen offset:592
    s_mov_b64 exec, s[40:41]
    s_cbranch_execz L_sequential_preLN__sliding_block__glu_gated_glu__prompt_kernel_ns0
    buffer_store_dword v16, v228, s[20:23], s48 offen offset:0
    buffer_store_dword v17, v229, s[20:23], s48 offen offset:0
    buffer_store_dword v32, v228, s[20:23], s48 offen offset:592
    buffer_store_dword v33, v229, s[20:23], s48 offen offset:592
    buffer_store_dword v48, v228, s[20:23], s49 offen offset:0
    buffer_store_dword v49, v229, s[20:23], s49 offen offset:0
    buffer_store_dword v64, v228, s[20:23], s49 offen offset:592
    buffer_store_dword v65, v229, s[20:23], s49 offen offset:592
L_sequential_preLN__sliding_block__glu_gated_glu__prompt_kernel_ns0:
    s_mov_b64 exec, -1
    s_waitcnt lgkmcnt(2)
    v_fma_f32 v20, v192, v180, v20
    v_fma_f32 v21, v193, v180, v21
    v_fma_f32 v22, v194, v180, v22
    v_fma_f32 v23, v195, v180, v23
    v_mul_f32 v20, v20, v184
    v_mul_f32 v21, v21, v184
    v_mul_f32 v22, v22, v184
    v_mul_f32 v23, v23, v184
    v_cvt_pk_bf16_f32 v20, v20, v21
    v_cvt_pk_bf16_f32 v21, v22, v23
    v_fma_f32 v36, v192, v181, v36
    v_fma_f32 v37, v193, v181, v37
    v_fma_f32 v38, v194, v181, v38
    v_fma_f32 v39, v195, v181, v39
    v_mul_f32 v36, v36, v185
    v_mul_f32 v37, v37, v185
    v_mul_f32 v38, v38, v185
    v_mul_f32 v39, v39, v185
    v_cvt_pk_bf16_f32 v36, v36, v37
    v_cvt_pk_bf16_f32 v37, v38, v39
    v_fma_f32 v52, v192, v182, v52
    v_fma_f32 v53, v193, v182, v53
    v_fma_f32 v54, v194, v182, v54
    v_fma_f32 v55, v195, v182, v55
    v_mul_f32 v52, v52, v186
    v_mul_f32 v53, v53, v186
    v_mul_f32 v54, v54, v186
    v_mul_f32 v55, v55, v186
    v_cvt_pk_bf16_f32 v52, v52, v53
    v_cvt_pk_bf16_f32 v53, v54, v55
    v_fma_f32 v68, v192, v183, v68
    v_fma_f32 v69, v193, v183, v69
    v_fma_f32 v70, v194, v183, v70
    v_fma_f32 v71, v195, v183, v71
    v_mul_f32 v68, v68, v187
    v_mul_f32 v69, v69, v187
    v_mul_f32 v70, v70, v187
    v_mul_f32 v71, v71, v187
    v_cvt_pk_bf16_f32 v68, v68, v69
    v_cvt_pk_bf16_f32 v69, v70, v71
    s_andn2_b64 exec, -1, s[42:43]
    buffer_store_dwordx2 v[20:21], v230, s[20:23], s48 offen offset:0
    buffer_store_dwordx2 v[36:37], v230, s[20:23], s48 offen offset:592
    buffer_store_dwordx2 v[52:53], v230, s[20:23], s49 offen offset:0
    buffer_store_dwordx2 v[68:69], v230, s[20:23], s49 offen offset:592
    s_mov_b64 exec, s[42:43]
    s_cbranch_execz L_sequential_preLN__sliding_block__glu_gated_glu__prompt_kernel_ns1
    buffer_store_dword v20, v230, s[20:23], s48 offen offset:0
    buffer_store_dword v21, v231, s[20:23], s48 offen offset:0
    buffer_store_dword v36, v230, s[20:23], s48 offen offset:592
    buffer_store_dword v37, v231, s[20:23], s48 offen offset:592
    buffer_store_dword v52, v230, s[20:23], s49 offen offset:0
    buffer_store_dword v53, v231, s[20:23], s49 offen offset:0
    buffer_store_dword v68, v230, s[20:23], s49 offen offset:592
    buffer_store_dword v69, v231, s[20:23], s49 offen offset:592
L_sequential_preLN__sliding_block__glu_gated_glu__prompt_kernel_ns1:
    s_mov_b64 exec, -1
    s_waitcnt lgkmcnt(1)
    v_fma_f32 v24, v196, v180, v24
    v_fma_f32 v25, v197, v180, v25
    v_fma_f32 v26, v198, v180, v26
    v_fma_f32 v27, v199, v180, v27
    v_mul_f32 v24, v24, v184
    v_mul_f32 v25, v25, v184
    v_mul_f32 v26, v26, v184
    v_mul_f32 v27, v27, v184
    v_cvt_pk_bf16_f32 v24, v24, v25
    v_cvt_pk_bf16_f32 v25, v26, v27
    v_fma_f32 v40, v196, v181, v40
    v_fma_f32 v41, v197, v181, v41
    v_fma_f32 v42, v198, v181, v42
    v_fma_f32 v43, v199, v181, v43
    v_mul_f32 v40, v40, v185
    v_mul_f32 v41, v41, v185
    v_mul_f32 v42, v42, v185
    v_mul_f32 v43, v43, v185
    v_cvt_pk_bf16_f32 v40, v40, v41
    v_cvt_pk_bf16_f32 v41, v42, v43
    v_fma_f32 v56, v196, v182, v56
    v_fma_f32 v57, v197, v182, v57
    v_fma_f32 v58, v198, v182, v58
    v_fma_f32 v59, v199, v182, v59
    v_mul_f32 v56, v56, v186
    v_mul_f32 v57, v57, v186
    v_mul_f32 v58, v58, v186
    v_mul_f32 v59, v59, v186
    v_cvt_pk_bf16_f32 v56, v56, v57
    v_cvt_pk_bf16_f32 v57, v58, v59
    v_fma_f32 v72, v196, v183, v72
    v_fma_f32 v73, v197, v183, v73
    v_fma_f32 v74, v198, v183, v74
    v_fma_f32 v75, v199, v183, v75
    v_mul_f32 v72, v72, v187
    v_mul_f32 v73, v73, v187
    v_mul_f32 v74, v74, v187
    v_mul_f32 v75, v75, v187
    v_cvt_pk_bf16_f32 v72, v72, v73
    v_cvt_pk_bf16_f32 v73, v74, v75
    s_andn2_b64 exec, -1, s[44:45]
    buffer_store_dwordx2 v[24:25], v232, s[20:23], s48 offen offset:0
    buffer_store_dwordx2 v[40:41], v232, s[20:23], s48 offen offset:592
    buffer_store_dwordx2 v[56:57], v232, s[20:23], s49 offen offset:0
    buffer_store_dwordx2 v[72:73], v232, s[20:23], s49 offen offset:592
    s_mov_b64 exec, s[44:45]
    s_cbranch_execz L_sequential_preLN__sliding_block__glu_gated_glu__prompt_kernel_ns2
    buffer_store_dword v24, v232, s[20:23], s48 offen offset:0
    buffer_store_dword v25, v233, s[20:23], s48 offen offset:0
    buffer_store_dword v40, v232, s[20:23], s48 offen offset:592
    buffer_store_dword v41, v233, s[20:23], s48 offen offset:592
    buffer_store_dword v56, v232, s[20:23], s49 offen offset:0
    buffer_store_dword v57, v233, s[20:23], s49 offen offset:0
    buffer_store_dword v72, v232, s[20:23], s49 offen offset:592
    buffer_store_dword v73, v233, s[20:23], s49 offen offset:592
L_sequential_preLN__sliding_block__glu_gated_glu__prompt_kernel_ns2:
    s_mov_b64 exec, -1
    s_waitcnt lgkmcnt(0)
    v_fma_f32 v28, v200, v180, v28
    v_fma_f32 v29, v201, v180, v29
    v_fma_f32 v30, v202, v180, v30
    v_fma_f32 v31, v203, v180, v31
    v_mul_f32 v28, v28, v184
    v_mul_f32 v29, v29, v184
    v_mul_f32 v30, v30, v184
    v_mul_f32 v31, v31, v184
    v_cvt_pk_bf16_f32 v28, v28, v29
    v_cvt_pk_bf16_f32 v29, v30, v31
    v_fma_f32 v44, v200, v181, v44
    v_fma_f32 v45, v201, v181, v45
    v_fma_f32 v46, v202, v181, v46
    v_fma_f32 v47, v203, v181, v47
    v_mul_f32 v44, v44, v185
    v_mul_f32 v45, v45, v185
    v_mul_f32 v46, v46, v185
    v_mul_f32 v47, v47, v185
    v_cvt_pk_bf16_f32 v44, v44, v45
    v_cvt_pk_bf16_f32 v45, v46, v47
    v_fma_f32 v60, v200, v182, v60
    v_fma_f32 v61, v201, v182, v61
    v_fma_f32 v62, v202, v182, v62
    v_fma_f32 v63, v203, v182, v63
    v_mul_f32 v60, v60, v186
    v_mul_f32 v61, v61, v186
    v_mul_f32 v62, v62, v186
    v_mul_f32 v63, v63, v186
    v_cvt_pk_bf16_f32 v60, v60, v61
    v_cvt_pk_bf16_f32 v61, v62, v63
    v_fma_f32 v76, v200, v183, v76
    v_fma_f32 v77, v201, v183, v77
    v_fma_f32 v78, v202, v183, v78
    v_fma_f32 v79, v203, v183, v79
    v_mul_f32 v76, v76, v187
    v_mul_f32 v77, v77, v187
    v_mul_f32 v78, v78, v187
    v_mul_f32 v79, v79, v187
    v_cvt_pk_bf16_f32 v76, v76, v77
    v_cvt_pk_bf16_f32 v77, v78, v79
    s_andn2_b64 exec, -1, s[46:47]
    buffer_store_dwordx2 v[28:29], v234, s[20:23], s48 offen offset:0
    buffer_store_dwordx2 v[44:45], v234, s[20:23], s48 offen offset:592
    buffer_store_dwordx2 v[60:61], v234, s[20:23], s49 offen offset:0
    buffer_store_dwordx2 v[76:77], v234, s[20:23], s49 offen offset:592
    s_mov_b64 exec, s[46:47]
    s_cbranch_execz L_sequential_preLN__sliding_block__glu_gated_glu__prompt_kernel_ns3
    buffer_store_dword v28, v234, s[20:23], s48 offen offset:0
    buffer_store_dword v29, v235, s[20:23], s48 offen offset:0
    buffer_store_dword v44, v234, s[20:23], s48 offen offset:592
    buffer_store_dword v45, v235, s[20:23], s48 offen offset:592
    buffer_store_dword v60, v234, s[20:23], s49 offen offset:0
    buffer_store_dword v61, v235, s[20:23], s49 offen offset:0
    buffer_store_dword v76, v234, s[20:23], s49 offen offset:592
    buffer_store_dword v77, v235, s[20:23], s49 offen offset:592
L_sequential_preLN__sliding_block__glu_gated_glu__prompt_kernel_ns3:
    s_mov_b64 exec, -1
    s_endpgm
L_sequential_preLN__sliding_block__glu_gated_glu__prompt_kernel_v:
    s_sub_u32 s38, s31, 18
    s_lshl_b32 s38, s38, 6
    v_and_b32 v220, 15, v0
    v_add_u32 v220, s38, v220
    v_lshrrev_b32 v221, 4, v0
    s_lshl_b32 s27, s29, 5
    s_lshl_b32 s37, s25, 2
    s_lshl_b32 s28, s29, 1
    s_add_u32 s37, s37, s28
    s_add_u32 s48, s37, s30
    s_sub_u32 s49, 1, s30
    s_add_u32 s49, s49, s37
    s_xor_b32 s28, s27, 0
    v_add_u32 v222, s28, v220
    v_mul_u32_u24 v223, 3641, v222
    v_lshrrev_b32 v223, 16, v223
    v_mul_u32_u24 v224, 18, v223
    v_sub_u32 v224, v222, v224
    v_cmp_lt_u32 vcc, 15, v224
    v_lshlrev_b32 v223, 6, v223
    v_add_u32 v225, s48, v223
    v_lshlrev_b32 v226, 10, v225
    v_lshl_add_u32 v226, v221, 8, v226
    v_lshl_add_u32 v226, v224, 4, v226
    v_add_u32 v226, 5455872, v226
    v_mul_u32_u24 v227, 144, v225
    v_lshl_add_u32 v227, v221, 5, v227
    v_lshl_add_u32 v227, v224, 4, v227
    v_add_u32 v227, 7552768, v227
    v_cndmask_b32 v228, v226, v227, vcc
    v_add_u32 v225, s49, v223
    v_lshlrev_b32 v226, 10, v225
    v_lshl_add_u32 v226, v221, 8, v226
    v_lshl_add_u32 v226, v224, 4, v226
    v_add_u32 v226, 5455872, v226
    v_mul_u32_u24 v227, 144, v225
    v_lshl_add_u32 v227, v221, 5, v227
    v_lshl_add_u32 v227, v224, 4, v227
    v_add_u32 v227, 7552768, v227
    v_cndmask_b32 v229, v226, v227, vcc
    s_xor_b32 s28, s27, 16
    v_add_u32 v222, s28, v220
    v_mul_u32_u24 v223, 3641, v222
    v_lshrrev_b32 v223, 16, v223
    v_mul_u32_u24 v224, 18, v223
    v_sub_u32 v224, v222, v224
    v_cmp_lt_u32 vcc, 15, v224
    v_lshlrev_b32 v223, 6, v223
    v_add_u32 v225, s48, v223
    v_lshlrev_b32 v226, 10, v225
    v_lshl_add_u32 v226, v221, 8, v226
    v_lshl_add_u32 v226, v224, 4, v226
    v_add_u32 v226, 5455872, v226
    v_mul_u32_u24 v227, 144, v225
    v_lshl_add_u32 v227, v221, 5, v227
    v_lshl_add_u32 v227, v224, 4, v227
    v_add_u32 v227, 7552768, v227
    v_cndmask_b32 v230, v226, v227, vcc
    v_add_u32 v225, s49, v223
    v_lshlrev_b32 v226, 10, v225
    v_lshl_add_u32 v226, v221, 8, v226
    v_lshl_add_u32 v226, v224, 4, v226
    v_add_u32 v226, 5455872, v226
    v_mul_u32_u24 v227, 144, v225
    v_lshl_add_u32 v227, v221, 5, v227
    v_lshl_add_u32 v227, v224, 4, v227
    v_add_u32 v227, 7552768, v227
    v_cndmask_b32 v231, v226, v227, vcc
    s_xor_b32 s28, s27, 32
    v_add_u32 v222, s28, v220
    v_mul_u32_u24 v223, 3641, v222
    v_lshrrev_b32 v223, 16, v223
    v_mul_u32_u24 v224, 18, v223
    v_sub_u32 v224, v222, v224
    v_cmp_lt_u32 vcc, 15, v224
    v_lshlrev_b32 v223, 6, v223
    v_add_u32 v225, s48, v223
    v_lshlrev_b32 v226, 10, v225
    v_lshl_add_u32 v226, v221, 8, v226
    v_lshl_add_u32 v226, v224, 4, v226
    v_add_u32 v226, 5455872, v226
    v_mul_u32_u24 v227, 144, v225
    v_lshl_add_u32 v227, v221, 5, v227
    v_lshl_add_u32 v227, v224, 4, v227
    v_add_u32 v227, 7552768, v227
    v_cndmask_b32 v232, v226, v227, vcc
    v_add_u32 v225, s49, v223
    v_lshlrev_b32 v226, 10, v225
    v_lshl_add_u32 v226, v221, 8, v226
    v_lshl_add_u32 v226, v224, 4, v226
    v_add_u32 v226, 5455872, v226
    v_mul_u32_u24 v227, 144, v225
    v_lshl_add_u32 v227, v221, 5, v227
    v_lshl_add_u32 v227, v224, 4, v227
    v_add_u32 v227, 7552768, v227
    v_cndmask_b32 v233, v226, v227, vcc
    s_xor_b32 s28, s27, 48
    v_add_u32 v222, s28, v220
    v_mul_u32_u24 v223, 3641, v222
    v_lshrrev_b32 v223, 16, v223
    v_mul_u32_u24 v224, 18, v223
    v_sub_u32 v224, v222, v224
    v_cmp_lt_u32 vcc, 15, v224
    v_lshlrev_b32 v223, 6, v223
    v_add_u32 v225, s48, v223
    v_lshlrev_b32 v226, 10, v225
    v_lshl_add_u32 v226, v221, 8, v226
    v_lshl_add_u32 v226, v224, 4, v226
    v_add_u32 v226, 5455872, v226
    v_mul_u32_u24 v227, 144, v225
    v_lshl_add_u32 v227, v221, 5, v227
    v_lshl_add_u32 v227, v224, 4, v227
    v_add_u32 v227, 7552768, v227
    v_cndmask_b32 v234, v226, v227, vcc
    v_add_u32 v225, s49, v223
    v_lshlrev_b32 v226, 10, v225
    v_lshl_add_u32 v226, v221, 8, v226
    v_lshl_add_u32 v226, v224, 4, v226
    v_add_u32 v226, 5455872, v226
    v_mul_u32_u24 v227, 144, v225
    v_lshl_add_u32 v227, v221, 5, v227
    v_lshl_add_u32 v227, v224, 4, v227
    v_add_u32 v227, 7552768, v227
    v_cndmask_b32 v235, v226, v227, vcc
    v_and_b32 v180, 15, v0
    v_lshlrev_b32 v180, 2, v180
    s_lshl_b32 s27, s29, 8
    s_lshl_b32 s28, s30, 7
    s_add_u32 s27, s27, s28
    s_add_u32 s27, s27, 131072
    v_add_u32 v172, s27, v180
    s_lshl_b32 s27, s30, 8
    s_lshl_b32 s28, s29, 7
    s_add_u32 s27, s27, s28
    s_add_u32 s27, s27, 132096
    v_add_u32 v173, s27, v180
    v_lshrrev_b32 v180, 4, v0
    v_lshlrev_b32 v180, 4, v180
    s_lshl_b32 s27, s29, 8
    s_lshl_b32 s28, s30, 7
    s_add_u32 s27, s27, 131072
    s_add_u32 s35, s27, s28
    v_add_u32 v174, s35, v180
    s_sub_u32 s28, 128, s28
    s_add_u32 s35, s27, s28
    v_add_u32 v175, s35, v180
    v_and_b32 v180, 15, v0
    v_lshlrev_b32 v180, 2, v180
    s_lshl_b32 s27, s30, 8
    s_lshl_b32 s28, s29, 7
    s_add_u32 s27, s27, 132096
    s_add_u32 s35, s27, s28
    v_add_u32 v176, s35, v180
    s_sub_u32 s28, 128, s28
    s_add_u32 s35, s27, s28
    v_add_u32 v177, s35, v180
    s_waitcnt vmcnt(8)
    s_barrier
    ds_read_b128 v[80:83], v3 offset:0
    ds_read_b64_tr_b16 v[112:113], v7 offset:0
    ds_read_b64_tr_b16 v[114:115], v7 offset:1024
    ds_read_b128 v[84:87], v3 offset:2048
    ds_read_b64_tr_b16 v[116:117], v9 offset:0
    ds_read_b64_tr_b16 v[118:119], v9 offset:1024
    ds_read_b128 v[88:91], v240 offset:0
    ds_read_b64_tr_b16 v[120:121], v11 offset:0
    ds_read_b64_tr_b16 v[122:123], v11 offset:1024
    ds_read_b128 v[92:95], v240 offset:2048
    ds_read_b64_tr_b16 v[124:125], v13 offset:0
    ds_read_b64_tr_b16 v[126:127], v13 offset:1024
    s_waitcnt lgkmcnt(9)
    v_mfma_f32_16x16x32_bf16 v[16:19], v[80:83], v[112:115], 0
    ds_read_b128 v[96:99], v5 offset:0
    s_waitcnt lgkmcnt(7)
    v_mfma_f32_16x16x32_bf16 v[20:23], v[80:83], v[116:119], 0
    ds_read_b64_tr_b16 v[128:129], v7 offset:4096
    s_lshl_b32 s60, s62, 7
    s_add_u32 s60, s60, s33
    s_mul_i32 s61, s62, 221184
    s_add_u32 s61, s61, s34
    s_add_u32 s62, s62, 1
    s_cmp_eq_u32 s62, 9
    s_cselect_b32 s62, 0, s62
    s_add_u32 m0, s32, 65536
    s_add_u32 s35, s60, 0
    buffer_load_dwordx4 v1, s[12:15], s35 offen lds
    s_waitcnt lgkmcnt(5)
    v_mfma_f32_16x16x32_bf16 v[24:27], v[80:83], v[120:123], 0
    ds_read_b64_tr_b16 v[130:131], v7 offset:5120
    s_waitcnt lgkmcnt(3)
    v_mfma_f32_16x16x32_bf16 v[28:31], v[80:83], v[124:127], 0
    ds_read_b128 v[100:103], v5 offset:2048
    s_add_u32 m0, s32, 81920
    s_add_u32 s35, s61, 0
    buffer_load_dwordx4 v2, s[16:19], s35 offen lds
    v_mfma_f32_16x16x32_bf16 v[32:35], v[84:87], v[112:115], 0
    ds_read_b64_tr_b16 v[132:133], v9 offset:4096
    v_mfma_f32_16x16x32_bf16 v[36:39], v[84:87], v[116:119], 0
    ds_read_b64_tr_b16 v[134:135], v9 offset:5120
    s_add_u32 m0, s32, 69632
    s_add_u32 s35, s60, 36864
    buffer_load_dwordx4 v1, s[12:15], s35 offen lds
    v_mfma_f32_16x16x32_bf16 v[40:43], v[84:87], v[120:123], 0
    ds_read_b128 v[104:107], v242 offset:0
    v_mfma_f32_16x16x32_bf16 v[44:47], v[84:87], v[124:127], 0
    ds_read_b64_tr_b16 v[136:137], v11 offset:4096
    s_add_u32 m0, s32, 86016
    s_add_u32 s35, s61, 110592
    buffer_load_dwordx4 v2, s[16:19], s35 offen lds
    v_mfma_f32_16x16x32_bf16 v[48:51], v[88:91], v[112:115], 0
    ds_read_b64_tr_b16 v[138:139], v11 offset:5120
    v_mfma_f32_16x16x32_bf16 v[52:55], v[88:91], v[116:119], 0
    ds_read_b128 v[108:111], v242 offset:2048
    s_add_u32 m0, s32, 73728
    s_add_u32 s35, s60, 73728
    buffer_load_dwordx4 v1, s[12:15], s35 offen lds
    v_mfma_f32_16x16x32_bf16 v[56:59], v[88:91], v[120:123], 0
    ds_read_b64_tr_b16 v[140:141], v13 offset:4096
    v_mfma_f32_16x16x32_bf16 v[144:147], v[168:171], v[80:83], 0
    v_mfma_f32_16x16x32_bf16 v[60:63], v[88:91], v[124:127], 0
    ds_read_b64_tr_b16 v[142:143], v13 offset:5120
    v_mfma_f32_16x16x32_bf16 v[152:155], v[80:83], v[80:83], 0
    s_add_u32 m0, s32, 90112
    s_add_u32 s35, s61, 128
    buffer_load_dwordx4 v2, s[16:19], s35 offen lds
    v_mfma_f32_16x16x32_bf16 v[64:67], v[92:95], v[112:115], 0
    v_mfma_f32_16x16x32_bf16 v[160:163], v[168:171], v[112:115], 0
    v_mfma_f32_16x16x32_bf16 v[68:71], v[92:95], v[116:119], 0
    v_mfma_f32_16x16x32_bf16 v[148:151], v[168:171], v[84:87], 0
    s_add_u32 m0, s32, 77824
    s_add_u32 s35, s60, 110592
    buffer_load_dwordx4 v1, s[12:15], s35 offen lds
    v_mfma_f32_16x16x32_bf16 v[72:75], v[92:95], v[120:123], 0
    v_mfma_f32_16x16x32_bf16 v[156:159], v[84:87], v[84:87], 0
    v_mfma_f32_16x16x32_bf16 v[76:79], v[92:95], v[124:127], 0
    v_mfma_f32_16x16x32_bf16 v[164:167], v[168:171], v[116:119], 0
    s_add_u32 m0, s32, 94208
    s_add_u32 s35, s61, 110720
    buffer_load_dwordx4 v2, s[16:19], s35 offen lds
    s_waitcnt vmcnt(8)
    s_waitcnt lgkmcnt(0)
    s_barrier
    v_mfma_f32_16x16x32_bf16 v[16:19], v[96:99], v[128:131], v[16:19]
    ds_read_b128 v[80:83], v3 offset:32768
    v_mfma_f32_16x16x32_bf16 v[20:23], v[96:99], v[132:135], v[20:23]
    ds_read_b64_tr_b16 v[112:113], v7 offset:32768
    s_lshl_b32 s60, s62, 7
    s_add_u32 s60, s60, s33
    s_mul_i32 s61, s62, 221184
    s_add_u32 s61, s61, s34
    s_add_u32 s62, s62, 1
    s_cmp_eq_u32 s62, 9
    s_cselect_b32 s62, 0, s62
    s_add_u32 m0, s32, 98304
    s_add_u32 s35, s60, 0
    buffer_load_dwordx4 v1, s[12:15], s35 offen lds
    v_mfma_f32_16x16x32_bf16 v[24:27], v[96:99], v[136:139], v[24:27]
    ds_read_b64_tr_b16 v[114:115], v7 offset:33792
    v_mfma_f32_16x16x32_bf16 v[28:31], v[96:99], v[140:143], v[28:31]
    ds_read_b128 v[84:87], v3 offset:34816
    s_add_u32 m0, s32, 114688
    s_add_u32 s35, s61, 0
    buffer_load_dwordx4 v2, s[16:19], s35 offen lds
    v_mfma_f32_16x16x32_bf16 v[32:35], v[100:103], v[128:131], v[32:35]
    ds_read_b64_tr_b16 v[116:117], v9 offset:32768
    v_mfma_f32_16x16x32_bf16 v[36:39], v[100:103], v[132:135], v[36:39]
    ds_read_b64_tr_b16 v[118:119], v9 offset:33792
    s_add_u32 m0, s32, 102400
    s_add_u32 s35, s60, 36864
    buffer_load_dwordx4 v1, s[12:15], s35 offen lds
    v_mfma_f32_16x16x32_bf16 v[40:43], v[100:103], v[136:139], v[40:43]
    ds_read_b128 v[88:91], v240 offset:32768
    v_mfma_f32_16x16x32_bf16 v[44:47], v[100:103], v[140:143], v[44:47]
    ds_read_b64_tr_b16 v[120:121], v11 offset:32768
    s_add_u32 m0, s32, 118784
    s_add_u32 s35, s61, 110592
    buffer_load_dwordx4 v2, s[16:19], s35 offen lds
    v_mfma_f32_16x16x32_bf16 v[48:51], v[104:107], v[128:131], v[48:51]
    ds_read_b64_tr_b16 v[122:123], v11 offset:33792
    v_mfma_f32_16x16x32_bf16 v[52:55], v[104:107], v[132:135], v[52:55]
    ds_read_b128 v[92:95], v240 offset:34816
    s_add_u32 m0, s32, 106496
    s_add_u32 s35, s60, 73728
    buffer_load_dwordx4 v1, s[12:15], s35 offen lds
    v_mfma_f32_16x16x32_bf16 v[56:59], v[104:107], v[136:139], v[56:59]
    ds_read_b64_tr_b16 v[124:125], v13 offset:32768
    v_mfma_f32_16x16x32_bf16 v[144:147], v[168:171], v[96:99], v[144:147]
    v_mfma_f32_16x16x32_bf16 v[60:63], v[104:107], v[140:143], v[60:63]
    ds_read_b64_tr_b16 v[126:127], v13 offset:33792
    v_mfma_f32_16x16x32_bf16 v[152:155], v[96:99], v[96:99], v[152:155]
    s_add_u32 m0, s32, 122880
    s_add_u32 s35, s61, 128
    buffer_load_dwordx4 v2, s[16:19], s35 offen lds
    v_mfma_f32_16x16x32_bf16 v[64:67], v[108:111], v[128:131], v[64:67]
    v_mfma_f32_16x16x32_bf16 v[160:163], v[168:171], v[128:131], v[160:163]
    v_mfma_f32_16x16x32_bf16 v[68:71], v[108:111], v[132:135], v[68:71]
    v_mfma_f32_16x16x32_bf16 v[148:151], v[168:171], v[100:103], v[148:151]
    s_add_u32 m0, s32, 110592
    s_add_u32 s35, s60, 110592
    buffer_load_dwordx4 v1, s[12:15], s35 offen lds
    v_mfma_f32_16x16x32_bf16 v[72:75], v[108:111], v[136:139], v[72:75]
    v_mfma_f32_16x16x32_bf16 v[156:159], v[100:103], v[100:103], v[156:159]
    v_mfma_f32_16x16x32_bf16 v[76:79], v[108:111], v[140:143], v[76:79]
    v_mfma_f32_16x16x32_bf16 v[164:167], v[168:171], v[132:135], v[164:167]
    s_add_u32 m0, s32, 126976
    s_add_u32 s35, s61, 110720
    buffer_load_dwordx4 v2, s[16:19], s35 offen lds
    s_waitcnt lgkmcnt(9)
    v_mfma_f32_16x16x32_bf16 v[16:19], v[80:83], v[112:115], v[16:19]
    ds_read_b128 v[96:99], v5 offset:32768
    s_waitcnt lgkmcnt(7)
    v_mfma_f32_16x16x32_bf16 v[20:23], v[80:83], v[116:119], v[20:23]
    ds_read_b64_tr_b16 v[128:129], v7 offset:36864
    s_lshl_b32 s60, s62, 7
    s_add_u32 s60, s60, s33
    s_mul_i32 s61, s62, 221184
    s_add_u32 s61, s61, s34
    s_add_u32 s62, s62, 1
    s_cmp_eq_u32 s62, 9
    s_cselect_b32 s62, 0, s62
    s_add_u32 m0, s32, 0
    s_add_u32 s35, s60, 0
    buffer_load_dwordx4 v1, s[12:15], s35 offen lds
    s_waitcnt lgkmcnt(5)
    v_mfma_f32_16x16x32_bf16 v[24:27], v[80:83], v[120:123], v[24:27]
    ds_read_b64_tr_b16 v[130:131], v7 offset:37888
    s_waitcnt lgkmcnt(3)
    v_mfma_f32_16x16x32_bf16 v[28:31], v[80:83], v[124:127], v[28:31]
    ds_read_b128 v[100:103], v5 offset:34816
    s_add_u32 m0, s32, 16384
    s_add_u32 s35, s61, 0
    buffer_load_dwordx4 v2, s[16:19], s35 offen lds
    v_mfma_f32_16x16x32_bf16 v[32:35], v[84:87], v[112:115], v[32:35]
    ds_read_b64_tr_b16 v[132:133], v9 offset:36864
    v_mfma_f32_16x16x32_bf16 v[36:39], v[84:87], v[116:119], v[36:39]
    ds_read_b64_tr_b16 v[134:135], v9 offset:37888
    s_add_u32 m0, s32, 4096
    s_add_u32 s35, s60, 36864
    buffer_load_dwordx4 v1, s[12:15], s35 offen lds
    v_mfma_f32_16x16x32_bf16 v[40:43], v[84:87], v[120:123], v[40:43]
    ds_read_b128 v[104:107], v242 offset:32768
    v_mfma_f32_16x16x32_bf16 v[44:47], v[84:87], v[124:127], v[44:47]
    ds_read_b64_tr_b16 v[136:137], v11 offset:36864
    s_add_u32 m0, s32, 20480
    s_add_u32 s35, s61, 110592
    buffer_load_dwordx4 v2, s[16:19], s35 offen lds
    v_mfma_f32_16x16x32_bf16 v[48:51], v[88:91], v[112:115], v[48:51]
    ds_read_b64_tr_b16 v[138:139], v11 offset:37888
    v_mfma_f32_16x16x32_bf16 v[52:55], v[88:91], v[116:119], v[52:55]
    ds_read_b128 v[108:111], v242 offset:34816
    s_add_u32 m0, s32, 8192
    s_add_u32 s35, s60, 73728
    buffer_load_dwordx4 v1, s[12:15], s35 offen lds
    v_mfma_f32_16x16x32_bf16 v[56:59], v[88:91], v[120:123], v[56:59]
    ds_read_b64_tr_b16 v[140:141], v13 offset:36864
    v_mfma_f32_16x16x32_bf16 v[144:147], v[168:171], v[80:83], v[144:147]
    v_mfma_f32_16x16x32_bf16 v[60:63], v[88:91], v[124:127], v[60:63]
    ds_read_b64_tr_b16 v[142:143], v13 offset:37888
    v_mfma_f32_16x16x32_bf16 v[152:155], v[80:83], v[80:83], v[152:155]
    s_add_u32 m0, s32, 24576
    s_add_u32 s35, s61, 128
    buffer_load_dwordx4 v2, s[16:19], s35 offen lds
    v_mfma_f32_16x16x32_bf16 v[64:67], v[92:95], v[112:115], v[64:67]
    v_mfma_f32_16x16x32_bf16 v[160:163], v[168:171], v[112:115], v[160:163]
    v_mfma_f32_16x16x32_bf16 v[68:71], v[92:95], v[116:119], v[68:71]
    v_mfma_f32_16x16x32_bf16 v[148:151], v[168:171], v[84:87], v[148:151]
    s_add_u32 m0, s32, 12288
    s_add_u32 s35, s60, 110592
    buffer_load_dwordx4 v1, s[12:15], s35 offen lds
    v_mfma_f32_16x16x32_bf16 v[72:75], v[92:95], v[120:123], v[72:75]
    v_mfma_f32_16x16x32_bf16 v[156:159], v[84:87], v[84:87], v[156:159]
    v_mfma_f32_16x16x32_bf16 v[76:79], v[92:95], v[124:127], v[76:79]
    v_mfma_f32_16x16x32_bf16 v[164:167], v[168:171], v[116:119], v[164:167]
    s_add_u32 m0, s32, 28672
    s_add_u32 s35, s61, 110720
    buffer_load_dwordx4 v2, s[16:19], s35 offen lds
    s_waitcnt vmcnt(16)
    s_waitcnt lgkmcnt(0)
    s_barrier
    v_mfma_f32_16x16x32_bf16 v[16:19], v[96:99], v[128:131], v[16:19]
    ds_read_b128 v[80:83], v4 offset:0
    v_mfma_f32_16x16x32_bf16 v[20:23], v[96:99], v[132:135], v[20:23]
    ds_read_b64_tr_b16 v[112:113], v8 offset:0
    s_lshl_b32 s60, s62, 7
    s_add_u32 s60, s60, s33
    s_mul_i32 s61, s62, 221184
    s_add_u32 s61, s61, s34
    s_add_u32 s62, s62, 1
    s_cmp_eq_u32 s62, 9
    s_cselect_b32 s62, 0, s62
    s_add_u32 m0, s32, 32768
    s_add_u32 s35, s60, 0
    buffer_load_dwordx4 v1, s[12:15], s35 offen lds
    v_mfma_f32_16x16x32_bf16 v[24:27], v[96:99], v[136:139], v[24:27]
    ds_read_b64_tr_b16 v[114:115], v8 offset:1024
    v_mfma_f32_16x16x32_bf16 v[28:31], v[96:99], v[140:143], v[28:31]
    ds_read_b128 v[84:87], v4 offset:2048
    s_add_u32 m0, s32, 49152
    s_add_u32 s35, s61, 0
    buffer_load_dwordx4 v2, s[16:19], s35 offen lds
    v_mfma_f32_16x16x32_bf16 v[32:35], v[100:103], v[128:131], v[32:35]
    ds_read_b64_tr_b16 v[116:117], v10 offset:0
    v_mfma_f32_16x16x32_bf16 v[36:39], v[100:103], v[132:135], v[36:39]
    ds_read_b64_tr_b16 v[118:119], v10 offset:1024
    s_add_u32 m0, s32, 36864
    s_add_u32 s35, s60, 36864
    buffer_load_dwordx4 v1, s[12:15], s35 offen lds
    v_mfma_f32_16x16x32_bf16 v[40:43], v[100:103], v[136:139], v[40:43]
    ds_read_b128 v[88:91], v241 offset:0
    v_mfma_f32_16x16x32_bf16 v[44:47], v[100:103], v[140:143], v[44:47]
    ds_read_b64_tr_b16 v[120:121], v12 offset:0
    s_add_u32 m0, s32, 53248
    s_add_u32 s35, s61, 110592
    buffer_load_dwordx4 v2, s[16:19], s35 offen lds
    v_mfma_f32_16x16x32_bf16 v[48:51], v[104:107], v[128:131], v[48:51]
    ds_read_b64_tr_b16 v[122:123], v12 offset:1024
    v_mfma_f32_16x16x32_bf16 v[52:55], v[104:107], v[132:135], v[52:55]
    ds_read_b128 v[92:95], v241 offset:2048
    s_add_u32 m0, s32, 40960
    s_add_u32 s35, s60, 73728
    buffer_load_dwordx4 v1, s[12:15], s35 offen lds
    v_mfma_f32_16x16x32_bf16 v[56:59], v[104:107], v[136:139], v[56:59]
    ds_read_b64_tr_b16 v[124:125], v14 offset:0
    v_mfma_f32_16x16x32_bf16 v[144:147], v[168:171], v[96:99], v[144:147]
    v_mfma_f32_16x16x32_bf16 v[60:63], v[104:107], v[140:143], v[60:63]
    ds_read_b64_tr_b16 v[126:127], v14 offset:1024
    v_mfma_f32_16x16x32_bf16 v[152:155], v[96:99], v[96:99], v[152:155]
    s_add_u32 m0, s32, 57344
    s_add_u32 s35, s61, 128
    buffer_load_dwordx4 v2, s[16:19], s35 offen lds
    v_mfma_f32_16x16x32_bf16 v[64:67], v[108:111], v[128:131], v[64:67]
    v_mfma_f32_16x16x32_bf16 v[160:163], v[168:171], v[128:131], v[160:163]
    v_mfma_f32_16x16x32_bf16 v[68:71], v[108:111], v[132:135], v[68:71]
    v_mfma_f32_16x16x32_bf16 v[148:151], v[168:171], v[100:103], v[148:151]
    s_add_u32 m0, s32, 45056
    s_add_u32 s35, s60, 110592
    buffer_load_dwordx4 v1, s[12:15], s35 offen lds
    v_mfma_f32_16x16x32_bf16 v[72:75], v[108:111], v[136:139], v[72:75]
    v_mfma_f32_16x16x32_bf16 v[156:159], v[100:103], v[100:103], v[156:159]
    v_mfma_f32_16x16x32_bf16 v[76:79], v[108:111], v[140:143], v[76:79]
    v_mfma_f32_16x16x32_bf16 v[164:167], v[168:171], v[132:135], v[164:167]
    s_add_u32 m0, s32, 61440
    s_add_u32 s35, s61, 110720
    buffer_load_dwordx4 v2, s[16:19], s35 offen lds
    s_waitcnt lgkmcnt(9)
    v_mfma_f32_16x16x32_bf16 v[16:19], v[80:83], v[112:115], v[16:19]
    ds_read_b128 v[96:99], v6 offset:0
    s_waitcnt lgkmcnt(7)
    v_mfma_f32_16x16x32_bf16 v[20:23], v[80:83], v[116:119], v[20:23]
    ds_read_b64_tr_b16 v[128:129], v8 offset:4096
    s_waitcnt lgkmcnt(5)
    v_mfma_f32_16x16x32_bf16 v[24:27], v[80:83], v[120:123], v[24:27]
    ds_read_b64_tr_b16 v[130:131], v8 offset:5120
    s_waitcnt lgkmcnt(3)
    v_mfma_f32_16x16x32_bf16 v[28:31], v[80:83], v[124:127], v[28:31]
    ds_read_b128 v[100:103], v6 offset:2048
    v_mfma_f32_16x16x32_bf16 v[32:35], v[84:87], v[112:115], v[32:35]
    ds_read_b64_tr_b16 v[132:133], v10 offset:4096
    v_mfma_f32_16x16x32_bf16 v[36:39], v[84:87], v[116:119], v[36:39]
    ds_read_b64_tr_b16 v[134:135], v10 offset:5120
    v_mfma_f32_16x16x32_bf16 v[40:43], v[84:87], v[120:123], v[40:43]
    ds_read_b128 v[104:107], v243 offset:0
    v_mfma_f32_16x16x32_bf16 v[44:47], v[84:87], v[124:127], v[44:47]
    ds_read_b64_tr_b16 v[136:137], v12 offset:4096
    v_mfma_f32_16x16x32_bf16 v[48:51], v[88:91], v[112:115], v[48:51]
    ds_read_b64_tr_b16 v[138:139], v12 offset:5120
    v_mfma_f32_16x16x32_bf16 v[52:55], v[88:91], v[116:119], v[52:55]
    ds_read_b128 v[108:111], v243 offset:2048
    v_mfma_f32_16x16x32_bf16 v[56:59], v[88:91], v[120:123], v[56:59]
    ds_read_b64_tr_b16 v[140:141], v14 offset:4096
    v_mfma_f32_16x16x32_bf16 v[144:147], v[168:171], v[80:83], v[144:147]
    v_mfma_f32_16x16x32_bf16 v[60:63], v[88:91], v[124:127], v[60:63]
    ds_read_b64_tr_b16 v[142:143], v14 offset:5120
    v_mfma_f32_16x16x32_bf16 v[152:155], v[80:83], v[80:83], v[152:155]
    v_mfma_f32_16x16x32_bf16 v[64:67], v[92:95], v[112:115], v[64:67]
    v_mfma_f32_16x16x32_bf16 v[160:163], v[168:171], v[112:115], v[160:163]
    v_mfma_f32_16x16x32_bf16 v[68:71], v[92:95], v[116:119], v[68:71]
    v_mfma_f32_16x16x32_bf16 v[148:151], v[168:171], v[84:87], v[148:151]
    v_mfma_f32_16x16x32_bf16 v[72:75], v[92:95], v[120:123], v[72:75]
    v_mfma_f32_16x16x32_bf16 v[156:159], v[84:87], v[84:87], v[156:159]
    v_mfma_f32_16x16x32_bf16 v[76:79], v[92:95], v[124:127], v[76:79]
    v_mfma_f32_16x16x32_bf16 v[164:167], v[168:171], v[116:119], v[164:167]
    s_waitcnt vmcnt(16)
    s_waitcnt lgkmcnt(0)
    s_barrier
    v_mfma_f32_16x16x32_bf16 v[16:19], v[96:99], v[128:131], v[16:19]
    ds_read_b128 v[80:83], v4 offset:32768
    v_mfma_f32_16x16x32_bf16 v[20:23], v[96:99], v[132:135], v[20:23]
    ds_read_b64_tr_b16 v[112:113], v8 offset:32768
    s_lshl_b32 s60, s62, 7
    s_add_u32 s60, s60, s33
    s_mul_i32 s61, s62, 221184
    s_add_u32 s61, s61, s34
    s_add_u32 s62, s62, 1
    s_cmp_eq_u32 s62, 9
    s_cselect_b32 s62, 0, s62
    s_add_u32 m0, s32, 65536
    s_add_u32 s35, s60, 0
    buffer_load_dwordx4 v1, s[12:15], s35 offen lds
    v_mfma_f32_16x16x32_bf16 v[24:27], v[96:99], v[136:139], v[24:27]
    ds_read_b64_tr_b16 v[114:115], v8 offset:33792
    v_mfma_f32_16x16x32_bf16 v[28:31], v[96:99], v[140:143], v[28:31]
    ds_read_b128 v[84:87], v4 offset:34816
    s_add_u32 m0, s32, 81920
    s_add_u32 s35, s61, 0
    buffer_load_dwordx4 v2, s[16:19], s35 offen lds
    v_mfma_f32_16x16x32_bf16 v[32:35], v[100:103], v[128:131], v[32:35]
    ds_read_b64_tr_b16 v[116:117], v10 offset:32768
    v_mfma_f32_16x16x32_bf16 v[36:39], v[100:103], v[132:135], v[36:39]
    ds_read_b64_tr_b16 v[118:119], v10 offset:33792
    s_add_u32 m0, s32, 69632
    s_add_u32 s35, s60, 36864
    buffer_load_dwordx4 v1, s[12:15], s35 offen lds
    v_mfma_f32_16x16x32_bf16 v[40:43], v[100:103], v[136:139], v[40:43]
    ds_read_b128 v[88:91], v241 offset:32768
    v_mfma_f32_16x16x32_bf16 v[44:47], v[100:103], v[140:143], v[44:47]
    ds_read_b64_tr_b16 v[120:121], v12 offset:32768
    s_add_u32 m0, s32, 86016
    s_add_u32 s35, s61, 110592
    buffer_load_dwordx4 v2, s[16:19], s35 offen lds
    v_mfma_f32_16x16x32_bf16 v[48:51], v[104:107], v[128:131], v[48:51]
    ds_read_b64_tr_b16 v[122:123], v12 offset:33792
    v_mfma_f32_16x16x32_bf16 v[52:55], v[104:107], v[132:135], v[52:55]
    ds_read_b128 v[92:95], v241 offset:34816
    s_add_u32 m0, s32, 73728
    s_add_u32 s35, s60, 73728
    buffer_load_dwordx4 v1, s[12:15], s35 offen lds
    v_mfma_f32_16x16x32_bf16 v[56:59], v[104:107], v[136:139], v[56:59]
    ds_read_b64_tr_b16 v[124:125], v14 offset:32768
    v_mfma_f32_16x16x32_bf16 v[144:147], v[168:171], v[96:99], v[144:147]
    v_mfma_f32_16x16x32_bf16 v[60:63], v[104:107], v[140:143], v[60:63]
    ds_read_b64_tr_b16 v[126:127], v14 offset:33792
    v_mfma_f32_16x16x32_bf16 v[152:155], v[96:99], v[96:99], v[152:155]
    s_add_u32 m0, s32, 90112
    s_add_u32 s35, s61, 128
    buffer_load_dwordx4 v2, s[16:19], s35 offen lds
    v_mfma_f32_16x16x32_bf16 v[64:67], v[108:111], v[128:131], v[64:67]
    v_mfma_f32_16x16x32_bf16 v[160:163], v[168:171], v[128:131], v[160:163]
    v_mfma_f32_16x16x32_bf16 v[68:71], v[108:111], v[132:135], v[68:71]
    v_mfma_f32_16x16x32_bf16 v[148:151], v[168:171], v[100:103], v[148:151]
    s_add_u32 m0, s32, 77824
    s_add_u32 s35, s60, 110592
    buffer_load_dwordx4 v1, s[12:15], s35 offen lds
    v_mfma_f32_16x16x32_bf16 v[72:75], v[108:111], v[136:139], v[72:75]
    v_mfma_f32_16x16x32_bf16 v[156:159], v[100:103], v[100:103], v[156:159]
    v_mfma_f32_16x16x32_bf16 v[76:79], v[108:111], v[140:143], v[76:79]
    v_mfma_f32_16x16x32_bf16 v[164:167], v[168:171], v[132:135], v[164:167]
    s_add_u32 m0, s32, 94208
    s_add_u32 s35, s61, 110720
    buffer_load_dwordx4 v2, s[16:19], s35 offen lds
    s_waitcnt lgkmcnt(9)
    v_mfma_f32_16x16x32_bf16 v[16:19], v[80:83], v[112:115], v[16:19]
    ds_read_b128 v[96:99], v6 offset:32768
    s_waitcnt lgkmcnt(7)
    v_mfma_f32_16x16x32_bf16 v[20:23], v[80:83], v[116:119], v[20:23]
    ds_read_b64_tr_b16 v[128:129], v8 offset:36864
    s_waitcnt lgkmcnt(5)
    v_mfma_f32_16x16x32_bf16 v[24:27], v[80:83], v[120:123], v[24:27]
    ds_read_b64_tr_b16 v[130:131], v8 offset:37888
    s_waitcnt lgkmcnt(3)
    v_mfma_f32_16x16x32_bf16 v[28:31], v[80:83], v[124:127], v[28:31]
    ds_read_b128 v[100:103], v6 offset:34816
    v_mfma_f32_16x16x32_bf16 v[32:35], v[84:87], v[112:115], v[32:35]
    ds_read_b64_tr_b16 v[132:133], v10 offset:36864
    v_mfma_f32_16x16x32_bf16 v[36:39], v[84:87], v[116:119], v[36:39]
    ds_read_b64_tr_b16 v[134:135], v10 offset:37888
    v_mfma_f32_16x16x32_bf16 v[40:43], v[84:87], v[120:123], v[40:43]
    ds_read_b128 v[104:107], v243 offset:32768
    v_mfma_f32_16x16x32_bf16 v[44:47], v[84:87], v[124:127], v[44:47]
    ds_read_b64_tr_b16 v[136:137], v12 offset:36864
    v_mfma_f32_16x16x32_bf16 v[48:51], v[88:91], v[112:115], v[48:51]
    ds_read_b64_tr_b16 v[138:139], v12 offset:37888
    v_mfma_f32_16x16x32_bf16 v[52:55], v[88:91], v[116:119], v[52:55]
    ds_read_b128 v[108:111], v243 offset:34816
    v_mfma_f32_16x16x32_bf16 v[56:59], v[88:91], v[120:123], v[56:59]
    ds_read_b64_tr_b16 v[140:141], v14 offset:36864
    v_mfma_f32_16x16x32_bf16 v[144:147], v[168:171], v[80:83], v[144:147]
    v_mfma_f32_16x16x32_bf16 v[60:63], v[88:91], v[124:127], v[60:63]
    ds_read_b64_tr_b16 v[142:143], v14 offset:37888
    v_mfma_f32_16x16x32_bf16 v[152:155], v[80:83], v[80:83], v[152:155]
    v_mfma_f32_16x16x32_bf16 v[64:67], v[92:95], v[112:115], v[64:67]
    v_mfma_f32_16x16x32_bf16 v[160:163], v[168:171], v[112:115], v[160:163]
    v_mfma_f32_16x16x32_bf16 v[68:71], v[92:95], v[116:119], v[68:71]
    v_mfma_f32_16x16x32_bf16 v[148:151], v[168:171], v[84:87], v[148:151]
    v_mfma_f32_16x16x32_bf16 v[72:75], v[92:95], v[120:123], v[72:75]
    v_mfma_f32_16x16x32_bf16 v[156:159], v[84:87], v[84:87], v[156:159]
    v_mfma_f32_16x16x32_bf16 v[76:79], v[92:95], v[124:127], v[76:79]
    v_mfma_f32_16x16x32_bf16 v[164:167], v[168:171], v[116:119], v[164:167]
    s_waitcnt vmcnt(16)
    s_waitcnt lgkmcnt(0)
    s_barrier
    v_mfma_f32_16x16x32_bf16 v[16:19], v[96:99], v[128:131], v[16:19]
    ds_read_b128 v[80:83], v3 offset:0
    v_mfma_f32_16x16x32_bf16 v[20:23], v[96:99], v[132:135], v[20:23]
    ds_read_b64_tr_b16 v[112:113], v7 offset:0
    s_lshl_b32 s60, s62, 7
    s_add_u32 s60, s60, s33
    s_mul_i32 s61, s62, 221184
    s_add_u32 s61, s61, s34
    s_add_u32 s62, s62, 1
    s_cmp_eq_u32 s62, 9
    s_cselect_b32 s62, 0, s62
    s_add_u32 m0, s32, 98304
    s_add_u32 s35, s60, 0
    buffer_load_dwordx4 v1, s[12:15], s35 offen lds
    v_mfma_f32_16x16x32_bf16 v[24:27], v[96:99], v[136:139], v[24:27]
    ds_read_b64_tr_b16 v[114:115], v7 offset:1024
    v_mfma_f32_16x16x32_bf16 v[28:31], v[96:99], v[140:143], v[28:31]
    ds_read_b128 v[84:87], v3 offset:2048
    s_add_u32 m0, s32, 114688
    s_add_u32 s35, s61, 0
    buffer_load_dwordx4 v2, s[16:19], s35 offen lds
    v_mfma_f32_16x16x32_bf16 v[32:35], v[100:103], v[128:131], v[32:35]
    ds_read_b64_tr_b16 v[116:117], v9 offset:0
    v_mfma_f32_16x16x32_bf16 v[36:39], v[100:103], v[132:135], v[36:39]
    ds_read_b64_tr_b16 v[118:119], v9 offset:1024
    s_add_u32 m0, s32, 102400
    s_add_u32 s35, s60, 36864
    buffer_load_dwordx4 v1, s[12:15], s35 offen lds
    v_mfma_f32_16x16x32_bf16 v[40:43], v[100:103], v[136:139], v[40:43]
    ds_read_b128 v[88:91], v240 offset:0
    v_mfma_f32_16x16x32_bf16 v[44:47], v[100:103], v[140:143], v[44:47]
    ds_read_b64_tr_b16 v[120:121], v11 offset:0
    s_add_u32 m0, s32, 118784
    s_add_u32 s35, s61, 110592
    buffer_load_dwordx4 v2, s[16:19], s35 offen lds
    v_mfma_f32_16x16x32_bf16 v[48:51], v[104:107], v[128:131], v[48:51]
    ds_read_b64_tr_b16 v[122:123], v11 offset:1024
    v_mfma_f32_16x16x32_bf16 v[52:55], v[104:107], v[132:135], v[52:55]
    ds_read_b128 v[92:95], v240 offset:2048
    s_add_u32 m0, s32, 106496
    s_add_u32 s35, s60, 73728
    buffer_load_dwordx4 v1, s[12:15], s35 offen lds
    v_mfma_f32_16x16x32_bf16 v[56:59], v[104:107], v[136:139], v[56:59]
    ds_read_b64_tr_b16 v[124:125], v13 offset:0
    v_mfma_f32_16x16x32_bf16 v[144:147], v[168:171], v[96:99], v[144:147]
    v_mfma_f32_16x16x32_bf16 v[60:63], v[104:107], v[140:143], v[60:63]
    ds_read_b64_tr_b16 v[126:127], v13 offset:1024
    v_mfma_f32_16x16x32_bf16 v[152:155], v[96:99], v[96:99], v[152:155]
    s_add_u32 m0, s32, 122880
    s_add_u32 s35, s61, 128
    buffer_load_dwordx4 v2, s[16:19], s35 offen lds
    v_mfma_f32_16x16x32_bf16 v[64:67], v[108:111], v[128:131], v[64:67]
    v_mfma_f32_16x16x32_bf16 v[160:163], v[168:171], v[128:131], v[160:163]
    v_mfma_f32_16x16x32_bf16 v[68:71], v[108:111], v[132:135], v[68:71]
    v_mfma_f32_16x16x32_bf16 v[148:151], v[168:171], v[100:103], v[148:151]
    s_add_u32 m0, s32, 110592
    s_add_u32 s35, s60, 110592
    buffer_load_dwordx4 v1, s[12:15], s35 offen lds
    v_mfma_f32_16x16x32_bf16 v[72:75], v[108:111], v[136:139], v[72:75]
    v_mfma_f32_16x16x32_bf16 v[156:159], v[100:103], v[100:103], v[156:159]
    v_mfma_f32_16x16x32_bf16 v[76:79], v[108:111], v[140:143], v[76:79]
    v_mfma_f32_16x16x32_bf16 v[164:167], v[168:171], v[132:135], v[164:167]
    s_add_u32 m0, s32, 126976
    s_add_u32 s35, s61, 110720
    buffer_load_dwordx4 v2, s[16:19], s35 offen lds
    s_waitcnt lgkmcnt(9)
    v_mfma_f32_16x16x32_bf16 v[16:19], v[80:83], v[112:115], v[16:19]
    ds_read_b128 v[96:99], v5 offset:0
    s_waitcnt lgkmcnt(7)
    v_mfma_f32_16x16x32_bf16 v[20:23], v[80:83], v[116:119], v[20:23]
    ds_read_b64_tr_b16 v[128:129], v7 offset:4096
    s_waitcnt lgkmcnt(5)
    v_mfma_f32_16x16x32_bf16 v[24:27], v[80:83], v[120:123], v[24:27]
    ds_read_b64_tr_b16 v[130:131], v7 offset:5120
    s_waitcnt lgkmcnt(3)
    v_mfma_f32_16x16x32_bf16 v[28:31], v[80:83], v[124:127], v[28:31]
    ds_read_b128 v[100:103], v5 offset:2048
    v_mfma_f32_16x16x32_bf16 v[32:35], v[84:87], v[112:115], v[32:35]
    ds_read_b64_tr_b16 v[132:133], v9 offset:4096
    v_mfma_f32_16x16x32_bf16 v[36:39], v[84:87], v[116:119], v[36:39]
    ds_read_b64_tr_b16 v[134:135], v9 offset:5120
    v_mfma_f32_16x16x32_bf16 v[40:43], v[84:87], v[120:123], v[40:43]
    ds_read_b128 v[104:107], v242 offset:0
    v_mfma_f32_16x16x32_bf16 v[44:47], v[84:87], v[124:127], v[44:47]
    ds_read_b64_tr_b16 v[136:137], v11 offset:4096
    v_mfma_f32_16x16x32_bf16 v[48:51], v[88:91], v[112:115], v[48:51]
    ds_read_b64_tr_b16 v[138:139], v11 offset:5120
    v_mfma_f32_16x16x32_bf16 v[52:55], v[88:91], v[116:119], v[52:55]
    ds_read_b128 v[108:111], v242 offset:2048
    v_mfma_f32_16x16x32_bf16 v[56:59], v[88:91], v[120:123], v[56:59]
    ds_read_b64_tr_b16 v[140:141], v13 offset:4096
    v_mfma_f32_16x16x32_bf16 v[144:147], v[168:171], v[80:83], v[144:147]
    v_mfma_f32_16x16x32_bf16 v[60:63], v[88:91], v[124:127], v[60:63]
    ds_read_b64_tr_b16 v[142:143], v13 offset:5120
    v_mfma_f32_16x16x32_bf16 v[152:155], v[80:83], v[80:83], v[152:155]
    v_mfma_f32_16x16x32_bf16 v[64:67], v[92:95], v[112:115], v[64:67]
    v_mfma_f32_16x16x32_bf16 v[160:163], v[168:171], v[112:115], v[160:163]
    v_mfma_f32_16x16x32_bf16 v[68:71], v[92:95], v[116:119], v[68:71]
    v_mfma_f32_16x16x32_bf16 v[148:151], v[168:171], v[84:87], v[148:151]
    v_mfma_f32_16x16x32_bf16 v[72:75], v[92:95], v[120:123], v[72:75]
    v_mfma_f32_16x16x32_bf16 v[156:159], v[84:87], v[84:87], v[156:159]
    v_mfma_f32_16x16x32_bf16 v[76:79], v[92:95], v[124:127], v[76:79]
    v_mfma_f32_16x16x32_bf16 v[164:167], v[168:171], v[116:119], v[164:167]
    s_waitcnt vmcnt(16)
    s_waitcnt lgkmcnt(0)
    s_barrier
    v_mfma_f32_16x16x32_bf16 v[16:19], v[96:99], v[128:131], v[16:19]
    ds_read_b128 v[80:83], v3 offset:32768
    v_mfma_f32_16x16x32_bf16 v[20:23], v[96:99], v[132:135], v[20:23]
    ds_read_b64_tr_b16 v[112:113], v7 offset:32768
    s_lshl_b32 s60, s62, 7
    s_add_u32 s60, s60, s33
    s_mul_i32 s61, s62, 221184
    s_add_u32 s61, s61, s34
    s_add_u32 s62, s62, 1
    s_cmp_eq_u32 s62, 9
    s_cselect_b32 s62, 0, s62
    s_add_u32 m0, s32, 0
    s_add_u32 s35, s60, 0
    buffer_load_dwordx4 v1, s[12:15], s35 offen lds
    v_mfma_f32_16x16x32_bf16 v[24:27], v[96:99], v[136:139], v[24:27]
    ds_read_b64_tr_b16 v[114:115], v7 offset:33792
    v_mfma_f32_16x16x32_bf16 v[28:31], v[96:99], v[140:143], v[28:31]
    ds_read_b128 v[84:87], v3 offset:34816
    s_add_u32 m0, s32, 16384
    s_add_u32 s35, s61, 0
    buffer_load_dwordx4 v2, s[16:19], s35 offen lds
    v_mfma_f32_16x16x32_bf16 v[32:35], v[100:103], v[128:131], v[32:35]
    ds_read_b64_tr_b16 v[116:117], v9 offset:32768
    v_mfma_f32_16x16x32_bf16 v[36:39], v[100:103], v[132:135], v[36:39]
    ds_read_b64_tr_b16 v[118:119], v9 offset:33792
    s_add_u32 m0, s32, 4096
    s_add_u32 s35, s60, 36864
    buffer_load_dwordx4 v1, s[12:15], s35 offen lds
    v_mfma_f32_16x16x32_bf16 v[40:43], v[100:103], v[136:139], v[40:43]
    ds_read_b128 v[88:91], v240 offset:32768
    v_mfma_f32_16x16x32_bf16 v[44:47], v[100:103], v[140:143], v[44:47]
    ds_read_b64_tr_b16 v[120:121], v11 offset:32768
    s_add_u32 m0, s32, 20480
    s_add_u32 s35, s61, 110592
    buffer_load_dwordx4 v2, s[16:19], s35 offen lds
    v_mfma_f32_16x16x32_bf16 v[48:51], v[104:107], v[128:131], v[48:51]
    ds_read_b64_tr_b16 v[122:123], v11 offset:33792
    v_mfma_f32_16x16x32_bf16 v[52:55], v[104:107], v[132:135], v[52:55]
    ds_read_b128 v[92:95], v240 offset:34816
    s_add_u32 m0, s32, 8192
    s_add_u32 s35, s60, 73728
    buffer_load_dwordx4 v1, s[12:15], s35 offen lds
    v_mfma_f32_16x16x32_bf16 v[56:59], v[104:107], v[136:139], v[56:59]
    ds_read_b64_tr_b16 v[124:125], v13 offset:32768
    v_mfma_f32_16x16x32_bf16 v[144:147], v[168:171], v[96:99], v[144:147]
    v_mfma_f32_16x16x32_bf16 v[60:63], v[104:107], v[140:143], v[60:63]
    ds_read_b64_tr_b16 v[126:127], v13 offset:33792
    v_mfma_f32_16x16x32_bf16 v[152:155], v[96:99], v[96:99], v[152:155]
    s_add_u32 m0, s32, 24576
    s_add_u32 s35, s61, 128
    buffer_load_dwordx4 v2, s[16:19], s35 offen lds
    v_mfma_f32_16x16x32_bf16 v[64:67], v[108:111], v[128:131], v[64:67]
    v_mfma_f32_16x16x32_bf16 v[160:163], v[168:171], v[128:131], v[160:163]
    v_mfma_f32_16x16x32_bf16 v[68:71], v[108:111], v[132:135], v[68:71]
    v_mfma_f32_16x16x32_bf16 v[148:151], v[168:171], v[100:103], v[148:151]
    s_add_u32 m0, s32, 12288
    s_add_u32 s35, s60, 110592
    buffer_load_dwordx4 v1, s[12:15], s35 offen lds
    v_mfma_f32_16x16x32_bf16 v[72:75], v[108:111], v[136:139], v[72:75]
    v_mfma_f32_16x16x32_bf16 v[156:159], v[100:103], v[100:103], v[156:159]
    v_mfma_f32_16x16x32_bf16 v[76:79], v[108:111], v[140:143], v[76:79]
    v_mfma_f32_16x16x32_bf16 v[164:167], v[168:171], v[132:135], v[164:167]
    s_add_u32 m0, s32, 28672
    s_add_u32 s35, s61, 110720
    buffer_load_dwordx4 v2, s[16:19], s35 offen lds
    s_waitcnt lgkmcnt(9)
    v_mfma_f32_16x16x32_bf16 v[16:19], v[80:83], v[112:115], v[16:19]
    ds_read_b128 v[96:99], v5 offset:32768
    s_waitcnt lgkmcnt(7)
    v_mfma_f32_16x16x32_bf16 v[20:23], v[80:83], v[116:119], v[20:23]
    ds_read_b64_tr_b16 v[128:129], v7 offset:36864
    s_waitcnt lgkmcnt(5)
    v_mfma_f32_16x16x32_bf16 v[24:27], v[80:83], v[120:123], v[24:27]
    ds_read_b64_tr_b16 v[130:131], v7 offset:37888
    s_waitcnt lgkmcnt(3)
    v_mfma_f32_16x16x32_bf16 v[28:31], v[80:83], v[124:127], v[28:31]
    ds_read_b128 v[100:103], v5 offset:34816
    v_mfma_f32_16x16x32_bf16 v[32:35], v[84:87], v[112:115], v[32:35]
    ds_read_b64_tr_b16 v[132:133], v9 offset:36864
    v_mfma_f32_16x16x32_bf16 v[36:39], v[84:87], v[116:119], v[36:39]
    ds_read_b64_tr_b16 v[134:135], v9 offset:37888
    v_mfma_f32_16x16x32_bf16 v[40:43], v[84:87], v[120:123], v[40:43]
    ds_read_b128 v[104:107], v242 offset:32768
    v_mfma_f32_16x16x32_bf16 v[44:47], v[84:87], v[124:127], v[44:47]
    ds_read_b64_tr_b16 v[136:137], v11 offset:36864
    v_mfma_f32_16x16x32_bf16 v[48:51], v[88:91], v[112:115], v[48:51]
    ds_read_b64_tr_b16 v[138:139], v11 offset:37888
    v_mfma_f32_16x16x32_bf16 v[52:55], v[88:91], v[116:119], v[52:55]
    ds_read_b128 v[108:111], v242 offset:34816
    v_mfma_f32_16x16x32_bf16 v[56:59], v[88:91], v[120:123], v[56:59]
    ds_read_b64_tr_b16 v[140:141], v13 offset:36864
    v_mfma_f32_16x16x32_bf16 v[144:147], v[168:171], v[80:83], v[144:147]
    v_mfma_f32_16x16x32_bf16 v[60:63], v[88:91], v[124:127], v[60:63]
    ds_read_b64_tr_b16 v[142:143], v13 offset:37888
    v_mfma_f32_16x16x32_bf16 v[152:155], v[80:83], v[80:83], v[152:155]
    v_mfma_f32_16x16x32_bf16 v[64:67], v[92:95], v[112:115], v[64:67]
    v_mfma_f32_16x16x32_bf16 v[160:163], v[168:171], v[112:115], v[160:163]
    v_mfma_f32_16x16x32_bf16 v[68:71], v[92:95], v[116:119], v[68:71]
    v_mfma_f32_16x16x32_bf16 v[148:151], v[168:171], v[84:87], v[148:151]
    v_mfma_f32_16x16x32_bf16 v[72:75], v[92:95], v[120:123], v[72:75]
    v_mfma_f32_16x16x32_bf16 v[156:159], v[84:87], v[84:87], v[156:159]
    v_mfma_f32_16x16x32_bf16 v[76:79], v[92:95], v[124:127], v[76:79]
    v_mfma_f32_16x16x32_bf16 v[164:167], v[168:171], v[116:119], v[164:167]
    s_waitcnt vmcnt(16)
    s_waitcnt lgkmcnt(0)
    s_barrier
    v_mfma_f32_16x16x32_bf16 v[16:19], v[96:99], v[128:131], v[16:19]
    ds_read_b128 v[80:83], v4 offset:0
    v_mfma_f32_16x16x32_bf16 v[20:23], v[96:99], v[132:135], v[20:23]
    ds_read_b64_tr_b16 v[112:113], v8 offset:0
    v_mfma_f32_16x16x32_bf16 v[24:27], v[96:99], v[136:139], v[24:27]
    ds_read_b64_tr_b16 v[114:115], v8 offset:1024
    v_mfma_f32_16x16x32_bf16 v[28:31], v[96:99], v[140:143], v[28:31]
    ds_read_b128 v[84:87], v4 offset:2048
    v_mfma_f32_16x16x32_bf16 v[32:35], v[100:103], v[128:131], v[32:35]
    ds_read_b64_tr_b16 v[116:117], v10 offset:0
    v_mfma_f32_16x16x32_bf16 v[36:39], v[100:103], v[132:135], v[36:39]
    ds_read_b64_tr_b16 v[118:119], v10 offset:1024
    v_mfma_f32_16x16x32_bf16 v[40:43], v[100:103], v[136:139], v[40:43]
    ds_read_b128 v[88:91], v241 offset:0
    v_mfma_f32_16x16x32_bf16 v[44:47], v[100:103], v[140:143], v[44:47]
    ds_read_b64_tr_b16 v[120:121], v12 offset:0
    v_mfma_f32_16x16x32_bf16 v[48:51], v[104:107], v[128:131], v[48:51]
    ds_read_b64_tr_b16 v[122:123], v12 offset:1024
    v_mfma_f32_16x16x32_bf16 v[52:55], v[104:107], v[132:135], v[52:55]
    ds_read_b128 v[92:95], v241 offset:2048
    v_mfma_f32_16x16x32_bf16 v[56:59], v[104:107], v[136:139], v[56:59]
    ds_read_b64_tr_b16 v[124:125], v14 offset:0
    v_mfma_f32_16x16x32_bf16 v[144:147], v[168:171], v[96:99], v[144:147]
    v_mfma_f32_16x16x32_bf16 v[60:63], v[104:107], v[140:143], v[60:63]
    ds_read_b64_tr_b16 v[126:127], v14 offset:1024
    v_mfma_f32_16x16x32_bf16 v[152:155], v[96:99], v[96:99], v[152:155]
    v_mfma_f32_16x16x32_bf16 v[64:67], v[108:111], v[128:131], v[64:67]
    v_mfma_f32_16x16x32_bf16 v[160:163], v[168:171], v[128:131], v[160:163]
    v_mfma_f32_16x16x32_bf16 v[68:71], v[108:111], v[132:135], v[68:71]
    v_mfma_f32_16x16x32_bf16 v[148:151], v[168:171], v[100:103], v[148:151]
    v_mfma_f32_16x16x32_bf16 v[72:75], v[108:111], v[136:139], v[72:75]
    v_mfma_f32_16x16x32_bf16 v[156:159], v[100:103], v[100:103], v[156:159]
    v_mfma_f32_16x16x32_bf16 v[76:79], v[108:111], v[140:143], v[76:79]
    v_mfma_f32_16x16x32_bf16 v[164:167], v[168:171], v[132:135], v[164:167]
    s_waitcnt lgkmcnt(9)
    v_mfma_f32_16x16x32_bf16 v[16:19], v[80:83], v[112:115], v[16:19]
    ds_read_b128 v[96:99], v6 offset:0
    s_waitcnt lgkmcnt(7)
    v_mfma_f32_16x16x32_bf16 v[20:23], v[80:83], v[116:119], v[20:23]
    ds_read_b64_tr_b16 v[128:129], v8 offset:4096
    s_waitcnt lgkmcnt(5)
    v_mfma_f32_16x16x32_bf16 v[24:27], v[80:83], v[120:123], v[24:27]
    ds_read_b64_tr_b16 v[130:131], v8 offset:5120
    s_waitcnt lgkmcnt(3)
    v_mfma_f32_16x16x32_bf16 v[28:31], v[80:83], v[124:127], v[28:31]
    ds_read_b128 v[100:103], v6 offset:2048
    v_mfma_f32_16x16x32_bf16 v[32:35], v[84:87], v[112:115], v[32:35]
    ds_read_b64_tr_b16 v[132:133], v10 offset:4096
    v_mfma_f32_16x16x32_bf16 v[36:39], v[84:87], v[116:119], v[36:39]
    ds_read_b64_tr_b16 v[134:135], v10 offset:5120
    v_mfma_f32_16x16x32_bf16 v[40:43], v[84:87], v[120:123], v[40:43]
    ds_read_b128 v[104:107], v243 offset:0
    v_mfma_f32_16x16x32_bf16 v[44:47], v[84:87], v[124:127], v[44:47]
    ds_read_b64_tr_b16 v[136:137], v12 offset:4096
    v_mfma_f32_16x16x32_bf16 v[48:51], v[88:91], v[112:115], v[48:51]
    ds_read_b64_tr_b16 v[138:139], v12 offset:5120
    v_mfma_f32_16x16x32_bf16 v[52:55], v[88:91], v[116:119], v[52:55]
    ds_read_b128 v[108:111], v243 offset:2048
    v_mfma_f32_16x16x32_bf16 v[56:59], v[88:91], v[120:123], v[56:59]
    ds_read_b64_tr_b16 v[140:141], v14 offset:4096
    v_mfma_f32_16x16x32_bf16 v[144:147], v[168:171], v[80:83], v[144:147]
    v_mfma_f32_16x16x32_bf16 v[60:63], v[88:91], v[124:127], v[60:63]
    ds_read_b64_tr_b16 v[142:143], v14 offset:5120
    v_mfma_f32_16x16x32_bf16 v[152:155], v[80:83], v[80:83], v[152:155]
    v_mfma_f32_16x16x32_bf16 v[64:67], v[92:95], v[112:115], v[64:67]
    v_mfma_f32_16x16x32_bf16 v[160:163], v[168:171], v[112:115], v[160:163]
    v_mfma_f32_16x16x32_bf16 v[68:71], v[92:95], v[116:119], v[68:71]
    v_mfma_f32_16x16x32_bf16 v[148:151], v[168:171], v[84:87], v[148:151]
    v_mfma_f32_16x16x32_bf16 v[72:75], v[92:95], v[120:123], v[72:75]
    v_mfma_f32_16x16x32_bf16 v[156:159], v[84:87], v[84:87], v[156:159]
    v_mfma_f32_16x16x32_bf16 v[76:79], v[92:95], v[124:127], v[76:79]
    v_mfma_f32_16x16x32_bf16 v[164:167], v[168:171], v[116:119], v[164:167]
    s_waitcnt vmcnt(8)
    s_waitcnt lgkmcnt(0)
    s_barrier
    v_mfma_f32_16x16x32_bf16 v[16:19], v[96:99], v[128:131], v[16:19]
    ds_read_b128 v[80:83], v4 offset:32768
    v_mfma_f32_16x16x32_bf16 v[20:23], v[96:99], v[132:135], v[20:23]
    ds_read_b64_tr_b16 v[112:113], v8 offset:32768
    v_mfma_f32_16x16x32_bf16 v[24:27], v[96:99], v[136:139], v[24:27]
    ds_read_b64_tr_b16 v[114:115], v8 offset:33792
    v_mfma_f32_16x16x32_bf16 v[28:31], v[96:99], v[140:143], v[28:31]
    ds_read_b128 v[84:87], v4 offset:34816
    v_mfma_f32_16x16x32_bf16 v[32:35], v[100:103], v[128:131], v[32:35]
    ds_read_b64_tr_b16 v[116:117], v10 offset:32768
    v_mfma_f32_16x16x32_bf16 v[36:39], v[100:103], v[132:135], v[36:39]
    ds_read_b64_tr_b16 v[118:119], v10 offset:33792
    v_mfma_f32_16x16x32_bf16 v[40:43], v[100:103], v[136:139], v[40:43]
    ds_read_b128 v[88:91], v241 offset:32768
    v_mfma_f32_16x16x32_bf16 v[44:47], v[100:103], v[140:143], v[44:47]
    ds_read_b64_tr_b16 v[120:121], v12 offset:32768
    v_mfma_f32_16x16x32_bf16 v[48:51], v[104:107], v[128:131], v[48:51]
    ds_read_b64_tr_b16 v[122:123], v12 offset:33792
    v_mfma_f32_16x16x32_bf16 v[52:55], v[104:107], v[132:135], v[52:55]
    ds_read_b128 v[92:95], v241 offset:34816
    v_mfma_f32_16x16x32_bf16 v[56:59], v[104:107], v[136:139], v[56:59]
    ds_read_b64_tr_b16 v[124:125], v14 offset:32768
    v_mfma_f32_16x16x32_bf16 v[144:147], v[168:171], v[96:99], v[144:147]
    v_mfma_f32_16x16x32_bf16 v[60:63], v[104:107], v[140:143], v[60:63]
    ds_read_b64_tr_b16 v[126:127], v14 offset:33792
    v_mfma_f32_16x16x32_bf16 v[152:155], v[96:99], v[96:99], v[152:155]
    v_mfma_f32_16x16x32_bf16 v[64:67], v[108:111], v[128:131], v[64:67]
    v_mfma_f32_16x16x32_bf16 v[160:163], v[168:171], v[128:131], v[160:163]
    v_mfma_f32_16x16x32_bf16 v[68:71], v[108:111], v[132:135], v[68:71]
    v_mfma_f32_16x16x32_bf16 v[148:151], v[168:171], v[100:103], v[148:151]
    v_mfma_f32_16x16x32_bf16 v[72:75], v[108:111], v[136:139], v[72:75]
    v_mfma_f32_16x16x32_bf16 v[156:159], v[100:103], v[100:103], v[156:159]
    v_mfma_f32_16x16x32_bf16 v[76:79], v[108:111], v[140:143], v[76:79]
    v_mfma_f32_16x16x32_bf16 v[164:167], v[168:171], v[132:135], v[164:167]
    s_waitcnt lgkmcnt(9)
    v_mfma_f32_16x16x32_bf16 v[16:19], v[80:83], v[112:115], v[16:19]
    ds_read_b128 v[96:99], v6 offset:32768
    s_waitcnt lgkmcnt(7)
    v_mfma_f32_16x16x32_bf16 v[20:23], v[80:83], v[116:119], v[20:23]
    ds_read_b64_tr_b16 v[128:129], v8 offset:36864
    s_waitcnt lgkmcnt(5)
    v_mfma_f32_16x16x32_bf16 v[24:27], v[80:83], v[120:123], v[24:27]
    ds_read_b64_tr_b16 v[130:131], v8 offset:37888
    s_waitcnt lgkmcnt(3)
    v_mfma_f32_16x16x32_bf16 v[28:31], v[80:83], v[124:127], v[28:31]
    ds_read_b128 v[100:103], v6 offset:34816
    v_mfma_f32_16x16x32_bf16 v[32:35], v[84:87], v[112:115], v[32:35]
    ds_read_b64_tr_b16 v[132:133], v10 offset:36864
    v_mfma_f32_16x16x32_bf16 v[36:39], v[84:87], v[116:119], v[36:39]
    ds_read_b64_tr_b16 v[134:135], v10 offset:37888
    v_mfma_f32_16x16x32_bf16 v[40:43], v[84:87], v[120:123], v[40:43]
    ds_read_b128 v[104:107], v243 offset:32768
    v_mfma_f32_16x16x32_bf16 v[44:47], v[84:87], v[124:127], v[44:47]
    ds_read_b64_tr_b16 v[136:137], v12 offset:36864
    v_mfma_f32_16x16x32_bf16 v[48:51], v[88:91], v[112:115], v[48:51]
    ds_read_b64_tr_b16 v[138:139], v12 offset:37888
    v_mfma_f32_16x16x32_bf16 v[52:55], v[88:91], v[116:119], v[52:55]
    ds_read_b128 v[108:111], v243 offset:34816
    v_mfma_f32_16x16x32_bf16 v[56:59], v[88:91], v[120:123], v[56:59]
    ds_read_b64_tr_b16 v[140:141], v14 offset:36864
    v_mfma_f32_16x16x32_bf16 v[144:147], v[168:171], v[80:83], v[144:147]
    v_mfma_f32_16x16x32_bf16 v[60:63], v[88:91], v[124:127], v[60:63]
    ds_read_b64_tr_b16 v[142:143], v14 offset:37888
    v_mfma_f32_16x16x32_bf16 v[152:155], v[80:83], v[80:83], v[152:155]
    v_mfma_f32_16x16x32_bf16 v[64:67], v[92:95], v[112:115], v[64:67]
    v_mfma_f32_16x16x32_bf16 v[160:163], v[168:171], v[112:115], v[160:163]
    v_mfma_f32_16x16x32_bf16 v[68:71], v[92:95], v[116:119], v[68:71]
    v_mfma_f32_16x16x32_bf16 v[148:151], v[168:171], v[84:87], v[148:151]
    v_mfma_f32_16x16x32_bf16 v[72:75], v[92:95], v[120:123], v[72:75]
    v_mfma_f32_16x16x32_bf16 v[156:159], v[84:87], v[84:87], v[156:159]
    v_mfma_f32_16x16x32_bf16 v[76:79], v[92:95], v[124:127], v[76:79]
    v_mfma_f32_16x16x32_bf16 v[164:167], v[168:171], v[116:119], v[164:167]
    s_waitcnt vmcnt(0)
    s_waitcnt lgkmcnt(0)
    s_barrier
    v_mfma_f32_16x16x32_bf16 v[16:19], v[96:99], v[128:131], v[16:19]
    ds_read_b128 v[80:83], v3 offset:0
    v_mfma_f32_16x16x32_bf16 v[20:23], v[96:99], v[132:135], v[20:23]
    ds_read_b64_tr_b16 v[112:113], v7 offset:0
    v_mfma_f32_16x16x32_bf16 v[24:27], v[96:99], v[136:139], v[24:27]
    ds_read_b64_tr_b16 v[114:115], v7 offset:1024
    v_mfma_f32_16x16x32_bf16 v[28:31], v[96:99], v[140:143], v[28:31]
    ds_read_b128 v[84:87], v3 offset:2048
    v_mfma_f32_16x16x32_bf16 v[32:35], v[100:103], v[128:131], v[32:35]
    ds_read_b64_tr_b16 v[116:117], v9 offset:0
    v_mfma_f32_16x16x32_bf16 v[36:39], v[100:103], v[132:135], v[36:39]
    ds_read_b64_tr_b16 v[118:119], v9 offset:1024
    v_mfma_f32_16x16x32_bf16 v[40:43], v[100:103], v[136:139], v[40:43]
    ds_read_b128 v[88:91], v240 offset:0
    v_mfma_f32_16x16x32_bf16 v[44:47], v[100:103], v[140:143], v[44:47]
    ds_read_b64_tr_b16 v[120:121], v11 offset:0
    v_mfma_f32_16x16x32_bf16 v[48:51], v[104:107], v[128:131], v[48:51]
    ds_read_b64_tr_b16 v[122:123], v11 offset:1024
    v_mfma_f32_16x16x32_bf16 v[52:55], v[104:107], v[132:135], v[52:55]
    ds_read_b128 v[92:95], v240 offset:2048
    v_mfma_f32_16x16x32_bf16 v[56:59], v[104:107], v[136:139], v[56:59]
    ds_read_b64_tr_b16 v[124:125], v13 offset:0
    v_mfma_f32_16x16x32_bf16 v[144:147], v[168:171], v[96:99], v[144:147]
    v_mfma_f32_16x16x32_bf16 v[60:63], v[104:107], v[140:143], v[60:63]
    ds_read_b64_tr_b16 v[126:127], v13 offset:1024
    v_mfma_f32_16x16x32_bf16 v[152:155], v[96:99], v[96:99], v[152:155]
    v_mfma_f32_16x16x32_bf16 v[64:67], v[108:111], v[128:131], v[64:67]
    v_mfma_f32_16x16x32_bf16 v[160:163], v[168:171], v[128:131], v[160:163]
    v_mfma_f32_16x16x32_bf16 v[68:71], v[108:111], v[132:135], v[68:71]
    v_mfma_f32_16x16x32_bf16 v[148:151], v[168:171], v[100:103], v[148:151]
    v_mfma_f32_16x16x32_bf16 v[72:75], v[108:111], v[136:139], v[72:75]
    v_mfma_f32_16x16x32_bf16 v[156:159], v[100:103], v[100:103], v[156:159]
    v_mfma_f32_16x16x32_bf16 v[76:79], v[108:111], v[140:143], v[76:79]
    v_mfma_f32_16x16x32_bf16 v[164:167], v[168:171], v[132:135], v[164:167]
    s_waitcnt lgkmcnt(9)
    v_mfma_f32_16x16x32_bf16 v[16:19], v[80:83], v[112:115], v[16:19]
    ds_read_b128 v[96:99], v5 offset:0
    s_waitcnt lgkmcnt(7)
    v_mfma_f32_16x16x32_bf16 v[20:23], v[80:83], v[116:119], v[20:23]
    ds_read_b64_tr_b16 v[128:129], v7 offset:4096
    s_waitcnt lgkmcnt(5)
    v_mfma_f32_16x16x32_bf16 v[24:27], v[80:83], v[120:123], v[24:27]
    ds_read_b64_tr_b16 v[130:131], v7 offset:5120
    s_waitcnt lgkmcnt(3)
    v_mfma_f32_16x16x32_bf16 v[28:31], v[80:83], v[124:127], v[28:31]
    ds_read_b128 v[100:103], v5 offset:2048
    v_mfma_f32_16x16x32_bf16 v[32:35], v[84:87], v[112:115], v[32:35]
    ds_read_b64_tr_b16 v[132:133], v9 offset:4096
    v_mfma_f32_16x16x32_bf16 v[36:39], v[84:87], v[116:119], v[36:39]
    ds_read_b64_tr_b16 v[134:135], v9 offset:5120
    v_mfma_f32_16x16x32_bf16 v[40:43], v[84:87], v[120:123], v[40:43]
    ds_read_b128 v[104:107], v242 offset:0
    v_mfma_f32_16x16x32_bf16 v[44:47], v[84:87], v[124:127], v[44:47]
    ds_read_b64_tr_b16 v[136:137], v11 offset:4096
    v_mfma_f32_16x16x32_bf16 v[48:51], v[88:91], v[112:115], v[48:51]
    ds_read_b64_tr_b16 v[138:139], v11 offset:5120
    v_mfma_f32_16x16x32_bf16 v[52:55], v[88:91], v[116:119], v[52:55]
    ds_read_b128 v[108:111], v242 offset:2048
    v_mfma_f32_16x16x32_bf16 v[56:59], v[88:91], v[120:123], v[56:59]
    ds_read_b64_tr_b16 v[140:141], v13 offset:4096
    v_mfma_f32_16x16x32_bf16 v[144:147], v[168:171], v[80:83], v[144:147]
    v_mfma_f32_16x16x32_bf16 v[60:63], v[88:91], v[124:127], v[60:63]
    ds_read_b64_tr_b16 v[142:143], v13 offset:5120
    v_mfma_f32_16x16x32_bf16 v[152:155], v[80:83], v[80:83], v[152:155]
    v_mfma_f32_16x16x32_bf16 v[64:67], v[92:95], v[112:115], v[64:67]
    v_mfma_f32_16x16x32_bf16 v[160:163], v[168:171], v[112:115], v[160:163]
    v_mfma_f32_16x16x32_bf16 v[68:71], v[92:95], v[116:119], v[68:71]
    v_mfma_f32_16x16x32_bf16 v[148:151], v[168:171], v[84:87], v[148:151]
    v_mfma_f32_16x16x32_bf16 v[72:75], v[92:95], v[120:123], v[72:75]
    v_mfma_f32_16x16x32_bf16 v[156:159], v[84:87], v[84:87], v[156:159]
    v_mfma_f32_16x16x32_bf16 v[76:79], v[92:95], v[124:127], v[76:79]
    v_mfma_f32_16x16x32_bf16 v[164:167], v[168:171], v[116:119], v[164:167]
    s_waitcnt lgkmcnt(9)
    v_mfma_f32_16x16x32_bf16 v[16:19], v[96:99], v[128:131], v[16:19]
    s_waitcnt lgkmcnt(6)
    v_mfma_f32_16x16x32_bf16 v[20:23], v[96:99], v[132:135], v[20:23]
    s_waitcnt lgkmcnt(3)
    v_mfma_f32_16x16x32_bf16 v[24:27], v[96:99], v[136:139], v[24:27]
    s_waitcnt lgkmcnt(0)
    v_mfma_f32_16x16x32_bf16 v[28:31], v[96:99], v[140:143], v[28:31]
    v_mfma_f32_16x16x32_bf16 v[32:35], v[100:103], v[128:131], v[32:35]
    v_mfma_f32_16x16x32_bf16 v[36:39], v[100:103], v[132:135], v[36:39]
    v_mfma_f32_16x16x32_bf16 v[40:43], v[100:103], v[136:139], v[40:43]
    v_mfma_f32_16x16x32_bf16 v[44:47], v[100:103], v[140:143], v[44:47]
    v_mfma_f32_16x16x32_bf16 v[48:51], v[104:107], v[128:131], v[48:51]
    v_mfma_f32_16x16x32_bf16 v[52:55], v[104:107], v[132:135], v[52:55]
    v_mfma_f32_16x16x32_bf16 v[56:59], v[104:107], v[136:139], v[56:59]
    v_mfma_f32_16x16x32_bf16 v[144:147], v[168:171], v[96:99], v[144:147]
    v_mfma_f32_16x16x32_bf16 v[60:63], v[104:107], v[140:143], v[60:63]
    v_mfma_f32_16x16x32_bf16 v[152:155], v[96:99], v[96:99], v[152:155]
    v_mfma_f32_16x16x32_bf16 v[64:67], v[108:111], v[128:131], v[64:67]
    v_mfma_f32_16x16x32_bf16 v[160:163], v[168:171], v[128:131], v[160:163]
    v_mfma_f32_16x16x32_bf16 v[68:71], v[108:111], v[132:135], v[68:71]
    v_mfma_f32_16x16x32_bf16 v[148:151], v[168:171], v[100:103], v[148:151]
    v_mfma_f32_16x16x32_bf16 v[72:75], v[108:111], v[136:139], v[72:75]
    v_mfma_f32_16x16x32_bf16 v[156:159], v[100:103], v[100:103], v[156:159]
    v_mfma_f32_16x16x32_bf16 v[76:79], v[108:111], v[140:143], v[76:79]
    v_mfma_f32_16x16x32_bf16 v[164:167], v[168:171], v[132:135], v[164:167]
    v_cndmask_b32 v152, v152, v153, s[52:53]
    s_nop 4
    v_cndmask_b32 v156, v156, v157, s[52:53]
    v_cndmask_b32 v152, v152, v154, s[54:55]
    v_cndmask_b32 v156, v156, v158, s[54:55]
    v_cndmask_b32 v152, v152, v155, s[56:57]
    v_cndmask_b32 v156, v156, v159, s[56:57]
    v_mul_f32 v144, 0x3ae38e39, v144
    v_mul_f32 v148, 0x3ae38e39, v148
    v_mov_b32 v145, v144
    v_mov_b32 v149, v148
    v_mul_f32 v152, 0x3ae38e39, v152
    v_mul_f32 v156, 0x3ae38e39, v156
    v_fma_f32 v152, -v144, v144, v152
    v_fma_f32 v156, -v148, v148, v156
    v_max_f32 v152, 0, v152
    v_max_f32 v156, 0, v156
    v_cvt_pk_bf16_f32 v144, v144, v144
    v_cvt_pk_bf16_f32 v148, v148, v148
    v_lshlrev_b32 v144, 16, v144
    v_lshlrev_b32 v148, 16, v148
    v_cvt_pk_bf16_f32 v152, v152, v152
    v_cvt_pk_bf16_f32 v156, v156, v156
    v_lshlrev_b32 v152, 16, v152
    v_lshlrev_b32 v156, 16, v156
    v_add_f32 v152, 0x3727c5ac, v152
    v_add_f32 v156, 0x3727c5ac, v156
    v_cvt_pk_bf16_f32 v152, v152, v152
    v_cvt_pk_bf16_f32 v156, v156, v156
    v_lshlrev_b32 v152, 16, v152
    v_lshlrev_b32 v156, 16, v156
    v_sqrt_f32 v152, v152
    v_sqrt_f32 v156, v156
    v_cvt_pk_bf16_f32 v152, v152, v152
    v_cvt_pk_bf16_f32 v156, v156, v156
    v_lshlrev_b32 v152, 16, v152
    v_lshlrev_b32 v156, 16, v156
    v_rcp_f32 v152, v152
    v_rcp_f32 v156, v156
    v_sub_f32 v144, 0, v144
    v_sub_f32 v148, 0, v148
    s_mov_b64 exec, s[58:59]
    ds_write_b32 v172, v144
    ds_write_b32 v172, v148 offset:64
    ds_write_b32 v172, v152 offset:512
    ds_write_b32 v172, v156 offset:576
    ds_write_b32 v173, v160
    ds_write_b32 v173, v164 offset:64
    s_mov_b64 exec, -1
    s_waitcnt lgkmcnt(0)
    s_barrier
    s_cmp_ge_u32 s31, 27
    s_cbranch_scc1 L_sequential_preLN__sliding_block__glu_gated_glu__prompt_kernel_x
    ds_read_b128 v[180:183], v174 offset:0
    ds_read_b128 v[196:199], v174 offset:512
    ds_read_b128 v[184:187], v174 offset:64
    ds_read_b128 v[200:203], v174 offset:576
    ds_read_b128 v[188:191], v175 offset:0
    ds_read_b128 v[204:207], v175 offset:512
    ds_read_b128 v[192:195], v175 offset:64
    ds_read_b128 v[208:211], v175 offset:576
    ds_read_b32 v212, v176 offset:0
    ds_read_b32 v213, v176 offset:64
    ds_read_b32 v214, v177 offset:0
    ds_read_b32 v215, v177 offset:64
    s_waitcnt lgkmcnt(3)
    v_fma_f32 v16, v212, v180, v16
    v_fma_f32 v17, v212, v181, v17
    v_fma_f32 v18, v212, v182, v18
    v_fma_f32 v19, v212, v183, v19
    v_mul_f32 v16, v16, v196
    v_mul_f32 v17, v17, v197
    v_mul_f32 v18, v18, v198
    v_mul_f32 v19, v19, v199
    v_cvt_pk_bf16_f32 v112, v16, v17
    v_cvt_pk_bf16_f32 v113, v18, v19
    v_fma_f32 v32, v212, v184, v32
    v_fma_f32 v33, v212, v185, v33
    v_fma_f32 v34, v212, v186, v34
    v_fma_f32 v35, v212, v187, v35
    v_mul_f32 v32, v32, v200
    v_mul_f32 v33, v33, v201
    v_mul_f32 v34, v34, v202
    v_mul_f32 v35, v35, v203
    v_cvt_pk_bf16_f32 v114, v32, v33
    v_cvt_pk_bf16_f32 v115, v34, v35
    buffer_store_dwordx4 v[112:115], v228, s[20:23], 0 offen
    v_fma_f32 v48, v212, v188, v48
    v_fma_f32 v49, v212, v189, v49
    v_fma_f32 v50, v212, v190, v50
    v_fma_f32 v51, v212, v191, v51
    v_mul_f32 v48, v48, v204
    v_mul_f32 v49, v49, v205
    v_mul_f32 v50, v50, v206
    v_mul_f32 v51, v51, v207
    v_cvt_pk_bf16_f32 v116, v48, v49
    v_cvt_pk_bf16_f32 v117, v50, v51
    v_fma_f32 v64, v212, v192, v64
    v_fma_f32 v65, v212, v193, v65
    v_fma_f32 v66, v212, v194, v66
    v_fma_f32 v67, v212, v195, v67
    v_mul_f32 v64, v64, v208
    v_mul_f32 v65, v65, v209
    v_mul_f32 v66, v66, v210
    v_mul_f32 v67, v67, v211
    v_cvt_pk_bf16_f32 v118, v64, v65
    v_cvt_pk_bf16_f32 v119, v66, v67
    buffer_store_dwordx4 v[116:119], v229, s[20:23], 0 offen
    s_waitcnt lgkmcnt(2)
    v_fma_f32 v20, v213, v180, v20
    v_fma_f32 v21, v213, v181, v21
    v_fma_f32 v22, v213, v182, v22
    v_fma_f32 v23, v213, v183, v23
    v_mul_f32 v20, v20, v196
    v_mul_f32 v21, v21, v197
    v_mul_f32 v22, v22, v198
    v_mul_f32 v23, v23, v199
    v_cvt_pk_bf16_f32 v120, v20, v21
    v_cvt_pk_bf16_f32 v121, v22, v23
    v_fma_f32 v36, v213, v184, v36
    v_fma_f32 v37, v213, v185, v37
    v_fma_f32 v38, v213, v186, v38
    v_fma_f32 v39, v213, v187, v39
    v_mul_f32 v36, v36, v200
    v_mul_f32 v37, v37, v201
    v_mul_f32 v38, v38, v202
    v_mul_f32 v39, v39, v203
    v_cvt_pk_bf16_f32 v122, v36, v37
    v_cvt_pk_bf16_f32 v123, v38, v39
    buffer_store_dwordx4 v[120:123], v230, s[20:23], 0 offen
    v_fma_f32 v52, v213, v188, v52
    v_fma_f32 v53, v213, v189, v53
    v_fma_f32 v54, v213, v190, v54
    v_fma_f32 v55, v213, v191, v55
    v_mul_f32 v52, v52, v204
    v_mul_f32 v53, v53, v205
    v_mul_f32 v54, v54, v206
    v_mul_f32 v55, v55, v207
    v_cvt_pk_bf16_f32 v124, v52, v53
    v_cvt_pk_bf16_f32 v125, v54, v55
    v_fma_f32 v68, v213, v192, v68
    v_fma_f32 v69, v213, v193, v69
    v_fma_f32 v70, v213, v194, v70
    v_fma_f32 v71, v213, v195, v71
    v_mul_f32 v68, v68, v208
    v_mul_f32 v69, v69, v209
    v_mul_f32 v70, v70, v210
    v_mul_f32 v71, v71, v211
    v_cvt_pk_bf16_f32 v126, v68, v69
    v_cvt_pk_bf16_f32 v127, v70, v71
    buffer_store_dwordx4 v[124:127], v231, s[20:23], 0 offen
    s_waitcnt lgkmcnt(1)
    v_fma_f32 v24, v214, v180, v24
    v_fma_f32 v25, v214, v181, v25
    v_fma_f32 v26, v214, v182, v26
    v_fma_f32 v27, v214, v183, v27
    v_mul_f32 v24, v24, v196
    v_mul_f32 v25, v25, v197
    v_mul_f32 v26, v26, v198
    v_mul_f32 v27, v27, v199
    v_cvt_pk_bf16_f32 v128, v24, v25
    v_cvt_pk_bf16_f32 v129, v26, v27
    v_fma_f32 v40, v214, v184, v40
    v_fma_f32 v41, v214, v185, v41
    v_fma_f32 v42, v214, v186, v42
    v_fma_f32 v43, v214, v187, v43
    v_mul_f32 v40, v40, v200
    v_mul_f32 v41, v41, v201
    v_mul_f32 v42, v42, v202
    v_mul_f32 v43, v43, v203
    v_cvt_pk_bf16_f32 v130, v40, v41
    v_cvt_pk_bf16_f32 v131, v42, v43
    buffer_store_dwordx4 v[128:131], v232, s[20:23], 0 offen
    v_fma_f32 v56, v214, v188, v56
    v_fma_f32 v57, v214, v189, v57
    v_fma_f32 v58, v214, v190, v58
    v_fma_f32 v59, v214, v191, v59
    v_mul_f32 v56, v56, v204
    v_mul_f32 v57, v57, v205
    v_mul_f32 v58, v58, v206
    v_mul_f32 v59, v59, v207
    v_cvt_pk_bf16_f32 v132, v56, v57
    v_cvt_pk_bf16_f32 v133, v58, v59
    v_fma_f32 v72, v214, v192, v72
    v_fma_f32 v73, v214, v193, v73
    v_fma_f32 v74, v214, v194, v74
    v_fma_f32 v75, v214, v195, v75
    v_mul_f32 v72, v72, v208
    v_mul_f32 v73, v73, v209
    v_mul_f32 v74, v74, v210
    v_mul_f32 v75, v75, v211
    v_cvt_pk_bf16_f32 v134, v72, v73
    v_cvt_pk_bf16_f32 v135, v74, v75
    buffer_store_dwordx4 v[132:135], v233, s[20:23], 0 offen
    s_waitcnt lgkmcnt(0)
    v_fma_f32 v28, v215, v180, v28
    v_fma_f32 v29, v215, v181, v29
    v_fma_f32 v30, v215, v182, v30
    v_fma_f32 v31, v215, v183, v31
    v_mul_f32 v28, v28, v196
    v_mul_f32 v29, v29, v197
    v_mul_f32 v30, v30, v198
    v_mul_f32 v31, v31, v199
    v_cvt_pk_bf16_f32 v136, v28, v29
    v_cvt_pk_bf16_f32 v137, v30, v31
    v_fma_f32 v44, v215, v184, v44
    v_fma_f32 v45, v215, v185, v45
    v_fma_f32 v46, v215, v186, v46
    v_fma_f32 v47, v215, v187, v47
    v_mul_f32 v44, v44, v200
    v_mul_f32 v45, v45, v201
    v_mul_f32 v46, v46, v202
    v_mul_f32 v47, v47, v203
    v_cvt_pk_bf16_f32 v138, v44, v45
    v_cvt_pk_bf16_f32 v139, v46, v47
    buffer_store_dwordx4 v[136:139], v234, s[20:23], 0 offen
    v_fma_f32 v60, v215, v188, v60
    v_fma_f32 v61, v215, v189, v61
    v_fma_f32 v62, v215, v190, v62
    v_fma_f32 v63, v215, v191, v63
    v_mul_f32 v60, v60, v204
    v_mul_f32 v61, v61, v205
    v_mul_f32 v62, v62, v206
    v_mul_f32 v63, v63, v207
    v_cvt_pk_bf16_f32 v140, v60, v61
    v_cvt_pk_bf16_f32 v141, v62, v63
    v_fma_f32 v76, v215, v192, v76
    v_fma_f32 v77, v215, v193, v77
    v_fma_f32 v78, v215, v194, v78
    v_fma_f32 v79, v215, v195, v79
    v_mul_f32 v76, v76, v208
    v_mul_f32 v77, v77, v209
    v_mul_f32 v78, v78, v210
    v_mul_f32 v79, v79, v211
    v_cvt_pk_bf16_f32 v142, v76, v77
    v_cvt_pk_bf16_f32 v143, v78, v79
    buffer_store_dwordx4 v[140:143], v235, s[20:23], 0 offen
L_sequential_preLN__sliding_block__glu_gated_glu__prompt_kernel_x:
    s_endpgm
L_sequential_preLN__sliding_block__glu_gated_glu__prompt_kernel_pf:
    s_load_dwordx2 s[4:5], s[0:1], 16
    s_load_dwordx2 s[8:9], s[0:1], 72
    s_sub_u32 s27, s2, 224
    s_lshl_b32 s27, s27, 2
    s_add_u32 s27, s27, s24
    v_lshrrev_b32 v1, 3, v0
    v_mul_u32_u24 v2, 1152, v1
    v_and_b32 v3, 7, v0
    v_lshl_add_u32 v2, v3, 4, v2
    s_mul_i32 s28, s27, 9216
    s_mov_b32 s36, 10048
    s_waitcnt lgkmcnt(0)
    s_mov_b32 s12, s4
    s_mov_b32 s13, s5
    s_mov_b32 s14, 663552
    s_mov_b32 s15, 0x00020000
    s_mov_b32 s20, s8
    s_mov_b32 s21, s9
    s_mov_b32 s22, 75497472
    s_mov_b32 s23, 0x00020000
    buffer_load_dwordx4 v[16:19], v2, s[12:15], s28 offen offset:0
    buffer_load_dwordx4 v[20:23], v2, s[12:15], s28 offen offset:128
    buffer_load_dwordx4 v[24:27], v2, s[12:15], s28 offen offset:256
    buffer_load_dwordx4 v[28:31], v2, s[12:15], s28 offen offset:384
    buffer_load_dwordx4 v[32:35], v2, s[12:15], s28 offen offset:512
    buffer_load_dwordx4 v[36:39], v2, s[12:15], s28 offen offset:640
    buffer_load_dwordx4 v[40:43], v2, s[12:15], s28 offen offset:768
    buffer_load_dwordx4 v[44:47], v2, s[12:15], s28 offen offset:896
    buffer_load_dwordx4 v[48:51], v2, s[12:15], s28 offen offset:1024
    v_mov_b32 v60, 0
    v_mov_b32 v61, 0
    v_mov_b32 v62, 0
    v_mov_b32 v63, 0
    v_mov_b32 v64, 0x3f803f80
    v_mov_b32 v65, 0x3f803f80
    v_mov_b32 v66, 0x3f803f80
    v_mov_b32 v67, 0x3f803f80
    s_lshl_b32 s25, s27, 6
    v_add_u32 v56, s25, v0
    v_lshrrev_b32 v57, 7, v56
    v_and_b32 v58, 127, v56
    v_mul_u32_u24 v57, 85248, v57
    v_mul_u32_u24 v58, 592, v58
    v_add3_u32 v57, v57, v58, s36
    buffer_store_dwordx4 v[60:63], v57, s[20:23], 0 offen
    v_mul_u32_u24 v58, 144, v56
    v_add_u32 v58, 7553152, v58
    s_cmp_ge_u32 s27, 32
    s_cbranch_scc1 L_sequential_preLN__sliding_block__glu_gated_glu__prompt_kernel_nov
    buffer_store_dwordx4 v[64:67], v58, s[20:23], 0 offen
L_sequential_preLN__sliding_block__glu_gated_glu__prompt_kernel_nov:
    s_sub_u32 s25, s2, 224
    s_mul_i32 s25, s25, 85248
    s_add_u32 s25, s25, 2727936
    s_lshl_b32 s26, s24, 6
    v_add_u32 v56, s26, v0
    v_mov_b32 v69, 0
    v_mov_b32 v70, 0
    v_mov_b32 v71, 0
    v_mov_b32 v73, 0
    v_mov_b32 v74, 0
    v_mov_b32 v75, 0
    v_mov_b32 v77, 0
    v_mov_b32 v78, 0
    v_mov_b32 v79, 0
    v_mov_b32 v59, 0xff7f
    v_mul_u32_u24 v57, 1772, v56
    v_lshrrev_b32 v57, 16, v57
    v_mul_u32_u24 v57, 37, v57
    v_sub_u32 v57, v56, v57
    v_cmp_eq_u32 vcc, 36, v57
    s_nop 1
    v_cndmask_b32 v68, 0, v59, vcc
    v_lshlrev_b32 v80, 4, v56
    v_cmp_gt_u32 vcc, 0x250, v56
    s_nop 0
    s_and_saveexec_b64 s[42:43], vcc
    s_cbranch_execz L_sequential_preLN__sliding_block__glu_gated_glu__prompt_kernel_dk0
    buffer_store_dwordx4 v[68:71], v80, s[20:23], s25 offen
L_sequential_preLN__sliding_block__glu_gated_glu__prompt_kernel_dk0:
    s_mov_b64 exec, -1
    v_add_u32 v56, 256, v56
    v_mul_u32_u24 v57, 1772, v56
    v_lshrrev_b32 v57, 16, v57
    v_mul_u32_u24 v57, 37, v57
    v_sub_u32 v57, v56, v57
    v_cmp_eq_u32 vcc, 36, v57
    s_nop 1
    v_cndmask_b32 v72, 0, v59, vcc
    v_lshlrev_b32 v81, 4, v56
    v_cmp_gt_u32 vcc, 0x250, v56
    s_nop 0
    s_and_saveexec_b64 s[42:43], vcc
    s_cbranch_execz L_sequential_preLN__sliding_block__glu_gated_glu__prompt_kernel_dk1
    buffer_store_dwordx4 v[72:75], v81, s[20:23], s25 offen
L_sequential_preLN__sliding_block__glu_gated_glu__prompt_kernel_dk1:
    s_mov_b64 exec, -1
    v_add_u32 v56, 256, v56
    v_mul_u32_u24 v57, 1772, v56
    v_lshrrev_b32 v57, 16, v57
    v_mul_u32_u24 v57, 37, v57
    v_sub_u32 v57, v56, v57
    v_cmp_eq_u32 vcc, 36, v57
    s_nop 1
    v_cndmask_b32 v76, 0, v59, vcc
    v_lshlrev_b32 v82, 4, v56
    v_cmp_gt_u32 vcc, 0x250, v56
    s_nop 0
    s_and_saveexec_b64 s[42:43], vcc
    s_cbranch_execz L_sequential_preLN__sliding_block__glu_gated_glu__prompt_kernel_dk2
    buffer_store_dwordx4 v[76:79], v82, s[20:23], s25 offen
L_sequential_preLN__sliding_block__glu_gated_glu__prompt_kernel_dk2:
    s_mov_b64 exec, -1
    v_add_u32 v56, 256, v56
    s_cmp_ge_u32 s27, 72
    s_cbranch_scc1 L_sequential_preLN__sliding_block__glu_gated_glu__prompt_kernel_x
    s_lshl_b32 s27, s27, 3
    v_add_u32 v1, s27, v1
    v_lshrrev_b32 v4, 5, v1
    v_lshlrev_b32 v5, 6, v4
    v_bfe_u32 v4, v1, 2, 2
    v_lshl_add_u32 v5, v4, 4, v5
    v_bfe_u32 v4, v1, 4, 1
    v_lshl_add_u32 v5, v4, 3, v5
    v_and_b32 v4, 3, v1
    v_lshl_add_u32 v5, v4, 1, v5
    v_add_u32 v5, 43532288, v5
    v_mov_b32 v6, 0
    v_mov_b32 v7, 0
    v_cmp_eq_u32 s[40:41], 0, v3
    s_waitcnt vmcnt(9)
    v_lshlrev_b32 v8, 16, v16
    v_and_b32 v9, 0xffff0000, v16
    v_add_f32 v6, v6, v8
    v_add_f32 v7, v7, v9
    v_lshlrev_b32 v8, 16, v17
    v_and_b32 v9, 0xffff0000, v17
    v_add_f32 v6, v6, v8
    v_add_f32 v7, v7, v9
    v_lshlrev_b32 v8, 16, v18
    v_and_b32 v9, 0xffff0000, v18
    v_add_f32 v6, v6, v8
    v_add_f32 v7, v7, v9
    v_lshlrev_b32 v8, 16, v19
    v_and_b32 v9, 0xffff0000, v19
    v_add_f32 v6, v6, v8
    v_add_f32 v7, v7, v9
    s_waitcnt vmcnt(8)
    v_lshlrev_b32 v8, 16, v20
    v_and_b32 v9, 0xffff0000, v20
    v_add_f32 v6, v6, v8
    v_add_f32 v7, v7, v9
    v_lshlrev_b32 v8, 16, v21
    v_and_b32 v9, 0xffff0000, v21
    v_add_f32 v6, v6, v8
    v_add_f32 v7, v7, v9
    v_lshlrev_b32 v8, 16, v22
    v_and_b32 v9, 0xffff0000, v22
    v_add_f32 v6, v6, v8
    v_add_f32 v7, v7, v9
    v_lshlrev_b32 v8, 16, v23
    v_and_b32 v9, 0xffff0000, v23
    v_add_f32 v6, v6, v8
    v_add_f32 v7, v7, v9
    s_waitcnt vmcnt(7)
    v_lshlrev_b32 v8, 16, v24
    v_and_b32 v9, 0xffff0000, v24
    v_add_f32 v6, v6, v8
    v_add_f32 v7, v7, v9
    v_lshlrev_b32 v8, 16, v25
    v_and_b32 v9, 0xffff0000, v25
    v_add_f32 v6, v6, v8
    v_add_f32 v7, v7, v9
    v_lshlrev_b32 v8, 16, v26
    v_and_b32 v9, 0xffff0000, v26
    v_add_f32 v6, v6, v8
    v_add_f32 v7, v7, v9
    v_lshlrev_b32 v8, 16, v27
    v_and_b32 v9, 0xffff0000, v27
    v_add_f32 v6, v6, v8
    v_add_f32 v7, v7, v9
    s_waitcnt vmcnt(6)
    v_lshlrev_b32 v8, 16, v28
    v_and_b32 v9, 0xffff0000, v28
    v_add_f32 v6, v6, v8
    v_add_f32 v7, v7, v9
    v_lshlrev_b32 v8, 16, v29
    v_and_b32 v9, 0xffff0000, v29
    v_add_f32 v6, v6, v8
    v_add_f32 v7, v7, v9
    v_lshlrev_b32 v8, 16, v30
    v_and_b32 v9, 0xffff0000, v30
    v_add_f32 v6, v6, v8
    v_add_f32 v7, v7, v9
    v_lshlrev_b32 v8, 16, v31
    v_and_b32 v9, 0xffff0000, v31
    v_add_f32 v6, v6, v8
    v_add_f32 v7, v7, v9
    s_waitcnt vmcnt(5)
    v_lshlrev_b32 v8, 16, v32
    v_and_b32 v9, 0xffff0000, v32
    v_add_f32 v6, v6, v8
    v_add_f32 v7, v7, v9
    v_lshlrev_b32 v8, 16, v33
    v_and_b32 v9, 0xffff0000, v33
    v_add_f32 v6, v6, v8
    v_add_f32 v7, v7, v9
    v_lshlrev_b32 v8, 16, v34
    v_and_b32 v9, 0xffff0000, v34
    v_add_f32 v6, v6, v8
    v_add_f32 v7, v7, v9
    v_lshlrev_b32 v8, 16, v35
    v_and_b32 v9, 0xffff0000, v35
    v_add_f32 v6, v6, v8
    v_add_f32 v7, v7, v9
    s_waitcnt vmcnt(4)
    v_lshlrev_b32 v8, 16, v36
    v_and_b32 v9, 0xffff0000, v36
    v_add_f32 v6, v6, v8
    v_add_f32 v7, v7, v9
    v_lshlrev_b32 v8, 16, v37
    v_and_b32 v9, 0xffff0000, v37
    v_add_f32 v6, v6, v8
    v_add_f32 v7, v7, v9
    v_lshlrev_b32 v8, 16, v38
    v_and_b32 v9, 0xffff0000, v38
    v_add_f32 v6, v6, v8
    v_add_f32 v7, v7, v9
    v_lshlrev_b32 v8, 16, v39
    v_and_b32 v9, 0xffff0000, v39
    v_add_f32 v6, v6, v8
    v_add_f32 v7, v7, v9
    s_waitcnt vmcnt(3)
    v_lshlrev_b32 v8, 16, v40
    v_and_b32 v9, 0xffff0000, v40
    v_add_f32 v6, v6, v8
    v_add_f32 v7, v7, v9
    v_lshlrev_b32 v8, 16, v41
    v_and_b32 v9, 0xffff0000, v41
    v_add_f32 v6, v6, v8
    v_add_f32 v7, v7, v9
    v_lshlrev_b32 v8, 16, v42
    v_and_b32 v9, 0xffff0000, v42
    v_add_f32 v6, v6, v8
    v_add_f32 v7, v7, v9
    v_lshlrev_b32 v8, 16, v43
    v_and_b32 v9, 0xffff0000, v43
    v_add_f32 v6, v6, v8
    v_add_f32 v7, v7, v9
    s_waitcnt vmcnt(2)
    v_lshlrev_b32 v8, 16, v44
    v_and_b32 v9, 0xffff0000, v44
    v_add_f32 v6, v6, v8
    v_add_f32 v7, v7, v9
    v_lshlrev_b32 v8, 16, v45
    v_and_b32 v9, 0xffff0000, v45
    v_add_f32 v6, v6, v8
    v_add_f32 v7, v7, v9
    v_lshlrev_b32 v8, 16, v46
    v_and_b32 v9, 0xffff0000, v46
    v_add_f32 v6, v6, v8
    v_add_f32 v7, v7, v9
    v_lshlrev_b32 v8, 16, v47
    v_and_b32 v9, 0xffff0000, v47
    v_add_f32 v6, v6, v8
    v_add_f32 v7, v7, v9
    s_waitcnt vmcnt(1)
    v_lshlrev_b32 v8, 16, v48
    v_and_b32 v9, 0xffff0000, v48
    v_add_f32 v6, v6, v8
    v_add_f32 v7, v7, v9
    v_lshlrev_b32 v8, 16, v49
    v_and_b32 v9, 0xffff0000, v49
    v_add_f32 v6, v6, v8
    v_add_f32 v7, v7, v9
    v_lshlrev_b32 v8, 16, v50
    v_and_b32 v9, 0xffff0000, v50
    v_add_f32 v6, v6, v8
    v_add_f32 v7, v7, v9
    v_lshlrev_b32 v8, 16, v51
    v_and_b32 v9, 0xffff0000, v51
    v_add_f32 v6, v6, v8
    v_add_f32 v7, v7, v9
    v_add_f32 v6, v6, v7
    s_nop 1
    v_add_f32_dpp v7, v6, v6 quad_perm:[1,0,3,2] row_mask:0xf bank_mask:0xf
    s_nop 1
    v_add_f32_dpp v6, v7, v7 quad_perm:[2,3,0,1] row_mask:0xf bank_mask:0xf
    s_nop 1
    v_add_f32_dpp v7, v6, v6 row_half_mirror row_mask:0xf bank_mask:0xf
    v_mul_f32 v7, 0x3ae38e39, v7
    v_cvt_pk_bf16_f32 v8, v7, v7
    v_lshlrev_b32 v9, 16, v8
    v_sub_f32 v7, v7, v9
    v_cvt_pk_bf16_f32 v9, v7, v7
    s_mov_b64 exec, s[40:41]
    buffer_store_short v8, v5, s[20:23], 0 offen
    buffer_store_short v9, v5, s[20:23], 0 offen offset:1152
    s_endpgm
.globl k2_kernel
.p2align 8
.type k2_kernel,@function
k2_kernel:
    s_cmp_ge_u32 s2, 256
    s_cbranch_scc1 L_k2_kernel_cs
    s_load_dwordx2 s[4:5], s[0:1], 72
    s_load_dwordx8 s[40:47], s[0:1], 16
    v_lshrrev_b32 v72, 6, v0
    v_and_b32 v0, 63, v0
    v_readfirstlane_b32 s20, v72
    v_lshlrev_b32 v1, 4, v0
    s_and_b32 s23, s2, 7
    s_lshr_b32 s24, s2, 3
    s_lshl_b32 s21, s23, 2
    s_and_b32 s23, s24, 3
    s_add_u32 s21, s21, s23
    s_lshr_b32 s22, s24, 2
    s_lshl_b32 s22, s22, 2
    s_add_u32 s22, s22, s20
    s_mul_i32 s23, s21, 144
    s_lshl_b32 s24, s22, 2
    s_add_u32 s23, s23, s24
    s_mul_i32 s29, s23, 592
    s_add_u32 s25, s29, 2727936
    s_add_u32 s26, s25, 3552
    s_add_u32 s27, s25, 7104
    s_add_u32 s28, s25, 10656
    s_add_u32 s29, s29, 9472
    s_lshl_b32 s23, s21, 6
    s_lshl_b32 s24, s22, 1
    s_add_u32 s23, s23, s24
    s_lshl_b32 s30, s23, 10
    s_add_u32 s30, s30, 5447680
    s_add_u32 s31, s30, 4096
    s_add_u32 s32, s30, 8192
    s_mul_i32 s33, s23, 144
    s_add_u32 s33, s33, 7551872
    s_mul_i32 s34, s22, 73728
    s_add_u32 s34, s34, 7864320
    v_lshlrev_b32 v2, 2, v0
    v_add_u32 v2, 384, v2
    v_min_u32 v2, 576, v2
    v_cmp_gt_u32 vcc, 32, v0
    v_lshrrev_b32 v72, 4, v0
    v_lshlrev_b32 v3, 5, v72
    v_cndmask_b32 v2, v2, v1, vcc
    v_and_b32 v73, 1, v0
    v_lshl_add_u32 v3, v73, 4, v3
    v_and_b32 v73, 14, v0
    v_cmp_eq_u32 vcc, 0, v73
    v_mov_b32 v74, 128
    s_waitcnt lgkmcnt(0)
    v_cndmask_b32 v3, v74, v3, vcc
    s_mov_b32 s12, s4
    s_mov_b32 s13, s5
    s_mov_b32 s14, 75497472
    s_mov_b32 s15, 0x00020000
    s_mov_b32 s60, 0
    s_mov_b32 s61, -1
    s_mov_b32 s62, 0
    s_mov_b32 s63, 0xffff0000
    buffer_load_dwordx4 v[104:107], v2, s[12:15], s29 offen offset:0
    buffer_load_dwordx4 v[108:111], v2, s[12:15], s29 offen offset:592
    buffer_load_dwordx4 v[112:115], v2, s[12:15], s29 offen offset:1184
    buffer_load_dwordx4 v[116:119], v2, s[12:15], s29 offen offset:1776
    buffer_load_dwordx4 a[0:3], v2, s[12:15], s25 offen offset:0
    buffer_load_dwordx4 a[4:7], v2, s[12:15], s25 offen offset:592
    buffer_load_dwordx4 a[8:11], v2, s[12:15], s25 offen offset:1184
    buffer_load_dwordx4 a[12:15], v2, s[12:15], s25 offen offset:1776
    buffer_load_dwordx4 a[16:19], v2, s[12:15], s25 offen offset:2368
    buffer_load_dwordx4 a[20:23], v2, s[12:15], s25 offen offset:2960
    buffer_load_dwordx4 a[24:27], v2, s[12:15], s26 offen offset:0
    buffer_load_dwordx4 a[28:31], v2, s[12:15], s26 offen offset:592
    buffer_load_dwordx4 a[32:35], v2, s[12:15], s26 offen offset:1184
    buffer_load_dwordx4 a[36:39], v2, s[12:15], s26 offen offset:1776
    buffer_load_dwordx4 a[40:43], v2, s[12:15], s26 offen offset:2368
    buffer_load_dwordx4 a[44:47], v2, s[12:15], s26 offen offset:2960
    buffer_load_dwordx4 a[48:51], v2, s[12:15], s27 offen offset:0
    buffer_load_dwordx4 a[52:55], v2, s[12:15], s27 offen offset:592
    buffer_load_dwordx4 a[56:59], v2, s[12:15], s27 offen offset:1184
    buffer_load_dwordx4 a[60:63], v2, s[12:15], s27 offen offset:1776
    buffer_load_dwordx4 a[64:67], v2, s[12:15], s27 offen offset:2368
    v_lshrrev_b32 v72, 4, v0
    v_lshlrev_b32 v72, 2, v72
    v_and_b32 v73, 15, v0
    v_mov_b32 v74, 0xff7fffff
    v_add_u32 v75, 0, v72
    v_cmp_gt_u32 vcc, v75, v73
    s_nop 1
    v_cndmask_b32 v8, 0, v74, vcc
    v_sub_f32 v12, v74, v8
    v_add_u32 v75, 1, v72
    v_cmp_gt_u32 vcc, v75, v73
    s_nop 1
    v_cndmask_b32 v9, 0, v74, vcc
    v_sub_f32 v13, v74, v9
    v_add_u32 v75, 2, v72
    v_cmp_gt_u32 vcc, v75, v73
    s_nop 1
    v_cndmask_b32 v10, 0, v74, vcc
    v_sub_f32 v14, v74, v10
    v_add_u32 v75, 3, v72
    v_cmp_gt_u32 vcc, v75, v73
    s_nop 1
    v_cndmask_b32 v11, 0, v74, vcc
    v_sub_f32 v15, v74, v11
    s_mul_i32 s23, s21, 18
    v_add_u32 v75, s23, v72
    v_lshrrev_b32 v76, 5, v75
    v_lshlrev_b32 v4, 10, v76
    v_bfe_u32 v76, v75, 2, 2
    v_lshl_add_u32 v4, v76, 8, v4
    v_lshl_add_u32 v4, v73, 4, v4
    v_bfe_u32 v76, v75, 4, 1
    v_lshl_add_u32 v4, v76, 3, v4
    v_bfe_u32 v76, v75, 1, 1
    v_lshl_add_u32 v4, v76, 2, v4
    v_add_u32 v75, s23, v72
    v_add_u32 v75, 2, v75
    v_lshrrev_b32 v76, 5, v75
    v_lshlrev_b32 v5, 10, v76
    v_bfe_u32 v76, v75, 2, 2
    v_lshl_add_u32 v5, v76, 8, v5
    v_lshl_add_u32 v5, v73, 4, v5
    v_bfe_u32 v76, v75, 4, 1
    v_lshl_add_u32 v5, v76, 3, v5
    v_bfe_u32 v76, v75, 1, 1
    v_lshl_add_u32 v5, v76, 2, v5
    s_add_u32 s23, s23, 16
    v_mov_b32 v75, s23
    v_lshrrev_b32 v76, 5, v75
    v_lshlrev_b32 v6, 10, v76
    v_bfe_u32 v76, v75, 2, 2
    v_lshl_add_u32 v6, v76, 8, v6
    v_lshl_add_u32 v6, v73, 4, v6
    v_bfe_u32 v76, v75, 4, 1
    v_lshl_add_u32 v6, v76, 3, v6
    v_bfe_u32 v76, v75, 1, 1
    v_lshl_add_u32 v6, v76, 2, v6
    s_lshr_b32 s23, s2, 3
    s_lshl_b32 s23, s23, 2
    s_add_u32 s23, s23, s20
    s_cmp_lt_u32 s23, 64
    s_cselect_b32 s48, s44, s46
    s_cselect_b32 s49, s45, s47
    s_mov_b32 s50, 5308416
    s_mov_b32 s51, 0x00020000
    s_mov_b32 s52, s40
    s_mov_b32 s53, s41
    s_mov_b32 s54, 663552
    s_mov_b32 s55, 0x00020000
    s_lshl_b32 s24, s23, 6
    v_add_u32 v84, s24, v0
    v_lshlrev_b32 v84, 7, v84
    s_and_b32 s23, s23, 63
    s_mul_i32 s23, s23, 90
    v_add_u32 v85, s23, v0
    s_and_b32 s23, s2, 3
    s_mul_i32 s23, s23, 2304
    v_mul_u32_u24 v86, 3641, v85
    v_lshrrev_b32 v86, 16, v86
    v_mul_u32_u24 v86, 6912, v86
    v_lshl_add_u32 v80, v85, 7, v86
    v_add_u32 v80, s23, v80
    v_add_u32 v85, 45, v85
    v_mul_u32_u24 v86, 3641, v85
    v_lshrrev_b32 v86, 16, v86
    v_mul_u32_u24 v86, 6912, v86
    v_lshl_add_u32 v81, v85, 7, v86
    v_add_u32 v81, s23, v81
    s_mov_b64 exec, s[60:61]
    s_waitcnt vmcnt(20)
    v_mov_b32 v105, 0
    v_mov_b32 v106, 0
    v_mov_b32 v107, 0
    s_waitcnt vmcnt(19)
    v_mov_b32 v109, 0
    v_mov_b32 v110, 0
    v_mov_b32 v111, 0
    s_waitcnt vmcnt(18)
    v_mov_b32 v113, 0
    v_mov_b32 v114, 0
    v_mov_b32 v115, 0
    s_waitcnt vmcnt(17)
    v_mov_b32 v117, 0
    v_mov_b32 v118, 0
    v_mov_b32 v119, 0
    s_mov_b64 exec, s[62:63]
    v_mov_b32 v104, 0x3f80
    v_mov_b32 v108, 0x3f80
    v_mov_b32 v112, 0x3f80
    v_mov_b32 v116, 0x3f80
    s_mov_b64 exec, -1
    s_waitcnt vmcnt(16)
    v_mfma_f32_16x16x32_bf16 v[132:135], a[0:3], v[104:107], v[12:15]
    s_waitcnt vmcnt(15)
    v_mfma_f32_16x16x32_bf16 v[136:139], a[4:7], v[104:107], 0
    s_waitcnt vmcnt(14)
    v_mfma_f32_16x16x32_bf16 v[140:143], a[8:11], v[104:107], 0
    buffer_load_dwordx4 a[80:83], v1, s[12:15], s30 offen offset:0
    s_waitcnt vmcnt(14)
    v_mfma_f32_16x16x32_bf16 v[144:147], a[12:15], v[104:107], 0
    s_nop 0
    v_max3_f32 v68, v132, v133, v134
    buffer_load_dwordx4 a[120:123], v3, s[12:15], s33 offen offset:0
    v_max_f32 v68, v68, v135
    s_waitcnt vmcnt(14)
    v_mfma_f32_16x16x32_bf16 v[148:151], a[16:19], v[104:107], 0
    buffer_load_dwordx4 a[84:87], v1, s[12:15], s30 offen offset:1024
    v_max3_f32 v69, v136, v137, v138
    v_max_f32 v69, v69, v139
    buffer_load_dwordx4 a[124:127], v3, s[12:15], s33 offen offset:144
    s_waitcnt vmcnt(15)
    v_mfma_f32_16x16x32_bf16 v[152:155], a[20:23], v[104:107], 0
    v_max3_f32 v68, v68, v140, v141
    buffer_load_dwordx4 a[68:71], v2, s[12:15], s27 offen offset:2960
    v_max3_f32 v68, v68, v142, v143
    s_waitcnt vmcnt(15)
    v_mfma_f32_16x16x32_bf16 v[132:135], a[24:27], v[104:107], 0
    v_max3_f32 v69, v69, v144, v145
    buffer_load_dwordx4 a[88:91], v1, s[12:15], s30 offen offset:2048
    v_max3_f32 v69, v69, v146, v147
    s_waitcnt vmcnt(15)
    v_mfma_f32_16x16x32_bf16 v[136:139], a[28:31], v[104:107], 0
    buffer_load_dwordx4 a[128:131], v3, s[12:15], s33 offen offset:288
    v_max3_f32 v68, v68, v148, v149
    v_max3_f32 v68, v68, v150, v151
    buffer_load_dwordx4 a[92:95], v1, s[12:15], s30 offen offset:3072
    s_waitcnt vmcnt(16)
    v_mfma_f32_16x16x32_bf16 v[140:143], a[32:35], v[104:107], 0
    v_max3_f32 v69, v69, v152, v153
    buffer_load_dwordx4 a[132:135], v3, s[12:15], s33 offen offset:432
    v_max3_f32 v69, v69, v154, v155
    s_waitcnt vmcnt(16)
    v_mfma_f32_16x16x32_bf16 v[144:147], a[36:39], v[104:107], 0
    buffer_load_dwordx4 a[96:99], v1, s[12:15], s31 offen offset:0
    v_max3_f32 v68, v68, v132, v133
    v_max3_f32 v68, v68, v134, v135
    buffer_load_dwordx4 a[136:139], v3, s[12:15], s33 offen offset:576
    s_waitcnt vmcnt(17)
    v_mfma_f32_16x16x32_bf16 v[148:151], a[40:43], v[104:107], 0
    v_max3_f32 v69, v69, v136, v137
    v_max3_f32 v69, v69, v138, v139
    buffer_load_dwordx4 a[100:103], v1, s[12:15], s31 offen offset:1024
    s_waitcnt vmcnt(17)
    v_mfma_f32_16x16x32_bf16 v[152:155], a[44:47], v[104:107], 0
    v_max3_f32 v68, v68, v140, v141
    buffer_load_dwordx4 a[140:143], v3, s[12:15], s33 offen offset:720
    v_max3_f32 v68, v68, v142, v143
    s_waitcnt vmcnt(17)
    v_mfma_f32_16x16x32_bf16 v[132:135], a[48:51], v[104:107], 0
    buffer_load_dwordx4 a[104:107], v1, s[12:15], s31 offen offset:2048
    v_max3_f32 v69, v69, v144, v145
    v_max3_f32 v69, v69, v146, v147
    buffer_load_dwordx4 a[144:147], v3, s[12:15], s33 offen offset:864
    s_waitcnt vmcnt(18)
    v_mfma_f32_16x16x32_bf16 v[136:139], a[52:55], v[104:107], 0
    v_max3_f32 v68, v68, v148, v149
    buffer_load_dwordx4 a[108:111], v1, s[12:15], s31 offen offset:3072
    v_max3_f32 v68, v68, v150, v151
    s_waitcnt vmcnt(18)
    v_mfma_f32_16x16x32_bf16 v[140:143], a[56:59], v[104:107], 0
    buffer_load_dwordx4 a[148:151], v3, s[12:15], s33 offen offset:1008
    v_max3_f32 v69, v69, v152, v153
    v_max3_f32 v69, v69, v154, v155
    s_waitcnt vmcnt(18)
    v_mfma_f32_16x16x32_bf16 v[144:147], a[60:63], v[104:107], 0
    buffer_load_dwordx4 a[112:115], v1, s[12:15], s32 offen offset:0
    v_max3_f32 v68, v68, v132, v133
    v_max3_f32 v68, v68, v134, v135
    buffer_load_dwordx4 a[152:155], v3, s[12:15], s33 offen offset:1152
    s_waitcnt vmcnt(19)
    v_mfma_f32_16x16x32_bf16 v[148:151], a[64:67], v[104:107], v[8:11]
    v_max3_f32 v69, v69, v136, v137
    buffer_load_dwordx4 a[72:75], v2, s[12:15], s28 offen offset:0
    v_max3_f32 v69, v69, v138, v139
    v_max3_f32 v68, v68, v140, v141
    buffer_load_dwordx4 a[76:79], v2, s[12:15], s28 offen offset:592
    v_max3_f32 v68, v68, v142, v143
    v_max3_f32 v69, v69, v144, v145
    buffer_load_dwordx4 a[116:119], v1, s[12:15], s32 offen offset:1024
    v_max3_f32 v69, v69, v146, v147
    v_max3_f32 v68, v68, v148, v149
    buffer_load_dwordx4 a[156:159], v3, s[12:15], s33 offen offset:1296
    v_max3_f32 v68, v68, v150, v151
    v_max_f32 v68, v68, v69
    v_mov_b32 v156, v68
    s_nop 1
    v_permlane16_swap_b32 v68, v156
    v_max_f32 v68, v68, v156
    v_mov_b32 v156, v68
    s_nop 1
    v_permlane32_swap_b32 v68, v156
    v_max_f32 v68, v68, v156
    v_sub_f32 v16, 0, v68
    v_sub_f32 v17, 0, v68
    v_sub_f32 v18, 0, v68
    v_sub_f32 v19, 0, v68
    v_sub_f32 v20, v8, v68
    v_sub_f32 v24, v12, v68
    v_sub_f32 v21, v9, v68
    v_sub_f32 v25, v13, v68
    v_sub_f32 v22, v10, v68
    v_sub_f32 v26, v14, v68
    v_sub_f32 v23, v11, v68
    v_sub_f32 v27, v15, v68
    s_nop 1
    v_mfma_f32_16x16x32_bf16 v[28:31], a[0:3], v[104:107], v[24:27]
    v_mfma_f32_16x16x32_bf16 v[32:35], a[4:7], v[104:107], v[16:19]
    v_mfma_f32_16x16x32_bf16 v[132:135], a[4:7], v[108:111], v[12:15]
    v_mfma_f32_16x16x32_bf16 v[36:39], a[8:11], v[104:107], v[16:19]
    v_mfma_f32_16x16x32_bf16 v[40:43], a[12:15], v[104:107], v[16:19]
    v_mfma_f32_16x16x32_bf16 v[136:139], a[8:11], v[108:111], 0
    s_nop 2
    v_exp_f32 v28, v28
    v_exp_f32 v29, v29
    v_mfma_f32_16x16x32_bf16 v[140:143], a[12:15], v[108:111], 0
    v_exp_f32 v30, v30
    v_exp_f32 v31, v31
    v_mfma_f32_16x16x32_bf16 v[144:147], a[16:19], v[108:111], 0
    v_cvt_pk_bf16_f32 v52, v28, v29
    v_cvt_pk_bf16_f32 v53, v30, v31
    v_max3_f32 v68, v132, v133, v134
    v_exp_f32 v32, v32
    v_exp_f32 v33, v33
    v_max_f32 v68, v68, v135
    v_exp_f32 v34, v34
    v_exp_f32 v35, v35
    v_mfma_f32_16x16x32_bf16 v[148:151], a[20:23], v[108:111], 0
    v_cvt_pk_bf16_f32 v54, v32, v33
    v_cvt_pk_bf16_f32 v55, v34, v35
    v_max3_f32 v69, v136, v137, v138
    v_mfma_f32_16x16x32_bf16 v[44:47], a[16:19], v[104:107], v[16:19]
    v_mfma_f32_16x16x32_bf16 v[48:51], a[20:23], v[104:107], v[16:19]
    v_max_f32 v69, v69, v139
    v_exp_f32 v36, v36
    v_exp_f32 v37, v37
    v_mfma_f32_16x16x32_bf16 v[152:155], a[24:27], v[108:111], 0
    s_waitcnt vmcnt(22)
    v_mfma_f32_16x16x32_bf16 v[60:63], a[80:83], v[52:55], 0
    s_waitcnt vmcnt(21)
    v_mfma_f32_16x16x32_bf16 v[64:67], a[120:123], v[52:55], 0
    v_max3_f32 v68, v68, v140, v141
    v_exp_f32 v38, v38
    v_exp_f32 v39, v39
    v_max3_f32 v68, v68, v142, v143
    v_cvt_pk_bf16_f32 v56, v36, v37
    v_cvt_pk_bf16_f32 v57, v38, v39
    v_mfma_f32_16x16x32_bf16 v[132:135], a[28:31], v[108:111], 0
    v_exp_f32 v40, v40
    v_exp_f32 v41, v41
    v_max3_f32 v69, v69, v144, v145
    v_exp_f32 v42, v42
    v_exp_f32 v43, v43
    v_max3_f32 v69, v69, v146, v147
    v_cvt_pk_bf16_f32 v58, v40, v41
    v_cvt_pk_bf16_f32 v59, v42, v43
    v_mfma_f32_16x16x32_bf16 v[136:139], a[32:35], v[108:111], 0
    v_mfma_f32_16x16x32_bf16 v[28:31], a[24:27], v[104:107], v[16:19]
    v_mfma_f32_16x16x32_bf16 v[32:35], a[28:31], v[104:107], v[16:19]
    v_max3_f32 v68, v68, v148, v149
    v_exp_f32 v44, v44
    v_exp_f32 v45, v45
    v_max3_f32 v68, v68, v150, v151
    s_waitcnt vmcnt(20)
    v_mfma_f32_16x16x32_bf16 v[60:63], a[84:87], v[56:59], v[60:63]
    s_waitcnt vmcnt(19)
    v_mfma_f32_16x16x32_bf16 v[64:67], a[124:127], v[56:59], v[64:67]
    v_mfma_f32_16x16x32_bf16 v[140:143], a[36:39], v[108:111], 0
    v_exp_f32 v46, v46
    v_exp_f32 v47, v47
    v_max3_f32 v69, v69, v152, v153
    v_cvt_pk_bf16_f32 v52, v44, v45
    v_cvt_pk_bf16_f32 v53, v46, v47
    v_max3_f32 v69, v69, v154, v155
    v_exp_f32 v48, v48
    v_exp_f32 v49, v49
    v_mfma_f32_16x16x32_bf16 v[144:147], a[40:43], v[108:111], 0
    v_exp_f32 v50, v50
    v_exp_f32 v51, v51
    v_max3_f32 v68, v68, v132, v133
    v_cvt_pk_bf16_f32 v54, v48, v49
    v_cvt_pk_bf16_f32 v55, v50, v51
    v_max3_f32 v68, v68, v134, v135
    v_mfma_f32_16x16x32_bf16 v[36:39], a[32:35], v[104:107], v[16:19]
    v_mfma_f32_16x16x32_bf16 v[40:43], a[36:39], v[104:107], v[16:19]
    v_mfma_f32_16x16x32_bf16 v[148:151], a[44:47], v[108:111], 0
    v_exp_f32 v28, v28
    v_exp_f32 v29, v29
    v_max3_f32 v69, v69, v136, v137
    s_waitcnt vmcnt(17)
    v_mfma_f32_16x16x32_bf16 v[60:63], a[88:91], v[52:55], v[60:63]
    s_waitcnt vmcnt(16)
    v_mfma_f32_16x16x32_bf16 v[64:67], a[128:131], v[52:55], v[64:67]
    v_max3_f32 v69, v69, v138, v139
    v_exp_f32 v30, v30
    v_exp_f32 v31, v31
    v_mfma_f32_16x16x32_bf16 v[152:155], a[48:51], v[108:111], 0
    v_cvt_pk_bf16_f32 v56, v28, v29
    v_cvt_pk_bf16_f32 v57, v30, v31
    v_max3_f32 v68, v68, v140, v141
    v_exp_f32 v32, v32
    v_exp_f32 v33, v33
    v_max3_f32 v68, v68, v142, v143
    v_exp_f32 v34, v34
    v_exp_f32 v35, v35
    v_mfma_f32_16x16x32_bf16 v[132:135], a[52:55], v[108:111], 0
    v_cvt_pk_bf16_f32 v58, v32, v33
    v_cvt_pk_bf16_f32 v59, v34, v35
    v_max3_f32 v69, v69, v144, v145
    v_mfma_f32_16x16x32_bf16 v[44:47], a[40:43], v[104:107], v[16:19]
    v_mfma_f32_16x16x32_bf16 v[48:51], a[44:47], v[104:107], v[16:19]
    v_max3_f32 v69, v69, v146, v147
    v_exp_f32 v36, v36
    v_exp_f32 v37, v37
    v_mfma_f32_16x16x32_bf16 v[136:139], a[56:59], v[108:111], 0
    s_waitcnt vmcnt(15)
    v_mfma_f32_16x16x32_bf16 v[60:63], a[92:95], v[56:59], v[60:63]
    s_waitcnt vmcnt(14)
    v_mfma_f32_16x16x32_bf16 v[64:67], a[132:135], v[56:59], v[64:67]
    v_max3_f32 v68, v68, v148, v149
    v_exp_f32 v38, v38
    v_exp_f32 v39, v39
    v_max3_f32 v68, v68, v150, v151
    v_cvt_pk_bf16_f32 v52, v36, v37
    v_cvt_pk_bf16_f32 v53, v38, v39
    v_mfma_f32_16x16x32_bf16 v[140:143], a[60:63], v[108:111], 0
    v_exp_f32 v40, v40
    v_exp_f32 v41, v41
    v_max3_f32 v69, v69, v152, v153
    v_exp_f32 v42, v42
    v_exp_f32 v43, v43
    v_max3_f32 v69, v69, v154, v155
    v_cvt_pk_bf16_f32 v54, v40, v41
    v_cvt_pk_bf16_f32 v55, v42, v43
    v_mfma_f32_16x16x32_bf16 v[144:147], a[64:67], v[108:111], 0
    v_mfma_f32_16x16x32_bf16 v[28:31], a[48:51], v[104:107], v[16:19]
    v_mfma_f32_16x16x32_bf16 v[32:35], a[52:55], v[104:107], v[16:19]
    v_max3_f32 v68, v68, v132, v133
    v_exp_f32 v44, v44
    v_exp_f32 v45, v45
    v_max3_f32 v68, v68, v134, v135
    s_waitcnt vmcnt(13)
    v_mfma_f32_16x16x32_bf16 v[60:63], a[96:99], v[52:55], v[60:63]
    s_waitcnt vmcnt(12)
    v_mfma_f32_16x16x32_bf16 v[64:67], a[136:139], v[52:55], v[64:67]
    v_mfma_f32_16x16x32_bf16 v[148:151], a[68:71], v[108:111], v[8:11]
    v_exp_f32 v46, v46
    v_exp_f32 v47, v47
    v_max3_f32 v69, v69, v136, v137
    v_cvt_pk_bf16_f32 v56, v44, v45
    v_cvt_pk_bf16_f32 v57, v46, v47
    v_max3_f32 v69, v69, v138, v139
    v_exp_f32 v48, v48
    v_exp_f32 v49, v49
    v_max3_f32 v68, v68, v140, v141
    v_exp_f32 v50, v50
    v_exp_f32 v51, v51
    v_max3_f32 v68, v68, v142, v143
    v_cvt_pk_bf16_f32 v58, v48, v49
    v_cvt_pk_bf16_f32 v59, v50, v51
    v_max3_f32 v69, v69, v144, v145
    v_mfma_f32_16x16x32_bf16 v[36:39], a[56:59], v[104:107], v[16:19]
    v_mfma_f32_16x16x32_bf16 v[40:43], a[60:63], v[104:107], v[16:19]
    v_max3_f32 v69, v69, v146, v147
    v_exp_f32 v28, v28
    v_exp_f32 v29, v29
    v_max3_f32 v68, v68, v148, v149
    s_waitcnt vmcnt(11)
    v_mfma_f32_16x16x32_bf16 v[60:63], a[100:103], v[56:59], v[60:63]
    s_waitcnt vmcnt(10)
    v_mfma_f32_16x16x32_bf16 v[64:67], a[140:143], v[56:59], v[64:67]
    v_max3_f32 v68, v68, v150, v151
    v_exp_f32 v30, v30
    v_exp_f32 v31, v31
    v_max_f32 v68, v68, v69
    v_cvt_pk_bf16_f32 v52, v28, v29
    v_cvt_pk_bf16_f32 v53, v30, v31
    v_mov_b32 v156, v68
    v_exp_f32 v32, v32
    v_exp_f32 v33, v33
    v_permlane16_swap_b32 v68, v156
    v_exp_f32 v34, v34
    v_exp_f32 v35, v35
    v_max_f32 v68, v68, v156
    v_cvt_pk_bf16_f32 v54, v32, v33
    v_cvt_pk_bf16_f32 v55, v34, v35
    v_mov_b32 v156, v68
    v_mfma_f32_16x16x32_bf16 v[44:47], a[64:67], v[104:107], v[20:23]
    v_exp_f32 v36, v36
    v_permlane32_swap_b32 v68, v156
    v_exp_f32 v37, v37
    s_waitcnt vmcnt(9)
    v_mfma_f32_16x16x32_bf16 v[60:63], a[104:107], v[52:55], v[60:63]
    v_max_f32 v68, v68, v156
    s_waitcnt vmcnt(8)
    v_mfma_f32_16x16x32_bf16 v[64:67], a[144:147], v[52:55], v[64:67]
    v_exp_f32 v38, v38
    v_sub_f32 v120, 0, v68
    v_exp_f32 v39, v39
    v_cvt_pk_bf16_f32 v56, v36, v37
    v_sub_f32 v121, 0, v68
    v_cvt_pk_bf16_f32 v57, v38, v39
    v_exp_f32 v40, v40
    v_sub_f32 v122, 0, v68
    v_exp_f32 v41, v41
    v_exp_f32 v42, v42
    v_sub_f32 v123, 0, v68
    v_exp_f32 v43, v43
    v_cvt_pk_bf16_f32 v58, v40, v41
    v_sub_f32 v124, v8, v68
    v_cvt_pk_bf16_f32 v59, v42, v43
    v_exp_f32 v44, v44
    v_sub_f32 v128, v12, v68
    v_exp_f32 v45, v45
    s_waitcnt vmcnt(7)
    v_mfma_f32_16x16x32_bf16 v[60:63], a[108:111], v[56:59], v[60:63]
    v_sub_f32 v125, v9, v68
    s_waitcnt vmcnt(6)
    v_mfma_f32_16x16x32_bf16 v[64:67], a[148:151], v[56:59], v[64:67]
    v_exp_f32 v46, v46
    v_sub_f32 v129, v13, v68
    v_exp_f32 v47, v47
    v_cvt_pk_bf16_f32 v52, v44, v45
    v_sub_f32 v126, v10, v68
    v_cvt_pk_bf16_f32 v53, v46, v47
    v_mov_b32 v54, 0
    v_sub_f32 v130, v14, v68
    v_mov_b32 v55, 0
    s_nop 1
    v_sub_f32 v127, v11, v68
    s_waitcnt vmcnt(5)
    v_mfma_f32_16x16x32_bf16 v[60:63], a[112:115], v[52:55], v[60:63]
    s_waitcnt vmcnt(4)
    v_mfma_f32_16x16x32_bf16 v[64:67], a[152:155], v[52:55], v[64:67]
    v_sub_f32 v131, v15, v68
    s_waitcnt vmcnt(0)
    s_lshr_b32 s24, s2, 3
    s_lshl_b32 s24, s24, 2
    s_add_u32 s24, s24, s20
    s_and_b32 s24, s24, 15
    s_getpc_b64 s[8:9]
L_pfc3:
    s_add_u32 s8, s8, k3_kernel-L_pfc3
    s_addc_u32 s9, s9, (k3_kernel-L_pfc3)>>32
    s_lshl_b32 s23, s24, 6
    v_add_u32 v100, s23, v0
    v_lshlrev_b32 v100, 7, v100
    s_mov_b32 s23, k5_kernel-k3_kernel
    v_cmp_gt_u32 s[10:11], s23, v100
    v_mov_b32 v101, s9
    v_add_co_u32 v100, vcc, s8, v100
    s_nop 1
    v_addc_co_u32 v101, vcc, 0, v101, vcc
    s_mov_b64 exec, s[10:11]
    s_cbranch_execz L_pfc3_s
    global_load_dword v100, v[100:101], off
L_pfc3_s:
    s_mov_b64 exec, -1
    buffer_load_dword v84, v84, s[52:55], 0 offen
    s_bfm_b64 exec, 45, 0
    buffer_load_dword v80, v80, s[48:51], 0 offen
    buffer_load_dword v81, v81, s[48:51], 0 offen
    s_mov_b64 exec, -1
    v_mfma_f32_16x16x32_bf16 v[48:51], a[4:7], v[108:111], v[128:131]
    v_mfma_f32_16x16x32_bf16 v[28:31], a[8:11], v[108:111], v[120:123]
    v_mfma_f32_16x16x32_bf16 v[32:35], a[12:15], v[108:111], v[120:123]
    v_mfma_f32_16x16x32_bf16 v[132:135], a[8:11], v[112:115], v[12:15]
    v_rcp_f32 v72, v66
    s_nop 0
    v_mul_f32 v60, v60, v72
    v_mfma_f32_16x16x32_bf16 v[136:139], a[12:15], v[112:115], 0
    v_mul_f32 v61, v61, v72
    v_mul_f32 v62, v62, v72
    v_mfma_f32_16x16x32_bf16 v[140:143], a[16:19], v[112:115], 0
    v_mul_f32 v63, v63, v72
    v_mul_f32 v64, v64, v72
    v_mfma_f32_16x16x32_bf16 v[144:147], a[20:23], v[112:115], 0
    v_mul_f32 v65, v65, v72
    v_cvt_pk_bf16_f32 v87, v60, v61
    v_max3_f32 v68, v132, v133, v134
    v_cvt_pk_bf16_f32 v88, v62, v63
    v_cvt_pk_bf16_f32 v89, v64, v65
    v_max_f32 v68, v68, v135
    v_mov_b32 v52, 0
    v_mov_b32 v53, 0
    v_mfma_f32_16x16x32_bf16 v[148:151], a[24:27], v[112:115], 0
    v_exp_f32 v48, v48
    v_exp_f32 v49, v49
    v_exp_f32 v50, v50
    v_max3_f32 v69, v136, v137, v138
    v_exp_f32 v51, v51
    v_cvt_pk_bf16_f32 v54, v48, v49
    v_max_f32 v69, v69, v139
    v_cvt_pk_bf16_f32 v55, v50, v51
    v_mfma_f32_16x16x32_bf16 v[36:39], a[16:19], v[108:111], v[120:123]
    v_mfma_f32_16x16x32_bf16 v[152:155], a[28:31], v[112:115], 0
    v_mfma_f32_16x16x32_bf16 v[40:43], a[20:23], v[108:111], v[120:123]
    v_exp_f32 v28, v28
    v_max3_f32 v68, v68, v140, v141
    v_exp_f32 v29, v29
    v_mfma_f32_16x16x32_bf16 v[60:63], a[80:83], v[52:55], 0
    v_max3_f32 v68, v68, v142, v143
    v_mfma_f32_16x16x32_bf16 v[64:67], a[120:123], v[52:55], 0
    v_exp_f32 v30, v30
    v_mfma_f32_16x16x32_bf16 v[132:135], a[32:35], v[112:115], 0
    v_exp_f32 v31, v31
    v_cvt_pk_bf16_f32 v56, v28, v29
    v_max3_f32 v69, v69, v144, v145
    v_cvt_pk_bf16_f32 v57, v30, v31
    v_exp_f32 v32, v32
    v_exp_f32 v33, v33
    v_max3_f32 v69, v69, v146, v147
    v_exp_f32 v34, v34
    v_exp_f32 v35, v35
    v_mfma_f32_16x16x32_bf16 v[136:139], a[36:39], v[112:115], 0
    v_cvt_pk_bf16_f32 v58, v32, v33
    v_cvt_pk_bf16_f32 v59, v34, v35
    v_max3_f32 v68, v68, v148, v149
    v_mfma_f32_16x16x32_bf16 v[44:47], a[24:27], v[108:111], v[120:123]
    v_mfma_f32_16x16x32_bf16 v[48:51], a[28:31], v[108:111], v[120:123]
    v_max3_f32 v68, v68, v150, v151
    v_exp_f32 v36, v36
    v_exp_f32 v37, v37
    v_mfma_f32_16x16x32_bf16 v[140:143], a[40:43], v[112:115], 0
    v_mfma_f32_16x16x32_bf16 v[60:63], a[84:87], v[56:59], v[60:63]
    v_mfma_f32_16x16x32_bf16 v[64:67], a[124:127], v[56:59], v[64:67]
    v_max3_f32 v69, v69, v152, v153
    v_exp_f32 v38, v38
    v_exp_f32 v39, v39
    v_max3_f32 v69, v69, v154, v155
    v_cvt_pk_bf16_f32 v52, v36, v37
    v_cvt_pk_bf16_f32 v53, v38, v39
    v_exp_f32 v40, v40
    v_mfma_f32_16x16x32_bf16 v[144:147], a[44:47], v[112:115], 0
    v_exp_f32 v41, v41
    v_exp_f32 v42, v42
    v_max3_f32 v68, v68, v132, v133
    v_exp_f32 v43, v43
    v_cvt_pk_bf16_f32 v54, v40, v41
    v_max3_f32 v68, v68, v134, v135
    v_cvt_pk_bf16_f32 v55, v42, v43
    v_mfma_f32_16x16x32_bf16 v[28:31], a[32:35], v[108:111], v[120:123]
    v_mfma_f32_16x16x32_bf16 v[148:151], a[48:51], v[112:115], 0
    v_mfma_f32_16x16x32_bf16 v[32:35], a[36:39], v[108:111], v[120:123]
    v_exp_f32 v44, v44
    v_max3_f32 v69, v69, v136, v137
    v_exp_f32 v45, v45
    v_mfma_f32_16x16x32_bf16 v[60:63], a[88:91], v[52:55], v[60:63]
    v_max3_f32 v69, v69, v138, v139
    v_mfma_f32_16x16x32_bf16 v[64:67], a[128:131], v[52:55], v[64:67]
    v_exp_f32 v46, v46
    v_mfma_f32_16x16x32_bf16 v[152:155], a[52:55], v[112:115], 0
    v_exp_f32 v47, v47
    v_cvt_pk_bf16_f32 v56, v44, v45
    v_cvt_pk_bf16_f32 v57, v46, v47
    v_max3_f32 v68, v68, v140, v141
    v_exp_f32 v48, v48
    v_exp_f32 v49, v49
    v_max3_f32 v68, v68, v142, v143
    v_exp_f32 v50, v50
    v_exp_f32 v51, v51
    v_mfma_f32_16x16x32_bf16 v[132:135], a[56:59], v[112:115], 0
    v_cvt_pk_bf16_f32 v58, v48, v49
    v_cvt_pk_bf16_f32 v59, v50, v51
    v_max3_f32 v69, v69, v144, v145
    v_mfma_f32_16x16x32_bf16 v[36:39], a[40:43], v[108:111], v[120:123]
    v_mfma_f32_16x16x32_bf16 v[40:43], a[44:47], v[108:111], v[120:123]
    v_max3_f32 v69, v69, v146, v147
    v_exp_f32 v28, v28
    v_exp_f32 v29, v29
    v_mfma_f32_16x16x32_bf16 v[136:139], a[60:63], v[112:115], 0
    v_mfma_f32_16x16x32_bf16 v[60:63], a[92:95], v[56:59], v[60:63]
    v_mfma_f32_16x16x32_bf16 v[64:67], a[132:135], v[56:59], v[64:67]
    v_max3_f32 v68, v68, v148, v149
    v_exp_f32 v30, v30
    v_exp_f32 v31, v31
    v_cvt_pk_bf16_f32 v52, v28, v29
    v_max3_f32 v68, v68, v150, v151
    v_cvt_pk_bf16_f32 v53, v30, v31
    v_exp_f32 v32, v32
    v_mfma_f32_16x16x32_bf16 v[140:143], a[64:67], v[112:115], 0
    v_exp_f32 v33, v33
    v_exp_f32 v34, v34
    v_max3_f32 v69, v69, v152, v153
    v_exp_f32 v35, v35
    v_cvt_pk_bf16_f32 v54, v32, v33
    v_max3_f32 v69, v69, v154, v155
    v_cvt_pk_bf16_f32 v55, v34, v35
    v_mfma_f32_16x16x32_bf16 v[44:47], a[48:51], v[108:111], v[120:123]
    v_mfma_f32_16x16x32_bf16 v[144:147], a[68:71], v[112:115], 0
    v_mfma_f32_16x16x32_bf16 v[48:51], a[52:55], v[108:111], v[120:123]
    v_exp_f32 v36, v36
    v_max3_f32 v68, v68, v132, v133
    v_exp_f32 v37, v37
    v_mfma_f32_16x16x32_bf16 v[60:63], a[96:99], v[52:55], v[60:63]
    v_max3_f32 v68, v68, v134, v135
    v_mfma_f32_16x16x32_bf16 v[64:67], a[136:139], v[52:55], v[64:67]
    v_exp_f32 v38, v38
    v_exp_f32 v39, v39
    v_mfma_f32_16x16x32_bf16 v[148:151], a[72:75], v[112:115], v[8:11]
    v_cvt_pk_bf16_f32 v56, v36, v37
    v_cvt_pk_bf16_f32 v57, v38, v39
    v_max3_f32 v69, v69, v136, v137
    v_exp_f32 v40, v40
    v_exp_f32 v41, v41
    v_max3_f32 v69, v69, v138, v139
    v_exp_f32 v42, v42
    v_exp_f32 v43, v43
    v_max3_f32 v68, v68, v140, v141
    v_cvt_pk_bf16_f32 v58, v40, v41
    v_cvt_pk_bf16_f32 v59, v42, v43
    v_max3_f32 v68, v68, v142, v143
    v_mfma_f32_16x16x32_bf16 v[28:31], a[56:59], v[108:111], v[120:123]
    v_mfma_f32_16x16x32_bf16 v[32:35], a[60:63], v[108:111], v[120:123]
    v_max3_f32 v69, v69, v144, v145
    v_exp_f32 v44, v44
    v_exp_f32 v45, v45
    v_max3_f32 v69, v69, v146, v147
    v_mfma_f32_16x16x32_bf16 v[60:63], a[100:103], v[56:59], v[60:63]
    v_mfma_f32_16x16x32_bf16 v[64:67], a[140:143], v[56:59], v[64:67]
    v_exp_f32 v46, v46
    v_max3_f32 v68, v68, v148, v149
    v_exp_f32 v47, v47
    v_cvt_pk_bf16_f32 v52, v44, v45
    v_max3_f32 v68, v68, v150, v151
    v_cvt_pk_bf16_f32 v53, v46, v47
    v_exp_f32 v48, v48
    v_max_f32 v68, v68, v69
    v_exp_f32 v49, v49
    v_exp_f32 v50, v50
    v_mov_b32 v156, v68
    v_exp_f32 v51, v51
    v_cvt_pk_bf16_f32 v54, v48, v49
    v_permlane16_swap_b32 v68, v156
    v_cvt_pk_bf16_f32 v55, v50, v51
    v_mfma_f32_16x16x32_bf16 v[36:39], a[64:67], v[108:111], v[120:123]
    v_max_f32 v68, v68, v156
    v_mfma_f32_16x16x32_bf16 v[40:43], a[68:71], v[108:111], v[124:127]
    v_exp_f32 v28, v28
    v_mov_b32 v156, v68
    v_exp_f32 v29, v29
    v_mfma_f32_16x16x32_bf16 v[60:63], a[104:107], v[52:55], v[60:63]
    v_mfma_f32_16x16x32_bf16 v[64:67], a[144:147], v[52:55], v[64:67]
    v_permlane32_swap_b32 v68, v156
    v_exp_f32 v30, v30
    v_exp_f32 v31, v31
    v_max_f32 v68, v68, v156
    v_cvt_pk_bf16_f32 v56, v28, v29
    v_cvt_pk_bf16_f32 v57, v30, v31
    v_sub_f32 v16, 0, v68
    v_exp_f32 v32, v32
    v_exp_f32 v33, v33
    v_sub_f32 v17, 0, v68
    v_exp_f32 v34, v34
    v_exp_f32 v35, v35
    v_sub_f32 v18, 0, v68
    v_cvt_pk_bf16_f32 v58, v32, v33
    v_cvt_pk_bf16_f32 v59, v34, v35
    v_sub_f32 v19, 0, v68
    v_exp_f32 v36, v36
    v_exp_f32 v37, v37
    v_sub_f32 v20, v8, v68
    v_mfma_f32_16x16x32_bf16 v[60:63], a[108:111], v[56:59], v[60:63]
    v_mfma_f32_16x16x32_bf16 v[64:67], a[148:151], v[56:59], v[64:67]
    v_exp_f32 v38, v38
    v_sub_f32 v24, v12, v68
    v_exp_f32 v39, v39
    v_cvt_pk_bf16_f32 v52, v36, v37
    v_sub_f32 v21, v9, v68
    v_cvt_pk_bf16_f32 v53, v38, v39
    v_exp_f32 v40, v40
    v_sub_f32 v25, v13, v68
    v_exp_f32 v41, v41
    v_exp_f32 v42, v42
    v_sub_f32 v22, v10, v68
    v_exp_f32 v43, v43
    v_cvt_pk_bf16_f32 v54, v40, v41
    v_sub_f32 v26, v14, v68
    v_cvt_pk_bf16_f32 v55, v42, v43
    s_nop 1
    v_sub_f32 v23, v11, v68
    v_mfma_f32_16x16x32_bf16 v[60:63], a[112:115], v[52:55], v[60:63]
    v_mfma_f32_16x16x32_bf16 v[64:67], a[152:155], v[52:55], v[64:67]
    v_sub_f32 v27, v15, v68
    s_nop 1
    v_mfma_f32_16x16x32_bf16 v[44:47], a[8:11], v[112:115], v[24:27]
    v_mfma_f32_16x16x32_bf16 v[48:51], a[12:15], v[112:115], v[16:19]
    v_mfma_f32_16x16x32_bf16 v[28:31], a[16:19], v[112:115], v[16:19]
    v_mfma_f32_16x16x32_bf16 v[132:135], a[12:15], v[116:119], v[12:15]
    s_nop 0
    v_rcp_f32 v72, v66
    s_nop 0
    v_mul_f32 v60, v60, v72
    v_mfma_f32_16x16x32_bf16 v[136:139], a[16:19], v[116:119], 0
    v_mul_f32 v61, v61, v72
    v_mul_f32 v62, v62, v72
    v_mfma_f32_16x16x32_bf16 v[140:143], a[20:23], v[116:119], 0
    v_mul_f32 v63, v63, v72
    v_mul_f32 v64, v64, v72
    v_mfma_f32_16x16x32_bf16 v[144:147], a[24:27], v[116:119], 0
    v_mul_f32 v65, v65, v72
    v_cvt_pk_bf16_f32 v90, v60, v61
    v_max3_f32 v68, v132, v133, v134
    v_cvt_pk_bf16_f32 v91, v62, v63
    v_cvt_pk_bf16_f32 v92, v64, v65
    v_max_f32 v68, v68, v135
    v_mfma_f32_16x16x32_bf16 v[32:35], a[20:23], v[112:115], v[16:19]
    v_exp_f32 v44, v44
    v_mfma_f32_16x16x32_bf16 v[148:151], a[28:31], v[116:119], 0
    v_exp_f32 v45, v45
    v_exp_f32 v46, v46
    v_exp_f32 v47, v47
    v_max3_f32 v69, v136, v137, v138
    v_cvt_pk_bf16_f32 v52, v44, v45
    v_cvt_pk_bf16_f32 v53, v46, v47
    v_max_f32 v69, v69, v139
    v_exp_f32 v48, v48
    v_exp_f32 v49, v49
    v_mfma_f32_16x16x32_bf16 v[152:155], a[32:35], v[116:119], 0
    v_exp_f32 v50, v50
    v_exp_f32 v51, v51
    v_max3_f32 v68, v68, v140, v141
    v_cvt_pk_bf16_f32 v54, v48, v49
    v_cvt_pk_bf16_f32 v55, v50, v51
    v_max3_f32 v68, v68, v142, v143
    v_mfma_f32_16x16x32_bf16 v[36:39], a[24:27], v[112:115], v[16:19]
    v_mfma_f32_16x16x32_bf16 v[40:43], a[28:31], v[112:115], v[16:19]
    v_mfma_f32_16x16x32_bf16 v[132:135], a[36:39], v[116:119], 0
    v_exp_f32 v28, v28
    v_exp_f32 v29, v29
    v_max3_f32 v69, v69, v144, v145
    v_mfma_f32_16x16x32_bf16 v[60:63], a[84:87], v[52:55], 0
    v_mfma_f32_16x16x32_bf16 v[64:67], a[124:127], v[52:55], 0
    v_exp_f32 v30, v30
    v_max3_f32 v69, v69, v146, v147
    v_exp_f32 v31, v31
    v_cvt_pk_bf16_f32 v56, v28, v29
    v_mfma_f32_16x16x32_bf16 v[136:139], a[40:43], v[116:119], 0
    v_cvt_pk_bf16_f32 v57, v30, v31
    v_exp_f32 v32, v32
    v_max3_f32 v68, v68, v148, v149
    v_exp_f32 v33, v33
    v_exp_f32 v34, v34
    v_max3_f32 v68, v68, v150, v151
    v_exp_f32 v35, v35
    v_cvt_pk_bf16_f32 v58, v32, v33
    v_mfma_f32_16x16x32_bf16 v[140:143], a[44:47], v[116:119], 0
    v_cvt_pk_bf16_f32 v59, v34, v35
    v_mfma_f32_16x16x32_bf16 v[44:47], a[32:35], v[112:115], v[16:19]
    v_max3_f32 v69, v69, v152, v153
    v_mfma_f32_16x16x32_bf16 v[48:51], a[36:39], v[112:115], v[16:19]
    v_exp_f32 v36, v36
    v_max3_f32 v69, v69, v154, v155
    v_exp_f32 v37, v37
    v_mfma_f32_16x16x32_bf16 v[60:63], a[88:91], v[56:59], v[60:63]
    v_mfma_f32_16x16x32_bf16 v[64:67], a[128:131], v[56:59], v[64:67]
    v_mfma_f32_16x16x32_bf16 v[144:147], a[48:51], v[116:119], 0
    v_exp_f32 v38, v38
    v_exp_f32 v39, v39
    v_max3_f32 v68, v68, v132, v133
    v_cvt_pk_bf16_f32 v52, v36, v37
    v_cvt_pk_bf16_f32 v53, v38, v39
    v_max3_f32 v68, v68, v134, v135
    v_exp_f32 v40, v40
    v_exp_f32 v41, v41
    v_mfma_f32_16x16x32_bf16 v[148:151], a[52:55], v[116:119], 0
    v_exp_f32 v42, v42
    v_exp_f32 v43, v43
    v_max3_f32 v69, v69, v136, v137
    v_cvt_pk_bf16_f32 v54, v40, v41
    v_cvt_pk_bf16_f32 v55, v42, v43
    v_max3_f32 v69, v69, v138, v139
    v_mfma_f32_16x16x32_bf16 v[28:31], a[40:43], v[112:115], v[16:19]
    v_mfma_f32_16x16x32_bf16 v[32:35], a[44:47], v[112:115], v[16:19]
    v_mfma_f32_16x16x32_bf16 v[152:155], a[56:59], v[116:119], 0
    v_exp_f32 v44, v44
    v_exp_f32 v45, v45
    v_mfma_f32_16x16x32_bf16 v[60:63], a[92:95], v[52:55], v[60:63]
    v_max3_f32 v68, v68, v140, v141
    v_mfma_f32_16x16x32_bf16 v[64:67], a[132:135], v[52:55], v[64:67]
    v_exp_f32 v46, v46
    v_max3_f32 v68, v68, v142, v143
    v_exp_f32 v47, v47
    v_cvt_pk_bf16_f32 v56, v44, v45
    v_mfma_f32_16x16x32_bf16 v[132:135], a[60:63], v[116:119], 0
    v_cvt_pk_bf16_f32 v57, v46, v47
    v_exp_f32 v48, v48
    v_max3_f32 v69, v69, v144, v145
    v_exp_f32 v49, v49
    v_exp_f32 v50, v50
    v_max3_f32 v69, v69, v146, v147
    v_exp_f32 v51, v51
    v_cvt_pk_bf16_f32 v58, v48, v49
    v_mfma_f32_16x16x32_bf16 v[136:139], a[64:67], v[116:119], 0
    v_cvt_pk_bf16_f32 v59, v50, v51
    v_mfma_f32_16x16x32_bf16 v[36:39], a[48:51], v[112:115], v[16:19]
    v_max3_f32 v68, v68, v148, v149
    v_mfma_f32_16x16x32_bf16 v[40:43], a[52:55], v[112:115], v[16:19]
    v_exp_f32 v28, v28
    v_exp_f32 v29, v29
    v_max3_f32 v68, v68, v150, v151
    v_mfma_f32_16x16x32_bf16 v[60:63], a[96:99], v[56:59], v[60:63]
    v_mfma_f32_16x16x32_bf16 v[64:67], a[136:139], v[56:59], v[64:67]
    v_mfma_f32_16x16x32_bf16 v[140:143], a[68:71], v[116:119], 0
    v_exp_f32 v30, v30
    v_exp_f32 v31, v31
    v_max3_f32 v69, v69, v152, v153
    v_cvt_pk_bf16_f32 v52, v28, v29
    v_cvt_pk_bf16_f32 v53, v30, v31
    v_max3_f32 v69, v69, v154, v155
    v_exp_f32 v32, v32
    v_exp_f32 v33, v33
    v_mfma_f32_16x16x32_bf16 v[144:147], a[72:75], v[116:119], 0
    v_exp_f32 v34, v34
    v_exp_f32 v35, v35
    v_max3_f32 v68, v68, v132, v133
    v_cvt_pk_bf16_f32 v54, v32, v33
    v_cvt_pk_bf16_f32 v55, v34, v35
    v_max3_f32 v68, v68, v134, v135
    v_mfma_f32_16x16x32_bf16 v[44:47], a[56:59], v[112:115], v[16:19]
    v_mfma_f32_16x16x32_bf16 v[48:51], a[60:63], v[112:115], v[16:19]
    v_exp_f32 v36, v36
    v_mfma_f32_16x16x32_bf16 v[148:151], a[76:79], v[116:119], v[8:11]
    v_exp_f32 v37, v37
    v_mfma_f32_16x16x32_bf16 v[60:63], a[100:103], v[52:55], v[60:63]
    v_max3_f32 v69, v69, v136, v137
    v_mfma_f32_16x16x32_bf16 v[64:67], a[140:143], v[52:55], v[64:67]
    v_exp_f32 v38, v38
    v_max3_f32 v69, v69, v138, v139
    v_exp_f32 v39, v39
    v_cvt_pk_bf16_f32 v56, v36, v37
    v_max3_f32 v68, v68, v140, v141
    v_cvt_pk_bf16_f32 v57, v38, v39
    v_exp_f32 v40, v40
    v_max3_f32 v68, v68, v142, v143
    v_exp_f32 v41, v41
    v_exp_f32 v42, v42
    v_max3_f32 v69, v69, v144, v145
    v_exp_f32 v43, v43
    v_cvt_pk_bf16_f32 v58, v40, v41
    v_max3_f32 v69, v69, v146, v147
    v_cvt_pk_bf16_f32 v59, v42, v43
    v_mfma_f32_16x16x32_bf16 v[28:31], a[64:67], v[112:115], v[16:19]
    v_mfma_f32_16x16x32_bf16 v[32:35], a[68:71], v[112:115], v[16:19]
    v_max3_f32 v68, v68, v148, v149
    v_exp_f32 v44, v44
    v_exp_f32 v45, v45
    v_max3_f32 v68, v68, v150, v151
    v_mfma_f32_16x16x32_bf16 v[60:63], a[104:107], v[56:59], v[60:63]
    v_mfma_f32_16x16x32_bf16 v[64:67], a[144:147], v[56:59], v[64:67]
    v_max_f32 v68, v68, v69
    v_exp_f32 v46, v46
    v_exp_f32 v47, v47
    v_mov_b32 v156, v68
    v_cvt_pk_bf16_f32 v52, v44, v45
    v_cvt_pk_bf16_f32 v53, v46, v47
    v_permlane16_swap_b32 v68, v156
    v_exp_f32 v48, v48
    v_exp_f32 v49, v49
    v_max_f32 v68, v68, v156
    v_exp_f32 v50, v50
    v_exp_f32 v51, v51
    v_mov_b32 v156, v68
    v_cvt_pk_bf16_f32 v54, v48, v49
    v_cvt_pk_bf16_f32 v55, v50, v51
    v_mfma_f32_16x16x32_bf16 v[36:39], a[72:75], v[112:115], v[20:23]
    v_permlane32_swap_b32 v68, v156
    v_exp_f32 v28, v28
    v_exp_f32 v29, v29
    v_max_f32 v68, v68, v156
    v_mfma_f32_16x16x32_bf16 v[60:63], a[108:111], v[52:55], v[60:63]
    v_mfma_f32_16x16x32_bf16 v[64:67], a[148:151], v[52:55], v[64:67]
    v_sub_f32 v120, 0, v68
    v_exp_f32 v30, v30
    v_exp_f32 v31, v31
    v_sub_f32 v121, 0, v68
    v_cvt_pk_bf16_f32 v56, v28, v29
    v_cvt_pk_bf16_f32 v57, v30, v31
    v_sub_f32 v122, 0, v68
    v_exp_f32 v32, v32
    v_exp_f32 v33, v33
    v_sub_f32 v123, 0, v68
    v_exp_f32 v34, v34
    v_exp_f32 v35, v35
    v_sub_f32 v124, v8, v68
    v_cvt_pk_bf16_f32 v58, v32, v33
    v_cvt_pk_bf16_f32 v59, v34, v35
    v_exp_f32 v36, v36
    v_sub_f32 v128, v12, v68
    v_exp_f32 v37, v37
    v_mfma_f32_16x16x32_bf16 v[60:63], a[112:115], v[56:59], v[60:63]
    v_sub_f32 v125, v9, v68
    v_mfma_f32_16x16x32_bf16 v[64:67], a[152:155], v[56:59], v[64:67]
    v_exp_f32 v38, v38
    v_sub_f32 v129, v13, v68
    v_exp_f32 v39, v39
    v_cvt_pk_bf16_f32 v52, v36, v37
    v_sub_f32 v126, v10, v68
    v_cvt_pk_bf16_f32 v53, v38, v39
    v_mov_b32 v54, 0
    v_sub_f32 v130, v14, v68
    v_mov_b32 v55, 0
    s_nop 1
    v_sub_f32 v127, v11, v68
    v_mfma_f32_16x16x32_bf16 v[60:63], a[116:119], v[52:55], v[60:63]
    v_mfma_f32_16x16x32_bf16 v[64:67], a[156:159], v[52:55], v[64:67]
    v_sub_f32 v131, v15, v68
    s_nop 1
    v_mfma_f32_16x16x32_bf16 v[40:43], a[12:15], v[116:119], v[128:131]
    v_mfma_f32_16x16x32_bf16 v[44:47], a[16:19], v[116:119], v[120:123]
    v_mfma_f32_16x16x32_bf16 v[48:51], a[20:23], v[116:119], v[120:123]
    s_nop 1
    v_rcp_f32 v72, v66
    s_nop 0
    v_mul_f32 v60, v60, v72
    v_mul_f32 v61, v61, v72
    v_mul_f32 v62, v62, v72
    v_mul_f32 v63, v63, v72
    v_mul_f32 v64, v64, v72
    v_mul_f32 v65, v65, v72
    v_cvt_pk_bf16_f32 v93, v60, v61
    v_cvt_pk_bf16_f32 v94, v62, v63
    v_cvt_pk_bf16_f32 v95, v64, v65
    v_mov_b32 v52, 0
    v_mov_b32 v53, 0
    v_exp_f32 v40, v40
    v_exp_f32 v41, v41
    v_exp_f32 v42, v42
    v_exp_f32 v43, v43
    v_cvt_pk_bf16_f32 v54, v40, v41
    v_cvt_pk_bf16_f32 v55, v42, v43
    v_mfma_f32_16x16x32_bf16 v[28:31], a[24:27], v[116:119], v[120:123]
    v_mfma_f32_16x16x32_bf16 v[32:35], a[28:31], v[116:119], v[120:123]
    v_exp_f32 v44, v44
    v_exp_f32 v45, v45
    v_mfma_f32_16x16x32_bf16 v[60:63], a[84:87], v[52:55], 0
    v_mfma_f32_16x16x32_bf16 v[64:67], a[124:127], v[52:55], 0
    v_exp_f32 v46, v46
    v_exp_f32 v47, v47
    v_cvt_pk_bf16_f32 v56, v44, v45
    v_cvt_pk_bf16_f32 v57, v46, v47
    v_exp_f32 v48, v48
    v_exp_f32 v49, v49
    v_exp_f32 v50, v50
    v_exp_f32 v51, v51
    v_cvt_pk_bf16_f32 v58, v48, v49
    v_cvt_pk_bf16_f32 v59, v50, v51
    v_mfma_f32_16x16x32_bf16 v[36:39], a[32:35], v[116:119], v[120:123]
    v_mfma_f32_16x16x32_bf16 v[40:43], a[36:39], v[116:119], v[120:123]
    v_exp_f32 v28, v28
    v_exp_f32 v29, v29
    v_mfma_f32_16x16x32_bf16 v[60:63], a[88:91], v[56:59], v[60:63]
    v_mfma_f32_16x16x32_bf16 v[64:67], a[128:131], v[56:59], v[64:67]
    v_exp_f32 v30, v30
    v_exp_f32 v31, v31
    v_cvt_pk_bf16_f32 v52, v28, v29
    v_cvt_pk_bf16_f32 v53, v30, v31
    v_exp_f32 v32, v32
    v_exp_f32 v33, v33
    v_exp_f32 v34, v34
    v_exp_f32 v35, v35
    v_cvt_pk_bf16_f32 v54, v32, v33
    v_cvt_pk_bf16_f32 v55, v34, v35
    v_mfma_f32_16x16x32_bf16 v[44:47], a[40:43], v[116:119], v[120:123]
    v_mfma_f32_16x16x32_bf16 v[48:51], a[44:47], v[116:119], v[120:123]
    v_exp_f32 v36, v36
    v_exp_f32 v37, v37
    v_mfma_f32_16x16x32_bf16 v[60:63], a[92:95], v[52:55], v[60:63]
    v_mfma_f32_16x16x32_bf16 v[64:67], a[132:135], v[52:55], v[64:67]
    v_exp_f32 v38, v38
    v_exp_f32 v39, v39
    v_cvt_pk_bf16_f32 v56, v36, v37
    v_cvt_pk_bf16_f32 v57, v38, v39
    v_exp_f32 v40, v40
    v_exp_f32 v41, v41
    v_exp_f32 v42, v42
    v_exp_f32 v43, v43
    v_cvt_pk_bf16_f32 v58, v40, v41
    v_cvt_pk_bf16_f32 v59, v42, v43
    v_mfma_f32_16x16x32_bf16 v[28:31], a[48:51], v[116:119], v[120:123]
    v_mfma_f32_16x16x32_bf16 v[32:35], a[52:55], v[116:119], v[120:123]
    v_exp_f32 v44, v44
    v_exp_f32 v45, v45
    v_mfma_f32_16x16x32_bf16 v[60:63], a[96:99], v[56:59], v[60:63]
    v_mfma_f32_16x16x32_bf16 v[64:67], a[136:139], v[56:59], v[64:67]
    v_exp_f32 v46, v46
    v_exp_f32 v47, v47
    v_cvt_pk_bf16_f32 v52, v44, v45
    v_cvt_pk_bf16_f32 v53, v46, v47
    v_exp_f32 v48, v48
    v_exp_f32 v49, v49
    v_exp_f32 v50, v50
    v_exp_f32 v51, v51
    v_cvt_pk_bf16_f32 v54, v48, v49
    v_cvt_pk_bf16_f32 v55, v50, v51
    v_mfma_f32_16x16x32_bf16 v[36:39], a[56:59], v[116:119], v[120:123]
    v_mfma_f32_16x16x32_bf16 v[40:43], a[60:63], v[116:119], v[120:123]
    v_exp_f32 v28, v28
    v_exp_f32 v29, v29
    v_mfma_f32_16x16x32_bf16 v[60:63], a[100:103], v[52:55], v[60:63]
    v_mfma_f32_16x16x32_bf16 v[64:67], a[140:143], v[52:55], v[64:67]
    v_exp_f32 v30, v30
    v_exp_f32 v31, v31
    v_cvt_pk_bf16_f32 v56, v28, v29
    v_cvt_pk_bf16_f32 v57, v30, v31
    v_exp_f32 v32, v32
    v_exp_f32 v33, v33
    v_exp_f32 v34, v34
    v_exp_f32 v35, v35
    v_cvt_pk_bf16_f32 v58, v32, v33
    v_cvt_pk_bf16_f32 v59, v34, v35
    v_mfma_f32_16x16x32_bf16 v[44:47], a[64:67], v[116:119], v[120:123]
    v_mfma_f32_16x16x32_bf16 v[48:51], a[68:71], v[116:119], v[120:123]
    v_exp_f32 v36, v36
    v_exp_f32 v37, v37
    v_mfma_f32_16x16x32_bf16 v[60:63], a[104:107], v[56:59], v[60:63]
    v_mfma_f32_16x16x32_bf16 v[64:67], a[144:147], v[56:59], v[64:67]
    v_exp_f32 v38, v38
    v_exp_f32 v39, v39
    v_cvt_pk_bf16_f32 v52, v36, v37
    v_cvt_pk_bf16_f32 v53, v38, v39
    v_exp_f32 v40, v40
    v_exp_f32 v41, v41
    v_exp_f32 v42, v42
    v_exp_f32 v43, v43
    v_cvt_pk_bf16_f32 v54, v40, v41
    v_cvt_pk_bf16_f32 v55, v42, v43
    v_mfma_f32_16x16x32_bf16 v[28:31], a[72:75], v[116:119], v[120:123]
    v_mfma_f32_16x16x32_bf16 v[32:35], a[76:79], v[116:119], v[124:127]
    v_exp_f32 v44, v44
    v_exp_f32 v45, v45
    v_mfma_f32_16x16x32_bf16 v[60:63], a[108:111], v[52:55], v[60:63]
    v_mfma_f32_16x16x32_bf16 v[64:67], a[148:151], v[52:55], v[64:67]
    v_exp_f32 v46, v46
    v_exp_f32 v47, v47
    v_cvt_pk_bf16_f32 v56, v44, v45
    v_cvt_pk_bf16_f32 v57, v46, v47
    v_exp_f32 v48, v48
    v_exp_f32 v49, v49
    v_exp_f32 v50, v50
    v_exp_f32 v51, v51
    v_cvt_pk_bf16_f32 v58, v48, v49
    v_cvt_pk_bf16_f32 v59, v50, v51
    v_exp_f32 v28, v28
    v_exp_f32 v29, v29
    v_mfma_f32_16x16x32_bf16 v[60:63], a[112:115], v[56:59], v[60:63]
    v_mfma_f32_16x16x32_bf16 v[64:67], a[152:155], v[56:59], v[64:67]
    v_exp_f32 v30, v30
    v_exp_f32 v31, v31
    v_cvt_pk_bf16_f32 v52, v28, v29
    v_cvt_pk_bf16_f32 v53, v30, v31
    v_exp_f32 v32, v32
    v_exp_f32 v33, v33
    v_exp_f32 v34, v34
    v_exp_f32 v35, v35
    v_cvt_pk_bf16_f32 v54, v32, v33
    v_cvt_pk_bf16_f32 v55, v34, v35
    s_nop 1
    v_mfma_f32_16x16x32_bf16 v[60:63], a[116:119], v[52:55], v[60:63]
    v_mfma_f32_16x16x32_bf16 v[64:67], a[156:159], v[52:55], v[64:67]
    s_nop 7
    v_rcp_f32 v72, v66
    s_nop 0
    v_mul_f32 v60, v60, v72
    v_mul_f32 v61, v61, v72
    v_mul_f32 v62, v62, v72
    v_mul_f32 v63, v63, v72
    v_mul_f32 v64, v64, v72
    v_mul_f32 v65, v65, v72
    v_cvt_pk_bf16_f32 v96, v60, v61
    v_cvt_pk_bf16_f32 v97, v62, v63
    v_cvt_pk_bf16_f32 v98, v64, v65
    s_add_u32 s25, s34, 0
    buffer_store_dword v87, v4, s[12:15], s25 offen
    buffer_store_dword v88, v5, s[12:15], s25 offen
    s_add_u32 s25, s34, 18432
    buffer_store_dword v90, v4, s[12:15], s25 offen
    buffer_store_dword v91, v5, s[12:15], s25 offen
    s_add_u32 s25, s34, 36864
    buffer_store_dword v93, v4, s[12:15], s25 offen
    buffer_store_dword v94, v5, s[12:15], s25 offen
    s_add_u32 s25, s34, 55296
    buffer_store_dword v96, v4, s[12:15], s25 offen
    buffer_store_dword v97, v5, s[12:15], s25 offen
    s_mov_b64 exec, 0xffff
    s_add_u32 s25, s34, 0
    buffer_store_dword v89, v6, s[12:15], s25 offen
    s_add_u32 s25, s34, 18432
    buffer_store_dword v92, v6, s[12:15], s25 offen
    s_add_u32 s25, s34, 36864
    buffer_store_dword v95, v6, s[12:15], s25 offen
    s_add_u32 s25, s34, 55296
    buffer_store_dword v98, v6, s[12:15], s25 offen
    s_mov_b64 exec, -1
    s_endpgm
L_k2_kernel_cs:
    s_endpgm
.globl k3_kernel
.p2align 8
.type k3_kernel,@function
k3_kernel:
    s_and_b32 s39, s2, 7
    s_lshr_b32 s40, s2, 3
    s_mul_i32 s39, s39, 30
    s_add_u32 s39, s39, s40
    s_cmp_ge_u32 s2, 240
    s_cbranch_scc1 L_k3_kernel_x
    s_cmp_ge_u32 s39, 234
    s_cbranch_scc1 L_k3_kernel_end
    s_load_dwordx2 s[4:5], s[0:1], 0
    s_load_dwordx2 s[6:7], s[0:1], 16
    s_load_dwordx2 s[8:9], s[0:1], 72
    s_load_dwordx8 s[12:19], s[0:1], 32
    v_lshrrev_b32 v72, 6, v0
    v_and_b32 v0, 63, v0
    v_readfirstlane_b32 s36, v72
    v_lshlrev_b32 v1, 4, v0
    s_mul_i32 s37, s39, 7282
    s_lshr_b32 s37, s37, 16
    s_mul_i32 s40, s37, 9
    s_sub_u32 s38, s39, s40
    v_lshrrev_b32 v72, 3, v0
    v_mul_u32_u24 v2, 1152, v72
    v_lshrrev_b32 v72, 4, v0
    v_lshlrev_b32 v72, 1, v72
    v_and_b32 v73, 7, v0
    v_xor_b32 v72, v72, v73
    v_lshl_add_u32 v2, v72, 4, v2
    s_lshl_b32 s42, s36, 10
    s_mul_i32 s43, s36, 9216
    s_lshl_b32 s39, s38, 7
    s_add_u32 s43, s43, s39
    s_mul_i32 s41, s37, 5
    s_add_u32 s41, s41, s36
    s_mul_i32 s44, s41, 18432
    s_waitcnt lgkmcnt(0)
    s_mov_b32 s20, s6
    s_mov_b32 s21, s7
    s_mov_b32 s22, 663552
    s_mov_b32 s23, 0x00020000
    s_add_u32 s24, s8, 7864320
    s_addc_u32 s25, s9, 0
    s_mov_b32 s26, 2359296
    s_mov_b32 s27, 0x00020000
    s_mov_b32 s28, s4
    s_mov_b32 s29, s5
    s_mov_b32 s30, 2359296
    s_mov_b32 s31, 0x00020000
    s_mov_b32 s32, s8
    s_mov_b32 s33, s9
    s_mov_b32 s34, 75497472
    s_mov_b32 s35, 0x00020000
    s_min_u32 s39, s36, 2
    s_lshl_b32 s39, s39, 10
    s_add_u32 m0, s39, 87040
    s_add_u32 s39, s39, 43532288
    buffer_load_dwordx4 v1, s[32:35], s39 offen lds
    s_add_u32 m0, s42, 0
    s_nop 0
    buffer_load_dwordx4 v2, s[20:23], s43 offen lds
    s_add_u32 m0, s42, 5120
    s_add_u32 s43, s43, 46080
    buffer_load_dwordx4 v2, s[20:23], s43 offen lds
    s_add_u32 m0, s42, 10240
    s_add_u32 s43, s43, 46080
    buffer_load_dwordx4 v2, s[20:23], s43 offen lds
    s_add_u32 m0, s42, 15360
    s_add_u32 s43, s43, 46080
    buffer_load_dwordx4 v2, s[20:23], s43 offen lds
    s_add_u32 m0, s42, 20480
    s_add_u32 s43, s43, 46080
    buffer_load_dwordx4 v2, s[20:23], s43 offen lds
    buffer_load_dwordx4 v[96:99], v1, s[24:27], s44 offen offset:0
    buffer_load_dwordx4 v[100:103], v1, s[24:27], s44 offen offset:1024
    buffer_load_dwordx4 v[104:107], v1, s[24:27], s44 offen offset:2048
    buffer_load_dwordx4 v[108:111], v1, s[24:27], s44 offen offset:3072
    s_add_u32 s44, s44, 4096
    buffer_load_dwordx4 v[112:115], v1, s[24:27], s44 offen offset:0
    buffer_load_dwordx4 v[116:119], v1, s[24:27], s44 offen offset:1024
    v_lshrrev_b32 v72, 2, v0
    v_lshlrev_b32 v73, 7, v72
    v_and_b32 v74, 3, v0
    v_lshl_add_u32 v73, v74, 3, v73
    v_bfe_u32 v74, v0, 3, 2
    v_xor_b32 v75, 0, v74
    v_lshl_add_u32 v4, v75, 5, v73
    v_xor_b32 v75, 1, v74
    v_lshl_add_u32 v5, v75, 5, v73
    v_xor_b32 v75, 2, v74
    v_lshl_add_u32 v6, v75, 5, v73
    v_xor_b32 v75, 3, v74
    v_lshl_add_u32 v7, v75, 5, v73
    s_mul_i32 s45, s41, 18432
    s_lshl_b32 s40, s38, 7
    s_add_u32 s45, s45, s40
    s_add_u32 s46, s45, 9216
    s_lshl_b32 s40, s36, 11
    s_lshl_b32 s47, s41, 6
    s_add_u32 s47, s47, 43515904
    v_and_b32 v72, 15, v0
    v_lshlrev_b32 v3, 7, v72
    v_lshlrev_b32 v37, 2, v72
    v_lshrrev_b32 v73, 4, v0
    v_lshl_add_u32 v3, v73, 3, v3
    v_add_u32 v3, s40, v3
    v_add_u32 v3, 76800, v3
    v_and_b32 v72, 1, v0
    v_mul_u32_u24 v36, 1152, v72
    v_lshl_add_u32 v36, v73, 4, v36
    v_add_u32 v36, 87040, v36
    s_cmp_lg_u32 s2, 0
    s_cbranch_scc1 L_k3_kernel_nofl
    s_lshl_b32 s39, s36, 10
    s_add_u32 s39, s39, 43548672
    v_mov_b32 v8, 0
    v_mov_b32 v9, 0
    v_mov_b32 v10, 0
    v_mov_b32 v11, 0
    buffer_store_dwordx4 v[8:11], v1, s[32:35], s39 offen
    s_nop 1
L_k3_kernel_nofl:
    v_add_u32 v76, 61440, v4
    v_add_u32 v77, 61440, v5
    v_add_u32 v78, 61440, v6
    v_add_u32 v79, 61440, v7
    s_waitcnt vmcnt(6)
    s_barrier
    ds_read_b64_tr_b16 v[40:41], v4 offset:0
    ds_read_b64_tr_b16 v[42:43], v4 offset:2048
    ds_read_b64_tr_b16 v[44:45], v5 offset:0
    ds_read_b64_tr_b16 v[46:47], v5 offset:2048
    ds_read_b64_tr_b16 v[48:49], v6 offset:0
    ds_read_b64_tr_b16 v[50:51], v6 offset:2048
    ds_read_b64_tr_b16 v[52:53], v7 offset:0
    ds_read_b64_tr_b16 v[54:55], v7 offset:2048
    ds_read_b128 v[28:31], v36 offset:0
    ds_read_b64_tr_b16 v[56:57], v4 offset:4096
    ds_read_b64_tr_b16 v[58:59], v4 offset:6144
    s_waitcnt vmcnt(5) lgkmcnt(9)
    v_mfma_f32_16x16x32_bf16 v[8:11], v[40:43], v[96:99], 0
    s_add_u32 m0, s42, 25600
    s_add_u32 s43, s43, 46080
    buffer_load_dwordx4 v2, s[20:23], s43 offen lds
    ds_read_b64_tr_b16 v[60:61], v5 offset:4096
    ds_read_b64_tr_b16 v[62:63], v5 offset:6144
    s_waitcnt lgkmcnt(9)
    v_mfma_f32_16x16x32_bf16 v[12:15], v[44:47], v[96:99], 0
    s_add_u32 m0, s42, 30720
    s_add_u32 s43, s43, 46080
    buffer_load_dwordx4 v2, s[20:23], s43 offen lds
    ds_read_b64_tr_b16 v[64:65], v6 offset:4096
    ds_read_b64_tr_b16 v[66:67], v6 offset:6144
    s_waitcnt lgkmcnt(9)
    v_mfma_f32_16x16x32_bf16 v[16:19], v[48:51], v[96:99], 0
    s_add_u32 m0, s42, 35840
    s_add_u32 s43, s43, 46080
    buffer_load_dwordx4 v2, s[20:23], s43 offen lds
    ds_read_b64_tr_b16 v[68:69], v7 offset:4096
    ds_read_b64_tr_b16 v[70:71], v7 offset:6144
    s_waitcnt lgkmcnt(9)
    v_mfma_f32_16x16x32_bf16 v[20:23], v[52:55], v[96:99], 0
    s_add_u32 m0, s42, 40960
    s_add_u32 s43, s43, 46080
    buffer_load_dwordx4 v2, s[20:23], s43 offen lds
    ds_read_b128 v[32:35], v36 offset:64
    s_waitcnt lgkmcnt(9)
    v_mfma_f32_16x16x32_bf16 v[24:27], v[28:31], v[96:99], 0
    ds_read_b64_tr_b16 v[40:41], v4 offset:8192
    ds_read_b64_tr_b16 v[42:43], v4 offset:10240
    s_waitcnt vmcnt(8) lgkmcnt(9)
    v_mfma_f32_16x16x32_bf16 v[8:11], v[56:59], v[100:103], v[8:11]
    s_add_u32 m0, s42, 46080
    s_add_u32 s43, s43, 46080
    buffer_load_dwordx4 v2, s[20:23], s43 offen lds
    ds_read_b64_tr_b16 v[44:45], v5 offset:8192
    ds_read_b64_tr_b16 v[46:47], v5 offset:10240
    s_waitcnt lgkmcnt(9)
    v_mfma_f32_16x16x32_bf16 v[12:15], v[60:63], v[100:103], v[12:15]
    buffer_load_dwordx4 v[120:123], v1, s[24:27], s44 offen offset:2048
    ds_read_b64_tr_b16 v[48:49], v6 offset:8192
    ds_read_b64_tr_b16 v[50:51], v6 offset:10240
    s_waitcnt lgkmcnt(9)
    v_mfma_f32_16x16x32_bf16 v[16:19], v[64:67], v[100:103], v[16:19]
    buffer_load_dwordx4 v[124:127], v1, s[24:27], s44 offen offset:3072
    ds_read_b64_tr_b16 v[52:53], v7 offset:8192
    ds_read_b64_tr_b16 v[54:55], v7 offset:10240
    s_waitcnt lgkmcnt(9)
    v_mfma_f32_16x16x32_bf16 v[20:23], v[68:71], v[100:103], v[20:23]
    s_add_u32 s44, s44, 4096
    buffer_load_dwordx4 v[128:131], v1, s[24:27], s44 offen offset:0
    ds_read_b128 v[28:31], v36 offset:128
    s_waitcnt lgkmcnt(9)
    v_mfma_f32_16x16x32_bf16 v[24:27], v[32:35], v[100:103], v[24:27]
    ds_read_b64_tr_b16 v[56:57], v4 offset:12288
    ds_read_b64_tr_b16 v[58:59], v4 offset:14336
    s_waitcnt vmcnt(11) lgkmcnt(9)
    v_mfma_f32_16x16x32_bf16 v[8:11], v[40:43], v[104:107], v[8:11]
    buffer_load_dwordx4 v[132:135], v1, s[24:27], s44 offen offset:1024
    ds_read_b64_tr_b16 v[60:61], v5 offset:12288
    ds_read_b64_tr_b16 v[62:63], v5 offset:14336
    s_waitcnt lgkmcnt(9)
    v_mfma_f32_16x16x32_bf16 v[12:15], v[44:47], v[104:107], v[12:15]
    buffer_load_dwordx4 v[136:139], v1, s[24:27], s44 offen offset:2048
    ds_read_b64_tr_b16 v[64:65], v6 offset:12288
    ds_read_b64_tr_b16 v[66:67], v6 offset:14336
    s_waitcnt lgkmcnt(9)
    v_mfma_f32_16x16x32_bf16 v[16:19], v[48:51], v[104:107], v[16:19]
    buffer_load_dwordx4 v[140:143], v1, s[24:27], s44 offen offset:3072
    ds_read_b64_tr_b16 v[68:69], v7 offset:12288
    ds_read_b64_tr_b16 v[70:71], v7 offset:14336
    s_waitcnt lgkmcnt(9)
    v_mfma_f32_16x16x32_bf16 v[20:23], v[52:55], v[104:107], v[20:23]
    s_add_u32 m0, s42, 51200
    s_add_u32 s43, s43, 46080
    buffer_load_dwordx4 v2, s[20:23], s43 offen lds
    ds_read_b128 v[32:35], v36 offset:192
    s_waitcnt lgkmcnt(9)
    v_mfma_f32_16x16x32_bf16 v[24:27], v[28:31], v[104:107], v[24:27]
    ds_read_b64_tr_b16 v[40:41], v4 offset:16384
    ds_read_b64_tr_b16 v[42:43], v4 offset:18432
    s_waitcnt vmcnt(14) lgkmcnt(9)
    v_mfma_f32_16x16x32_bf16 v[8:11], v[56:59], v[108:111], v[8:11]
    s_add_u32 m0, s42, 56320
    s_add_u32 s43, s43, 46080
    buffer_load_dwordx4 v2, s[20:23], s43 offen lds
    ds_read_b64_tr_b16 v[44:45], v5 offset:16384
    ds_read_b64_tr_b16 v[46:47], v5 offset:18432
    s_waitcnt lgkmcnt(9)
    v_mfma_f32_16x16x32_bf16 v[12:15], v[60:63], v[108:111], v[12:15]
    s_add_u32 m0, s42, 61440
    s_add_u32 s43, s43, 46080
    buffer_load_dwordx4 v2, s[20:23], s43 offen lds
    ds_read_b64_tr_b16 v[48:49], v6 offset:16384
    ds_read_b64_tr_b16 v[50:51], v6 offset:18432
    s_waitcnt lgkmcnt(9)
    v_mfma_f32_16x16x32_bf16 v[16:19], v[64:67], v[108:111], v[16:19]
    s_add_u32 m0, s42, 66560
    s_add_u32 s43, s43, 46080
    buffer_load_dwordx4 v2, s[20:23], s43 offen lds
    ds_read_b64_tr_b16 v[52:53], v7 offset:16384
    ds_read_b64_tr_b16 v[54:55], v7 offset:18432
    s_waitcnt lgkmcnt(9)
    v_mfma_f32_16x16x32_bf16 v[20:23], v[68:71], v[108:111], v[20:23]
    s_add_u32 m0, s42, 71680
    s_add_u32 s43, s43, 46080
    buffer_load_dwordx4 v2, s[20:23], s43 offen lds
    ds_read_b128 v[28:31], v36 offset:256
    s_waitcnt lgkmcnt(9)
    v_mfma_f32_16x16x32_bf16 v[24:27], v[32:35], v[108:111], v[24:27]
    ds_read_b64_tr_b16 v[56:57], v4 offset:20480
    ds_read_b64_tr_b16 v[58:59], v4 offset:22528
    s_waitcnt vmcnt(17) lgkmcnt(9)
    v_mfma_f32_16x16x32_bf16 v[8:11], v[40:43], v[112:115], v[8:11]
    s_add_u32 s44, s44, 4096
    buffer_load_dwordx4 v[144:147], v1, s[24:27], s44 offen offset:0
    ds_read_b64_tr_b16 v[60:61], v5 offset:20480
    ds_read_b64_tr_b16 v[62:63], v5 offset:22528
    s_waitcnt lgkmcnt(9)
    v_mfma_f32_16x16x32_bf16 v[12:15], v[44:47], v[112:115], v[12:15]
    buffer_load_dwordx4 v[148:151], v1, s[24:27], s44 offen offset:1024
    ds_read_b64_tr_b16 v[64:65], v6 offset:20480
    ds_read_b64_tr_b16 v[66:67], v6 offset:22528
    s_waitcnt lgkmcnt(9)
    v_mfma_f32_16x16x32_bf16 v[16:19], v[48:51], v[112:115], v[16:19]
    buffer_load_dwordx4 v[152:155], v1, s[24:27], s44 offen offset:2048
    ds_read_b64_tr_b16 v[68:69], v7 offset:20480
    ds_read_b64_tr_b16 v[70:71], v7 offset:22528
    s_waitcnt lgkmcnt(9)
    v_mfma_f32_16x16x32_bf16 v[20:23], v[52:55], v[112:115], v[20:23]
    buffer_load_dwordx4 v[156:159], v1, s[24:27], s44 offen offset:3072
    ds_read_b128 v[32:35], v36 offset:320
    s_waitcnt lgkmcnt(9)
    v_mfma_f32_16x16x32_bf16 v[24:27], v[28:31], v[112:115], v[24:27]
    s_waitcnt vmcnt(15)
    s_barrier
    ds_read_b64_tr_b16 v[40:41], v4 offset:24576
    ds_read_b64_tr_b16 v[42:43], v4 offset:26624
    s_waitcnt lgkmcnt(9)
    v_mfma_f32_16x16x32_bf16 v[8:11], v[56:59], v[116:119], v[8:11]
    s_add_u32 s44, s44, 4096
    buffer_load_dwordx4 v[160:163], v1, s[24:27], s44 offen offset:0
    ds_read_b64_tr_b16 v[44:45], v5 offset:24576
    ds_read_b64_tr_b16 v[46:47], v5 offset:26624
    s_waitcnt lgkmcnt(9)
    v_mfma_f32_16x16x32_bf16 v[12:15], v[60:63], v[116:119], v[12:15]
    buffer_load_dwordx4 v[164:167], v1, s[24:27], s44 offen offset:1024
    ds_read_b64_tr_b16 v[48:49], v6 offset:24576
    ds_read_b64_tr_b16 v[50:51], v6 offset:26624
    s_waitcnt lgkmcnt(9)
    v_mfma_f32_16x16x32_bf16 v[16:19], v[64:67], v[116:119], v[16:19]
    s_add_u32 m0, s40, 76800
    s_nop 0
    buffer_load_dwordx4 v2, s[28:31], s45 offen lds
    ds_read_b64_tr_b16 v[52:53], v7 offset:24576
    ds_read_b64_tr_b16 v[54:55], v7 offset:26624
    s_waitcnt lgkmcnt(9)
    v_mfma_f32_16x16x32_bf16 v[20:23], v[68:71], v[116:119], v[20:23]
    s_add_u32 m0, s40, 77824
    s_nop 0
    buffer_load_dwordx4 v2, s[28:31], s46 offen lds
    ds_read_b128 v[28:31], v36 offset:384
    s_waitcnt lgkmcnt(9)
    v_mfma_f32_16x16x32_bf16 v[24:27], v[32:35], v[116:119], v[24:27]
    ds_read_b64_tr_b16 v[56:57], v4 offset:28672
    ds_read_b64_tr_b16 v[58:59], v4 offset:30720
    s_waitcnt vmcnt(18) lgkmcnt(9)
    v_mfma_f32_16x16x32_bf16 v[8:11], v[40:43], v[120:123], v[8:11]
    buffer_load_dword v37, v37, s[32:35], s47 offen
    ds_read_b64_tr_b16 v[60:61], v5 offset:28672
    ds_read_b64_tr_b16 v[62:63], v5 offset:30720
    s_waitcnt lgkmcnt(9)
    v_mfma_f32_16x16x32_bf16 v[12:15], v[44:47], v[120:123], v[12:15]
    ds_read_b64_tr_b16 v[64:65], v6 offset:28672
    ds_read_b64_tr_b16 v[66:67], v6 offset:30720
    s_waitcnt lgkmcnt(9)
    v_mfma_f32_16x16x32_bf16 v[16:19], v[48:51], v[120:123], v[16:19]
    ds_read_b64_tr_b16 v[68:69], v7 offset:28672
    ds_read_b64_tr_b16 v[70:71], v7 offset:30720
    s_waitcnt lgkmcnt(9)
    v_mfma_f32_16x16x32_bf16 v[20:23], v[52:55], v[120:123], v[20:23]
    ds_read_b128 v[32:35], v36 offset:448
    s_waitcnt lgkmcnt(9)
    v_mfma_f32_16x16x32_bf16 v[24:27], v[28:31], v[120:123], v[24:27]
    ds_read_b64_tr_b16 v[40:41], v4 offset:32768
    ds_read_b64_tr_b16 v[42:43], v4 offset:34816
    s_waitcnt vmcnt(18) lgkmcnt(9)
    v_mfma_f32_16x16x32_bf16 v[8:11], v[56:59], v[124:127], v[8:11]
    ds_read_b64_tr_b16 v[44:45], v5 offset:32768
    ds_read_b64_tr_b16 v[46:47], v5 offset:34816
    s_waitcnt lgkmcnt(9)
    v_mfma_f32_16x16x32_bf16 v[12:15], v[60:63], v[124:127], v[12:15]
    ds_read_b64_tr_b16 v[48:49], v6 offset:32768
    ds_read_b64_tr_b16 v[50:51], v6 offset:34816
    s_waitcnt lgkmcnt(9)
    v_mfma_f32_16x16x32_bf16 v[16:19], v[64:67], v[124:127], v[16:19]
    ds_read_b64_tr_b16 v[52:53], v7 offset:32768
    ds_read_b64_tr_b16 v[54:55], v7 offset:34816
    s_waitcnt lgkmcnt(9)
    v_mfma_f32_16x16x32_bf16 v[20:23], v[68:71], v[124:127], v[20:23]
    ds_read_b128 v[28:31], v36 offset:512
    s_waitcnt lgkmcnt(9)
    v_mfma_f32_16x16x32_bf16 v[24:27], v[32:35], v[124:127], v[24:27]
    ds_read_b64_tr_b16 v[56:57], v4 offset:36864
    ds_read_b64_tr_b16 v[58:59], v4 offset:38912
    s_waitcnt vmcnt(17) lgkmcnt(9)
    v_mfma_f32_16x16x32_bf16 v[8:11], v[40:43], v[128:131], v[8:11]
    ds_read_b64_tr_b16 v[60:61], v5 offset:36864
    ds_read_b64_tr_b16 v[62:63], v5 offset:38912
    s_waitcnt lgkmcnt(9)
    v_mfma_f32_16x16x32_bf16 v[12:15], v[44:47], v[128:131], v[12:15]
    ds_read_b64_tr_b16 v[64:65], v6 offset:36864
    ds_read_b64_tr_b16 v[66:67], v6 offset:38912
    s_waitcnt lgkmcnt(9)
    v_mfma_f32_16x16x32_bf16 v[16:19], v[48:51], v[128:131], v[16:19]
    ds_read_b64_tr_b16 v[68:69], v7 offset:36864
    ds_read_b64_tr_b16 v[70:71], v7 offset:38912
    s_waitcnt lgkmcnt(9)
    v_mfma_f32_16x16x32_bf16 v[20:23], v[52:55], v[128:131], v[20:23]
    ds_read_b128 v[32:35], v36 offset:576
    s_waitcnt lgkmcnt(9)
    v_mfma_f32_16x16x32_bf16 v[24:27], v[28:31], v[128:131], v[24:27]
    ds_read_b64_tr_b16 v[40:41], v4 offset:40960
    ds_read_b64_tr_b16 v[42:43], v4 offset:43008
    s_waitcnt vmcnt(16) lgkmcnt(9)
    v_mfma_f32_16x16x32_bf16 v[8:11], v[56:59], v[132:135], v[8:11]
    ds_read_b64_tr_b16 v[44:45], v5 offset:40960
    ds_read_b64_tr_b16 v[46:47], v5 offset:43008
    s_waitcnt lgkmcnt(9)
    v_mfma_f32_16x16x32_bf16 v[12:15], v[60:63], v[132:135], v[12:15]
    ds_read_b64_tr_b16 v[48:49], v6 offset:40960
    ds_read_b64_tr_b16 v[50:51], v6 offset:43008
    s_waitcnt lgkmcnt(9)
    v_mfma_f32_16x16x32_bf16 v[16:19], v[64:67], v[132:135], v[16:19]
    ds_read_b64_tr_b16 v[52:53], v7 offset:40960
    ds_read_b64_tr_b16 v[54:55], v7 offset:43008
    s_waitcnt lgkmcnt(9)
    v_mfma_f32_16x16x32_bf16 v[20:23], v[68:71], v[132:135], v[20:23]
    ds_read_b128 v[28:31], v36 offset:640
    s_waitcnt lgkmcnt(9)
    v_mfma_f32_16x16x32_bf16 v[24:27], v[32:35], v[132:135], v[24:27]
    ds_read_b64_tr_b16 v[56:57], v4 offset:45056
    ds_read_b64_tr_b16 v[58:59], v4 offset:47104
    s_waitcnt vmcnt(15) lgkmcnt(9)
    v_mfma_f32_16x16x32_bf16 v[8:11], v[40:43], v[136:139], v[8:11]
    ds_read_b64_tr_b16 v[60:61], v5 offset:45056
    ds_read_b64_tr_b16 v[62:63], v5 offset:47104
    s_waitcnt lgkmcnt(9)
    v_mfma_f32_16x16x32_bf16 v[12:15], v[44:47], v[136:139], v[12:15]
    ds_read_b64_tr_b16 v[64:65], v6 offset:45056
    ds_read_b64_tr_b16 v[66:67], v6 offset:47104
    s_waitcnt lgkmcnt(9)
    v_mfma_f32_16x16x32_bf16 v[16:19], v[48:51], v[136:139], v[16:19]
    ds_read_b64_tr_b16 v[68:69], v7 offset:45056
    ds_read_b64_tr_b16 v[70:71], v7 offset:47104
    s_waitcnt lgkmcnt(9)
    v_mfma_f32_16x16x32_bf16 v[20:23], v[52:55], v[136:139], v[20:23]
    ds_read_b128 v[32:35], v36 offset:704
    s_waitcnt lgkmcnt(9)
    v_mfma_f32_16x16x32_bf16 v[24:27], v[28:31], v[136:139], v[24:27]
    s_waitcnt vmcnt(9)
    s_barrier
    ds_read_b64_tr_b16 v[40:41], v4 offset:49152
    ds_read_b64_tr_b16 v[42:43], v4 offset:51200
    s_waitcnt lgkmcnt(9)
    v_mfma_f32_16x16x32_bf16 v[8:11], v[56:59], v[140:143], v[8:11]
    ds_read_b64_tr_b16 v[44:45], v5 offset:49152
    ds_read_b64_tr_b16 v[46:47], v5 offset:51200
    s_waitcnt lgkmcnt(9)
    v_mfma_f32_16x16x32_bf16 v[12:15], v[60:63], v[140:143], v[12:15]
    ds_read_b64_tr_b16 v[48:49], v6 offset:49152
    ds_read_b64_tr_b16 v[50:51], v6 offset:51200
    s_waitcnt lgkmcnt(9)
    v_mfma_f32_16x16x32_bf16 v[16:19], v[64:67], v[140:143], v[16:19]
    ds_read_b64_tr_b16 v[52:53], v7 offset:49152
    ds_read_b64_tr_b16 v[54:55], v7 offset:51200
    s_waitcnt lgkmcnt(9)
    v_mfma_f32_16x16x32_bf16 v[20:23], v[68:71], v[140:143], v[20:23]
    ds_read_b128 v[28:31], v36 offset:768
    s_waitcnt lgkmcnt(9)
    v_mfma_f32_16x16x32_bf16 v[24:27], v[32:35], v[140:143], v[24:27]
    ds_read_b64_tr_b16 v[56:57], v4 offset:53248
    ds_read_b64_tr_b16 v[58:59], v4 offset:55296
    s_waitcnt vmcnt(8) lgkmcnt(9)
    v_mfma_f32_16x16x32_bf16 v[8:11], v[40:43], v[144:147], v[8:11]
    ds_read_b64_tr_b16 v[60:61], v5 offset:53248
    ds_read_b64_tr_b16 v[62:63], v5 offset:55296
    s_waitcnt lgkmcnt(9)
    v_mfma_f32_16x16x32_bf16 v[12:15], v[44:47], v[144:147], v[12:15]
    ds_read_b64_tr_b16 v[64:65], v6 offset:53248
    ds_read_b64_tr_b16 v[66:67], v6 offset:55296
    s_waitcnt lgkmcnt(9)
    v_mfma_f32_16x16x32_bf16 v[16:19], v[48:51], v[144:147], v[16:19]
    ds_read_b64_tr_b16 v[68:69], v7 offset:53248
    ds_read_b64_tr_b16 v[70:71], v7 offset:55296
    s_waitcnt lgkmcnt(9)
    v_mfma_f32_16x16x32_bf16 v[20:23], v[52:55], v[144:147], v[20:23]
    ds_read_b128 v[32:35], v36 offset:832
    s_waitcnt lgkmcnt(9)
    v_mfma_f32_16x16x32_bf16 v[24:27], v[28:31], v[144:147], v[24:27]
    ds_read_b64_tr_b16 v[40:41], v4 offset:57344
    ds_read_b64_tr_b16 v[42:43], v4 offset:59392
    s_waitcnt vmcnt(7) lgkmcnt(9)
    v_mfma_f32_16x16x32_bf16 v[8:11], v[56:59], v[148:151], v[8:11]
    ds_read_b64_tr_b16 v[44:45], v5 offset:57344
    ds_read_b64_tr_b16 v[46:47], v5 offset:59392
    s_waitcnt lgkmcnt(9)
    v_mfma_f32_16x16x32_bf16 v[12:15], v[60:63], v[148:151], v[12:15]
    ds_read_b64_tr_b16 v[48:49], v6 offset:57344
    ds_read_b64_tr_b16 v[50:51], v6 offset:59392
    s_waitcnt lgkmcnt(9)
    v_mfma_f32_16x16x32_bf16 v[16:19], v[64:67], v[148:151], v[16:19]
    ds_read_b64_tr_b16 v[52:53], v7 offset:57344
    ds_read_b64_tr_b16 v[54:55], v7 offset:59392
    s_waitcnt lgkmcnt(9)
    v_mfma_f32_16x16x32_bf16 v[20:23], v[68:71], v[148:151], v[20:23]
    ds_read_b128 v[28:31], v36 offset:896
    s_waitcnt lgkmcnt(9)
    v_mfma_f32_16x16x32_bf16 v[24:27], v[32:35], v[148:151], v[24:27]
    ds_read_b64_tr_b16 v[56:57], v76 offset:0
    ds_read_b64_tr_b16 v[58:59], v76 offset:2048
    s_waitcnt vmcnt(6) lgkmcnt(9)
    v_mfma_f32_16x16x32_bf16 v[8:11], v[40:43], v[152:155], v[8:11]
    ds_read_b64_tr_b16 v[60:61], v77 offset:0
    ds_read_b64_tr_b16 v[62:63], v77 offset:2048
    s_waitcnt lgkmcnt(9)
    v_mfma_f32_16x16x32_bf16 v[12:15], v[44:47], v[152:155], v[12:15]
    ds_read_b64_tr_b16 v[64:65], v78 offset:0
    ds_read_b64_tr_b16 v[66:67], v78 offset:2048
    s_waitcnt lgkmcnt(9)
    v_mfma_f32_16x16x32_bf16 v[16:19], v[48:51], v[152:155], v[16:19]
    ds_read_b64_tr_b16 v[68:69], v79 offset:0
    ds_read_b64_tr_b16 v[70:71], v79 offset:2048
    s_waitcnt lgkmcnt(9)
    v_mfma_f32_16x16x32_bf16 v[20:23], v[52:55], v[152:155], v[20:23]
    ds_read_b128 v[32:35], v36 offset:960
    s_waitcnt lgkmcnt(9)
    v_mfma_f32_16x16x32_bf16 v[24:27], v[28:31], v[152:155], v[24:27]
    ds_read_b64_tr_b16 v[40:41], v76 offset:4096
    ds_read_b64_tr_b16 v[42:43], v76 offset:6144
    s_waitcnt vmcnt(5) lgkmcnt(9)
    v_mfma_f32_16x16x32_bf16 v[8:11], v[56:59], v[156:159], v[8:11]
    ds_read_b64_tr_b16 v[44:45], v77 offset:4096
    ds_read_b64_tr_b16 v[46:47], v77 offset:6144
    s_waitcnt lgkmcnt(9)
    v_mfma_f32_16x16x32_bf16 v[12:15], v[60:63], v[156:159], v[12:15]
    ds_read_b64_tr_b16 v[48:49], v78 offset:4096
    ds_read_b64_tr_b16 v[50:51], v78 offset:6144
    s_waitcnt lgkmcnt(9)
    v_mfma_f32_16x16x32_bf16 v[16:19], v[64:67], v[156:159], v[16:19]
    ds_read_b64_tr_b16 v[52:53], v79 offset:4096
    ds_read_b64_tr_b16 v[54:55], v79 offset:6144
    s_waitcnt lgkmcnt(9)
    v_mfma_f32_16x16x32_bf16 v[20:23], v[68:71], v[156:159], v[20:23]
    ds_read_b128 v[28:31], v36 offset:1024
    s_waitcnt lgkmcnt(9)
    v_mfma_f32_16x16x32_bf16 v[24:27], v[32:35], v[156:159], v[24:27]
    ds_read_b64_tr_b16 v[56:57], v76 offset:8192
    ds_read_b64_tr_b16 v[58:59], v76 offset:10240
    s_waitcnt vmcnt(4) lgkmcnt(9)
    v_mfma_f32_16x16x32_bf16 v[8:11], v[40:43], v[160:163], v[8:11]
    ds_read_b64_tr_b16 v[60:61], v77 offset:8192
    ds_read_b64_tr_b16 v[62:63], v77 offset:10240
    s_waitcnt lgkmcnt(9)
    v_mfma_f32_16x16x32_bf16 v[12:15], v[44:47], v[160:163], v[12:15]
    ds_read_b64_tr_b16 v[64:65], v78 offset:8192
    ds_read_b64_tr_b16 v[66:67], v78 offset:10240
    s_waitcnt lgkmcnt(9)
    v_mfma_f32_16x16x32_bf16 v[16:19], v[48:51], v[160:163], v[16:19]
    ds_read_b64_tr_b16 v[68:69], v79 offset:8192
    ds_read_b64_tr_b16 v[70:71], v79 offset:10240
    s_waitcnt lgkmcnt(9)
    v_mfma_f32_16x16x32_bf16 v[20:23], v[52:55], v[160:163], v[20:23]
    ds_read_b128 v[32:35], v36 offset:1088
    s_waitcnt lgkmcnt(9)
    v_mfma_f32_16x16x32_bf16 v[24:27], v[28:31], v[160:163], v[24:27]
    s_waitcnt vmcnt(3) lgkmcnt(7)
    v_mfma_f32_16x16x32_bf16 v[8:11], v[56:59], v[164:167], v[8:11]
    s_waitcnt lgkmcnt(5)
    v_mfma_f32_16x16x32_bf16 v[12:15], v[60:63], v[164:167], v[12:15]
    s_waitcnt lgkmcnt(3)
    v_mfma_f32_16x16x32_bf16 v[16:19], v[64:67], v[164:167], v[16:19]
    s_waitcnt lgkmcnt(1)
    v_mfma_f32_16x16x32_bf16 v[20:23], v[68:71], v[164:167], v[20:23]
    s_waitcnt lgkmcnt(0)
    v_mfma_f32_16x16x32_bf16 v[24:27], v[32:35], v[164:167], v[24:27]
    s_waitcnt vmcnt(1)
    v_bfe_u32 v72, v0, 1, 2
    v_xor_b32 v73, 0, v72
    v_lshl_add_u32 v73, v73, 5, v3
    ds_read_b64 v[80:81], v73
    v_xor_b32 v73, 1, v72
    v_lshl_add_u32 v73, v73, 5, v3
    ds_read_b64 v[82:83], v73
    v_xor_b32 v73, 2, v72
    v_lshl_add_u32 v73, v73, 5, v3
    ds_read_b64 v[84:85], v73
    v_xor_b32 v73, 3, v72
    v_lshl_add_u32 v73, v73, 5, v3
    ds_read_b64 v[86:87], v73
    v_cvt_pk_bf16_f32 v40, v8, v9
    v_cvt_pk_bf16_f32 v41, v10, v11
    v_cvt_pk_bf16_f32 v42, v12, v13
    v_cvt_pk_bf16_f32 v43, v14, v15
    v_cvt_pk_bf16_f32 v44, v16, v17
    v_cvt_pk_bf16_f32 v45, v18, v19
    v_cvt_pk_bf16_f32 v46, v20, v21
    v_cvt_pk_bf16_f32 v47, v22, v23
    v_lshlrev_b32 v8, 16, v40
    v_and_b32 v9, 0xffff0000, v40
    s_waitcnt lgkmcnt(3)
    v_lshlrev_b32 v48, 16, v80
    v_and_b32 v49, 0xffff0000, v80
    v_lshlrev_b32 v10, 16, v41
    v_and_b32 v11, 0xffff0000, v41
    v_lshlrev_b32 v50, 16, v81
    v_and_b32 v51, 0xffff0000, v81
    v_lshlrev_b32 v12, 16, v42
    v_and_b32 v13, 0xffff0000, v42
    s_waitcnt lgkmcnt(2)
    v_lshlrev_b32 v52, 16, v82
    v_and_b32 v53, 0xffff0000, v82
    v_lshlrev_b32 v14, 16, v43
    v_and_b32 v15, 0xffff0000, v43
    v_lshlrev_b32 v54, 16, v83
    v_and_b32 v55, 0xffff0000, v83
    v_lshlrev_b32 v16, 16, v44
    v_and_b32 v17, 0xffff0000, v44
    s_waitcnt lgkmcnt(1)
    v_lshlrev_b32 v56, 16, v84
    v_and_b32 v57, 0xffff0000, v84
    v_lshlrev_b32 v18, 16, v45
    v_and_b32 v19, 0xffff0000, v45
    v_lshlrev_b32 v58, 16, v85
    v_and_b32 v59, 0xffff0000, v85
    v_lshlrev_b32 v20, 16, v46
    v_and_b32 v21, 0xffff0000, v46
    s_waitcnt lgkmcnt(0)
    v_lshlrev_b32 v60, 16, v86
    v_and_b32 v61, 0xffff0000, v86
    v_lshlrev_b32 v22, 16, v47
    v_and_b32 v23, 0xffff0000, v47
    v_lshlrev_b32 v62, 16, v87
    v_and_b32 v63, 0xffff0000, v87
    v_add_f32 v8, v8, v48
    v_add_f32 v9, v9, v49
    v_add_f32 v10, v10, v50
    v_add_f32 v11, v11, v51
    v_add_f32 v12, v12, v52
    v_add_f32 v13, v13, v53
    v_add_f32 v14, v14, v54
    v_add_f32 v15, v15, v55
    v_add_f32 v16, v16, v56
    v_add_f32 v17, v17, v57
    v_add_f32 v18, v18, v58
    v_add_f32 v19, v19, v59
    v_add_f32 v20, v20, v60
    v_add_f32 v21, v21, v61
    v_add_f32 v22, v22, v62
    v_add_f32 v23, v23, v63
    v_cvt_pk_bf16_f32 v40, v8, v9
    v_cvt_pk_bf16_f32 v41, v10, v11
    v_cvt_pk_bf16_f32 v42, v12, v13
    v_cvt_pk_bf16_f32 v43, v14, v15
    v_cvt_pk_bf16_f32 v44, v16, v17
    v_cvt_pk_bf16_f32 v45, v18, v19
    v_cvt_pk_bf16_f32 v46, v20, v21
    v_cvt_pk_bf16_f32 v47, v22, v23
    s_cmp_ge_u32 s41, 128
    s_cbranch_scc1 L_k3_kernel_end
    s_mul_i32 s39, s41, 18
    s_lshl_b32 s40, s38, 1
    s_add_u32 s39, s39, s40
    s_lshl_b32 s39, s39, 10
    s_add_u32 s39, s39, 10223616
    buffer_store_dwordx4 v[40:43], v1, s[32:35], s39 offen
    buffer_store_dwordx4 v[44:47], v1, s[32:35], s39 offen offset:1024
    v_lshlrev_b32 v8, 16, v40
    v_and_b32 v9, 0xffff0000, v40
    v_lshlrev_b32 v10, 16, v41
    v_and_b32 v11, 0xffff0000, v41
    v_lshlrev_b32 v12, 16, v42
    v_and_b32 v13, 0xffff0000, v42
    v_lshlrev_b32 v14, 16, v43
    v_and_b32 v15, 0xffff0000, v43
    v_lshlrev_b32 v16, 16, v44
    v_and_b32 v17, 0xffff0000, v44
    v_lshlrev_b32 v18, 16, v45
    v_and_b32 v19, 0xffff0000, v45
    v_lshlrev_b32 v20, 16, v46
    v_and_b32 v21, 0xffff0000, v46
    v_lshlrev_b32 v22, 16, v47
    v_and_b32 v23, 0xffff0000, v47
    v_add_f32 v24, v24, v25
    s_waitcnt vmcnt(2)
    v_add_f32 v24, v24, v37
    v_cvt_pk_bf16_f32 v24, v24, v24
    v_lshlrev_b32 v24, 16, v24
    v_sub_f32 v48, v8, v24
    v_sub_f32 v49, v9, v24
    v_sub_f32 v50, v10, v24
    v_sub_f32 v51, v11, v24
    v_sub_f32 v52, v12, v24
    v_sub_f32 v53, v13, v24
    v_sub_f32 v54, v14, v24
    v_sub_f32 v55, v15, v24
    v_sub_f32 v56, v16, v24
    v_sub_f32 v57, v17, v24
    v_sub_f32 v58, v18, v24
    v_sub_f32 v59, v19, v24
    v_sub_f32 v60, v20, v24
    v_sub_f32 v61, v21, v24
    v_sub_f32 v62, v22, v24
    v_sub_f32 v63, v23, v24
    v_cvt_pk_bf16_f32 v96, v48, v49
    v_cvt_pk_bf16_f32 v97, v50, v51
    v_cvt_pk_bf16_f32 v98, v52, v53
    v_cvt_pk_bf16_f32 v99, v54, v55
    v_cvt_pk_bf16_f32 v100, v56, v57
    v_cvt_pk_bf16_f32 v101, v58, v59
    v_cvt_pk_bf16_f32 v102, v60, v61
    v_cvt_pk_bf16_f32 v103, v62, v63
    s_add_u32 s39, s39, 21233664
    buffer_store_dwordx4 v[96:99], v1, s[32:35], s39 offen
    buffer_store_dwordx4 v[100:103], v1, s[32:35], s39 offen offset:1024
    v_add_f32 v88, v8, v9
    v_add_f32 v72, v10, v11
    v_add_f32 v88, v88, v12
    v_add_f32 v72, v72, v13
    v_add_f32 v88, v88, v14
    v_add_f32 v72, v72, v15
    v_add_f32 v88, v88, v16
    v_add_f32 v72, v72, v17
    v_add_f32 v88, v88, v18
    v_add_f32 v72, v72, v19
    v_add_f32 v88, v88, v20
    v_add_f32 v72, v72, v21
    v_add_f32 v88, v88, v22
    v_add_f32 v72, v72, v23
    v_add_f32 v88, v88, v72
    v_mov_b32 v72, v88
    s_nop 1
    v_permlane16_swap_b32 v88, v72
    v_add_f32 v88, v88, v72
    v_mov_b32 v72, v88
    s_nop 1
    v_permlane32_swap_b32 v88, v72
    v_add_f32 v88, v88, v72
    v_mul_f32 v73, 0x3c800000, v88
    v_sub_f32 v8, v8, v73
    v_sub_f32 v9, v9, v73
    v_sub_f32 v10, v10, v73
    v_sub_f32 v11, v11, v73
    v_sub_f32 v12, v12, v73
    v_sub_f32 v13, v13, v73
    v_sub_f32 v14, v14, v73
    v_sub_f32 v15, v15, v73
    v_sub_f32 v16, v16, v73
    v_sub_f32 v17, v17, v73
    v_sub_f32 v18, v18, v73
    v_sub_f32 v19, v19, v73
    v_sub_f32 v20, v20, v73
    v_sub_f32 v21, v21, v73
    v_sub_f32 v22, v22, v73
    v_sub_f32 v23, v23, v73
    v_mul_f32 v89, v8, v8
    v_mul_f32 v72, v9, v9
    v_fmac_f32 v89, v10, v10
    v_fmac_f32 v72, v11, v11
    v_fmac_f32 v89, v12, v12
    v_fmac_f32 v72, v13, v13
    v_fmac_f32 v89, v14, v14
    v_fmac_f32 v72, v15, v15
    v_fmac_f32 v89, v16, v16
    v_fmac_f32 v72, v17, v17
    v_fmac_f32 v89, v18, v18
    v_fmac_f32 v72, v19, v19
    v_fmac_f32 v89, v20, v20
    v_fmac_f32 v72, v21, v21
    v_fmac_f32 v89, v22, v22
    v_fmac_f32 v72, v23, v23
    v_add_f32 v89, v89, v72
    v_mov_b32 v72, v89
    s_nop 1
    v_permlane16_swap_b32 v89, v72
    v_add_f32 v89, v89, v72
    v_mov_b32 v72, v89
    s_nop 1
    v_permlane32_swap_b32 v89, v72
    v_add_f32 v89, v89, v72
    v_lshlrev_b32 v72, 3, v0
    s_lshl_b32 s39, s41, 7
    s_lshl_b32 s40, s38, 14
    s_add_u32 s39, s39, s40
    s_add_u32 s39, s39, 43319296
    s_mov_b64 exec, 0xffff
    buffer_store_dwordx2 v[88:89], v72, s[32:35], s39 offen
    s_mov_b64 exec, -1
L_k3_kernel_end:
    s_endpgm
L_k3_kernel_x:
    s_endpgm
.globl k4_kernel
.p2align 8
.type k4_kernel,@function
k4_kernel:
    s_cmp_ge_u32 s2, 256
    s_cbranch_scc1 L_k4_kernel_end
    s_load_dwordx4 s[4:7], s[0:1], 32
    s_load_dwordx2 s[8:9], s[0:1], 72
    s_load_dwordx2 s[10:11], s[0:1], 48
    v_lshrrev_b32 v160, 6, v0
    v_and_b32 v0, 63, v0
    v_readfirstlane_b32 s24, v160
    v_lshlrev_b32 v1, 4, v0
    s_and_b32 s29, s2, 7
    s_lshr_b32 s30, s2, 3
    s_lshr_b32 s27, s29, 2
    s_lshl_b32 s27, s27, 2
    s_and_b32 s28, s30, 3
    s_add_u32 s27, s27, s28
    s_and_b32 s28, s29, 3
    s_lshl_b32 s28, s28, 3
    s_lshr_b32 s30, s30, 2
    s_add_u32 s28, s28, s30
    s_lshr_b32 s25, s24, 2
    s_and_b32 s26, s24, 3
    s_lshl_b32 s29, s26, 6
    v_add_u32 v160, s29, v0
    s_lshl_b32 s29, s26, 4
    v_add_u32 v163, s29, v0
    s_mul_i32 s31, s25, 73728
    s_lshl_b32 s29, s26, 8
    s_add_u32 s31, s31, s29
    s_mul_i32 s35, s28, 288
    s_mul_i32 s32, s25, 73728
    s_lshl_b32 s29, s26, 10
    s_add_u32 s32, s32, s29
    s_lshl_b32 s29, s27, 3
    s_add_u32 s29, s29, s24
    s_mul_i32 s33, s29, 36864
    s_add_u32 s33, s33, 31457280
    s_add_u32 s34, s33, 18432
    s_mul_i32 s36, s29, 294912
    s_add_u32 s36, s36, 12582912
    s_lshr_b32 s30, s28, 1
    s_mul_i32 s30, s30, 9216
    s_add_u32 s36, s36, s30
    s_and_b32 s30, s28, 1
    s_lshl_b32 s37, s30, 3
    s_add_u32 s37, s37, s36
    s_add_u32 s37, s37, 8192
    s_lshl_b32 s30, s30, 12
    s_add_u32 s36, s36, s30
    v_add_u32 v161, 0, v160
    v_mul_u32_u24 v162, 3641, v161
    v_lshrrev_b32 v162, 16, v162
    v_mul_u32_u24 v162, 8928, v162
    v_lshl_add_u32 v156, v161, 4, v162
    v_add_u32 v161, 256, v160
    v_mul_u32_u24 v162, 3641, v161
    v_lshrrev_b32 v162, 16, v162
    v_mul_u32_u24 v162, 8928, v162
    v_lshl_add_u32 v157, v161, 4, v162
    v_add_u32 v161, 512, v163
    v_mul_u32_u24 v162, 3641, v161
    v_lshrrev_b32 v162, 16, v162
    v_mul_u32_u24 v162, 8928, v162
    v_lshl_add_u32 v158, v161, 4, v162
    s_waitcnt lgkmcnt(0)
    s_cmp_eq_u32 s25, 0
    s_cselect_b32 s16, s4, s6
    s_cselect_b32 s17, s5, s7
    s_mov_b32 s18, 5308416
    s_mov_b32 s19, 0x00020000
    s_mov_b32 s20, s8
    s_mov_b32 s21, s9
    s_mov_b32 s22, 75497472
    s_mov_b32 s23, 0x00020000
    s_add_u32 m0, s32, 0
    s_nop 0
    buffer_load_dwordx4 v156, s[16:19], s35 offen lds
    s_add_u32 m0, s32, 4096
    s_nop 0
    buffer_load_dwordx4 v157, s[16:19], s35 offen lds
    s_add_u32 m0, s31, 8192
    s_mov_b64 exec, 0xffff
    buffer_load_dwordx4 v158, s[16:19], s35 offen lds
    s_mov_b64 exec, -1
    buffer_load_dwordx4 a[24:27], v1, s[20:23], s33 offen offset:0
    buffer_load_dwordx4 a[28:31], v1, s[20:23], s34 offen offset:0
    s_add_u32 m0, s32, 9216
    s_add_u32 s35, s35, 294912
    buffer_load_dwordx4 v156, s[16:19], s35 offen lds
    s_add_u32 m0, s32, 13312
    s_nop 0
    buffer_load_dwordx4 v157, s[16:19], s35 offen lds
    s_add_u32 m0, s31, 17408
    s_mov_b64 exec, 0xffff
    buffer_load_dwordx4 v158, s[16:19], s35 offen lds
    s_mov_b64 exec, -1
    buffer_load_dwordx4 a[32:35], v1, s[20:23], s33 offen offset:1024
    buffer_load_dwordx4 a[36:39], v1, s[20:23], s34 offen offset:1024
    v_lshrrev_b32 v164, 2, v0
    v_mul_u32_u24 v148, 288, v164
    v_and_b32 v165, 3, v0
    v_lshl_add_u32 v148, v165, 3, v148
    v_add_u32 v149, 36864, v148
    v_add_u32 v150, 73728, v148
    v_add_u32 v151, 110592, v148
    v_add_u32 v2, 147456, v1
    v_and_b32 v160, 31, v0
    v_lshlrev_b32 v160, 3, v160
    s_lshl_b32 s29, s29, 8
    s_add_u32 s29, s29, 43319296
    s_mov_b32 s38, s29
    buffer_load_dwordx2 v[162:163], v160, s[20:23], s38 offen
    s_add_u32 s38, s38, 16384
    buffer_load_dwordx2 v[164:165], v160, s[20:23], s38 offen
    s_add_u32 s38, s38, 16384
    buffer_load_dwordx2 v[166:167], v160, s[20:23], s38 offen
    s_add_u32 s38, s38, 16384
    buffer_load_dwordx2 v[168:169], v160, s[20:23], s38 offen
    s_add_u32 s38, s38, 16384
    buffer_load_dwordx2 v[170:171], v160, s[20:23], s38 offen
    s_add_u32 s38, s38, 16384
    buffer_load_dwordx2 v[172:173], v160, s[20:23], s38 offen
    s_add_u32 s38, s38, 16384
    buffer_load_dwordx2 v[174:175], v160, s[20:23], s38 offen
    s_add_u32 s38, s38, 16384
    buffer_load_dwordx2 v[176:177], v160, s[20:23], s38 offen
    s_add_u32 s38, s38, 16384
    buffer_load_dwordx2 v[178:179], v160, s[20:23], s38 offen
    s_lshl_b32 s29, s2, 3
    s_add_u32 s29, s29, s24
    s_cmp_ge_u32 s29, 8
    s_cbranch_scc1 L_k4_kernel_nofl
    s_lshl_b32 s29, s29, 10
    s_add_u32 s29, s29, 43548672
    v_mov_b32 v4, 0
    v_mov_b32 v5, 0
    v_mov_b32 v6, 0
    v_mov_b32 v7, 0
    buffer_store_dwordx4 v[4:7], v1, s[20:23], s29 offen
    s_nop 1
L_k4_kernel_nofl:
    s_lshr_b32 s29, s2, 3
    s_lshl_b32 s29, s29, 3
    s_add_u32 s29, s29, s24
    s_mul_i32 s29, s29, 41
    s_and_b32 s30, s2, 3
    s_mul_i32 s30, s30, 10368
    s_add_u32 s29, s29, s30
    v_add_u32 v3, s29, v0
    v_lshlrev_b32 v3, 7, v3
    s_mov_b32 s12, s10
    s_mov_b32 s13, s11
    s_mov_b32 s14, 5308416
    s_mov_b32 s15, 0x00020000
    s_mov_b32 s26, 0x3c800000
    s_mov_b32 s30, 0x42800000
    s_waitcnt vmcnt(16)
    s_barrier
    ds_read_b64_tr_b16 a[0:1], v148 offset:0
    ds_read_b64_tr_b16 a[2:3], v148 offset:4608
    ds_read_b64_tr_b16 a[4:5], v150 offset:0
    ds_read_b64_tr_b16 a[6:7], v150 offset:4608
    ds_read_b64_tr_b16 a[8:9], v148 offset:32
    ds_read_b64_tr_b16 a[10:11], v148 offset:4640
    ds_read_b64_tr_b16 a[12:13], v150 offset:32
    ds_read_b64_tr_b16 a[14:15], v150 offset:4640
    ds_read_b64_tr_b16 a[16:17], v148 offset:64
    ds_read_b64_tr_b16 a[18:19], v148 offset:4672
    ds_read_b64_tr_b16 a[20:21], v150 offset:64
    ds_read_b64_tr_b16 a[22:23], v150 offset:4672
    s_waitcnt vmcnt(15) lgkmcnt(10)
    v_mfma_f32_16x16x32_bf16 v[4:7], a[0:3], a[24:27], 0
    s_waitcnt vmcnt(14)
    v_mfma_f32_16x16x32_bf16 v[8:11], a[0:3], a[28:31], 0
    s_add_u32 m0, s32, 18432
    s_add_u32 s35, s35, 294912
    buffer_load_dwordx4 v156, s[16:19], s35 offen lds
    ds_read_b64_tr_b16 a[0:1], v148 offset:96
    ds_read_b64_tr_b16 a[2:3], v148 offset:4704
    s_waitcnt lgkmcnt(10)
    v_mfma_f32_16x16x32_bf16 v[12:15], a[4:7], a[24:27], 0
    v_mfma_f32_16x16x32_bf16 v[16:19], a[4:7], a[28:31], 0
    ds_read_b64_tr_b16 a[4:5], v150 offset:96
    ds_read_b64_tr_b16 a[6:7], v150 offset:4704
    s_waitcnt lgkmcnt(10)
    v_mfma_f32_16x16x32_bf16 v[20:23], a[8:11], a[24:27], 0
    v_mfma_f32_16x16x32_bf16 v[24:27], a[8:11], a[28:31], 0
    s_add_u32 m0, s32, 22528
    s_nop 0
    buffer_load_dwordx4 v157, s[16:19], s35 offen lds
    ds_read_b64_tr_b16 a[8:9], v148 offset:128
    ds_read_b64_tr_b16 a[10:11], v148 offset:4736
    s_waitcnt lgkmcnt(10)
    v_mfma_f32_16x16x32_bf16 v[28:31], a[12:15], a[24:27], 0
    v_mfma_f32_16x16x32_bf16 v[32:35], a[12:15], a[28:31], 0
    ds_read_b64_tr_b16 a[12:13], v150 offset:128
    ds_read_b64_tr_b16 a[14:15], v150 offset:4736
    s_waitcnt lgkmcnt(10)
    v_mfma_f32_16x16x32_bf16 v[36:39], a[16:19], a[24:27], 0
    v_mfma_f32_16x16x32_bf16 v[40:43], a[16:19], a[28:31], 0
    s_add_u32 m0, s31, 26624
    s_mov_b64 exec, 0xffff
    buffer_load_dwordx4 v158, s[16:19], s35 offen lds
    s_mov_b64 exec, -1
    ds_read_b64_tr_b16 a[16:17], v148 offset:160
    ds_read_b64_tr_b16 a[18:19], v148 offset:4768
    s_waitcnt lgkmcnt(10)
    v_mfma_f32_16x16x32_bf16 v[44:47], a[20:23], a[24:27], 0
    v_mfma_f32_16x16x32_bf16 v[48:51], a[20:23], a[28:31], 0
    ds_read_b64_tr_b16 a[20:21], v150 offset:160
    ds_read_b64_tr_b16 a[22:23], v150 offset:4768
    s_waitcnt lgkmcnt(10)
    v_mfma_f32_16x16x32_bf16 v[52:55], a[0:3], a[24:27], 0
    v_mfma_f32_16x16x32_bf16 v[56:59], a[0:3], a[28:31], 0
    buffer_load_dwordx4 a[40:43], v1, s[20:23], s33 offen offset:2048
    ds_read_b64_tr_b16 a[0:1], v148 offset:192
    ds_read_b64_tr_b16 a[2:3], v148 offset:4800
    s_waitcnt lgkmcnt(10)
    v_mfma_f32_16x16x32_bf16 v[60:63], a[4:7], a[24:27], 0
    v_mfma_f32_16x16x32_bf16 v[64:67], a[4:7], a[28:31], 0
    ds_read_b64_tr_b16 a[4:5], v150 offset:192
    ds_read_b64_tr_b16 a[6:7], v150 offset:4800
    s_waitcnt lgkmcnt(10)
    v_mfma_f32_16x16x32_bf16 v[68:71], a[8:11], a[24:27], 0
    v_mfma_f32_16x16x32_bf16 v[72:75], a[8:11], a[28:31], 0
    buffer_load_dwordx4 a[44:47], v1, s[20:23], s34 offen offset:2048
    ds_read_b64_tr_b16 a[8:9], v148 offset:224
    ds_read_b64_tr_b16 a[10:11], v148 offset:4832
    s_waitcnt lgkmcnt(10)
    v_mfma_f32_16x16x32_bf16 v[76:79], a[12:15], a[24:27], 0
    v_mfma_f32_16x16x32_bf16 v[80:83], a[12:15], a[28:31], 0
    ds_read_b64_tr_b16 a[12:13], v150 offset:224
    ds_read_b64_tr_b16 a[14:15], v150 offset:4832
    s_waitcnt lgkmcnt(10)
    v_mfma_f32_16x16x32_bf16 v[84:87], a[16:19], a[24:27], 0
    v_mfma_f32_16x16x32_bf16 v[88:91], a[16:19], a[28:31], 0
    s_add_u32 m0, s32, 27648
    s_add_u32 s35, s35, 294912
    buffer_load_dwordx4 v156, s[16:19], s35 offen lds
    ds_read_b64_tr_b16 a[16:17], v148 offset:256
    ds_read_b64_tr_b16 a[18:19], v148 offset:4864
    s_waitcnt lgkmcnt(10)
    v_mfma_f32_16x16x32_bf16 v[92:95], a[20:23], a[24:27], 0
    v_mfma_f32_16x16x32_bf16 v[96:99], a[20:23], a[28:31], 0
    ds_read_b64_tr_b16 a[20:21], v150 offset:256
    ds_read_b64_tr_b16 a[22:23], v150 offset:4864
    s_waitcnt lgkmcnt(10)
    v_mfma_f32_16x16x32_bf16 v[100:103], a[0:3], a[24:27], 0
    v_mfma_f32_16x16x32_bf16 v[104:107], a[0:3], a[28:31], 0
    s_add_u32 m0, s32, 31744
    s_nop 0
    buffer_load_dwordx4 v157, s[16:19], s35 offen lds
    s_waitcnt vmcnt(18)
    s_barrier
    ds_read_b64_tr_b16 a[0:1], v148 offset:9216
    ds_read_b64_tr_b16 a[2:3], v148 offset:13824
    s_waitcnt lgkmcnt(10)
    v_mfma_f32_16x16x32_bf16 v[108:111], a[4:7], a[24:27], 0
    v_mfma_f32_16x16x32_bf16 v[112:115], a[4:7], a[28:31], 0
    ds_read_b64_tr_b16 a[4:5], v150 offset:9216
    ds_read_b64_tr_b16 a[6:7], v150 offset:13824
    s_waitcnt lgkmcnt(10)
    v_mfma_f32_16x16x32_bf16 v[116:119], a[8:11], a[24:27], 0
    v_mfma_f32_16x16x32_bf16 v[120:123], a[8:11], a[28:31], 0
    s_add_u32 m0, s31, 35840
    s_mov_b64 exec, 0xffff
    buffer_load_dwordx4 v158, s[16:19], s35 offen lds
    s_mov_b64 exec, -1
    ds_read_b64_tr_b16 a[8:9], v148 offset:9248
    ds_read_b64_tr_b16 a[10:11], v148 offset:13856
    s_waitcnt lgkmcnt(10)
    v_mfma_f32_16x16x32_bf16 v[124:127], a[12:15], a[24:27], 0
    v_mfma_f32_16x16x32_bf16 v[128:131], a[12:15], a[28:31], 0
    ds_read_b64_tr_b16 a[12:13], v150 offset:9248
    ds_read_b64_tr_b16 a[14:15], v150 offset:13856
    s_waitcnt lgkmcnt(10)
    v_mfma_f32_16x16x32_bf16 v[132:135], a[16:19], a[24:27], 0
    v_mfma_f32_16x16x32_bf16 v[136:139], a[16:19], a[28:31], 0
    buffer_load_dwordx4 a[48:51], v1, s[20:23], s33 offen offset:3072
    ds_read_b64_tr_b16 a[16:17], v148 offset:9280
    ds_read_b64_tr_b16 a[18:19], v148 offset:13888
    s_waitcnt lgkmcnt(10)
    v_mfma_f32_16x16x32_bf16 v[140:143], a[20:23], a[24:27], 0
    v_mfma_f32_16x16x32_bf16 v[144:147], a[20:23], a[28:31], 0
    ds_read_b64_tr_b16 a[20:21], v150 offset:9280
    ds_read_b64_tr_b16 a[22:23], v150 offset:13888
    s_waitcnt vmcnt(19) lgkmcnt(10)
    v_mfma_f32_16x16x32_bf16 v[4:7], a[0:3], a[32:35], v[4:7]
    s_waitcnt vmcnt(18)
    v_mfma_f32_16x16x32_bf16 v[8:11], a[0:3], a[36:39], v[8:11]
    buffer_load_dwordx4 a[52:55], v1, s[20:23], s34 offen offset:3072
    ds_read_b64_tr_b16 a[0:1], v148 offset:9312
    ds_read_b64_tr_b16 a[2:3], v148 offset:13920
    s_waitcnt lgkmcnt(10)
    v_mfma_f32_16x16x32_bf16 v[12:15], a[4:7], a[32:35], v[12:15]
    v_mfma_f32_16x16x32_bf16 v[16:19], a[4:7], a[36:39], v[16:19]
    ds_read_b64_tr_b16 a[4:5], v150 offset:9312
    ds_read_b64_tr_b16 a[6:7], v150 offset:13920
    s_waitcnt lgkmcnt(10)
    v_mfma_f32_16x16x32_bf16 v[20:23], a[8:11], a[32:35], v[20:23]
    v_mfma_f32_16x16x32_bf16 v[24:27], a[8:11], a[36:39], v[24:27]
    s_add_u32 m0, s32, 36864
    s_add_u32 s35, s35, 294912
    buffer_load_dwordx4 v156, s[16:19], s35 offen lds
    ds_read_b64_tr_b16 a[8:9], v148 offset:9344
    ds_read_b64_tr_b16 a[10:11], v148 offset:13952
    s_waitcnt lgkmcnt(10)
    v_mfma_f32_16x16x32_bf16 v[28:31], a[12:15], a[32:35], v[28:31]
    v_mfma_f32_16x16x32_bf16 v[32:35], a[12:15], a[36:39], v[32:35]
    ds_read_b64_tr_b16 a[12:13], v150 offset:9344
    ds_read_b64_tr_b16 a[14:15], v150 offset:13952
    s_waitcnt lgkmcnt(10)
    v_mfma_f32_16x16x32_bf16 v[36:39], a[16:19], a[32:35], v[36:39]
    v_mfma_f32_16x16x32_bf16 v[40:43], a[16:19], a[36:39], v[40:43]
    s_add_u32 m0, s32, 40960
    s_nop 0
    buffer_load_dwordx4 v157, s[16:19], s35 offen lds
    ds_read_b64_tr_b16 a[16:17], v148 offset:9376
    ds_read_b64_tr_b16 a[18:19], v148 offset:13984
    s_waitcnt lgkmcnt(10)
    v_mfma_f32_16x16x32_bf16 v[44:47], a[20:23], a[32:35], v[44:47]
    v_mfma_f32_16x16x32_bf16 v[48:51], a[20:23], a[36:39], v[48:51]
    ds_read_b64_tr_b16 a[20:21], v150 offset:9376
    ds_read_b64_tr_b16 a[22:23], v150 offset:13984
    s_waitcnt lgkmcnt(10)
    v_mfma_f32_16x16x32_bf16 v[52:55], a[0:3], a[32:35], v[52:55]
    v_mfma_f32_16x16x32_bf16 v[56:59], a[0:3], a[36:39], v[56:59]
    s_add_u32 m0, s31, 45056
    s_mov_b64 exec, 0xffff
    buffer_load_dwordx4 v158, s[16:19], s35 offen lds
    s_mov_b64 exec, -1
    ds_read_b64_tr_b16 a[0:1], v148 offset:9408
    ds_read_b64_tr_b16 a[2:3], v148 offset:14016
    s_waitcnt lgkmcnt(10)
    v_mfma_f32_16x16x32_bf16 v[60:63], a[4:7], a[32:35], v[60:63]
    v_mfma_f32_16x16x32_bf16 v[64:67], a[4:7], a[36:39], v[64:67]
    ds_read_b64_tr_b16 a[4:5], v150 offset:9408
    ds_read_b64_tr_b16 a[6:7], v150 offset:14016
    s_waitcnt lgkmcnt(10)
    v_mfma_f32_16x16x32_bf16 v[68:71], a[8:11], a[32:35], v[68:71]
    v_mfma_f32_16x16x32_bf16 v[72:75], a[8:11], a[36:39], v[72:75]
    s_add_u32 s33, s33, 4096
    buffer_load_dwordx4 a[56:59], v1, s[20:23], s33 offen offset:0
    ds_read_b64_tr_b16 a[8:9], v148 offset:9440
    ds_read_b64_tr_b16 a[10:11], v148 offset:14048
    s_waitcnt lgkmcnt(10)
    v_mfma_f32_16x16x32_bf16 v[76:79], a[12:15], a[32:35], v[76:79]
    v_mfma_f32_16x16x32_bf16 v[80:83], a[12:15], a[36:39], v[80:83]
    ds_read_b64_tr_b16 a[12:13], v150 offset:9440
    ds_read_b64_tr_b16 a[14:15], v150 offset:14048
    s_waitcnt lgkmcnt(10)
    v_mfma_f32_16x16x32_bf16 v[84:87], a[16:19], a[32:35], v[84:87]
    v_mfma_f32_16x16x32_bf16 v[88:91], a[16:19], a[36:39], v[88:91]
    s_add_u32 s34, s34, 4096
    buffer_load_dwordx4 a[60:63], v1, s[20:23], s34 offen offset:0
    ds_read_b64_tr_b16 a[16:17], v148 offset:9472
    ds_read_b64_tr_b16 a[18:19], v148 offset:14080
    s_waitcnt lgkmcnt(10)
    v_mfma_f32_16x16x32_bf16 v[92:95], a[20:23], a[32:35], v[92:95]
    v_mfma_f32_16x16x32_bf16 v[96:99], a[20:23], a[36:39], v[96:99]
    ds_read_b64_tr_b16 a[20:21], v150 offset:9472
    ds_read_b64_tr_b16 a[22:23], v150 offset:14080
    s_waitcnt lgkmcnt(10)
    v_mfma_f32_16x16x32_bf16 v[100:103], a[0:3], a[32:35], v[100:103]
    v_mfma_f32_16x16x32_bf16 v[104:107], a[0:3], a[36:39], v[104:107]
    s_add_u32 m0, s32, 46080
    s_add_u32 s35, s35, 294912
    buffer_load_dwordx4 v156, s[16:19], s35 offen lds
    s_waitcnt vmcnt(13)
    s_barrier
    ds_read_b64_tr_b16 a[0:1], v148 offset:18432
    ds_read_b64_tr_b16 a[2:3], v148 offset:23040
    s_waitcnt lgkmcnt(10)
    v_mfma_f32_16x16x32_bf16 v[108:111], a[4:7], a[32:35], v[108:111]
    v_mfma_f32_16x16x32_bf16 v[112:115], a[4:7], a[36:39], v[112:115]
    ds_read_b64_tr_b16 a[4:5], v150 offset:18432
    ds_read_b64_tr_b16 a[6:7], v150 offset:23040
    s_waitcnt lgkmcnt(10)
    v_mfma_f32_16x16x32_bf16 v[116:119], a[8:11], a[32:35], v[116:119]
    v_mfma_f32_16x16x32_bf16 v[120:123], a[8:11], a[36:39], v[120:123]
    s_add_u32 m0, s32, 50176
    s_nop 0
    buffer_load_dwordx4 v157, s[16:19], s35 offen lds
    ds_read_b64_tr_b16 a[8:9], v148 offset:18464
    ds_read_b64_tr_b16 a[10:11], v148 offset:23072
    s_waitcnt lgkmcnt(10)
    v_mfma_f32_16x16x32_bf16 v[124:127], a[12:15], a[32:35], v[124:127]
    v_mfma_f32_16x16x32_bf16 v[128:131], a[12:15], a[36:39], v[128:131]
    ds_read_b64_tr_b16 a[12:13], v150 offset:18464
    ds_read_b64_tr_b16 a[14:15], v150 offset:23072
    s_waitcnt lgkmcnt(10)
    v_mfma_f32_16x16x32_bf16 v[132:135], a[16:19], a[32:35], v[132:135]
    v_mfma_f32_16x16x32_bf16 v[136:139], a[16:19], a[36:39], v[136:139]
    s_add_u32 m0, s31, 54272
    s_mov_b64 exec, 0xffff
    buffer_load_dwordx4 v158, s[16:19], s35 offen lds
    s_mov_b64 exec, -1
    ds_read_b64_tr_b16 a[16:17], v148 offset:18496
    ds_read_b64_tr_b16 a[18:19], v148 offset:23104
    s_waitcnt lgkmcnt(10)
    v_mfma_f32_16x16x32_bf16 v[140:143], a[20:23], a[32:35], v[140:143]
    v_mfma_f32_16x16x32_bf16 v[144:147], a[20:23], a[36:39], v[144:147]
    ds_read_b64_tr_b16 a[20:21], v150 offset:18496
    ds_read_b64_tr_b16 a[22:23], v150 offset:23104
    s_waitcnt vmcnt(14) lgkmcnt(10)
    v_mfma_f32_16x16x32_bf16 v[4:7], a[0:3], a[40:43], v[4:7]
    s_waitcnt vmcnt(13)
    v_mfma_f32_16x16x32_bf16 v[8:11], a[0:3], a[44:47], v[8:11]
    buffer_load_dwordx4 a[64:67], v1, s[20:23], s33 offen offset:1024
    ds_read_b64_tr_b16 a[0:1], v148 offset:18528
    ds_read_b64_tr_b16 a[2:3], v148 offset:23136
    s_waitcnt lgkmcnt(10)
    v_mfma_f32_16x16x32_bf16 v[12:15], a[4:7], a[40:43], v[12:15]
    v_mfma_f32_16x16x32_bf16 v[16:19], a[4:7], a[44:47], v[16:19]
    ds_read_b64_tr_b16 a[4:5], v150 offset:18528
    ds_read_b64_tr_b16 a[6:7], v150 offset:23136
    s_waitcnt lgkmcnt(10)
    v_mfma_f32_16x16x32_bf16 v[20:23], a[8:11], a[40:43], v[20:23]
    v_mfma_f32_16x16x32_bf16 v[24:27], a[8:11], a[44:47], v[24:27]
    buffer_load_dwordx4 a[68:71], v1, s[20:23], s34 offen offset:1024
    ds_read_b64_tr_b16 a[8:9], v148 offset:18560
    ds_read_b64_tr_b16 a[10:11], v148 offset:23168
    s_waitcnt lgkmcnt(10)
    v_mfma_f32_16x16x32_bf16 v[28:31], a[12:15], a[40:43], v[28:31]
    v_mfma_f32_16x16x32_bf16 v[32:35], a[12:15], a[44:47], v[32:35]
    ds_read_b64_tr_b16 a[12:13], v150 offset:18560
    ds_read_b64_tr_b16 a[14:15], v150 offset:23168
    s_waitcnt lgkmcnt(10)
    v_mfma_f32_16x16x32_bf16 v[36:39], a[16:19], a[40:43], v[36:39]
    v_mfma_f32_16x16x32_bf16 v[40:43], a[16:19], a[44:47], v[40:43]
    s_add_u32 m0, s32, 55296
    s_add_u32 s35, s35, 294912
    buffer_load_dwordx4 v156, s[16:19], s35 offen lds
    ds_read_b64_tr_b16 a[16:17], v148 offset:18592
    ds_read_b64_tr_b16 a[18:19], v148 offset:23200
    s_waitcnt lgkmcnt(10)
    v_mfma_f32_16x16x32_bf16 v[44:47], a[20:23], a[40:43], v[44:47]
    v_mfma_f32_16x16x32_bf16 v[48:51], a[20:23], a[44:47], v[48:51]
    ds_read_b64_tr_b16 a[20:21], v150 offset:18592
    ds_read_b64_tr_b16 a[22:23], v150 offset:23200
    s_waitcnt lgkmcnt(10)
    v_mfma_f32_16x16x32_bf16 v[52:55], a[0:3], a[40:43], v[52:55]
    v_mfma_f32_16x16x32_bf16 v[56:59], a[0:3], a[44:47], v[56:59]
    s_add_u32 m0, s32, 59392
    s_nop 0
    buffer_load_dwordx4 v157, s[16:19], s35 offen lds
    ds_read_b64_tr_b16 a[0:1], v148 offset:18624
    ds_read_b64_tr_b16 a[2:3], v148 offset:23232
    s_waitcnt lgkmcnt(10)
    v_mfma_f32_16x16x32_bf16 v[60:63], a[4:7], a[40:43], v[60:63]
    v_mfma_f32_16x16x32_bf16 v[64:67], a[4:7], a[44:47], v[64:67]
    ds_read_b64_tr_b16 a[4:5], v150 offset:18624
    ds_read_b64_tr_b16 a[6:7], v150 offset:23232
    s_waitcnt lgkmcnt(10)
    v_mfma_f32_16x16x32_bf16 v[68:71], a[8:11], a[40:43], v[68:71]
    v_mfma_f32_16x16x32_bf16 v[72:75], a[8:11], a[44:47], v[72:75]
    s_add_u32 m0, s31, 63488
    s_mov_b64 exec, 0xffff
    buffer_load_dwordx4 v158, s[16:19], s35 offen lds
    s_mov_b64 exec, -1
    ds_read_b64_tr_b16 a[8:9], v148 offset:18656
    ds_read_b64_tr_b16 a[10:11], v148 offset:23264
    s_waitcnt lgkmcnt(10)
    v_mfma_f32_16x16x32_bf16 v[76:79], a[12:15], a[40:43], v[76:79]
    v_mfma_f32_16x16x32_bf16 v[80:83], a[12:15], a[44:47], v[80:83]
    ds_read_b64_tr_b16 a[12:13], v150 offset:18656
    ds_read_b64_tr_b16 a[14:15], v150 offset:23264
    s_waitcnt lgkmcnt(10)
    v_mfma_f32_16x16x32_bf16 v[84:87], a[16:19], a[40:43], v[84:87]
    v_mfma_f32_16x16x32_bf16 v[88:91], a[16:19], a[44:47], v[88:91]
    buffer_load_dwordx4 a[24:27], v1, s[20:23], s33 offen offset:2048
    ds_read_b64_tr_b16 a[16:17], v148 offset:18688
    ds_read_b64_tr_b16 a[18:19], v148 offset:23296
    s_waitcnt lgkmcnt(10)
    v_mfma_f32_16x16x32_bf16 v[92:95], a[20:23], a[40:43], v[92:95]
    v_mfma_f32_16x16x32_bf16 v[96:99], a[20:23], a[44:47], v[96:99]
    ds_read_b64_tr_b16 a[20:21], v150 offset:18688
    ds_read_b64_tr_b16 a[22:23], v150 offset:23296
    s_waitcnt lgkmcnt(10)
    v_mfma_f32_16x16x32_bf16 v[100:103], a[0:3], a[40:43], v[100:103]
    v_mfma_f32_16x16x32_bf16 v[104:107], a[0:3], a[44:47], v[104:107]
    buffer_load_dwordx4 a[28:31], v1, s[20:23], s34 offen offset:2048
    s_waitcnt vmcnt(17)
    s_barrier
    ds_read_b64_tr_b16 a[0:1], v148 offset:27648
    ds_read_b64_tr_b16 a[2:3], v148 offset:32256
    s_waitcnt lgkmcnt(10)
    v_mfma_f32_16x16x32_bf16 v[108:111], a[4:7], a[40:43], v[108:111]
    v_mfma_f32_16x16x32_bf16 v[112:115], a[4:7], a[44:47], v[112:115]
    ds_read_b64_tr_b16 a[4:5], v150 offset:27648
    ds_read_b64_tr_b16 a[6:7], v150 offset:32256
    s_waitcnt lgkmcnt(10)
    v_mfma_f32_16x16x32_bf16 v[116:119], a[8:11], a[40:43], v[116:119]
    v_mfma_f32_16x16x32_bf16 v[120:123], a[8:11], a[44:47], v[120:123]
    s_add_u32 m0, s32, 64512
    s_add_u32 s35, s35, 294912
    buffer_load_dwordx4 v156, s[16:19], s35 offen lds
    ds_read_b64_tr_b16 a[8:9], v148 offset:27680
    ds_read_b64_tr_b16 a[10:11], v148 offset:32288
    s_waitcnt lgkmcnt(10)
    v_mfma_f32_16x16x32_bf16 v[124:127], a[12:15], a[40:43], v[124:127]
    v_mfma_f32_16x16x32_bf16 v[128:131], a[12:15], a[44:47], v[128:131]
    ds_read_b64_tr_b16 a[12:13], v150 offset:27680
    ds_read_b64_tr_b16 a[14:15], v150 offset:32288
    s_waitcnt lgkmcnt(10)
    v_mfma_f32_16x16x32_bf16 v[132:135], a[16:19], a[40:43], v[132:135]
    v_mfma_f32_16x16x32_bf16 v[136:139], a[16:19], a[44:47], v[136:139]
    s_add_u32 m0, s32, 68608
    s_nop 0
    buffer_load_dwordx4 v157, s[16:19], s35 offen lds
    ds_read_b64_tr_b16 a[16:17], v148 offset:27712
    ds_read_b64_tr_b16 a[18:19], v148 offset:32320
    s_waitcnt lgkmcnt(10)
    v_mfma_f32_16x16x32_bf16 v[140:143], a[20:23], a[40:43], v[140:143]
    v_mfma_f32_16x16x32_bf16 v[144:147], a[20:23], a[44:47], v[144:147]
    ds_read_b64_tr_b16 a[20:21], v150 offset:27712
    ds_read_b64_tr_b16 a[22:23], v150 offset:32320
    s_waitcnt vmcnt(18) lgkmcnt(10)
    v_mfma_f32_16x16x32_bf16 v[4:7], a[0:3], a[48:51], v[4:7]
    s_waitcnt vmcnt(17)
    v_mfma_f32_16x16x32_bf16 v[8:11], a[0:3], a[52:55], v[8:11]
    s_add_u32 m0, s31, 72704
    s_mov_b64 exec, 0xffff
    buffer_load_dwordx4 v158, s[16:19], s35 offen lds
    s_mov_b64 exec, -1
    ds_read_b64_tr_b16 a[0:1], v148 offset:27744
    ds_read_b64_tr_b16 a[2:3], v148 offset:32352
    s_waitcnt lgkmcnt(10)
    v_mfma_f32_16x16x32_bf16 v[12:15], a[4:7], a[48:51], v[12:15]
    v_mfma_f32_16x16x32_bf16 v[16:19], a[4:7], a[52:55], v[16:19]
    ds_read_b64_tr_b16 a[4:5], v150 offset:27744
    ds_read_b64_tr_b16 a[6:7], v150 offset:32352
    s_waitcnt lgkmcnt(10)
    v_mfma_f32_16x16x32_bf16 v[20:23], a[8:11], a[48:51], v[20:23]
    v_mfma_f32_16x16x32_bf16 v[24:27], a[8:11], a[52:55], v[24:27]
    buffer_load_dwordx4 a[32:35], v1, s[20:23], s33 offen offset:3072
    ds_read_b64_tr_b16 a[8:9], v148 offset:27776
    ds_read_b64_tr_b16 a[10:11], v148 offset:32384
    s_waitcnt lgkmcnt(10)
    v_mfma_f32_16x16x32_bf16 v[28:31], a[12:15], a[48:51], v[28:31]
    v_mfma_f32_16x16x32_bf16 v[32:35], a[12:15], a[52:55], v[32:35]
    ds_read_b64_tr_b16 a[12:13], v150 offset:27776
    ds_read_b64_tr_b16 a[14:15], v150 offset:32384
    s_waitcnt lgkmcnt(10)
    v_mfma_f32_16x16x32_bf16 v[36:39], a[16:19], a[48:51], v[36:39]
    v_mfma_f32_16x16x32_bf16 v[40:43], a[16:19], a[52:55], v[40:43]
    buffer_load_dwordx4 a[36:39], v1, s[20:23], s34 offen offset:3072
    ds_read_b64_tr_b16 a[16:17], v148 offset:27808
    ds_read_b64_tr_b16 a[18:19], v148 offset:32416
    s_waitcnt lgkmcnt(10)
    v_mfma_f32_16x16x32_bf16 v[44:47], a[20:23], a[48:51], v[44:47]
    v_mfma_f32_16x16x32_bf16 v[48:51], a[20:23], a[52:55], v[48:51]
    ds_read_b64_tr_b16 a[20:21], v150 offset:27808
    ds_read_b64_tr_b16 a[22:23], v150 offset:32416
    s_waitcnt lgkmcnt(10)
    v_mfma_f32_16x16x32_bf16 v[52:55], a[0:3], a[48:51], v[52:55]
    v_mfma_f32_16x16x32_bf16 v[56:59], a[0:3], a[52:55], v[56:59]
    s_add_u32 m0, s32, 0
    s_add_u32 s35, s35, 294912
    buffer_load_dwordx4 v156, s[16:19], s35 offen lds
    ds_read_b64_tr_b16 a[0:1], v148 offset:27840
    ds_read_b64_tr_b16 a[2:3], v148 offset:32448
    s_waitcnt lgkmcnt(10)
    v_mfma_f32_16x16x32_bf16 v[60:63], a[4:7], a[48:51], v[60:63]
    v_mfma_f32_16x16x32_bf16 v[64:67], a[4:7], a[52:55], v[64:67]
    ds_read_b64_tr_b16 a[4:5], v150 offset:27840
    ds_read_b64_tr_b16 a[6:7], v150 offset:32448
    s_waitcnt lgkmcnt(10)
    v_mfma_f32_16x16x32_bf16 v[68:71], a[8:11], a[48:51], v[68:71]
    v_mfma_f32_16x16x32_bf16 v[72:75], a[8:11], a[52:55], v[72:75]
    s_add_u32 m0, s32, 4096
    s_nop 0
    buffer_load_dwordx4 v157, s[16:19], s35 offen lds
    ds_read_b64_tr_b16 a[8:9], v148 offset:27872
    ds_read_b64_tr_b16 a[10:11], v148 offset:32480
    s_waitcnt lgkmcnt(10)
    v_mfma_f32_16x16x32_bf16 v[76:79], a[12:15], a[48:51], v[76:79]
    v_mfma_f32_16x16x32_bf16 v[80:83], a[12:15], a[52:55], v[80:83]
    ds_read_b64_tr_b16 a[12:13], v150 offset:27872
    ds_read_b64_tr_b16 a[14:15], v150 offset:32480
    s_waitcnt lgkmcnt(10)
    v_mfma_f32_16x16x32_bf16 v[84:87], a[16:19], a[48:51], v[84:87]
    v_mfma_f32_16x16x32_bf16 v[88:91], a[16:19], a[52:55], v[88:91]
    s_add_u32 m0, s31, 8192
    s_mov_b64 exec, 0xffff
    buffer_load_dwordx4 v158, s[16:19], s35 offen lds
    s_mov_b64 exec, -1
    ds_read_b64_tr_b16 a[16:17], v148 offset:27904
    ds_read_b64_tr_b16 a[18:19], v148 offset:32512
    s_waitcnt lgkmcnt(10)
    v_mfma_f32_16x16x32_bf16 v[92:95], a[20:23], a[48:51], v[92:95]
    v_mfma_f32_16x16x32_bf16 v[96:99], a[20:23], a[52:55], v[96:99]
    ds_read_b64_tr_b16 a[20:21], v150 offset:27904
    ds_read_b64_tr_b16 a[22:23], v150 offset:32512
    s_waitcnt lgkmcnt(10)
    v_mfma_f32_16x16x32_bf16 v[100:103], a[0:3], a[48:51], v[100:103]
    v_mfma_f32_16x16x32_bf16 v[104:107], a[0:3], a[52:55], v[104:107]
    s_add_u32 s33, s33, 4096
    buffer_load_dwordx4 a[40:43], v1, s[20:23], s33 offen offset:0
    s_waitcnt vmcnt(21)
    s_barrier
    ds_read_b64_tr_b16 a[0:1], v149 offset:0
    ds_read_b64_tr_b16 a[2:3], v149 offset:4608
    s_waitcnt lgkmcnt(10)
    v_mfma_f32_16x16x32_bf16 v[108:111], a[4:7], a[48:51], v[108:111]
    v_mfma_f32_16x16x32_bf16 v[112:115], a[4:7], a[52:55], v[112:115]
    ds_read_b64_tr_b16 a[4:5], v151 offset:0
    ds_read_b64_tr_b16 a[6:7], v151 offset:4608
    s_waitcnt lgkmcnt(10)
    v_mfma_f32_16x16x32_bf16 v[116:119], a[8:11], a[48:51], v[116:119]
    v_mfma_f32_16x16x32_bf16 v[120:123], a[8:11], a[52:55], v[120:123]
    s_add_u32 s34, s34, 4096
    buffer_load_dwordx4 a[44:47], v1, s[20:23], s34 offen offset:0
    ds_read_b64_tr_b16 a[8:9], v149 offset:32
    ds_read_b64_tr_b16 a[10:11], v149 offset:4640
    s_waitcnt lgkmcnt(10)
    v_mfma_f32_16x16x32_bf16 v[124:127], a[12:15], a[48:51], v[124:127]
    v_mfma_f32_16x16x32_bf16 v[128:131], a[12:15], a[52:55], v[128:131]
    ds_read_b64_tr_b16 a[12:13], v151 offset:32
    ds_read_b64_tr_b16 a[14:15], v151 offset:4640
    s_waitcnt lgkmcnt(10)
    v_mfma_f32_16x16x32_bf16 v[132:135], a[16:19], a[48:51], v[132:135]
    v_mfma_f32_16x16x32_bf16 v[136:139], a[16:19], a[52:55], v[136:139]
    s_add_u32 m0, s32, 9216
    s_add_u32 s35, s35, 294912
    buffer_load_dwordx4 v156, s[16:19], s35 offen lds
    ds_read_b64_tr_b16 a[16:17], v149 offset:64
    ds_read_b64_tr_b16 a[18:19], v149 offset:4672
    s_waitcnt lgkmcnt(10)
    v_mfma_f32_16x16x32_bf16 v[140:143], a[20:23], a[48:51], v[140:143]
    v_mfma_f32_16x16x32_bf16 v[144:147], a[20:23], a[52:55], v[144:147]
    ds_read_b64_tr_b16 a[20:21], v151 offset:64
    ds_read_b64_tr_b16 a[22:23], v151 offset:4672
    s_waitcnt vmcnt(22) lgkmcnt(10)
    v_mfma_f32_16x16x32_bf16 v[4:7], a[0:3], a[56:59], v[4:7]
    s_waitcnt vmcnt(21)
    v_mfma_f32_16x16x32_bf16 v[8:11], a[0:3], a[60:63], v[8:11]
    s_add_u32 m0, s32, 13312
    s_nop 0
    buffer_load_dwordx4 v157, s[16:19], s35 offen lds
    ds_read_b64_tr_b16 a[0:1], v149 offset:96
    ds_read_b64_tr_b16 a[2:3], v149 offset:4704
    s_waitcnt lgkmcnt(10)
    v_mfma_f32_16x16x32_bf16 v[12:15], a[4:7], a[56:59], v[12:15]
    v_mfma_f32_16x16x32_bf16 v[16:19], a[4:7], a[60:63], v[16:19]
    ds_read_b64_tr_b16 a[4:5], v151 offset:96
    ds_read_b64_tr_b16 a[6:7], v151 offset:4704
    s_waitcnt lgkmcnt(10)
    v_mfma_f32_16x16x32_bf16 v[20:23], a[8:11], a[56:59], v[20:23]
    v_mfma_f32_16x16x32_bf16 v[24:27], a[8:11], a[60:63], v[24:27]
    s_add_u32 m0, s31, 17408
    s_mov_b64 exec, 0xffff
    buffer_load_dwordx4 v158, s[16:19], s35 offen lds
    s_mov_b64 exec, -1
    ds_read_b64_tr_b16 a[8:9], v149 offset:128
    ds_read_b64_tr_b16 a[10:11], v149 offset:4736
    s_waitcnt lgkmcnt(10)
    v_mfma_f32_16x16x32_bf16 v[28:31], a[12:15], a[56:59], v[28:31]
    v_mfma_f32_16x16x32_bf16 v[32:35], a[12:15], a[60:63], v[32:35]
    ds_read_b64_tr_b16 a[12:13], v151 offset:128
    ds_read_b64_tr_b16 a[14:15], v151 offset:4736
    s_waitcnt lgkmcnt(10)
    v_mfma_f32_16x16x32_bf16 v[36:39], a[16:19], a[56:59], v[36:39]
    v_mfma_f32_16x16x32_bf16 v[40:43], a[16:19], a[60:63], v[40:43]
    buffer_load_dwordx4 a[48:51], v1, s[20:23], s33 offen offset:1024
    ds_read_b64_tr_b16 a[16:17], v149 offset:160
    ds_read_b64_tr_b16 a[18:19], v149 offset:4768
    s_waitcnt lgkmcnt(10)
    v_mfma_f32_16x16x32_bf16 v[44:47], a[20:23], a[56:59], v[44:47]
    v_mfma_f32_16x16x32_bf16 v[48:51], a[20:23], a[60:63], v[48:51]
    ds_read_b64_tr_b16 a[20:21], v151 offset:160
    ds_read_b64_tr_b16 a[22:23], v151 offset:4768
    s_waitcnt lgkmcnt(10)
    v_mfma_f32_16x16x32_bf16 v[52:55], a[0:3], a[56:59], v[52:55]
    v_mfma_f32_16x16x32_bf16 v[56:59], a[0:3], a[60:63], v[56:59]
    buffer_load_dwordx4 a[52:55], v1, s[20:23], s34 offen offset:1024
    ds_read_b64_tr_b16 a[0:1], v149 offset:192
    ds_read_b64_tr_b16 a[2:3], v149 offset:4800
    s_waitcnt lgkmcnt(10)
    v_mfma_f32_16x16x32_bf16 v[60:63], a[4:7], a[56:59], v[60:63]
    v_mfma_f32_16x16x32_bf16 v[64:67], a[4:7], a[60:63], v[64:67]
    ds_read_b64_tr_b16 a[4:5], v151 offset:192
    ds_read_b64_tr_b16 a[6:7], v151 offset:4800
    s_waitcnt lgkmcnt(10)
    v_mfma_f32_16x16x32_bf16 v[68:71], a[8:11], a[56:59], v[68:71]
    v_mfma_f32_16x16x32_bf16 v[72:75], a[8:11], a[60:63], v[72:75]
    s_add_u32 m0, s32, 18432
    s_add_u32 s35, s35, 294912
    buffer_load_dwordx4 v156, s[16:19], s35 offen lds
    ds_read_b64_tr_b16 a[8:9], v149 offset:224
    ds_read_b64_tr_b16 a[10:11], v149 offset:4832
    s_waitcnt lgkmcnt(10)
    v_mfma_f32_16x16x32_bf16 v[76:79], a[12:15], a[56:59], v[76:79]
    v_mfma_f32_16x16x32_bf16 v[80:83], a[12:15], a[60:63], v[80:83]
    ds_read_b64_tr_b16 a[12:13], v151 offset:224
    ds_read_b64_tr_b16 a[14:15], v151 offset:4832
    s_waitcnt lgkmcnt(10)
    v_mfma_f32_16x16x32_bf16 v[84:87], a[16:19], a[56:59], v[84:87]
    v_mfma_f32_16x16x32_bf16 v[88:91], a[16:19], a[60:63], v[88:91]
    s_add_u32 m0, s32, 22528
    s_nop 0
    buffer_load_dwordx4 v157, s[16:19], s35 offen lds
    ds_read_b64_tr_b16 a[16:17], v149 offset:256
    ds_read_b64_tr_b16 a[18:19], v149 offset:4864
    s_waitcnt lgkmcnt(10)
    v_mfma_f32_16x16x32_bf16 v[92:95], a[20:23], a[56:59], v[92:95]
    v_mfma_f32_16x16x32_bf16 v[96:99], a[20:23], a[60:63], v[96:99]
    ds_read_b64_tr_b16 a[20:21], v151 offset:256
    ds_read_b64_tr_b16 a[22:23], v151 offset:4864
    s_waitcnt lgkmcnt(10)
    v_mfma_f32_16x16x32_bf16 v[100:103], a[0:3], a[56:59], v[100:103]
    v_mfma_f32_16x16x32_bf16 v[104:107], a[0:3], a[60:63], v[104:107]
    s_add_u32 m0, s31, 26624
    s_mov_b64 exec, 0xffff
    buffer_load_dwordx4 v158, s[16:19], s35 offen lds
    s_mov_b64 exec, -1
    s_waitcnt vmcnt(25)
    s_barrier
    ds_read_b64_tr_b16 a[0:1], v149 offset:9216
    ds_read_b64_tr_b16 a[2:3], v149 offset:13824
    s_waitcnt lgkmcnt(10)
    v_mfma_f32_16x16x32_bf16 v[108:111], a[4:7], a[56:59], v[108:111]
    v_mfma_f32_16x16x32_bf16 v[112:115], a[4:7], a[60:63], v[112:115]
    ds_read_b64_tr_b16 a[4:5], v151 offset:9216
    ds_read_b64_tr_b16 a[6:7], v151 offset:13824
    s_waitcnt lgkmcnt(10)
    v_mfma_f32_16x16x32_bf16 v[116:119], a[8:11], a[56:59], v[116:119]
    v_mfma_f32_16x16x32_bf16 v[120:123], a[8:11], a[60:63], v[120:123]
    s_add_u32 m0, s32, 27648
    s_add_u32 s35, s35, 294912
    buffer_load_dwordx4 v156, s[16:19], s35 offen lds
    ds_read_b64_tr_b16 a[8:9], v149 offset:9248
    ds_read_b64_tr_b16 a[10:11], v149 offset:13856
    s_waitcnt lgkmcnt(10)
    v_mfma_f32_16x16x32_bf16 v[124:127], a[12:15], a[56:59], v[124:127]
    v_mfma_f32_16x16x32_bf16 v[128:131], a[12:15], a[60:63], v[128:131]
    ds_read_b64_tr_b16 a[12:13], v151 offset:9248
    ds_read_b64_tr_b16 a[14:15], v151 offset:13856
    s_waitcnt lgkmcnt(10)
    v_mfma_f32_16x16x32_bf16 v[132:135], a[16:19], a[56:59], v[132:135]
    v_mfma_f32_16x16x32_bf16 v[136:139], a[16:19], a[60:63], v[136:139]
    s_add_u32 m0, s32, 31744
    s_nop 0
    buffer_load_dwordx4 v157, s[16:19], s35 offen lds
    ds_read_b64_tr_b16 a[16:17], v149 offset:9280
    ds_read_b64_tr_b16 a[18:19], v149 offset:13888
    s_waitcnt lgkmcnt(10)
    v_mfma_f32_16x16x32_bf16 v[140:143], a[20:23], a[56:59], v[140:143]
    v_mfma_f32_16x16x32_bf16 v[144:147], a[20:23], a[60:63], v[144:147]
    ds_read_b64_tr_b16 a[20:21], v151 offset:9280
    ds_read_b64_tr_b16 a[22:23], v151 offset:13888
    s_waitcnt vmcnt(26) lgkmcnt(10)
    v_mfma_f32_16x16x32_bf16 v[4:7], a[0:3], a[64:67], v[4:7]
    s_waitcnt vmcnt(25)
    v_mfma_f32_16x16x32_bf16 v[8:11], a[0:3], a[68:71], v[8:11]
    buffer_load_dwordx4 a[56:59], v1, s[20:23], s33 offen offset:2048
    ds_read_b64_tr_b16 a[0:1], v149 offset:9312
    ds_read_b64_tr_b16 a[2:3], v149 offset:13920
    s_waitcnt lgkmcnt(10)
    v_mfma_f32_16x16x32_bf16 v[12:15], a[4:7], a[64:67], v[12:15]
    v_mfma_f32_16x16x32_bf16 v[16:19], a[4:7], a[68:71], v[16:19]
    ds_read_b64_tr_b16 a[4:5], v151 offset:9312
    ds_read_b64_tr_b16 a[6:7], v151 offset:13920
    s_waitcnt lgkmcnt(10)
    v_mfma_f32_16x16x32_bf16 v[20:23], a[8:11], a[64:67], v[20:23]
    v_mfma_f32_16x16x32_bf16 v[24:27], a[8:11], a[68:71], v[24:27]
    buffer_load_dwordx4 a[60:63], v1, s[20:23], s34 offen offset:2048
    ds_read_b64_tr_b16 a[8:9], v149 offset:9344
    ds_read_b64_tr_b16 a[10:11], v149 offset:13952
    s_waitcnt lgkmcnt(10)
    v_mfma_f32_16x16x32_bf16 v[28:31], a[12:15], a[64:67], v[28:31]
    v_mfma_f32_16x16x32_bf16 v[32:35], a[12:15], a[68:71], v[32:35]
    ds_read_b64_tr_b16 a[12:13], v151 offset:9344
    ds_read_b64_tr_b16 a[14:15], v151 offset:13952
    s_waitcnt lgkmcnt(10)
    v_mfma_f32_16x16x32_bf16 v[36:39], a[16:19], a[64:67], v[36:39]
    v_mfma_f32_16x16x32_bf16 v[40:43], a[16:19], a[68:71], v[40:43]
    s_add_u32 m0, s31, 35840
    s_mov_b64 exec, 0xffff
    buffer_load_dwordx4 v158, s[16:19], s35 offen lds
    s_mov_b64 exec, -1
    ds_read_b64_tr_b16 a[16:17], v149 offset:9376
    ds_read_b64_tr_b16 a[18:19], v149 offset:13984
    s_waitcnt lgkmcnt(10)
    v_mfma_f32_16x16x32_bf16 v[44:47], a[20:23], a[64:67], v[44:47]
    v_mfma_f32_16x16x32_bf16 v[48:51], a[20:23], a[68:71], v[48:51]
    ds_read_b64_tr_b16 a[20:21], v151 offset:9376
    ds_read_b64_tr_b16 a[22:23], v151 offset:13984
    s_waitcnt lgkmcnt(10)
    v_mfma_f32_16x16x32_bf16 v[52:55], a[0:3], a[64:67], v[52:55]
    v_mfma_f32_16x16x32_bf16 v[56:59], a[0:3], a[68:71], v[56:59]
    ds_read_b64_tr_b16 a[0:1], v149 offset:9408
    ds_read_b64_tr_b16 a[2:3], v149 offset:14016
    s_waitcnt lgkmcnt(10)
    v_mfma_f32_16x16x32_bf16 v[60:63], a[4:7], a[64:67], v[60:63]
    v_mfma_f32_16x16x32_bf16 v[64:67], a[4:7], a[68:71], v[64:67]
    ds_read_b64_tr_b16 a[4:5], v151 offset:9408
    ds_read_b64_tr_b16 a[6:7], v151 offset:14016
    s_waitcnt lgkmcnt(10)
    v_mfma_f32_16x16x32_bf16 v[68:71], a[8:11], a[64:67], v[68:71]
    v_mfma_f32_16x16x32_bf16 v[72:75], a[8:11], a[68:71], v[72:75]
    ds_read_b64_tr_b16 a[8:9], v149 offset:9440
    ds_read_b64_tr_b16 a[10:11], v149 offset:14048
    s_waitcnt lgkmcnt(10)
    v_mfma_f32_16x16x32_bf16 v[76:79], a[12:15], a[64:67], v[76:79]
    v_mfma_f32_16x16x32_bf16 v[80:83], a[12:15], a[68:71], v[80:83]
    ds_read_b64_tr_b16 a[12:13], v151 offset:9440
    ds_read_b64_tr_b16 a[14:15], v151 offset:14048
    s_waitcnt lgkmcnt(10)
    v_mfma_f32_16x16x32_bf16 v[84:87], a[16:19], a[64:67], v[84:87]
    v_mfma_f32_16x16x32_bf16 v[88:91], a[16:19], a[68:71], v[88:91]
    ds_read_b64_tr_b16 a[16:17], v149 offset:9472
    ds_read_b64_tr_b16 a[18:19], v149 offset:14080
    s_waitcnt lgkmcnt(10)
    v_mfma_f32_16x16x32_bf16 v[92:95], a[20:23], a[64:67], v[92:95]
    v_mfma_f32_16x16x32_bf16 v[96:99], a[20:23], a[68:71], v[96:99]
    ds_read_b64_tr_b16 a[20:21], v151 offset:9472
    ds_read_b64_tr_b16 a[22:23], v151 offset:14080
    s_waitcnt lgkmcnt(10)
    v_mfma_f32_16x16x32_bf16 v[100:103], a[0:3], a[64:67], v[100:103]
    v_mfma_f32_16x16x32_bf16 v[104:107], a[0:3], a[68:71], v[104:107]
    s_waitcnt vmcnt(25)
    s_barrier
    ds_read_b64_tr_b16 a[0:1], v149 offset:18432
    ds_read_b64_tr_b16 a[2:3], v149 offset:23040
    s_waitcnt lgkmcnt(10)
    v_mfma_f32_16x16x32_bf16 v[108:111], a[4:7], a[64:67], v[108:111]
    v_mfma_f32_16x16x32_bf16 v[112:115], a[4:7], a[68:71], v[112:115]
    ds_read_b64_tr_b16 a[4:5], v151 offset:18432
    ds_read_b64_tr_b16 a[6:7], v151 offset:23040
    s_waitcnt lgkmcnt(10)
    v_mfma_f32_16x16x32_bf16 v[116:119], a[8:11], a[64:67], v[116:119]
    v_mfma_f32_16x16x32_bf16 v[120:123], a[8:11], a[68:71], v[120:123]
    s_add_u32 m0, s32, 36864
    s_add_u32 s35, s35, 294912
    buffer_load_dwordx4 v156, s[16:19], s35 offen lds
    ds_read_b64_tr_b16 a[8:9], v149 offset:18464
    ds_read_b64_tr_b16 a[10:11], v149 offset:23072
    s_waitcnt lgkmcnt(10)
    v_mfma_f32_16x16x32_bf16 v[124:127], a[12:15], a[64:67], v[124:127]
    v_mfma_f32_16x16x32_bf16 v[128:131], a[12:15], a[68:71], v[128:131]
    ds_read_b64_tr_b16 a[12:13], v151 offset:18464
    ds_read_b64_tr_b16 a[14:15], v151 offset:23072
    s_waitcnt lgkmcnt(10)
    v_mfma_f32_16x16x32_bf16 v[132:135], a[16:19], a[64:67], v[132:135]
    v_mfma_f32_16x16x32_bf16 v[136:139], a[16:19], a[68:71], v[136:139]
    s_add_u32 m0, s32, 40960
    s_nop 0
    buffer_load_dwordx4 v157, s[16:19], s35 offen lds
    ds_read_b64_tr_b16 a[16:17], v149 offset:18496
    ds_read_b64_tr_b16 a[18:19], v149 offset:23104
    s_waitcnt lgkmcnt(10)
    v_mfma_f32_16x16x32_bf16 v[140:143], a[20:23], a[64:67], v[140:143]
    v_mfma_f32_16x16x32_bf16 v[144:147], a[20:23], a[68:71], v[144:147]
    ds_read_b64_tr_b16 a[20:21], v151 offset:18496
    ds_read_b64_tr_b16 a[22:23], v151 offset:23104
    s_waitcnt vmcnt(26) lgkmcnt(10)
    v_mfma_f32_16x16x32_bf16 v[4:7], a[0:3], a[24:27], v[4:7]
    v_add_f32 v160, v162, v164
    s_waitcnt vmcnt(25)
    v_mfma_f32_16x16x32_bf16 v[8:11], a[0:3], a[28:31], v[8:11]
    v_add_f32 v160, v160, v166
    buffer_load_dwordx4 a[64:67], v1, s[20:23], s33 offen offset:3072
    ds_read_b64_tr_b16 a[0:1], v149 offset:18528
    ds_read_b64_tr_b16 a[2:3], v149 offset:23136
    s_waitcnt lgkmcnt(10)
    v_mfma_f32_16x16x32_bf16 v[12:15], a[4:7], a[24:27], v[12:15]
    v_add_f32 v160, v160, v168
    v_mfma_f32_16x16x32_bf16 v[16:19], a[4:7], a[28:31], v[16:19]
    v_add_f32 v160, v160, v170
    ds_read_b64_tr_b16 a[4:5], v151 offset:18528
    ds_read_b64_tr_b16 a[6:7], v151 offset:23136
    s_waitcnt lgkmcnt(10)
    v_mfma_f32_16x16x32_bf16 v[20:23], a[8:11], a[24:27], v[20:23]
    v_add_f32 v160, v160, v172
    v_mfma_f32_16x16x32_bf16 v[24:27], a[8:11], a[28:31], v[24:27]
    v_add_f32 v160, v160, v174
    buffer_load_dwordx4 a[68:71], v1, s[20:23], s34 offen offset:3072
    ds_read_b64_tr_b16 a[8:9], v149 offset:18560
    ds_read_b64_tr_b16 a[10:11], v149 offset:23168
    s_waitcnt lgkmcnt(10)
    v_mfma_f32_16x16x32_bf16 v[28:31], a[12:15], a[24:27], v[28:31]
    v_add_f32 v160, v160, v176
    v_mfma_f32_16x16x32_bf16 v[32:35], a[12:15], a[28:31], v[32:35]
    v_add_f32 v160, v160, v178
    ds_read_b64_tr_b16 a[12:13], v151 offset:18560
    ds_read_b64_tr_b16 a[14:15], v151 offset:23168
    s_waitcnt lgkmcnt(10)
    v_mfma_f32_16x16x32_bf16 v[36:39], a[16:19], a[24:27], v[36:39]
    v_mul_f32 v160, 0x3ae38e39, v160
    v_mfma_f32_16x16x32_bf16 v[40:43], a[16:19], a[28:31], v[40:43]
    s_add_u32 m0, s31, 45056
    s_mov_b64 exec, 0xffff
    buffer_load_dwordx4 v158, s[16:19], s35 offen lds
    s_mov_b64 exec, -1
    ds_read_b64_tr_b16 a[16:17], v149 offset:18592
    ds_read_b64_tr_b16 a[18:19], v149 offset:23200
    s_waitcnt lgkmcnt(10)
    v_mfma_f32_16x16x32_bf16 v[44:47], a[20:23], a[24:27], v[44:47]
    v_mov_b32 v161, 0
    v_mfma_f32_16x16x32_bf16 v[48:51], a[20:23], a[28:31], v[48:51]
    v_fma_f32 v162, v162, s26, -v160
    ds_read_b64_tr_b16 a[20:21], v151 offset:18592
    ds_read_b64_tr_b16 a[22:23], v151 offset:23200
    s_waitcnt lgkmcnt(10)
    v_mfma_f32_16x16x32_bf16 v[52:55], a[0:3], a[24:27], v[52:55]
    v_mul_f32 v162, v162, v162
    v_mfma_f32_16x16x32_bf16 v[56:59], a[0:3], a[28:31], v[56:59]
    v_add_f32 v161, v161, v163
    ds_read_b64_tr_b16 a[0:1], v149 offset:18624
    ds_read_b64_tr_b16 a[2:3], v149 offset:23232
    s_waitcnt lgkmcnt(10)
    v_mfma_f32_16x16x32_bf16 v[60:63], a[4:7], a[24:27], v[60:63]
    v_fma_f32 v161, v162, s30, v161
    v_mfma_f32_16x16x32_bf16 v[64:67], a[4:7], a[28:31], v[64:67]
    v_fma_f32 v164, v164, s26, -v160
    ds_read_b64_tr_b16 a[4:5], v151 offset:18624
    ds_read_b64_tr_b16 a[6:7], v151 offset:23232
    s_waitcnt lgkmcnt(10)
    v_mfma_f32_16x16x32_bf16 v[68:71], a[8:11], a[24:27], v[68:71]
    v_mul_f32 v164, v164, v164
    v_mfma_f32_16x16x32_bf16 v[72:75], a[8:11], a[28:31], v[72:75]
    ds_read_b64_tr_b16 a[8:9], v149 offset:18656
    ds_read_b64_tr_b16 a[10:11], v149 offset:23264
    s_waitcnt lgkmcnt(10)
    v_mfma_f32_16x16x32_bf16 v[76:79], a[12:15], a[24:27], v[76:79]
    v_add_f32 v161, v161, v165
    v_mfma_f32_16x16x32_bf16 v[80:83], a[12:15], a[28:31], v[80:83]
    v_fma_f32 v161, v164, s30, v161
    ds_read_b64_tr_b16 a[12:13], v151 offset:18656
    ds_read_b64_tr_b16 a[14:15], v151 offset:23264
    s_waitcnt lgkmcnt(10)
    v_mfma_f32_16x16x32_bf16 v[84:87], a[16:19], a[24:27], v[84:87]
    v_fma_f32 v166, v166, s26, -v160
    v_mfma_f32_16x16x32_bf16 v[88:91], a[16:19], a[28:31], v[88:91]
    v_mul_f32 v166, v166, v166
    ds_read_b64_tr_b16 a[16:17], v149 offset:18688
    ds_read_b64_tr_b16 a[18:19], v149 offset:23296
    s_waitcnt lgkmcnt(10)
    v_mfma_f32_16x16x32_bf16 v[92:95], a[20:23], a[24:27], v[92:95]
    v_add_f32 v161, v161, v167
    v_mfma_f32_16x16x32_bf16 v[96:99], a[20:23], a[28:31], v[96:99]
    v_fma_f32 v161, v166, s30, v161
    ds_read_b64_tr_b16 a[20:21], v151 offset:18688
    ds_read_b64_tr_b16 a[22:23], v151 offset:23296
    s_waitcnt lgkmcnt(10)
    v_mfma_f32_16x16x32_bf16 v[100:103], a[0:3], a[24:27], v[100:103]
    v_fma_f32 v168, v168, s26, -v160
    v_mfma_f32_16x16x32_bf16 v[104:107], a[0:3], a[28:31], v[104:107]
    v_mul_f32 v168, v168, v168
    s_waitcnt vmcnt(25)
    s_barrier
    ds_read_b64_tr_b16 a[0:1], v149 offset:27648
    ds_read_b64_tr_b16 a[2:3], v149 offset:32256
    s_waitcnt lgkmcnt(10)
    v_mfma_f32_16x16x32_bf16 v[108:111], a[4:7], a[24:27], v[108:111]
    v_add_f32 v161, v161, v169
    v_mfma_f32_16x16x32_bf16 v[112:115], a[4:7], a[28:31], v[112:115]
    ds_read_b64_tr_b16 a[4:5], v151 offset:27648
    ds_read_b64_tr_b16 a[6:7], v151 offset:32256
    s_waitcnt lgkmcnt(10)
    v_mfma_f32_16x16x32_bf16 v[116:119], a[8:11], a[24:27], v[116:119]
    v_fma_f32 v161, v168, s30, v161
    v_mfma_f32_16x16x32_bf16 v[120:123], a[8:11], a[28:31], v[120:123]
    v_fma_f32 v170, v170, s26, -v160
    s_add_u32 m0, s32, 46080
    s_add_u32 s35, s35, 294912
    buffer_load_dwordx4 v156, s[16:19], s35 offen lds
    ds_read_b64_tr_b16 a[8:9], v149 offset:27680
    ds_read_b64_tr_b16 a[10:11], v149 offset:32288
    s_waitcnt lgkmcnt(10)
    v_mfma_f32_16x16x32_bf16 v[124:127], a[12:15], a[24:27], v[124:127]
    v_mul_f32 v170, v170, v170
    v_mfma_f32_16x16x32_bf16 v[128:131], a[12:15], a[28:31], v[128:131]
    v_add_f32 v161, v161, v171
    ds_read_b64_tr_b16 a[12:13], v151 offset:27680
    ds_read_b64_tr_b16 a[14:15], v151 offset:32288
    s_waitcnt lgkmcnt(10)
    v_mfma_f32_16x16x32_bf16 v[132:135], a[16:19], a[24:27], v[132:135]
    v_fma_f32 v161, v170, s30, v161
    v_mfma_f32_16x16x32_bf16 v[136:139], a[16:19], a[28:31], v[136:139]
    v_fma_f32 v172, v172, s26, -v160
    s_add_u32 m0, s32, 50176
    s_nop 0
    buffer_load_dwordx4 v157, s[16:19], s35 offen lds
    ds_read_b64_tr_b16 a[16:17], v149 offset:27712
    ds_read_b64_tr_b16 a[18:19], v149 offset:32320
    s_waitcnt lgkmcnt(10)
    v_mfma_f32_16x16x32_bf16 v[140:143], a[20:23], a[24:27], v[140:143]
    v_mul_f32 v172, v172, v172
    v_mfma_f32_16x16x32_bf16 v[144:147], a[20:23], a[28:31], v[144:147]
    ds_read_b64_tr_b16 a[20:21], v151 offset:27712
    ds_read_b64_tr_b16 a[22:23], v151 offset:32320
    s_waitcnt vmcnt(26) lgkmcnt(10)
    v_mfma_f32_16x16x32_bf16 v[4:7], a[0:3], a[32:35], v[4:7]
    v_add_f32 v161, v161, v173
    s_waitcnt vmcnt(25)
    v_mfma_f32_16x16x32_bf16 v[8:11], a[0:3], a[36:39], v[8:11]
    v_fma_f32 v161, v172, s30, v161
    s_add_u32 m0, s31, 54272
    s_mov_b64 exec, 0xffff
    buffer_load_dwordx4 v158, s[16:19], s35 offen lds
    s_mov_b64 exec, -1
    ds_read_b64_tr_b16 a[0:1], v149 offset:27744
    ds_read_b64_tr_b16 a[2:3], v149 offset:32352
    s_waitcnt lgkmcnt(10)
    v_mfma_f32_16x16x32_bf16 v[12:15], a[4:7], a[32:35], v[12:15]
    v_fma_f32 v174, v174, s26, -v160
    v_mfma_f32_16x16x32_bf16 v[16:19], a[4:7], a[36:39], v[16:19]
    v_mul_f32 v174, v174, v174
    ds_read_b64_tr_b16 a[4:5], v151 offset:27744
    ds_read_b64_tr_b16 a[6:7], v151 offset:32352
    s_waitcnt lgkmcnt(10)
    v_mfma_f32_16x16x32_bf16 v[20:23], a[8:11], a[32:35], v[20:23]
    v_add_f32 v161, v161, v175
    v_mfma_f32_16x16x32_bf16 v[24:27], a[8:11], a[36:39], v[24:27]
    v_fma_f32 v161, v174, s30, v161
    s_add_u32 s33, s33, 4096
    buffer_load_dwordx4 a[24:27], v1, s[20:23], s33 offen offset:0
    ds_read_b64_tr_b16 a[8:9], v149 offset:27776
    ds_read_b64_tr_b16 a[10:11], v149 offset:32384
    s_waitcnt lgkmcnt(10)
    v_mfma_f32_16x16x32_bf16 v[28:31], a[12:15], a[32:35], v[28:31]
    v_fma_f32 v176, v176, s26, -v160
    v_mfma_f32_16x16x32_bf16 v[32:35], a[12:15], a[36:39], v[32:35]
    v_mul_f32 v176, v176, v176
    ds_read_b64_tr_b16 a[12:13], v151 offset:27776
    ds_read_b64_tr_b16 a[14:15], v151 offset:32384
    s_waitcnt lgkmcnt(10)
    v_mfma_f32_16x16x32_bf16 v[36:39], a[16:19], a[32:35], v[36:39]
    v_add_f32 v161, v161, v177
    v_mfma_f32_16x16x32_bf16 v[40:43], a[16:19], a[36:39], v[40:43]
    s_add_u32 s34, s34, 4096
    buffer_load_dwordx4 a[28:31], v1, s[20:23], s34 offen offset:0
    ds_read_b64_tr_b16 a[16:17], v149 offset:27808
    ds_read_b64_tr_b16 a[18:19], v149 offset:32416
    s_waitcnt lgkmcnt(10)
    v_mfma_f32_16x16x32_bf16 v[44:47], a[20:23], a[32:35], v[44:47]
    v_fma_f32 v161, v176, s30, v161
    v_mfma_f32_16x16x32_bf16 v[48:51], a[20:23], a[36:39], v[48:51]
    v_fma_f32 v178, v178, s26, -v160
    ds_read_b64_tr_b16 a[20:21], v151 offset:27808
    ds_read_b64_tr_b16 a[22:23], v151 offset:32416
    s_waitcnt lgkmcnt(10)
    v_mfma_f32_16x16x32_bf16 v[52:55], a[0:3], a[32:35], v[52:55]
    v_mul_f32 v178, v178, v178
    v_mfma_f32_16x16x32_bf16 v[56:59], a[0:3], a[36:39], v[56:59]
    v_add_f32 v161, v161, v179
    ds_read_b64_tr_b16 a[0:1], v149 offset:27840
    ds_read_b64_tr_b16 a[2:3], v149 offset:32448
    s_waitcnt lgkmcnt(10)
    v_mfma_f32_16x16x32_bf16 v[60:63], a[4:7], a[32:35], v[60:63]
    v_fma_f32 v161, v178, s30, v161
    v_mfma_f32_16x16x32_bf16 v[64:67], a[4:7], a[36:39], v[64:67]
    v_mul_f32 v161, 0x3ae38e39, v161
    ds_read_b64_tr_b16 a[4:5], v151 offset:27840
    ds_read_b64_tr_b16 a[6:7], v151 offset:32448
    s_waitcnt lgkmcnt(10)
    v_mfma_f32_16x16x32_bf16 v[68:71], a[8:11], a[32:35], v[68:71]
    v_cvt_pk_bf16_f32 v160, v160, v160
    v_mfma_f32_16x16x32_bf16 v[72:75], a[8:11], a[36:39], v[72:75]
    ds_read_b64_tr_b16 a[8:9], v149 offset:27872
    ds_read_b64_tr_b16 a[10:11], v149 offset:32480
    s_waitcnt lgkmcnt(10)
    v_mfma_f32_16x16x32_bf16 v[76:79], a[12:15], a[32:35], v[76:79]
    v_lshlrev_b32 v160, 16, v160
    v_mfma_f32_16x16x32_bf16 v[80:83], a[12:15], a[36:39], v[80:83]
    v_cvt_pk_bf16_f32 v161, v161, v161
    ds_read_b64_tr_b16 a[12:13], v151 offset:27872
    ds_read_b64_tr_b16 a[14:15], v151 offset:32480
    s_waitcnt lgkmcnt(10)
    v_mfma_f32_16x16x32_bf16 v[84:87], a[16:19], a[32:35], v[84:87]
    v_lshlrev_b32 v161, 16, v161
    v_mfma_f32_16x16x32_bf16 v[88:91], a[16:19], a[36:39], v[88:91]
    v_add_f32 v161, 0x3727c5ac, v161
    ds_read_b64_tr_b16 a[16:17], v149 offset:27904
    ds_read_b64_tr_b16 a[18:19], v149 offset:32512
    s_waitcnt lgkmcnt(10)
    v_mfma_f32_16x16x32_bf16 v[92:95], a[20:23], a[32:35], v[92:95]
    v_cvt_pk_bf16_f32 v161, v161, v161
    v_mfma_f32_16x16x32_bf16 v[96:99], a[20:23], a[36:39], v[96:99]
    v_lshlrev_b32 v161, 16, v161
    ds_read_b64_tr_b16 a[20:21], v151 offset:27904
    ds_read_b64_tr_b16 a[22:23], v151 offset:32512
    s_waitcnt lgkmcnt(10)
    v_mfma_f32_16x16x32_bf16 v[100:103], a[0:3], a[32:35], v[100:103]
    v_sqrt_f32 v161, v161
    v_mfma_f32_16x16x32_bf16 v[104:107], a[0:3], a[36:39], v[104:107]
    v_cvt_pk_bf16_f32 v161, v161, v161
    s_waitcnt vmcnt(25)
    s_barrier
    ds_read_b64_tr_b16 a[0:1], v148 offset:0
    ds_read_b64_tr_b16 a[2:3], v148 offset:4608
    s_waitcnt lgkmcnt(10)
    v_mfma_f32_16x16x32_bf16 v[108:111], a[4:7], a[32:35], v[108:111]
    v_lshlrev_b32 v161, 16, v161
    v_mfma_f32_16x16x32_bf16 v[112:115], a[4:7], a[36:39], v[112:115]
    ds_read_b64_tr_b16 a[4:5], v150 offset:0
    ds_read_b64_tr_b16 a[6:7], v150 offset:4608
    s_waitcnt lgkmcnt(10)
    v_mfma_f32_16x16x32_bf16 v[116:119], a[8:11], a[32:35], v[116:119]
    v_mov_b32 v154, v161
    v_mfma_f32_16x16x32_bf16 v[120:123], a[8:11], a[36:39], v[120:123]
    v_mov_b32 v155, v161
    s_add_u32 m0, s32, 55296
    s_add_u32 s35, s35, 294912
    buffer_load_dwordx4 v156, s[16:19], s35 offen lds
    ds_read_b64_tr_b16 a[8:9], v148 offset:32
    ds_read_b64_tr_b16 a[10:11], v148 offset:4640
    s_waitcnt lgkmcnt(10)
    v_mfma_f32_16x16x32_bf16 v[124:127], a[12:15], a[32:35], v[124:127]
    v_rcp_f32 v152, v161
    v_mfma_f32_16x16x32_bf16 v[128:131], a[12:15], a[36:39], v[128:131]
    v_mul_f32 v152, 0xbfb8aa3b, v152
    ds_read_b64_tr_b16 a[12:13], v150 offset:32
    ds_read_b64_tr_b16 a[14:15], v150 offset:4640
    s_waitcnt lgkmcnt(10)
    v_mfma_f32_16x16x32_bf16 v[132:135], a[16:19], a[32:35], v[132:135]
    v_mov_b32 v153, v152
    v_mfma_f32_16x16x32_bf16 v[136:139], a[16:19], a[36:39], v[136:139]
    v_permlane16_swap_b32 v154, v155
    s_add_u32 m0, s32, 59392
    s_nop 0
    buffer_load_dwordx4 v157, s[16:19], s35 offen lds
    ds_read_b64_tr_b16 a[16:17], v148 offset:64
    ds_read_b64_tr_b16 a[18:19], v148 offset:4672
    s_waitcnt lgkmcnt(10)
    v_mfma_f32_16x16x32_bf16 v[140:143], a[20:23], a[32:35], v[140:143]
    v_permlane16_swap_b32 v152, v153
    v_mfma_f32_16x16x32_bf16 v[144:147], a[20:23], a[36:39], v[144:147]
    ds_read_b64_tr_b16 a[20:21], v150 offset:64
    ds_read_b64_tr_b16 a[22:23], v150 offset:4672
    s_waitcnt vmcnt(26) lgkmcnt(10)
    v_mfma_f32_16x16x32_bf16 v[4:7], a[0:3], a[40:43], v[4:7]
    s_waitcnt vmcnt(25)
    v_mfma_f32_16x16x32_bf16 v[8:11], a[0:3], a[44:47], v[8:11]
    s_add_u32 m0, s31, 63488
    s_mov_b64 exec, 0xffff
    buffer_load_dwordx4 v158, s[16:19], s35 offen lds
    s_mov_b64 exec, -1
    ds_read_b64_tr_b16 a[0:1], v148 offset:96
    ds_read_b64_tr_b16 a[2:3], v148 offset:4704
    s_waitcnt lgkmcnt(10)
    v_mfma_f32_16x16x32_bf16 v[12:15], a[4:7], a[40:43], v[12:15]
    v_mfma_f32_16x16x32_bf16 v[16:19], a[4:7], a[44:47], v[16:19]
    ds_read_b64_tr_b16 a[4:5], v150 offset:96
    ds_read_b64_tr_b16 a[6:7], v150 offset:4704
    s_waitcnt lgkmcnt(10)
    v_mfma_f32_16x16x32_bf16 v[20:23], a[8:11], a[40:43], v[20:23]
    v_mfma_f32_16x16x32_bf16 v[24:27], a[8:11], a[44:47], v[24:27]
    buffer_load_dwordx4 a[32:35], v1, s[20:23], s33 offen offset:1024
    ds_read_b64_tr_b16 a[8:9], v148 offset:128
    ds_read_b64_tr_b16 a[10:11], v148 offset:4736
    s_waitcnt lgkmcnt(10)
    v_mfma_f32_16x16x32_bf16 v[28:31], a[12:15], a[40:43], v[28:31]
    v_mfma_f32_16x16x32_bf16 v[32:35], a[12:15], a[44:47], v[32:35]
    ds_read_b64_tr_b16 a[12:13], v150 offset:128
    ds_read_b64_tr_b16 a[14:15], v150 offset:4736
    s_waitcnt lgkmcnt(10)
    v_mfma_f32_16x16x32_bf16 v[36:39], a[16:19], a[40:43], v[36:39]
    v_mfma_f32_16x16x32_bf16 v[40:43], a[16:19], a[44:47], v[40:43]
    buffer_load_dwordx4 a[36:39], v1, s[20:23], s34 offen offset:1024
    ds_read_b64_tr_b16 a[16:17], v148 offset:160
    ds_read_b64_tr_b16 a[18:19], v148 offset:4768
    s_waitcnt lgkmcnt(10)
    v_mfma_f32_16x16x32_bf16 v[44:47], a[20:23], a[40:43], v[44:47]
    v_mfma_f32_16x16x32_bf16 v[48:51], a[20:23], a[44:47], v[48:51]
    ds_read_b64_tr_b16 a[20:21], v150 offset:160
    ds_read_b64_tr_b16 a[22:23], v150 offset:4768
    s_waitcnt lgkmcnt(10)
    v_mfma_f32_16x16x32_bf16 v[52:55], a[0:3], a[40:43], v[52:55]
    v_mfma_f32_16x16x32_bf16 v[56:59], a[0:3], a[44:47], v[56:59]
    ds_read_b64_tr_b16 a[0:1], v148 offset:192
    ds_read_b64_tr_b16 a[2:3], v148 offset:4800
    s_waitcnt lgkmcnt(10)
    v_mfma_f32_16x16x32_bf16 v[60:63], a[4:7], a[40:43], v[60:63]
    v_mfma_f32_16x16x32_bf16 v[64:67], a[4:7], a[44:47], v[64:67]
    ds_read_b64_tr_b16 a[4:5], v150 offset:192
    ds_read_b64_tr_b16 a[6:7], v150 offset:4800
    s_waitcnt lgkmcnt(10)
    v_mfma_f32_16x16x32_bf16 v[68:71], a[8:11], a[40:43], v[68:71]
    v_mfma_f32_16x16x32_bf16 v[72:75], a[8:11], a[44:47], v[72:75]
    ds_read_b64_tr_b16 a[8:9], v148 offset:224
    ds_read_b64_tr_b16 a[10:11], v148 offset:4832
    s_waitcnt lgkmcnt(10)
    v_mfma_f32_16x16x32_bf16 v[76:79], a[12:15], a[40:43], v[76:79]
    v_mfma_f32_16x16x32_bf16 v[80:83], a[12:15], a[44:47], v[80:83]
    ds_read_b64_tr_b16 a[12:13], v150 offset:224
    ds_read_b64_tr_b16 a[14:15], v150 offset:4832
    s_waitcnt lgkmcnt(10)
    v_mfma_f32_16x16x32_bf16 v[84:87], a[16:19], a[40:43], v[84:87]
    v_mfma_f32_16x16x32_bf16 v[88:91], a[16:19], a[44:47], v[88:91]
    ds_read_b64_tr_b16 a[16:17], v148 offset:256
    ds_read_b64_tr_b16 a[18:19], v148 offset:4864
    s_waitcnt lgkmcnt(10)
    v_mfma_f32_16x16x32_bf16 v[92:95], a[20:23], a[40:43], v[92:95]
    v_mfma_f32_16x16x32_bf16 v[96:99], a[20:23], a[44:47], v[96:99]
    ds_read_b64_tr_b16 a[20:21], v150 offset:256
    ds_read_b64_tr_b16 a[22:23], v150 offset:4864
    s_waitcnt lgkmcnt(10)
    v_mfma_f32_16x16x32_bf16 v[100:103], a[0:3], a[40:43], v[100:103]
    v_mfma_f32_16x16x32_bf16 v[104:107], a[0:3], a[44:47], v[104:107]
    s_waitcnt vmcnt(25)
    s_barrier
    ds_read_b64_tr_b16 a[0:1], v148 offset:9216
    ds_read_b64_tr_b16 a[2:3], v148 offset:13824
    s_waitcnt lgkmcnt(10)
    v_mfma_f32_16x16x32_bf16 v[108:111], a[4:7], a[40:43], v[108:111]
    v_mfma_f32_16x16x32_bf16 v[112:115], a[4:7], a[44:47], v[112:115]
    ds_read_b64_tr_b16 a[4:5], v150 offset:9216
    ds_read_b64_tr_b16 a[6:7], v150 offset:13824
    s_waitcnt lgkmcnt(10)
    v_mfma_f32_16x16x32_bf16 v[116:119], a[8:11], a[40:43], v[116:119]
    v_mfma_f32_16x16x32_bf16 v[120:123], a[8:11], a[44:47], v[120:123]
    s_add_u32 m0, s32, 64512
    s_add_u32 s35, s35, 294912
    buffer_load_dwordx4 v156, s[16:19], s35 offen lds
    ds_read_b64_tr_b16 a[8:9], v148 offset:9248
    ds_read_b64_tr_b16 a[10:11], v148 offset:13856
    s_waitcnt lgkmcnt(10)
    v_mfma_f32_16x16x32_bf16 v[124:127], a[12:15], a[40:43], v[124:127]
    v_mfma_f32_16x16x32_bf16 v[128:131], a[12:15], a[44:47], v[128:131]
    ds_read_b64_tr_b16 a[12:13], v150 offset:9248
    ds_read_b64_tr_b16 a[14:15], v150 offset:13856
    s_waitcnt lgkmcnt(10)
    v_mfma_f32_16x16x32_bf16 v[132:135], a[16:19], a[40:43], v[132:135]
    v_mfma_f32_16x16x32_bf16 v[136:139], a[16:19], a[44:47], v[136:139]
    s_add_u32 m0, s32, 68608
    s_nop 0
    buffer_load_dwordx4 v157, s[16:19], s35 offen lds
    ds_read_b64_tr_b16 a[16:17], v148 offset:9280
    ds_read_b64_tr_b16 a[18:19], v148 offset:13888
    s_waitcnt lgkmcnt(10)
    v_mfma_f32_16x16x32_bf16 v[140:143], a[20:23], a[40:43], v[140:143]
    v_mfma_f32_16x16x32_bf16 v[144:147], a[20:23], a[44:47], v[144:147]
    ds_read_b64_tr_b16 a[20:21], v150 offset:9280
    ds_read_b64_tr_b16 a[22:23], v150 offset:13888
    s_waitcnt vmcnt(26) lgkmcnt(10)
    v_mfma_f32_16x16x32_bf16 v[4:7], a[0:3], a[48:51], v[4:7]
    s_waitcnt vmcnt(25)
    v_mfma_f32_16x16x32_bf16 v[8:11], a[0:3], a[52:55], v[8:11]
    s_add_u32 m0, s31, 72704
    s_mov_b64 exec, 0xffff
    buffer_load_dwordx4 v158, s[16:19], s35 offen lds
    s_mov_b64 exec, -1
    ds_read_b64_tr_b16 a[0:1], v148 offset:9312
    ds_read_b64_tr_b16 a[2:3], v148 offset:13920
    s_waitcnt lgkmcnt(10)
    v_mfma_f32_16x16x32_bf16 v[12:15], a[4:7], a[48:51], v[12:15]
    v_mfma_f32_16x16x32_bf16 v[16:19], a[4:7], a[52:55], v[16:19]
    ds_read_b64_tr_b16 a[4:5], v150 offset:9312
    ds_read_b64_tr_b16 a[6:7], v150 offset:13920
    s_waitcnt lgkmcnt(10)
    v_mfma_f32_16x16x32_bf16 v[20:23], a[8:11], a[48:51], v[20:23]
    v_mfma_f32_16x16x32_bf16 v[24:27], a[8:11], a[52:55], v[24:27]
    buffer_load_dwordx4 a[40:43], v1, s[20:23], s33 offen offset:2048
    ds_read_b64_tr_b16 a[8:9], v148 offset:9344
    ds_read_b64_tr_b16 a[10:11], v148 offset:13952
    s_waitcnt lgkmcnt(10)
    v_mfma_f32_16x16x32_bf16 v[28:31], a[12:15], a[48:51], v[28:31]
    v_mfma_f32_16x16x32_bf16 v[32:35], a[12:15], a[52:55], v[32:35]
    ds_read_b64_tr_b16 a[12:13], v150 offset:9344
    ds_read_b64_tr_b16 a[14:15], v150 offset:13952
    s_waitcnt lgkmcnt(10)
    v_mfma_f32_16x16x32_bf16 v[36:39], a[16:19], a[48:51], v[36:39]
    v_mfma_f32_16x16x32_bf16 v[40:43], a[16:19], a[52:55], v[40:43]
    buffer_load_dwordx4 a[44:47], v1, s[20:23], s34 offen offset:2048
    ds_read_b64_tr_b16 a[16:17], v148 offset:9376
    ds_read_b64_tr_b16 a[18:19], v148 offset:13984
    s_waitcnt lgkmcnt(10)
    v_mfma_f32_16x16x32_bf16 v[44:47], a[20:23], a[48:51], v[44:47]
    v_mfma_f32_16x16x32_bf16 v[48:51], a[20:23], a[52:55], v[48:51]
    ds_read_b64_tr_b16 a[20:21], v150 offset:9376
    ds_read_b64_tr_b16 a[22:23], v150 offset:13984
    s_waitcnt lgkmcnt(10)
    v_mfma_f32_16x16x32_bf16 v[52:55], a[0:3], a[48:51], v[52:55]
    v_mfma_f32_16x16x32_bf16 v[56:59], a[0:3], a[52:55], v[56:59]
    ds_read_b64_tr_b16 a[0:1], v148 offset:9408
    ds_read_b64_tr_b16 a[2:3], v148 offset:14016
    s_waitcnt lgkmcnt(10)
    v_mfma_f32_16x16x32_bf16 v[60:63], a[4:7], a[48:51], v[60:63]
    v_mfma_f32_16x16x32_bf16 v[64:67], a[4:7], a[52:55], v[64:67]
    ds_read_b64_tr_b16 a[4:5], v150 offset:9408
    ds_read_b64_tr_b16 a[6:7], v150 offset:14016
    s_waitcnt lgkmcnt(10)
    v_mfma_f32_16x16x32_bf16 v[68:71], a[8:11], a[48:51], v[68:71]
    v_mfma_f32_16x16x32_bf16 v[72:75], a[8:11], a[52:55], v[72:75]
    ds_read_b64_tr_b16 a[8:9], v148 offset:9440
    ds_read_b64_tr_b16 a[10:11], v148 offset:14048
    s_waitcnt lgkmcnt(10)
    v_mfma_f32_16x16x32_bf16 v[76:79], a[12:15], a[48:51], v[76:79]
    v_mfma_f32_16x16x32_bf16 v[80:83], a[12:15], a[52:55], v[80:83]
    ds_read_b64_tr_b16 a[12:13], v150 offset:9440
    ds_read_b64_tr_b16 a[14:15], v150 offset:14048
    s_waitcnt lgkmcnt(10)
    v_mfma_f32_16x16x32_bf16 v[84:87], a[16:19], a[48:51], v[84:87]
    v_mfma_f32_16x16x32_bf16 v[88:91], a[16:19], a[52:55], v[88:91]
    ds_read_b64_tr_b16 a[16:17], v148 offset:9472
    ds_read_b64_tr_b16 a[18:19], v148 offset:14080
    s_waitcnt lgkmcnt(10)
    v_mfma_f32_16x16x32_bf16 v[92:95], a[20:23], a[48:51], v[92:95]
    v_mfma_f32_16x16x32_bf16 v[96:99], a[20:23], a[52:55], v[96:99]
    ds_read_b64_tr_b16 a[20:21], v150 offset:9472
    ds_read_b64_tr_b16 a[22:23], v150 offset:14080
    s_waitcnt lgkmcnt(10)
    v_mfma_f32_16x16x32_bf16 v[100:103], a[0:3], a[48:51], v[100:103]
    v_mfma_f32_16x16x32_bf16 v[104:107], a[0:3], a[52:55], v[104:107]
    s_waitcnt vmcnt(25)
    s_barrier
    ds_read_b64_tr_b16 a[0:1], v148 offset:18432
    ds_read_b64_tr_b16 a[2:3], v148 offset:23040
    s_waitcnt lgkmcnt(10)
    v_mfma_f32_16x16x32_bf16 v[108:111], a[4:7], a[48:51], v[108:111]
    v_mfma_f32_16x16x32_bf16 v[112:115], a[4:7], a[52:55], v[112:115]
    ds_read_b64_tr_b16 a[4:5], v150 offset:18432
    ds_read_b64_tr_b16 a[6:7], v150 offset:23040
    s_waitcnt lgkmcnt(10)
    v_mfma_f32_16x16x32_bf16 v[116:119], a[8:11], a[48:51], v[116:119]
    v_mfma_f32_16x16x32_bf16 v[120:123], a[8:11], a[52:55], v[120:123]
    s_add_u32 m0, s32, 0
    s_add_u32 s35, s35, 294912
    buffer_load_dwordx4 v156, s[16:19], s35 offen lds
    ds_read_b64_tr_b16 a[8:9], v148 offset:18464
    ds_read_b64_tr_b16 a[10:11], v148 offset:23072
    s_waitcnt lgkmcnt(10)
    v_mfma_f32_16x16x32_bf16 v[124:127], a[12:15], a[48:51], v[124:127]
    v_mfma_f32_16x16x32_bf16 v[128:131], a[12:15], a[52:55], v[128:131]
    ds_read_b64_tr_b16 a[12:13], v150 offset:18464
    ds_read_b64_tr_b16 a[14:15], v150 offset:23072
    s_waitcnt lgkmcnt(10)
    v_mfma_f32_16x16x32_bf16 v[132:135], a[16:19], a[48:51], v[132:135]
    v_mfma_f32_16x16x32_bf16 v[136:139], a[16:19], a[52:55], v[136:139]
    s_add_u32 m0, s32, 4096
    s_nop 0
    buffer_load_dwordx4 v157, s[16:19], s35 offen lds
    ds_read_b64_tr_b16 a[16:17], v148 offset:18496
    ds_read_b64_tr_b16 a[18:19], v148 offset:23104
    s_waitcnt lgkmcnt(10)
    v_mfma_f32_16x16x32_bf16 v[140:143], a[20:23], a[48:51], v[140:143]
    v_mfma_f32_16x16x32_bf16 v[144:147], a[20:23], a[52:55], v[144:147]
    ds_read_b64_tr_b16 a[20:21], v150 offset:18496
    ds_read_b64_tr_b16 a[22:23], v150 offset:23104
    s_waitcnt vmcnt(24) lgkmcnt(10)
    v_mfma_f32_16x16x32_bf16 v[4:7], a[0:3], a[56:59], v[4:7]
    s_waitcnt vmcnt(23)
    v_mfma_f32_16x16x32_bf16 v[8:11], a[0:3], a[60:63], v[8:11]
    s_add_u32 m0, s31, 8192
    s_mov_b64 exec, 0xffff
    buffer_load_dwordx4 v158, s[16:19], s35 offen lds
    s_mov_b64 exec, -1
    ds_read_b64_tr_b16 a[0:1], v148 offset:18528
    ds_read_b64_tr_b16 a[2:3], v148 offset:23136
    s_waitcnt lgkmcnt(10)
    v_mfma_f32_16x16x32_bf16 v[12:15], a[4:7], a[56:59], v[12:15]
    v_mfma_f32_16x16x32_bf16 v[16:19], a[4:7], a[60:63], v[16:19]
    ds_read_b64_tr_b16 a[4:5], v150 offset:18528
    ds_read_b64_tr_b16 a[6:7], v150 offset:23136
    s_waitcnt lgkmcnt(10)
    v_mfma_f32_16x16x32_bf16 v[20:23], a[8:11], a[56:59], v[20:23]
    v_mfma_f32_16x16x32_bf16 v[24:27], a[8:11], a[60:63], v[24:27]
    buffer_load_dwordx4 a[48:51], v1, s[20:23], s33 offen offset:3072
    ds_read_b64_tr_b16 a[8:9], v148 offset:18560
    ds_read_b64_tr_b16 a[10:11], v148 offset:23168
    s_waitcnt lgkmcnt(10)
    v_mfma_f32_16x16x32_bf16 v[28:31], a[12:15], a[56:59], v[28:31]
    v_mfma_f32_16x16x32_bf16 v[32:35], a[12:15], a[60:63], v[32:35]
    ds_read_b64_tr_b16 a[12:13], v150 offset:18560
    ds_read_b64_tr_b16 a[14:15], v150 offset:23168
    s_waitcnt lgkmcnt(10)
    v_mfma_f32_16x16x32_bf16 v[36:39], a[16:19], a[56:59], v[36:39]
    v_mfma_f32_16x16x32_bf16 v[40:43], a[16:19], a[60:63], v[40:43]
    buffer_load_dwordx4 a[52:55], v1, s[20:23], s34 offen offset:3072
    ds_read_b64_tr_b16 a[16:17], v148 offset:18592
    ds_read_b64_tr_b16 a[18:19], v148 offset:23200
    s_waitcnt lgkmcnt(10)
    v_mfma_f32_16x16x32_bf16 v[44:47], a[20:23], a[56:59], v[44:47]
    v_mfma_f32_16x16x32_bf16 v[48:51], a[20:23], a[60:63], v[48:51]
    ds_read_b64_tr_b16 a[20:21], v150 offset:18592
    ds_read_b64_tr_b16 a[22:23], v150 offset:23200
    s_waitcnt lgkmcnt(10)
    v_mfma_f32_16x16x32_bf16 v[52:55], a[0:3], a[56:59], v[52:55]
    v_mfma_f32_16x16x32_bf16 v[56:59], a[0:3], a[60:63], v[56:59]
    s_add_u32 s33, s33, 4096
    buffer_load_dwordx4 v[164:167], v1, s[20:23], s33 offen offset:0
    ds_read_b64_tr_b16 a[0:1], v148 offset:18624
    ds_read_b64_tr_b16 a[2:3], v148 offset:23232
    s_waitcnt lgkmcnt(10)
    v_mfma_f32_16x16x32_bf16 v[60:63], a[4:7], a[56:59], v[60:63]
    v_mfma_f32_16x16x32_bf16 v[64:67], a[4:7], a[60:63], v[64:67]
    ds_read_b64_tr_b16 a[4:5], v150 offset:18624
    ds_read_b64_tr_b16 a[6:7], v150 offset:23232
    s_waitcnt lgkmcnt(10)
    v_mfma_f32_16x16x32_bf16 v[68:71], a[8:11], a[56:59], v[68:71]
    v_mfma_f32_16x16x32_bf16 v[72:75], a[8:11], a[60:63], v[72:75]
    s_add_u32 s34, s34, 4096
    buffer_load_dwordx4 v[168:171], v1, s[20:23], s34 offen offset:0
    ds_read_b64_tr_b16 a[8:9], v148 offset:18656
    ds_read_b64_tr_b16 a[10:11], v148 offset:23264
    s_waitcnt lgkmcnt(10)
    v_mfma_f32_16x16x32_bf16 v[76:79], a[12:15], a[56:59], v[76:79]
    v_mfma_f32_16x16x32_bf16 v[80:83], a[12:15], a[60:63], v[80:83]
    ds_read_b64_tr_b16 a[12:13], v150 offset:18656
    ds_read_b64_tr_b16 a[14:15], v150 offset:23264
    s_waitcnt lgkmcnt(10)
    v_mfma_f32_16x16x32_bf16 v[84:87], a[16:19], a[56:59], v[84:87]
    v_mfma_f32_16x16x32_bf16 v[88:91], a[16:19], a[60:63], v[88:91]
    buffer_load_dwordx4 v[172:175], v1, s[20:23], s33 offen offset:1024
    ds_read_b64_tr_b16 a[16:17], v148 offset:18688
    ds_read_b64_tr_b16 a[18:19], v148 offset:23296
    s_waitcnt lgkmcnt(10)
    v_mfma_f32_16x16x32_bf16 v[92:95], a[20:23], a[56:59], v[92:95]
    v_mfma_f32_16x16x32_bf16 v[96:99], a[20:23], a[60:63], v[96:99]
    ds_read_b64_tr_b16 a[20:21], v150 offset:18688
    ds_read_b64_tr_b16 a[22:23], v150 offset:23296
    s_waitcnt lgkmcnt(10)
    v_mfma_f32_16x16x32_bf16 v[100:103], a[0:3], a[56:59], v[100:103]
    v_mfma_f32_16x16x32_bf16 v[104:107], a[0:3], a[60:63], v[104:107]
    buffer_load_dwordx4 v[176:179], v1, s[20:23], s34 offen offset:1024
    s_waitcnt vmcnt(29)
    s_barrier
    ds_read_b64_tr_b16 a[0:1], v148 offset:27648
    ds_read_b64_tr_b16 a[2:3], v148 offset:32256
    s_waitcnt lgkmcnt(10)
    v_mfma_f32_16x16x32_bf16 v[108:111], a[4:7], a[56:59], v[108:111]
    v_mfma_f32_16x16x32_bf16 v[112:115], a[4:7], a[60:63], v[112:115]
    ds_read_b64_tr_b16 a[4:5], v150 offset:27648
    ds_read_b64_tr_b16 a[6:7], v150 offset:32256
    s_waitcnt lgkmcnt(10)
    v_mfma_f32_16x16x32_bf16 v[116:119], a[8:11], a[56:59], v[116:119]
    v_mfma_f32_16x16x32_bf16 v[120:123], a[8:11], a[60:63], v[120:123]
    s_add_u32 m0, s32, 9216
    s_add_u32 s35, s35, 294912
    buffer_load_dwordx4 v156, s[16:19], s35 offen lds
    ds_read_b64_tr_b16 a[8:9], v148 offset:27680
    ds_read_b64_tr_b16 a[10:11], v148 offset:32288
    s_waitcnt lgkmcnt(10)
    v_mfma_f32_16x16x32_bf16 v[124:127], a[12:15], a[56:59], v[124:127]
    v_mfma_f32_16x16x32_bf16 v[128:131], a[12:15], a[60:63], v[128:131]
    ds_read_b64_tr_b16 a[12:13], v150 offset:27680
    ds_read_b64_tr_b16 a[14:15], v150 offset:32288
    s_waitcnt lgkmcnt(10)
    v_mfma_f32_16x16x32_bf16 v[132:135], a[16:19], a[56:59], v[132:135]
    v_mfma_f32_16x16x32_bf16 v[136:139], a[16:19], a[60:63], v[136:139]
    s_add_u32 m0, s32, 13312
    s_nop 0
    buffer_load_dwordx4 v157, s[16:19], s35 offen lds
    ds_read_b64_tr_b16 a[16:17], v148 offset:27712
    ds_read_b64_tr_b16 a[18:19], v148 offset:32320
    s_waitcnt lgkmcnt(10)
    v_mfma_f32_16x16x32_bf16 v[140:143], a[20:23], a[56:59], v[140:143]
    v_mfma_f32_16x16x32_bf16 v[144:147], a[20:23], a[60:63], v[144:147]
    ds_read_b64_tr_b16 a[20:21], v150 offset:27712
    ds_read_b64_tr_b16 a[22:23], v150 offset:32320
    s_waitcnt vmcnt(28) lgkmcnt(10)
    v_mfma_f32_16x16x32_bf16 v[4:7], a[0:3], a[64:67], v[4:7]
    s_waitcnt vmcnt(27)
    v_mfma_f32_16x16x32_bf16 v[8:11], a[0:3], a[68:71], v[8:11]
    s_add_u32 m0, s31, 17408
    s_mov_b64 exec, 0xffff
    buffer_load_dwordx4 v158, s[16:19], s35 offen lds
    s_mov_b64 exec, -1
    ds_read_b64_tr_b16 a[0:1], v148 offset:27744
    ds_read_b64_tr_b16 a[2:3], v148 offset:32352
    s_waitcnt lgkmcnt(10)
    v_mfma_f32_16x16x32_bf16 v[12:15], a[4:7], a[64:67], v[12:15]
    v_mfma_f32_16x16x32_bf16 v[16:19], a[4:7], a[68:71], v[16:19]
    ds_read_b64_tr_b16 a[4:5], v150 offset:27744
    ds_read_b64_tr_b16 a[6:7], v150 offset:32352
    s_waitcnt lgkmcnt(10)
    v_mfma_f32_16x16x32_bf16 v[20:23], a[8:11], a[64:67], v[20:23]
    v_mfma_f32_16x16x32_bf16 v[24:27], a[8:11], a[68:71], v[24:27]
    ds_read_b64_tr_b16 a[8:9], v148 offset:27776
    ds_read_b64_tr_b16 a[10:11], v148 offset:32384
    s_waitcnt lgkmcnt(10)
    v_mfma_f32_16x16x32_bf16 v[28:31], a[12:15], a[64:67], v[28:31]
    v_mfma_f32_16x16x32_bf16 v[32:35], a[12:15], a[68:71], v[32:35]
    ds_read_b64_tr_b16 a[12:13], v150 offset:27776
    ds_read_b64_tr_b16 a[14:15], v150 offset:32384
    s_waitcnt lgkmcnt(10)
    v_mfma_f32_16x16x32_bf16 v[36:39], a[16:19], a[64:67], v[36:39]
    v_mfma_f32_16x16x32_bf16 v[40:43], a[16:19], a[68:71], v[40:43]
    ds_read_b64_tr_b16 a[16:17], v148 offset:27808
    ds_read_b64_tr_b16 a[18:19], v148 offset:32416
    s_waitcnt lgkmcnt(10)
    v_mfma_f32_16x16x32_bf16 v[44:47], a[20:23], a[64:67], v[44:47]
    v_mfma_f32_16x16x32_bf16 v[48:51], a[20:23], a[68:71], v[48:51]
    ds_read_b64_tr_b16 a[20:21], v150 offset:27808
    ds_read_b64_tr_b16 a[22:23], v150 offset:32416
    s_waitcnt lgkmcnt(10)
    v_mfma_f32_16x16x32_bf16 v[52:55], a[0:3], a[64:67], v[52:55]
    v_mfma_f32_16x16x32_bf16 v[56:59], a[0:3], a[68:71], v[56:59]
    ds_read_b64_tr_b16 a[0:1], v148 offset:27840
    ds_read_b64_tr_b16 a[2:3], v148 offset:32448
    s_waitcnt lgkmcnt(10)
    v_mfma_f32_16x16x32_bf16 v[60:63], a[4:7], a[64:67], v[60:63]
    v_mfma_f32_16x16x32_bf16 v[64:67], a[4:7], a[68:71], v[64:67]
    ds_read_b64_tr_b16 a[4:5], v150 offset:27840
    ds_read_b64_tr_b16 a[6:7], v150 offset:32448
    s_waitcnt lgkmcnt(10)
    v_mfma_f32_16x16x32_bf16 v[68:71], a[8:11], a[64:67], v[68:71]
    v_mfma_f32_16x16x32_bf16 v[72:75], a[8:11], a[68:71], v[72:75]
    ds_read_b64_tr_b16 a[8:9], v148 offset:27872
    ds_read_b64_tr_b16 a[10:11], v148 offset:32480
    s_waitcnt lgkmcnt(10)
    v_mfma_f32_16x16x32_bf16 v[76:79], a[12:15], a[64:67], v[76:79]
    v_mfma_f32_16x16x32_bf16 v[80:83], a[12:15], a[68:71], v[80:83]
    ds_read_b64_tr_b16 a[12:13], v150 offset:27872
    ds_read_b64_tr_b16 a[14:15], v150 offset:32480
    s_waitcnt lgkmcnt(10)
    v_mfma_f32_16x16x32_bf16 v[84:87], a[16:19], a[64:67], v[84:87]
    v_mfma_f32_16x16x32_bf16 v[88:91], a[16:19], a[68:71], v[88:91]
    ds_read_b64_tr_b16 a[16:17], v148 offset:27904
    ds_read_b64_tr_b16 a[18:19], v148 offset:32512
    s_waitcnt lgkmcnt(10)
    v_mfma_f32_16x16x32_bf16 v[92:95], a[20:23], a[64:67], v[92:95]
    v_mfma_f32_16x16x32_bf16 v[96:99], a[20:23], a[68:71], v[96:99]
    ds_read_b64_tr_b16 a[20:21], v150 offset:27904
    ds_read_b64_tr_b16 a[22:23], v150 offset:32512
    s_waitcnt lgkmcnt(10)
    v_mfma_f32_16x16x32_bf16 v[100:103], a[0:3], a[64:67], v[100:103]
    v_mfma_f32_16x16x32_bf16 v[104:107], a[0:3], a[68:71], v[104:107]
    s_waitcnt vmcnt(27)
    s_barrier
    ds_read_b64_tr_b16 a[0:1], v149 offset:0
    ds_read_b64_tr_b16 a[2:3], v149 offset:4608
    s_waitcnt lgkmcnt(10)
    v_mfma_f32_16x16x32_bf16 v[108:111], a[4:7], a[64:67], v[108:111]
    v_mfma_f32_16x16x32_bf16 v[112:115], a[4:7], a[68:71], v[112:115]
    ds_read_b64_tr_b16 a[4:5], v151 offset:0
    ds_read_b64_tr_b16 a[6:7], v151 offset:4608
    s_waitcnt lgkmcnt(10)
    v_mfma_f32_16x16x32_bf16 v[116:119], a[8:11], a[64:67], v[116:119]
    v_mfma_f32_16x16x32_bf16 v[120:123], a[8:11], a[68:71], v[120:123]
    ds_read_b64_tr_b16 a[8:9], v149 offset:32
    ds_read_b64_tr_b16 a[10:11], v149 offset:4640
    s_waitcnt lgkmcnt(10)
    v_mfma_f32_16x16x32_bf16 v[124:127], a[12:15], a[64:67], v[124:127]
    v_mfma_f32_16x16x32_bf16 v[128:131], a[12:15], a[68:71], v[128:131]
    ds_read_b64_tr_b16 a[12:13], v151 offset:32
    ds_read_b64_tr_b16 a[14:15], v151 offset:4640
    s_waitcnt lgkmcnt(10)
    v_mfma_f32_16x16x32_bf16 v[132:135], a[16:19], a[64:67], v[132:135]
    v_mfma_f32_16x16x32_bf16 v[136:139], a[16:19], a[68:71], v[136:139]
    s_waitcnt vmcnt(24)
    s_barrier
    ds_read_b64_tr_b16 a[16:17], v149 offset:9216
    ds_read_b64_tr_b16 a[18:19], v149 offset:13824
    s_waitcnt lgkmcnt(10)
    v_mfma_f32_16x16x32_bf16 v[140:143], a[20:23], a[64:67], v[140:143]
    v_mfma_f32_16x16x32_bf16 v[144:147], a[20:23], a[68:71], v[144:147]
    ds_read_b64_tr_b16 a[20:21], v151 offset:9216
    ds_read_b64_tr_b16 a[22:23], v151 offset:13824
    s_waitcnt vmcnt(23) lgkmcnt(10)
    v_mfma_f32_16x16x32_bf16 v[4:7], a[0:3], a[24:27], v[4:7]
    s_waitcnt vmcnt(22)
    v_mfma_f32_16x16x32_bf16 v[8:11], a[0:3], a[28:31], v[8:11]
    ds_read_b64_tr_b16 a[0:1], v149 offset:9248
    ds_read_b64_tr_b16 a[2:3], v149 offset:13856
    s_waitcnt lgkmcnt(10)
    v_mfma_f32_16x16x32_bf16 v[12:15], a[4:7], a[24:27], v[12:15]
    v_mfma_f32_16x16x32_bf16 v[16:19], a[4:7], a[28:31], v[16:19]
    ds_read_b64_tr_b16 a[4:5], v151 offset:9248
    ds_read_b64_tr_b16 a[6:7], v151 offset:13856
    s_waitcnt lgkmcnt(10)
    v_mfma_f32_16x16x32_bf16 v[20:23], a[8:11], a[24:27], v[20:23]
    v_mfma_f32_16x16x32_bf16 v[24:27], a[8:11], a[28:31], v[24:27]
    s_waitcnt vmcnt(19)
    s_barrier
    ds_read_b64_tr_b16 a[8:9], v149 offset:18432
    ds_read_b64_tr_b16 a[10:11], v149 offset:23040
    s_waitcnt lgkmcnt(10)
    v_mfma_f32_16x16x32_bf16 v[28:31], a[12:15], a[24:27], v[28:31]
    v_mfma_f32_16x16x32_bf16 v[32:35], a[12:15], a[28:31], v[32:35]
    ds_read_b64_tr_b16 a[12:13], v151 offset:18432
    ds_read_b64_tr_b16 a[14:15], v151 offset:23040
    s_waitcnt vmcnt(18) lgkmcnt(10)
    v_mfma_f32_16x16x32_bf16 v[4:7], a[16:19], a[32:35], v[4:7]
    s_waitcnt vmcnt(17)
    v_mfma_f32_16x16x32_bf16 v[8:11], a[16:19], a[36:39], v[8:11]
    ds_read_b64_tr_b16 a[16:17], v149 offset:18464
    ds_read_b64_tr_b16 a[18:19], v149 offset:23072
    s_waitcnt lgkmcnt(10)
    v_mfma_f32_16x16x32_bf16 v[12:15], a[20:23], a[32:35], v[12:15]
    v_mfma_f32_16x16x32_bf16 v[16:19], a[20:23], a[36:39], v[16:19]
    ds_read_b64_tr_b16 a[20:21], v151 offset:18464
    ds_read_b64_tr_b16 a[22:23], v151 offset:23072
    s_waitcnt lgkmcnt(10)
    v_mfma_f32_16x16x32_bf16 v[20:23], a[0:3], a[32:35], v[20:23]
    v_mfma_f32_16x16x32_bf16 v[24:27], a[0:3], a[36:39], v[24:27]
    s_waitcnt vmcnt(14)
    s_barrier
    ds_read_b64_tr_b16 a[0:1], v149 offset:27648
    ds_read_b64_tr_b16 a[2:3], v149 offset:32256
    s_waitcnt lgkmcnt(10)
    v_mfma_f32_16x16x32_bf16 v[28:31], a[4:7], a[32:35], v[28:31]
    v_mfma_f32_16x16x32_bf16 v[32:35], a[4:7], a[36:39], v[32:35]
    ds_read_b64_tr_b16 a[4:5], v151 offset:27648
    ds_read_b64_tr_b16 a[6:7], v151 offset:32256
    s_waitcnt vmcnt(13) lgkmcnt(10)
    v_mfma_f32_16x16x32_bf16 v[4:7], a[8:11], a[40:43], v[4:7]
    s_waitcnt vmcnt(12)
    v_mfma_f32_16x16x32_bf16 v[8:11], a[8:11], a[44:47], v[8:11]
    ds_read_b64_tr_b16 a[8:9], v149 offset:27680
    ds_read_b64_tr_b16 a[10:11], v149 offset:32288
    s_waitcnt lgkmcnt(10)
    v_mfma_f32_16x16x32_bf16 v[12:15], a[12:15], a[40:43], v[12:15]
    v_mfma_f32_16x16x32_bf16 v[16:19], a[12:15], a[44:47], v[16:19]
    ds_read_b64_tr_b16 a[12:13], v151 offset:27680
    ds_read_b64_tr_b16 a[14:15], v151 offset:32288
    s_waitcnt lgkmcnt(10)
    v_mfma_f32_16x16x32_bf16 v[20:23], a[16:19], a[40:43], v[20:23]
    v_mfma_f32_16x16x32_bf16 v[24:27], a[16:19], a[44:47], v[24:27]
    s_waitcnt vmcnt(9)
    s_barrier
    ds_read_b64_tr_b16 a[16:17], v148 offset:0
    ds_read_b64_tr_b16 a[18:19], v148 offset:4608
    s_waitcnt lgkmcnt(10)
    v_mfma_f32_16x16x32_bf16 v[28:31], a[20:23], a[40:43], v[28:31]
    v_mfma_f32_16x16x32_bf16 v[32:35], a[20:23], a[44:47], v[32:35]
    ds_read_b64_tr_b16 a[20:21], v150 offset:0
    ds_read_b64_tr_b16 a[22:23], v150 offset:4608
    s_waitcnt vmcnt(8) lgkmcnt(10)
    v_mfma_f32_16x16x32_bf16 v[4:7], a[0:3], a[48:51], v[4:7]
    s_waitcnt vmcnt(7)
    v_mfma_f32_16x16x32_bf16 v[8:11], a[0:3], a[52:55], v[8:11]
    ds_read_b64_tr_b16 a[0:1], v148 offset:32
    ds_read_b64_tr_b16 a[2:3], v148 offset:4640
    s_waitcnt lgkmcnt(10)
    v_mfma_f32_16x16x32_bf16 v[12:15], a[4:7], a[48:51], v[12:15]
    v_mfma_f32_16x16x32_bf16 v[16:19], a[4:7], a[52:55], v[16:19]
    ds_read_b64_tr_b16 a[4:5], v150 offset:32
    ds_read_b64_tr_b16 a[6:7], v150 offset:4640
    s_waitcnt lgkmcnt(10)
    v_mfma_f32_16x16x32_bf16 v[20:23], a[8:11], a[48:51], v[20:23]
    v_mfma_f32_16x16x32_bf16 v[24:27], a[8:11], a[52:55], v[24:27]
    s_waitcnt vmcnt(0)
    s_barrier
    ds_read_b64_tr_b16 a[8:9], v148 offset:9216
    ds_read_b64_tr_b16 a[10:11], v148 offset:13824
    s_waitcnt lgkmcnt(10)
    v_mfma_f32_16x16x32_bf16 v[28:31], a[12:15], a[48:51], v[28:31]
    v_mfma_f32_16x16x32_bf16 v[32:35], a[12:15], a[52:55], v[32:35]
    ds_read_b64_tr_b16 a[12:13], v150 offset:9216
    ds_read_b64_tr_b16 a[14:15], v150 offset:13824
    s_waitcnt lgkmcnt(10)
    v_mfma_f32_16x16x32_bf16 v[4:7], a[16:19], v[164:167], v[4:7]
    v_mfma_f32_16x16x32_bf16 v[8:11], a[16:19], v[168:171], v[8:11]
    ds_read_b64_tr_b16 a[16:17], v148 offset:9248
    ds_read_b64_tr_b16 a[18:19], v148 offset:13856
    s_waitcnt lgkmcnt(10)
    v_mfma_f32_16x16x32_bf16 v[12:15], a[20:23], v[164:167], v[12:15]
    v_mfma_f32_16x16x32_bf16 v[16:19], a[20:23], v[168:171], v[16:19]
    ds_read_b64_tr_b16 a[20:21], v150 offset:9248
    ds_read_b64_tr_b16 a[22:23], v150 offset:13856
    s_waitcnt lgkmcnt(10)
    v_mfma_f32_16x16x32_bf16 v[20:23], a[0:3], v[164:167], v[20:23]
    v_mfma_f32_16x16x32_bf16 v[24:27], a[0:3], v[168:171], v[24:27]
    s_bfm_b64 exec, 41, 0
    buffer_load_dword v3, v3, s[12:15], 0 offen
    s_mov_b64 exec, -1
    s_lshr_b32 s30, s2, 3
    s_lshl_b32 s30, s30, 3
    s_add_u32 s30, s30, s24
    s_and_b32 s30, s30, 31
    s_getpc_b64 s[4:5]
L_pfc4:
    s_add_u32 s4, s4, k5_kernel-L_pfc4
    s_addc_u32 s5, s5, (k5_kernel-L_pfc4)>>32
    s_lshl_b32 s29, s30, 6
    v_add_u32 v156, s29, v0
    v_lshlrev_b32 v156, 7, v156
    s_mov_b32 s29, L_code_end-k5_kernel
    v_cmp_gt_u32 s[6:7], s29, v156
    v_mov_b32 v157, s5
    v_add_co_u32 v156, vcc, s4, v156
    s_nop 1
    v_addc_co_u32 v157, vcc, 0, v157, vcc
    s_mov_b64 exec, s[6:7]
    s_cbranch_execz L_pfc4_s
    global_load_dword v156, v[156:157], off
L_pfc4_s:
    s_mov_b64 exec, -1
    ds_read_b64_tr_b16 a[0:1], v149 offset:64
    ds_read_b64_tr_b16 a[2:3], v149 offset:4672
    s_waitcnt lgkmcnt(10)
    v_mfma_f32_16x16x32_bf16 v[28:31], a[4:7], v[164:167], v[28:31]
    v_mfma_f32_16x16x32_bf16 v[32:35], a[4:7], v[168:171], v[32:35]
    ds_read_b64_tr_b16 a[4:5], v151 offset:64
    ds_read_b64_tr_b16 a[6:7], v151 offset:4672
    s_waitcnt lgkmcnt(10)
    v_mfma_f32_16x16x32_bf16 v[4:7], a[8:11], v[172:175], v[4:7]
    v_mfma_f32_16x16x32_bf16 v[8:11], a[8:11], v[176:179], v[8:11]
    ds_read_b64_tr_b16 a[8:9], v149 offset:96
    ds_read_b64_tr_b16 a[10:11], v149 offset:4704
    s_waitcnt lgkmcnt(10)
    v_mfma_f32_16x16x32_bf16 v[12:15], a[12:15], v[172:175], v[12:15]
    v_mfma_f32_16x16x32_bf16 v[16:19], a[12:15], v[176:179], v[16:19]
    ds_read_b64_tr_b16 a[12:13], v151 offset:96
    ds_read_b64_tr_b16 a[14:15], v151 offset:4704
    s_waitcnt lgkmcnt(10)
    v_mfma_f32_16x16x32_bf16 v[20:23], a[16:19], v[172:175], v[20:23]
    v_mfma_f32_16x16x32_bf16 v[24:27], a[16:19], v[176:179], v[24:27]
    ds_read_b64_tr_b16 a[16:17], v149 offset:9280
    ds_read_b64_tr_b16 a[18:19], v149 offset:13888
    s_waitcnt lgkmcnt(10)
    v_mfma_f32_16x16x32_bf16 v[28:31], a[20:23], v[172:175], v[28:31]
    v_mfma_f32_16x16x32_bf16 v[32:35], a[20:23], v[176:179], v[32:35]
    ds_read_b64_tr_b16 a[20:21], v151 offset:9280
    ds_read_b64_tr_b16 a[22:23], v151 offset:13888
    s_waitcnt lgkmcnt(10)
    v_mfma_f32_16x16x32_bf16 v[36:39], a[0:3], a[24:27], v[36:39]
    v_mfma_f32_16x16x32_bf16 v[40:43], a[0:3], a[28:31], v[40:43]
    ds_read_b64_tr_b16 a[0:1], v149 offset:9312
    ds_read_b64_tr_b16 a[2:3], v149 offset:13920
    s_waitcnt lgkmcnt(10)
    v_mfma_f32_16x16x32_bf16 v[44:47], a[4:7], a[24:27], v[44:47]
    v_mul_f32 v4, v4, v152
    v_mul_f32 v5, v5, v152
    v_mul_f32 v6, v6, v152
    v_mfma_f32_16x16x32_bf16 v[48:51], a[4:7], a[28:31], v[48:51]
    v_mul_f32 v7, v7, v152
    v_mul_f32 v20, v20, v152
    ds_read_b64_tr_b16 a[4:5], v151 offset:9312
    ds_read_b64_tr_b16 a[6:7], v151 offset:13920
    s_waitcnt lgkmcnt(10)
    v_mfma_f32_16x16x32_bf16 v[52:55], a[8:11], a[24:27], v[52:55]
    v_mul_f32 v21, v21, v152
    v_mul_f32 v22, v22, v152
    v_mfma_f32_16x16x32_bf16 v[56:59], a[8:11], a[28:31], v[56:59]
    v_mul_f32 v23, v23, v152
    v_exp_f32 v4, v4
    ds_read_b64_tr_b16 a[8:9], v149 offset:18496
    ds_read_b64_tr_b16 a[10:11], v149 offset:23104
    s_waitcnt lgkmcnt(10)
    v_mfma_f32_16x16x32_bf16 v[60:63], a[12:15], a[24:27], v[60:63]
    v_exp_f32 v5, v5
    v_exp_f32 v6, v6
    v_mfma_f32_16x16x32_bf16 v[64:67], a[12:15], a[28:31], v[64:67]
    v_exp_f32 v7, v7
    v_exp_f32 v20, v20
    ds_read_b64_tr_b16 a[12:13], v151 offset:18496
    ds_read_b64_tr_b16 a[14:15], v151 offset:23104
    s_waitcnt lgkmcnt(10)
    v_mfma_f32_16x16x32_bf16 v[36:39], a[16:19], a[32:35], v[36:39]
    v_exp_f32 v21, v21
    v_exp_f32 v22, v22
    v_mfma_f32_16x16x32_bf16 v[40:43], a[16:19], a[36:39], v[40:43]
    v_exp_f32 v23, v23
    v_fma_f32 v4, v4, v154, v154
    ds_read_b64_tr_b16 a[16:17], v149 offset:18528
    ds_read_b64_tr_b16 a[18:19], v149 offset:23136
    s_waitcnt lgkmcnt(10)
    v_mfma_f32_16x16x32_bf16 v[44:47], a[20:23], a[32:35], v[44:47]
    v_fma_f32 v5, v5, v154, v154
    v_fma_f32 v6, v6, v154, v154
    v_mfma_f32_16x16x32_bf16 v[48:51], a[20:23], a[36:39], v[48:51]
    v_fma_f32 v7, v7, v154, v154
    v_fma_f32 v20, v20, v154, v154
    ds_read_b64_tr_b16 a[20:21], v151 offset:18528
    ds_read_b64_tr_b16 a[22:23], v151 offset:23136
    s_waitcnt lgkmcnt(10)
    v_mfma_f32_16x16x32_bf16 v[52:55], a[0:3], a[32:35], v[52:55]
    v_fma_f32 v21, v21, v154, v154
    v_fma_f32 v22, v22, v154, v154
    v_mfma_f32_16x16x32_bf16 v[56:59], a[0:3], a[36:39], v[56:59]
    v_fma_f32 v23, v23, v154, v154
    v_rcp_f32 v4, v4
    ds_read_b64_tr_b16 a[0:1], v149 offset:27712
    ds_read_b64_tr_b16 a[2:3], v149 offset:32320
    s_waitcnt lgkmcnt(10)
    v_mfma_f32_16x16x32_bf16 v[60:63], a[4:7], a[32:35], v[60:63]
    v_rcp_f32 v5, v5
    v_rcp_f32 v6, v6
    v_mfma_f32_16x16x32_bf16 v[64:67], a[4:7], a[36:39], v[64:67]
    v_rcp_f32 v7, v7
    v_rcp_f32 v20, v20
    ds_read_b64_tr_b16 a[4:5], v151 offset:27712
    ds_read_b64_tr_b16 a[6:7], v151 offset:32320
    s_waitcnt lgkmcnt(10)
    v_mfma_f32_16x16x32_bf16 v[36:39], a[8:11], a[40:43], v[36:39]
    v_rcp_f32 v21, v21
    v_rcp_f32 v22, v22
    v_mfma_f32_16x16x32_bf16 v[40:43], a[8:11], a[44:47], v[40:43]
    v_rcp_f32 v23, v23
    v_mul_f32 v12, v12, v4
    ds_read_b64_tr_b16 a[8:9], v149 offset:27744
    ds_read_b64_tr_b16 a[10:11], v149 offset:32352
    s_waitcnt lgkmcnt(10)
    v_mfma_f32_16x16x32_bf16 v[44:47], a[12:15], a[40:43], v[44:47]
    v_mul_f32 v13, v13, v5
    v_mul_f32 v14, v14, v6
    v_mfma_f32_16x16x32_bf16 v[48:51], a[12:15], a[44:47], v[48:51]
    v_mul_f32 v15, v15, v7
    v_mul_f32 v28, v28, v20
    ds_read_b64_tr_b16 a[12:13], v151 offset:27744
    ds_read_b64_tr_b16 a[14:15], v151 offset:32352
    s_waitcnt lgkmcnt(10)
    v_mfma_f32_16x16x32_bf16 v[52:55], a[16:19], a[40:43], v[52:55]
    v_mul_f32 v29, v29, v21
    v_mul_f32 v30, v30, v22
    v_mfma_f32_16x16x32_bf16 v[56:59], a[16:19], a[44:47], v[56:59]
    v_mul_f32 v31, v31, v23
    v_cvt_pk_bf16_f32 v4, v12, v13
    ds_read_b64_tr_b16 a[16:17], v148 offset:64
    ds_read_b64_tr_b16 a[18:19], v148 offset:4672
    s_waitcnt lgkmcnt(10)
    v_mfma_f32_16x16x32_bf16 v[60:63], a[20:23], a[40:43], v[60:63]
    v_cvt_pk_bf16_f32 v5, v14, v15
    v_cvt_pk_bf16_f32 v6, v28, v29
    v_mfma_f32_16x16x32_bf16 v[64:67], a[20:23], a[44:47], v[64:67]
    v_cvt_pk_bf16_f32 v7, v30, v31
    buffer_store_dwordx4 v[4:7], v1, s[20:23], s36 offen offset:0
    ds_read_b64_tr_b16 a[20:21], v150 offset:64
    ds_read_b64_tr_b16 a[22:23], v150 offset:4672
    s_waitcnt lgkmcnt(10)
    v_mfma_f32_16x16x32_bf16 v[36:39], a[0:3], a[48:51], v[36:39]
    v_mul_f32 v8, v8, v153
    v_mul_f32 v9, v9, v153
    v_mul_f32 v10, v10, v153
    v_mfma_f32_16x16x32_bf16 v[40:43], a[0:3], a[52:55], v[40:43]
    v_mul_f32 v11, v11, v153
    v_mul_f32 v24, v24, v153
    ds_read_b64_tr_b16 a[0:1], v148 offset:96
    ds_read_b64_tr_b16 a[2:3], v148 offset:4704
    s_waitcnt lgkmcnt(10)
    v_mfma_f32_16x16x32_bf16 v[44:47], a[4:7], a[48:51], v[44:47]
    v_mul_f32 v25, v25, v153
    v_mul_f32 v26, v26, v153
    v_mfma_f32_16x16x32_bf16 v[48:51], a[4:7], a[52:55], v[48:51]
    v_mul_f32 v27, v27, v153
    v_exp_f32 v8, v8
    ds_read_b64_tr_b16 a[4:5], v150 offset:96
    ds_read_b64_tr_b16 a[6:7], v150 offset:4704
    s_waitcnt lgkmcnt(10)
    v_mfma_f32_16x16x32_bf16 v[52:55], a[8:11], a[48:51], v[52:55]
    v_exp_f32 v9, v9
    v_exp_f32 v10, v10
    v_mfma_f32_16x16x32_bf16 v[56:59], a[8:11], a[52:55], v[56:59]
    v_exp_f32 v11, v11
    v_exp_f32 v24, v24
    ds_read_b64_tr_b16 a[8:9], v148 offset:9280
    ds_read_b64_tr_b16 a[10:11], v148 offset:13888
    s_waitcnt lgkmcnt(10)
    v_mfma_f32_16x16x32_bf16 v[60:63], a[12:15], a[48:51], v[60:63]
    v_exp_f32 v25, v25
    v_exp_f32 v26, v26
    v_mfma_f32_16x16x32_bf16 v[64:67], a[12:15], a[52:55], v[64:67]
    v_exp_f32 v27, v27
    v_fma_f32 v8, v8, v155, v155
    ds_read_b64_tr_b16 a[12:13], v150 offset:9280
    ds_read_b64_tr_b16 a[14:15], v150 offset:13888
    s_waitcnt lgkmcnt(10)
    v_mfma_f32_16x16x32_bf16 v[36:39], a[16:19], v[164:167], v[36:39]
    v_fma_f32 v9, v9, v155, v155
    v_fma_f32 v10, v10, v155, v155
    v_mfma_f32_16x16x32_bf16 v[40:43], a[16:19], v[168:171], v[40:43]
    v_fma_f32 v11, v11, v155, v155
    v_fma_f32 v24, v24, v155, v155
    ds_read_b64_tr_b16 a[16:17], v148 offset:9312
    ds_read_b64_tr_b16 a[18:19], v148 offset:13920
    s_waitcnt lgkmcnt(10)
    v_mfma_f32_16x16x32_bf16 v[44:47], a[20:23], v[164:167], v[44:47]
    v_fma_f32 v25, v25, v155, v155
    v_fma_f32 v26, v26, v155, v155
    v_mfma_f32_16x16x32_bf16 v[48:51], a[20:23], v[168:171], v[48:51]
    v_fma_f32 v27, v27, v155, v155
    v_rcp_f32 v8, v8
    ds_read_b64_tr_b16 a[20:21], v150 offset:9312
    ds_read_b64_tr_b16 a[22:23], v150 offset:13920
    s_waitcnt lgkmcnt(10)
    v_mfma_f32_16x16x32_bf16 v[52:55], a[0:3], v[164:167], v[52:55]
    v_rcp_f32 v9, v9
    v_rcp_f32 v10, v10
    v_mfma_f32_16x16x32_bf16 v[56:59], a[0:3], v[168:171], v[56:59]
    v_rcp_f32 v11, v11
    v_rcp_f32 v24, v24
    ds_read_b64_tr_b16 a[0:1], v149 offset:128
    ds_read_b64_tr_b16 a[2:3], v149 offset:4736
    s_waitcnt lgkmcnt(10)
    v_mfma_f32_16x16x32_bf16 v[60:63], a[4:7], v[164:167], v[60:63]
    v_rcp_f32 v25, v25
    v_rcp_f32 v26, v26
    v_mfma_f32_16x16x32_bf16 v[64:67], a[4:7], v[168:171], v[64:67]
    v_rcp_f32 v27, v27
    v_mul_f32 v16, v16, v8
    ds_read_b64_tr_b16 a[4:5], v151 offset:128
    ds_read_b64_tr_b16 a[6:7], v151 offset:4736
    s_waitcnt lgkmcnt(10)
    v_mfma_f32_16x16x32_bf16 v[36:39], a[8:11], v[172:175], v[36:39]
    v_mul_f32 v17, v17, v9
    v_mul_f32 v18, v18, v10
    v_mfma_f32_16x16x32_bf16 v[40:43], a[8:11], v[176:179], v[40:43]
    v_mul_f32 v19, v19, v11
    v_mul_f32 v32, v32, v24
    ds_read_b64_tr_b16 a[8:9], v149 offset:160
    ds_read_b64_tr_b16 a[10:11], v149 offset:4768
    s_waitcnt lgkmcnt(10)
    v_mfma_f32_16x16x32_bf16 v[44:47], a[12:15], v[172:175], v[44:47]
    v_mul_f32 v33, v33, v25
    v_mul_f32 v34, v34, v26
    v_mfma_f32_16x16x32_bf16 v[48:51], a[12:15], v[176:179], v[48:51]
    v_mul_f32 v35, v35, v27
    v_cvt_pk_bf16_f32 v8, v16, v17
    ds_read_b64_tr_b16 a[12:13], v151 offset:160
    ds_read_b64_tr_b16 a[14:15], v151 offset:4768
    s_waitcnt lgkmcnt(10)
    v_mfma_f32_16x16x32_bf16 v[52:55], a[16:19], v[172:175], v[52:55]
    v_cvt_pk_bf16_f32 v9, v18, v19
    v_cvt_pk_bf16_f32 v10, v32, v33
    v_mfma_f32_16x16x32_bf16 v[56:59], a[16:19], v[176:179], v[56:59]
    v_cvt_pk_bf16_f32 v11, v34, v35
    buffer_store_dwordx4 v[8:11], v2, s[20:23], s36 offen offset:0
    ds_read_b64_tr_b16 a[16:17], v149 offset:9344
    ds_read_b64_tr_b16 a[18:19], v149 offset:13952
    s_waitcnt lgkmcnt(10)
    v_mfma_f32_16x16x32_bf16 v[60:63], a[20:23], v[172:175], v[60:63]
    v_mfma_f32_16x16x32_bf16 v[64:67], a[20:23], v[176:179], v[64:67]
    ds_read_b64_tr_b16 a[20:21], v151 offset:9344
    ds_read_b64_tr_b16 a[22:23], v151 offset:13952
    s_waitcnt lgkmcnt(10)
    v_mfma_f32_16x16x32_bf16 v[68:71], a[0:3], a[24:27], v[68:71]
    v_mfma_f32_16x16x32_bf16 v[72:75], a[0:3], a[28:31], v[72:75]
    ds_read_b64_tr_b16 a[0:1], v149 offset:9376
    ds_read_b64_tr_b16 a[2:3], v149 offset:13984
    s_waitcnt lgkmcnt(10)
    v_mfma_f32_16x16x32_bf16 v[76:79], a[4:7], a[24:27], v[76:79]
    v_mul_f32 v36, v36, v152
    v_mul_f32 v37, v37, v152
    v_mul_f32 v38, v38, v152
    v_mfma_f32_16x16x32_bf16 v[80:83], a[4:7], a[28:31], v[80:83]
    v_mul_f32 v39, v39, v152
    v_mul_f32 v52, v52, v152
    ds_read_b64_tr_b16 a[4:5], v151 offset:9376
    ds_read_b64_tr_b16 a[6:7], v151 offset:13984
    s_waitcnt lgkmcnt(10)
    v_mfma_f32_16x16x32_bf16 v[84:87], a[8:11], a[24:27], v[84:87]
    v_mul_f32 v53, v53, v152
    v_mul_f32 v54, v54, v152
    v_mfma_f32_16x16x32_bf16 v[88:91], a[8:11], a[28:31], v[88:91]
    v_mul_f32 v55, v55, v152
    v_exp_f32 v36, v36
    ds_read_b64_tr_b16 a[8:9], v149 offset:18560
    ds_read_b64_tr_b16 a[10:11], v149 offset:23168
    s_waitcnt lgkmcnt(10)
    v_mfma_f32_16x16x32_bf16 v[92:95], a[12:15], a[24:27], v[92:95]
    v_exp_f32 v37, v37
    v_exp_f32 v38, v38
    v_mfma_f32_16x16x32_bf16 v[96:99], a[12:15], a[28:31], v[96:99]
    v_exp_f32 v39, v39
    v_exp_f32 v52, v52
    ds_read_b64_tr_b16 a[12:13], v151 offset:18560
    ds_read_b64_tr_b16 a[14:15], v151 offset:23168
    s_waitcnt lgkmcnt(10)
    v_mfma_f32_16x16x32_bf16 v[68:71], a[16:19], a[32:35], v[68:71]
    v_exp_f32 v53, v53
    v_exp_f32 v54, v54
    v_mfma_f32_16x16x32_bf16 v[72:75], a[16:19], a[36:39], v[72:75]
    v_exp_f32 v55, v55
    v_fma_f32 v36, v36, v154, v154
    ds_read_b64_tr_b16 a[16:17], v149 offset:18592
    ds_read_b64_tr_b16 a[18:19], v149 offset:23200
    s_waitcnt lgkmcnt(10)
    v_mfma_f32_16x16x32_bf16 v[76:79], a[20:23], a[32:35], v[76:79]
    v_fma_f32 v37, v37, v154, v154
    v_fma_f32 v38, v38, v154, v154
    v_mfma_f32_16x16x32_bf16 v[80:83], a[20:23], a[36:39], v[80:83]
    v_fma_f32 v39, v39, v154, v154
    v_fma_f32 v52, v52, v154, v154
    ds_read_b64_tr_b16 a[20:21], v151 offset:18592
    ds_read_b64_tr_b16 a[22:23], v151 offset:23200
    s_waitcnt lgkmcnt(10)
    v_mfma_f32_16x16x32_bf16 v[84:87], a[0:3], a[32:35], v[84:87]
    v_fma_f32 v53, v53, v154, v154
    v_fma_f32 v54, v54, v154, v154
    v_mfma_f32_16x16x32_bf16 v[88:91], a[0:3], a[36:39], v[88:91]
    v_fma_f32 v55, v55, v154, v154
    v_rcp_f32 v36, v36
    ds_read_b64_tr_b16 a[0:1], v149 offset:27776
    ds_read_b64_tr_b16 a[2:3], v149 offset:32384
    s_waitcnt lgkmcnt(10)
    v_mfma_f32_16x16x32_bf16 v[92:95], a[4:7], a[32:35], v[92:95]
    v_rcp_f32 v37, v37
    v_rcp_f32 v38, v38
    v_mfma_f32_16x16x32_bf16 v[96:99], a[4:7], a[36:39], v[96:99]
    v_rcp_f32 v39, v39
    v_rcp_f32 v52, v52
    ds_read_b64_tr_b16 a[4:5], v151 offset:27776
    ds_read_b64_tr_b16 a[6:7], v151 offset:32384
    s_waitcnt lgkmcnt(10)
    v_mfma_f32_16x16x32_bf16 v[68:71], a[8:11], a[40:43], v[68:71]
    v_rcp_f32 v53, v53
    v_rcp_f32 v54, v54
    v_mfma_f32_16x16x32_bf16 v[72:75], a[8:11], a[44:47], v[72:75]
    v_rcp_f32 v55, v55
    v_mul_f32 v44, v44, v36
    ds_read_b64_tr_b16 a[8:9], v149 offset:27808
    ds_read_b64_tr_b16 a[10:11], v149 offset:32416
    s_waitcnt lgkmcnt(10)
    v_mfma_f32_16x16x32_bf16 v[76:79], a[12:15], a[40:43], v[76:79]
    v_mul_f32 v45, v45, v37
    v_mul_f32 v46, v46, v38
    v_mfma_f32_16x16x32_bf16 v[80:83], a[12:15], a[44:47], v[80:83]
    v_mul_f32 v47, v47, v39
    v_mul_f32 v60, v60, v52
    ds_read_b64_tr_b16 a[12:13], v151 offset:27808
    ds_read_b64_tr_b16 a[14:15], v151 offset:32416
    s_waitcnt lgkmcnt(10)
    v_mfma_f32_16x16x32_bf16 v[84:87], a[16:19], a[40:43], v[84:87]
    v_mul_f32 v61, v61, v53
    v_mul_f32 v62, v62, v54
    v_mfma_f32_16x16x32_bf16 v[88:91], a[16:19], a[44:47], v[88:91]
    v_mul_f32 v63, v63, v55
    v_cvt_pk_bf16_f32 v36, v44, v45
    ds_read_b64_tr_b16 a[16:17], v148 offset:128
    ds_read_b64_tr_b16 a[18:19], v148 offset:4736
    s_waitcnt lgkmcnt(10)
    v_mfma_f32_16x16x32_bf16 v[92:95], a[20:23], a[40:43], v[92:95]
    v_cvt_pk_bf16_f32 v37, v46, v47
    v_cvt_pk_bf16_f32 v38, v60, v61
    v_mfma_f32_16x16x32_bf16 v[96:99], a[20:23], a[44:47], v[96:99]
    v_cvt_pk_bf16_f32 v39, v62, v63
    buffer_store_dwordx4 v[36:39], v1, s[20:23], s36 offen offset:1024
    ds_read_b64_tr_b16 a[20:21], v150 offset:128
    ds_read_b64_tr_b16 a[22:23], v150 offset:4736
    s_waitcnt lgkmcnt(10)
    v_mfma_f32_16x16x32_bf16 v[68:71], a[0:3], a[48:51], v[68:71]
    v_mul_f32 v40, v40, v153
    v_mul_f32 v41, v41, v153
    v_mul_f32 v42, v42, v153
    v_mfma_f32_16x16x32_bf16 v[72:75], a[0:3], a[52:55], v[72:75]
    v_mul_f32 v43, v43, v153
    v_mul_f32 v56, v56, v153
    ds_read_b64_tr_b16 a[0:1], v148 offset:160
    ds_read_b64_tr_b16 a[2:3], v148 offset:4768
    s_waitcnt lgkmcnt(10)
    v_mfma_f32_16x16x32_bf16 v[76:79], a[4:7], a[48:51], v[76:79]
    v_mul_f32 v57, v57, v153
    v_mul_f32 v58, v58, v153
    v_mfma_f32_16x16x32_bf16 v[80:83], a[4:7], a[52:55], v[80:83]
    v_mul_f32 v59, v59, v153
    v_exp_f32 v40, v40
    ds_read_b64_tr_b16 a[4:5], v150 offset:160
    ds_read_b64_tr_b16 a[6:7], v150 offset:4768
    s_waitcnt lgkmcnt(10)
    v_mfma_f32_16x16x32_bf16 v[84:87], a[8:11], a[48:51], v[84:87]
    v_exp_f32 v41, v41
    v_exp_f32 v42, v42
    v_mfma_f32_16x16x32_bf16 v[88:91], a[8:11], a[52:55], v[88:91]
    v_exp_f32 v43, v43
    v_exp_f32 v56, v56
    ds_read_b64_tr_b16 a[8:9], v148 offset:9344
    ds_read_b64_tr_b16 a[10:11], v148 offset:13952
    s_waitcnt lgkmcnt(10)
    v_mfma_f32_16x16x32_bf16 v[92:95], a[12:15], a[48:51], v[92:95]
    v_exp_f32 v57, v57
    v_exp_f32 v58, v58
    v_mfma_f32_16x16x32_bf16 v[96:99], a[12:15], a[52:55], v[96:99]
    v_exp_f32 v59, v59
    v_fma_f32 v40, v40, v155, v155
    ds_read_b64_tr_b16 a[12:13], v150 offset:9344
    ds_read_b64_tr_b16 a[14:15], v150 offset:13952
    s_waitcnt lgkmcnt(10)
    v_mfma_f32_16x16x32_bf16 v[68:71], a[16:19], v[164:167], v[68:71]
    v_fma_f32 v41, v41, v155, v155
    v_fma_f32 v42, v42, v155, v155
    v_mfma_f32_16x16x32_bf16 v[72:75], a[16:19], v[168:171], v[72:75]
    v_fma_f32 v43, v43, v155, v155
    v_fma_f32 v56, v56, v155, v155
    ds_read_b64_tr_b16 a[16:17], v148 offset:9376
    ds_read_b64_tr_b16 a[18:19], v148 offset:13984
    s_waitcnt lgkmcnt(10)
    v_mfma_f32_16x16x32_bf16 v[76:79], a[20:23], v[164:167], v[76:79]
    v_fma_f32 v57, v57, v155, v155
    v_fma_f32 v58, v58, v155, v155
    v_mfma_f32_16x16x32_bf16 v[80:83], a[20:23], v[168:171], v[80:83]
    v_fma_f32 v59, v59, v155, v155
    v_rcp_f32 v40, v40
    ds_read_b64_tr_b16 a[20:21], v150 offset:9376
    ds_read_b64_tr_b16 a[22:23], v150 offset:13984
    s_waitcnt lgkmcnt(10)
    v_mfma_f32_16x16x32_bf16 v[84:87], a[0:3], v[164:167], v[84:87]
    v_rcp_f32 v41, v41
    v_rcp_f32 v42, v42
    v_mfma_f32_16x16x32_bf16 v[88:91], a[0:3], v[168:171], v[88:91]
    v_rcp_f32 v43, v43
    v_rcp_f32 v56, v56
    ds_read_b64_tr_b16 a[0:1], v149 offset:192
    ds_read_b64_tr_b16 a[2:3], v149 offset:4800
    s_waitcnt lgkmcnt(10)
    v_mfma_f32_16x16x32_bf16 v[92:95], a[4:7], v[164:167], v[92:95]
    v_rcp_f32 v57, v57
    v_rcp_f32 v58, v58
    v_mfma_f32_16x16x32_bf16 v[96:99], a[4:7], v[168:171], v[96:99]
    v_rcp_f32 v59, v59
    v_mul_f32 v48, v48, v40
    ds_read_b64_tr_b16 a[4:5], v151 offset:192
    ds_read_b64_tr_b16 a[6:7], v151 offset:4800
    s_waitcnt lgkmcnt(10)
    v_mfma_f32_16x16x32_bf16 v[68:71], a[8:11], v[172:175], v[68:71]
    v_mul_f32 v49, v49, v41
    v_mul_f32 v50, v50, v42
    v_mfma_f32_16x16x32_bf16 v[72:75], a[8:11], v[176:179], v[72:75]
    v_mul_f32 v51, v51, v43
    v_mul_f32 v64, v64, v56
    ds_read_b64_tr_b16 a[8:9], v149 offset:224
    ds_read_b64_tr_b16 a[10:11], v149 offset:4832
    s_waitcnt lgkmcnt(10)
    v_mfma_f32_16x16x32_bf16 v[76:79], a[12:15], v[172:175], v[76:79]
    v_mul_f32 v65, v65, v57
    v_mul_f32 v66, v66, v58
    v_mfma_f32_16x16x32_bf16 v[80:83], a[12:15], v[176:179], v[80:83]
    v_mul_f32 v67, v67, v59
    v_cvt_pk_bf16_f32 v40, v48, v49
    ds_read_b64_tr_b16 a[12:13], v151 offset:224
    ds_read_b64_tr_b16 a[14:15], v151 offset:4832
    s_waitcnt lgkmcnt(10)
    v_mfma_f32_16x16x32_bf16 v[84:87], a[16:19], v[172:175], v[84:87]
    v_cvt_pk_bf16_f32 v41, v50, v51
    v_cvt_pk_bf16_f32 v42, v64, v65
    v_mfma_f32_16x16x32_bf16 v[88:91], a[16:19], v[176:179], v[88:91]
    v_cvt_pk_bf16_f32 v43, v66, v67
    buffer_store_dwordx4 v[40:43], v2, s[20:23], s36 offen offset:1024
    ds_read_b64_tr_b16 a[16:17], v149 offset:9408
    ds_read_b64_tr_b16 a[18:19], v149 offset:14016
    s_waitcnt lgkmcnt(10)
    v_mfma_f32_16x16x32_bf16 v[92:95], a[20:23], v[172:175], v[92:95]
    v_mfma_f32_16x16x32_bf16 v[96:99], a[20:23], v[176:179], v[96:99]
    ds_read_b64_tr_b16 a[20:21], v151 offset:9408
    ds_read_b64_tr_b16 a[22:23], v151 offset:14016
    s_waitcnt lgkmcnt(10)
    v_mfma_f32_16x16x32_bf16 v[100:103], a[0:3], a[24:27], v[100:103]
    v_mfma_f32_16x16x32_bf16 v[104:107], a[0:3], a[28:31], v[104:107]
    ds_read_b64_tr_b16 a[0:1], v149 offset:9440
    ds_read_b64_tr_b16 a[2:3], v149 offset:14048
    s_waitcnt lgkmcnt(10)
    v_mfma_f32_16x16x32_bf16 v[108:111], a[4:7], a[24:27], v[108:111]
    v_mul_f32 v68, v68, v152
    v_mul_f32 v69, v69, v152
    v_mul_f32 v70, v70, v152
    v_mfma_f32_16x16x32_bf16 v[112:115], a[4:7], a[28:31], v[112:115]
    v_mul_f32 v71, v71, v152
    v_mul_f32 v84, v84, v152
    ds_read_b64_tr_b16 a[4:5], v151 offset:9440
    ds_read_b64_tr_b16 a[6:7], v151 offset:14048
    s_waitcnt lgkmcnt(10)
    v_mfma_f32_16x16x32_bf16 v[116:119], a[8:11], a[24:27], v[116:119]
    v_mul_f32 v85, v85, v152
    v_mul_f32 v86, v86, v152
    v_mfma_f32_16x16x32_bf16 v[120:123], a[8:11], a[28:31], v[120:123]
    v_mul_f32 v87, v87, v152
    v_exp_f32 v68, v68
    ds_read_b64_tr_b16 a[8:9], v149 offset:18624
    ds_read_b64_tr_b16 a[10:11], v149 offset:23232
    s_waitcnt lgkmcnt(10)
    v_mfma_f32_16x16x32_bf16 v[124:127], a[12:15], a[24:27], v[124:127]
    v_exp_f32 v69, v69
    v_exp_f32 v70, v70
    v_mfma_f32_16x16x32_bf16 v[128:131], a[12:15], a[28:31], v[128:131]
    v_exp_f32 v71, v71
    v_exp_f32 v84, v84
    ds_read_b64_tr_b16 a[12:13], v151 offset:18624
    ds_read_b64_tr_b16 a[14:15], v151 offset:23232
    s_waitcnt lgkmcnt(10)
    v_mfma_f32_16x16x32_bf16 v[100:103], a[16:19], a[32:35], v[100:103]
    v_exp_f32 v85, v85
    v_exp_f32 v86, v86
    v_mfma_f32_16x16x32_bf16 v[104:107], a[16:19], a[36:39], v[104:107]
    v_exp_f32 v87, v87
    v_fma_f32 v68, v68, v154, v154
    ds_read_b64_tr_b16 a[16:17], v149 offset:18656
    ds_read_b64_tr_b16 a[18:19], v149 offset:23264
    s_waitcnt lgkmcnt(10)
    v_mfma_f32_16x16x32_bf16 v[108:111], a[20:23], a[32:35], v[108:111]
    v_fma_f32 v69, v69, v154, v154
    v_fma_f32 v70, v70, v154, v154
    v_mfma_f32_16x16x32_bf16 v[112:115], a[20:23], a[36:39], v[112:115]
    v_fma_f32 v71, v71, v154, v154
    v_fma_f32 v84, v84, v154, v154
    ds_read_b64_tr_b16 a[20:21], v151 offset:18656
    ds_read_b64_tr_b16 a[22:23], v151 offset:23264
    s_waitcnt lgkmcnt(10)
    v_mfma_f32_16x16x32_bf16 v[116:119], a[0:3], a[32:35], v[116:119]
    v_fma_f32 v85, v85, v154, v154
    v_fma_f32 v86, v86, v154, v154
    v_mfma_f32_16x16x32_bf16 v[120:123], a[0:3], a[36:39], v[120:123]
    v_fma_f32 v87, v87, v154, v154
    v_rcp_f32 v68, v68
    ds_read_b64_tr_b16 a[0:1], v149 offset:27840
    ds_read_b64_tr_b16 a[2:3], v149 offset:32448
    s_waitcnt lgkmcnt(10)
    v_mfma_f32_16x16x32_bf16 v[124:127], a[4:7], a[32:35], v[124:127]
    v_rcp_f32 v69, v69
    v_rcp_f32 v70, v70
    v_mfma_f32_16x16x32_bf16 v[128:131], a[4:7], a[36:39], v[128:131]
    v_rcp_f32 v71, v71
    v_rcp_f32 v84, v84
    ds_read_b64_tr_b16 a[4:5], v151 offset:27840
    ds_read_b64_tr_b16 a[6:7], v151 offset:32448
    s_waitcnt lgkmcnt(10)
    v_mfma_f32_16x16x32_bf16 v[100:103], a[8:11], a[40:43], v[100:103]
    v_rcp_f32 v85, v85
    v_rcp_f32 v86, v86
    v_mfma_f32_16x16x32_bf16 v[104:107], a[8:11], a[44:47], v[104:107]
    v_rcp_f32 v87, v87
    v_mul_f32 v76, v76, v68
    ds_read_b64_tr_b16 a[8:9], v149 offset:27872
    ds_read_b64_tr_b16 a[10:11], v149 offset:32480
    s_waitcnt lgkmcnt(10)
    v_mfma_f32_16x16x32_bf16 v[108:111], a[12:15], a[40:43], v[108:111]
    v_mul_f32 v77, v77, v69
    v_mul_f32 v78, v78, v70
    v_mfma_f32_16x16x32_bf16 v[112:115], a[12:15], a[44:47], v[112:115]
    v_mul_f32 v79, v79, v71
    v_mul_f32 v92, v92, v84
    ds_read_b64_tr_b16 a[12:13], v151 offset:27872
    ds_read_b64_tr_b16 a[14:15], v151 offset:32480
    s_waitcnt lgkmcnt(10)
    v_mfma_f32_16x16x32_bf16 v[116:119], a[16:19], a[40:43], v[116:119]
    v_mul_f32 v93, v93, v85
    v_mul_f32 v94, v94, v86
    v_mfma_f32_16x16x32_bf16 v[120:123], a[16:19], a[44:47], v[120:123]
    v_mul_f32 v95, v95, v87
    v_cvt_pk_bf16_f32 v68, v76, v77
    ds_read_b64_tr_b16 a[16:17], v148 offset:192
    ds_read_b64_tr_b16 a[18:19], v148 offset:4800
    s_waitcnt lgkmcnt(10)
    v_mfma_f32_16x16x32_bf16 v[124:127], a[20:23], a[40:43], v[124:127]
    v_cvt_pk_bf16_f32 v69, v78, v79
    v_cvt_pk_bf16_f32 v70, v92, v93
    v_mfma_f32_16x16x32_bf16 v[128:131], a[20:23], a[44:47], v[128:131]
    v_cvt_pk_bf16_f32 v71, v94, v95
    buffer_store_dwordx4 v[68:71], v1, s[20:23], s36 offen offset:2048
    ds_read_b64_tr_b16 a[20:21], v150 offset:192
    ds_read_b64_tr_b16 a[22:23], v150 offset:4800
    s_waitcnt lgkmcnt(10)
    v_mfma_f32_16x16x32_bf16 v[100:103], a[0:3], a[48:51], v[100:103]
    v_mul_f32 v72, v72, v153
    v_mul_f32 v73, v73, v153
    v_mul_f32 v74, v74, v153
    v_mfma_f32_16x16x32_bf16 v[104:107], a[0:3], a[52:55], v[104:107]
    v_mul_f32 v75, v75, v153
    v_mul_f32 v88, v88, v153
    ds_read_b64_tr_b16 a[0:1], v148 offset:224
    ds_read_b64_tr_b16 a[2:3], v148 offset:4832
    s_waitcnt lgkmcnt(10)
    v_mfma_f32_16x16x32_bf16 v[108:111], a[4:7], a[48:51], v[108:111]
    v_mul_f32 v89, v89, v153
    v_mul_f32 v90, v90, v153
    v_mfma_f32_16x16x32_bf16 v[112:115], a[4:7], a[52:55], v[112:115]
    v_mul_f32 v91, v91, v153
    v_exp_f32 v72, v72
    ds_read_b64_tr_b16 a[4:5], v150 offset:224
    ds_read_b64_tr_b16 a[6:7], v150 offset:4832
    s_waitcnt lgkmcnt(10)
    v_mfma_f32_16x16x32_bf16 v[116:119], a[8:11], a[48:51], v[116:119]
    v_exp_f32 v73, v73
    v_exp_f32 v74, v74
    v_mfma_f32_16x16x32_bf16 v[120:123], a[8:11], a[52:55], v[120:123]
    v_exp_f32 v75, v75
    v_exp_f32 v88, v88
    ds_read_b64_tr_b16 a[8:9], v148 offset:9408
    ds_read_b64_tr_b16 a[10:11], v148 offset:14016
    s_waitcnt lgkmcnt(10)
    v_mfma_f32_16x16x32_bf16 v[124:127], a[12:15], a[48:51], v[124:127]
    v_exp_f32 v89, v89
    v_exp_f32 v90, v90
    v_mfma_f32_16x16x32_bf16 v[128:131], a[12:15], a[52:55], v[128:131]
    v_exp_f32 v91, v91
    v_fma_f32 v72, v72, v155, v155
    ds_read_b64_tr_b16 a[12:13], v150 offset:9408
    ds_read_b64_tr_b16 a[14:15], v150 offset:14016
    s_waitcnt lgkmcnt(10)
    v_mfma_f32_16x16x32_bf16 v[100:103], a[16:19], v[164:167], v[100:103]
    v_fma_f32 v73, v73, v155, v155
    v_fma_f32 v74, v74, v155, v155
    v_mfma_f32_16x16x32_bf16 v[104:107], a[16:19], v[168:171], v[104:107]
    v_fma_f32 v75, v75, v155, v155
    v_fma_f32 v88, v88, v155, v155
    ds_read_b64_tr_b16 a[16:17], v148 offset:9440
    ds_read_b64_tr_b16 a[18:19], v148 offset:14048
    s_waitcnt lgkmcnt(10)
    v_mfma_f32_16x16x32_bf16 v[108:111], a[20:23], v[164:167], v[108:111]
    v_fma_f32 v89, v89, v155, v155
    v_fma_f32 v90, v90, v155, v155
    v_mfma_f32_16x16x32_bf16 v[112:115], a[20:23], v[168:171], v[112:115]
    v_fma_f32 v91, v91, v155, v155
    v_rcp_f32 v72, v72
    ds_read_b64_tr_b16 a[20:21], v150 offset:9440
    ds_read_b64_tr_b16 a[22:23], v150 offset:14048
    s_waitcnt lgkmcnt(10)
    v_mfma_f32_16x16x32_bf16 v[116:119], a[0:3], v[164:167], v[116:119]
    v_rcp_f32 v73, v73
    v_rcp_f32 v74, v74
    v_mfma_f32_16x16x32_bf16 v[120:123], a[0:3], v[168:171], v[120:123]
    v_rcp_f32 v75, v75
    v_rcp_f32 v88, v88
    ds_read_b64_tr_b16 a[0:1], v149 offset:256
    ds_read_b64_tr_b16 a[2:3], v149 offset:4864
    s_waitcnt lgkmcnt(10)
    v_mfma_f32_16x16x32_bf16 v[124:127], a[4:7], v[164:167], v[124:127]
    v_rcp_f32 v89, v89
    v_rcp_f32 v90, v90
    v_mfma_f32_16x16x32_bf16 v[128:131], a[4:7], v[168:171], v[128:131]
    v_rcp_f32 v91, v91
    v_mul_f32 v80, v80, v72
    ds_read_b64_tr_b16 a[4:5], v151 offset:256
    ds_read_b64_tr_b16 a[6:7], v151 offset:4864
    s_waitcnt lgkmcnt(10)
    v_mfma_f32_16x16x32_bf16 v[100:103], a[8:11], v[172:175], v[100:103]
    v_mul_f32 v81, v81, v73
    v_mul_f32 v82, v82, v74
    v_mfma_f32_16x16x32_bf16 v[104:107], a[8:11], v[176:179], v[104:107]
    v_mul_f32 v83, v83, v75
    v_mul_f32 v96, v96, v88
    ds_read_b64_tr_b16 a[8:9], v149 offset:9472
    ds_read_b64_tr_b16 a[10:11], v149 offset:14080
    s_waitcnt lgkmcnt(10)
    v_mfma_f32_16x16x32_bf16 v[108:111], a[12:15], v[172:175], v[108:111]
    v_mul_f32 v97, v97, v89
    v_mul_f32 v98, v98, v90
    v_mfma_f32_16x16x32_bf16 v[112:115], a[12:15], v[176:179], v[112:115]
    v_mul_f32 v99, v99, v91
    v_cvt_pk_bf16_f32 v72, v80, v81
    ds_read_b64_tr_b16 a[12:13], v151 offset:9472
    ds_read_b64_tr_b16 a[14:15], v151 offset:14080
    s_waitcnt lgkmcnt(10)
    v_mfma_f32_16x16x32_bf16 v[116:119], a[16:19], v[172:175], v[116:119]
    v_cvt_pk_bf16_f32 v73, v82, v83
    v_cvt_pk_bf16_f32 v74, v96, v97
    v_mfma_f32_16x16x32_bf16 v[120:123], a[16:19], v[176:179], v[120:123]
    v_cvt_pk_bf16_f32 v75, v98, v99
    buffer_store_dwordx4 v[72:75], v2, s[20:23], s36 offen offset:2048
    ds_read_b64_tr_b16 a[16:17], v149 offset:18688
    ds_read_b64_tr_b16 a[18:19], v149 offset:23296
    s_waitcnt lgkmcnt(10)
    v_mfma_f32_16x16x32_bf16 v[124:127], a[20:23], v[172:175], v[124:127]
    v_mfma_f32_16x16x32_bf16 v[128:131], a[20:23], v[176:179], v[128:131]
    ds_read_b64_tr_b16 a[20:21], v151 offset:18688
    ds_read_b64_tr_b16 a[22:23], v151 offset:23296
    s_waitcnt lgkmcnt(10)
    v_mfma_f32_16x16x32_bf16 v[132:135], a[0:3], a[24:27], v[132:135]
    v_mfma_f32_16x16x32_bf16 v[136:139], a[0:3], a[28:31], v[136:139]
    ds_read_b64_tr_b16 a[0:1], v149 offset:27904
    ds_read_b64_tr_b16 a[2:3], v149 offset:32512
    s_waitcnt lgkmcnt(10)
    v_mfma_f32_16x16x32_bf16 v[140:143], a[4:7], a[24:27], v[140:143]
    v_mul_f32 v100, v100, v152
    v_mul_f32 v101, v101, v152
    v_mul_f32 v102, v102, v152
    v_mul_f32 v103, v103, v152
    v_mul_f32 v116, v116, v152
    v_mfma_f32_16x16x32_bf16 v[144:147], a[4:7], a[28:31], v[144:147]
    v_mul_f32 v117, v117, v152
    v_mul_f32 v118, v118, v152
    v_mul_f32 v119, v119, v152
    v_exp_f32 v100, v100
    ds_read_b64_tr_b16 a[4:5], v151 offset:27904
    ds_read_b64_tr_b16 a[6:7], v151 offset:32512
    s_waitcnt lgkmcnt(10)
    v_mfma_f32_16x16x32_bf16 v[132:135], a[8:11], a[32:35], v[132:135]
    v_exp_f32 v101, v101
    v_exp_f32 v102, v102
    v_exp_f32 v103, v103
    v_exp_f32 v116, v116
    v_exp_f32 v117, v117
    v_mfma_f32_16x16x32_bf16 v[136:139], a[8:11], a[36:39], v[136:139]
    v_exp_f32 v118, v118
    v_exp_f32 v119, v119
    v_fma_f32 v100, v100, v154, v154
    v_fma_f32 v101, v101, v154, v154
    ds_read_b64_tr_b16 a[8:9], v148 offset:256
    ds_read_b64_tr_b16 a[10:11], v148 offset:4864
    s_waitcnt lgkmcnt(10)
    v_mfma_f32_16x16x32_bf16 v[140:143], a[12:15], a[32:35], v[140:143]
    v_fma_f32 v102, v102, v154, v154
    v_fma_f32 v103, v103, v154, v154
    v_fma_f32 v116, v116, v154, v154
    v_fma_f32 v117, v117, v154, v154
    v_fma_f32 v118, v118, v154, v154
    v_mfma_f32_16x16x32_bf16 v[144:147], a[12:15], a[36:39], v[144:147]
    v_fma_f32 v119, v119, v154, v154
    v_rcp_f32 v100, v100
    v_rcp_f32 v101, v101
    v_rcp_f32 v102, v102
    ds_read_b64_tr_b16 a[12:13], v150 offset:256
    ds_read_b64_tr_b16 a[14:15], v150 offset:4864
    s_waitcnt lgkmcnt(10)
    v_mfma_f32_16x16x32_bf16 v[132:135], a[16:19], a[40:43], v[132:135]
    v_rcp_f32 v103, v103
    v_rcp_f32 v116, v116
    v_rcp_f32 v117, v117
    v_rcp_f32 v118, v118
    v_rcp_f32 v119, v119
    v_mfma_f32_16x16x32_bf16 v[136:139], a[16:19], a[44:47], v[136:139]
    v_mul_f32 v108, v108, v100
    v_mul_f32 v109, v109, v101
    v_mul_f32 v110, v110, v102
    v_mul_f32 v111, v111, v103
    ds_read_b64_tr_b16 a[16:17], v148 offset:9472
    ds_read_b64_tr_b16 a[18:19], v148 offset:14080
    s_waitcnt lgkmcnt(10)
    v_mfma_f32_16x16x32_bf16 v[140:143], a[20:23], a[40:43], v[140:143]
    v_mul_f32 v124, v124, v116
    v_mul_f32 v125, v125, v117
    v_mul_f32 v126, v126, v118
    v_mul_f32 v127, v127, v119
    v_cvt_pk_bf16_f32 v100, v108, v109
    v_mfma_f32_16x16x32_bf16 v[144:147], a[20:23], a[44:47], v[144:147]
    v_cvt_pk_bf16_f32 v101, v110, v111
    v_cvt_pk_bf16_f32 v102, v124, v125
    v_cvt_pk_bf16_f32 v103, v126, v127
    buffer_store_dwordx4 v[100:103], v1, s[20:23], s36 offen offset:3072
    ds_read_b64_tr_b16 a[20:21], v150 offset:9472
    ds_read_b64_tr_b16 a[22:23], v150 offset:14080
    s_waitcnt lgkmcnt(10)
    v_mfma_f32_16x16x32_bf16 v[132:135], a[0:3], a[48:51], v[132:135]
    v_mul_f32 v104, v104, v153
    v_mul_f32 v105, v105, v153
    v_mul_f32 v106, v106, v153
    v_mul_f32 v107, v107, v153
    v_mul_f32 v120, v120, v153
    v_mfma_f32_16x16x32_bf16 v[136:139], a[0:3], a[52:55], v[136:139]
    v_mul_f32 v121, v121, v153
    v_mul_f32 v122, v122, v153
    v_mul_f32 v123, v123, v153
    v_exp_f32 v104, v104
    s_waitcnt lgkmcnt(8)
    v_mfma_f32_16x16x32_bf16 v[140:143], a[4:7], a[48:51], v[140:143]
    v_exp_f32 v105, v105
    v_exp_f32 v106, v106
    v_exp_f32 v107, v107
    v_exp_f32 v120, v120
    v_exp_f32 v121, v121
    v_mfma_f32_16x16x32_bf16 v[144:147], a[4:7], a[52:55], v[144:147]
    v_exp_f32 v122, v122
    v_exp_f32 v123, v123
    v_fma_f32 v104, v104, v155, v155
    v_fma_f32 v105, v105, v155, v155
    s_waitcnt lgkmcnt(6)
    v_mfma_f32_16x16x32_bf16 v[132:135], a[8:11], v[164:167], v[132:135]
    v_fma_f32 v106, v106, v155, v155
    v_fma_f32 v107, v107, v155, v155
    v_fma_f32 v120, v120, v155, v155
    v_fma_f32 v121, v121, v155, v155
    v_fma_f32 v122, v122, v155, v155
    v_mfma_f32_16x16x32_bf16 v[136:139], a[8:11], v[168:171], v[136:139]
    v_fma_f32 v123, v123, v155, v155
    v_rcp_f32 v104, v104
    v_rcp_f32 v105, v105
    v_rcp_f32 v106, v106
    s_waitcnt lgkmcnt(4)
    v_mfma_f32_16x16x32_bf16 v[140:143], a[12:15], v[164:167], v[140:143]
    v_rcp_f32 v107, v107
    v_rcp_f32 v120, v120
    v_rcp_f32 v121, v121
    v_rcp_f32 v122, v122
    v_rcp_f32 v123, v123
    v_mfma_f32_16x16x32_bf16 v[144:147], a[12:15], v[168:171], v[144:147]
    v_mul_f32 v112, v112, v104
    v_mul_f32 v113, v113, v105
    v_mul_f32 v114, v114, v106
    v_mul_f32 v115, v115, v107
    s_waitcnt lgkmcnt(2)
    v_mfma_f32_16x16x32_bf16 v[132:135], a[16:19], v[172:175], v[132:135]
    v_mul_f32 v128, v128, v120
    v_mul_f32 v129, v129, v121
    v_mul_f32 v130, v130, v122
    v_mul_f32 v131, v131, v123
    v_cvt_pk_bf16_f32 v104, v112, v113
    v_mfma_f32_16x16x32_bf16 v[136:139], a[16:19], v[176:179], v[136:139]
    v_cvt_pk_bf16_f32 v105, v114, v115
    v_cvt_pk_bf16_f32 v106, v128, v129
    v_cvt_pk_bf16_f32 v107, v130, v131
    buffer_store_dwordx4 v[104:107], v2, s[20:23], s36 offen offset:3072
    s_waitcnt lgkmcnt(0)
    v_mfma_f32_16x16x32_bf16 v[140:143], a[20:23], v[172:175], v[140:143]
    v_mfma_f32_16x16x32_bf16 v[144:147], a[20:23], v[176:179], v[144:147]
    v_mul_f32 v132, v132, v152
    v_mul_f32 v136, v136, v153
    v_mul_f32 v133, v133, v152
    v_mul_f32 v137, v137, v153
    v_mul_f32 v134, v134, v152
    v_mul_f32 v138, v138, v153
    v_mul_f32 v135, v135, v152
    v_mul_f32 v139, v139, v153
    v_exp_f32 v132, v132
    v_exp_f32 v136, v136
    v_exp_f32 v133, v133
    v_exp_f32 v137, v137
    v_exp_f32 v134, v134
    v_exp_f32 v138, v138
    v_exp_f32 v135, v135
    v_exp_f32 v139, v139
    v_fma_f32 v132, v132, v154, v154
    v_fma_f32 v136, v136, v155, v155
    v_fma_f32 v133, v133, v154, v154
    v_fma_f32 v137, v137, v155, v155
    v_fma_f32 v134, v134, v154, v154
    v_fma_f32 v138, v138, v155, v155
    v_fma_f32 v135, v135, v154, v154
    v_fma_f32 v139, v139, v155, v155
    v_rcp_f32 v132, v132
    v_rcp_f32 v136, v136
    v_rcp_f32 v133, v133
    v_rcp_f32 v137, v137
    v_rcp_f32 v134, v134
    v_rcp_f32 v138, v138
    v_rcp_f32 v135, v135
    v_rcp_f32 v139, v139
    v_mul_f32 v140, v140, v132
    v_mul_f32 v144, v144, v136
    v_mul_f32 v141, v141, v133
    v_mul_f32 v145, v145, v137
    v_mul_f32 v142, v142, v134
    v_mul_f32 v146, v146, v138
    v_mul_f32 v143, v143, v135
    v_mul_f32 v147, v147, v139
    v_cvt_pk_bf16_f32 v132, v140, v141
    v_cvt_pk_bf16_f32 v136, v144, v145
    v_cvt_pk_bf16_f32 v133, v142, v143
    v_cvt_pk_bf16_f32 v137, v146, v147
    buffer_store_dwordx2 v[132:133], v1, s[20:23], s37 offen
    buffer_store_dwordx2 v[136:137], v2, s[20:23], s37 offen
L_k4_kernel_end:
    s_endpgm
.globl k5_kernel
.p2align 8
.type k5_kernel,@function
k5_kernel:
    s_cmp_ge_u32 s2, 256
    s_cbranch_scc1 L_k5_kernel_end
    s_load_dwordx4 s[4:7], s[0:1], 48
    s_load_dwordx2 s[8:9], s[0:1], 72
    v_lshrrev_b32 v100, 6, v0
    v_and_b32 v0, 63, v0
    v_readfirstlane_b32 s24, v100
    v_lshlrev_b32 v1, 4, v0
    v_lshlrev_b32 v2, 3, v0
    s_and_b32 s27, s2, 3
    s_bfe_u32 s28, s2, 0x10002
    s_lshl_b32 s25, s28, 3
    s_bfe_u32 s28, s2, 0x30003
    s_add_u32 s25, s25, s28
    s_lshr_b32 s26, s2, 6
    s_mul_i32 s28, s24, 112
    v_add_u32 v100, s28, v0
    s_lshl_b32 s28, s24, 5
    v_add_u32 v103, s28, v0
    s_lshl_b32 s31, s24, 9
    s_add_u32 s31, s31, 86016
    s_mul_i32 s30, s24, 1792
    s_mul_i32 s34, s27, 1327104
    s_mul_i32 s29, s26, 288
    s_add_u32 s34, s34, s29
    s_mul_i32 s32, s27, 36864
    s_lshl_b32 s28, s25, 2
    s_add_u32 s28, s28, s24
    s_mul_i32 s28, s28, 294912
    s_add_u32 s32, s32, s28
    s_add_u32 s32, s32, 12582912
    s_add_u32 s33, s32, 147456
    v_add_u32 v101, 0, v100
    v_mul_u32_u24 v102, 4682, v101
    v_lshrrev_b32 v102, 16, v102
    v_mul_u32_u24 v104, 14, v102
    v_sub_u32 v101, v101, v104
    v_lshrrev_b32 v104, 2, v101
    v_add_u32 v104, 1, v104
    v_xor_b32 v105, s27, v104
    v_cmp_gt_u32 vcc, 12, v101
    v_and_b32 v101, 3, v101
    s_nop 0
    v_cndmask_b32 v104, v104, v105, vcc
    v_lshlrev_b32 v104, 6, v104
    v_lshl_add_u32 v104, v101, 4, v104
    v_mul_u32_u24 v105, 1152, v102
    v_add_u32 v9, v104, v105
    v_lshrrev_b32 v104, 4, v102
    v_mul_u32_u24 v104, 147456, v104
    v_add_u32 v12, v9, v104
    v_add_u32 v101, 64, v100
    v_mul_u32_u24 v102, 4682, v101
    v_lshrrev_b32 v102, 16, v102
    v_mul_u32_u24 v104, 14, v102
    v_sub_u32 v101, v101, v104
    v_lshrrev_b32 v104, 2, v101
    v_add_u32 v104, 1, v104
    v_xor_b32 v105, s27, v104
    v_cmp_gt_u32 vcc, 12, v101
    v_and_b32 v101, 3, v101
    s_nop 0
    v_cndmask_b32 v104, v104, v105, vcc
    v_lshlrev_b32 v104, 6, v104
    v_lshl_add_u32 v104, v101, 4, v104
    v_mul_u32_u24 v105, 1152, v102
    v_add_u32 v10, v104, v105
    v_lshrrev_b32 v104, 4, v102
    v_mul_u32_u24 v104, 147456, v104
    v_add_u32 v13, v10, v104
    v_lshrrev_b32 v102, 2, v103
    v_bfe_u32 v104, v103, 1, 1
    v_bfe_u32 v105, v103, 4, 1
    v_xor_b32 v104, v104, v105
    v_lshlrev_b32 v104, 5, v104
    v_and_b32 v105, 1, v103
    v_lshl_add_u32 v104, v105, 4, v104
    s_lshl_b32 s28, s27, 6
    v_add_u32 v104, s28, v104
    v_mul_u32_u24 v105, 1152, v102
    v_add_u32 v11, v104, v105
    v_lshrrev_b32 v104, 4, v102
    v_mul_u32_u24 v104, 147456, v104
    v_add_u32 v14, v11, v104
    s_waitcnt lgkmcnt(0)
    s_mov_b32 s12, s4
    s_mov_b32 s13, s5
    s_mov_b32 s14, 5308416
    s_mov_b32 s15, 0x00020000
    s_mov_b32 s16, s8
    s_mov_b32 s17, s9
    s_mov_b32 s18, 75497472
    s_mov_b32 s19, 0x00020000
    s_mov_b32 s20, s6
    s_mov_b32 s21, s7
    s_mov_b32 s22, 2359296
    s_mov_b32 s23, 0x00020000
    s_mov_b32 s40, 0
    s_add_u32 m0, s30, 0
    s_add_u32 s37, s40, 0
    s_and_b32 s37, s37, 3
    s_mul_i32 s37, s37, 331776
    s_add_u32 s37, s37, s34
    s_add_u32 s35, s37, 0
    buffer_load_dwordx4 v9, s[12:15], s35 offen lds
    s_add_u32 m0, s30, 1024
    s_bfm_b64 exec, 48, 0
    buffer_load_dwordx4 v10, s[12:15], s35 offen lds
    s_mov_b64 exec, -1
    s_add_u32 m0, s31, 0
    s_mov_b64 exec, 0xffffffff
    buffer_load_dwordx4 v11, s[12:15], s35 offen lds
    s_mov_b64 exec, -1
    s_add_u32 m0, s30, 7168
    s_add_u32 s35, s37, 36864
    buffer_load_dwordx4 v9, s[12:15], s35 offen lds
    s_add_u32 m0, s30, 8192
    s_bfm_b64 exec, 48, 0
    buffer_load_dwordx4 v10, s[12:15], s35 offen lds
    s_mov_b64 exec, -1
    s_add_u32 m0, s31, 2048
    s_mov_b64 exec, 0xffffffff
    buffer_load_dwordx4 v11, s[12:15], s35 offen lds
    s_mov_b64 exec, -1
    s_add_u32 s38, s40, 0
    s_and_b32 s38, s38, 3
    s_mul_i32 s38, s38, 9216
    s_add_u32 s38, s38, s32
    buffer_load_dwordx4 a[32:35], v1, s[16:19], s38 offen offset:0
    s_add_u32 s39, s40, 0
    s_and_b32 s39, s39, 3
    s_mul_i32 s39, s39, 9216
    s_add_u32 s39, s39, s33
    buffer_load_dwordx4 a[36:39], v1, s[16:19], s39 offen offset:0
    s_add_u32 m0, s30, 14336
    s_add_u32 s35, s37, 73728
    buffer_load_dwordx4 v9, s[12:15], s35 offen lds
    s_add_u32 m0, s30, 15360
    s_bfm_b64 exec, 48, 0
    buffer_load_dwordx4 v10, s[12:15], s35 offen lds
    s_mov_b64 exec, -1
    s_add_u32 m0, s31, 4096
    s_mov_b64 exec, 0xffffffff
    buffer_load_dwordx4 v11, s[12:15], s35 offen lds
    s_mov_b64 exec, -1
    s_add_u32 m0, s30, 21504
    s_add_u32 s35, s37, 110592
    buffer_load_dwordx4 v9, s[12:15], s35 offen lds
    s_add_u32 m0, s30, 22528
    s_bfm_b64 exec, 48, 0
    buffer_load_dwordx4 v10, s[12:15], s35 offen lds
    s_mov_b64 exec, -1
    s_add_u32 m0, s31, 6144
    s_mov_b64 exec, 0xffffffff
    buffer_load_dwordx4 v11, s[12:15], s35 offen lds
    s_mov_b64 exec, -1
    buffer_load_dwordx4 a[40:43], v1, s[16:19], s38 offen offset:1024
    v_lshrrev_b32 v104, 2, v0
    v_mul_u32_u24 v3, 224, v104
    v_and_b32 v105, 3, v0
    v_lshl_add_u32 v3, v105, 3, v3
    v_add_u32 v4, 43008, v3
    v_lshlrev_b32 v106, 6, v104
    v_lshl_add_u32 v106, v105, 3, v106
    v_add_u32 v106, 86016, v106
    v_bfe_u32 v105, v0, 4, 1
    v_lshl_add_u32 v5, v105, 5, v106
    v_xor_b32 v105, 1, v105
    v_lshl_add_u32 v7, v105, 5, v106
    v_add_u32 v6, 36864, v5
    v_add_u32 v8, 36864, v7
    s_lshl_b32 s36, s25, 2
    s_add_u32 s36, s36, s26
    s_lshl_b32 s43, s36, 7
    s_add_u32 s43, s43, 43548672
    s_lshl_b32 s41, s36, 17
    s_lshl_b32 s28, s24, 11
    s_add_u32 s41, s41, s28
    s_add_u32 s41, s41, 33816576
    s_lshl_b32 s42, s36, 14
    s_lshl_b32 s28, s24, 12
    s_add_u32 s42, s42, s28
    s_add_u32 s42, s42, 42205184
    s_lshl_b32 s28, s25, 3
    s_lshl_b32 s29, s24, 1
    s_add_u32 s28, s28, s29
    s_mul_i32 s44, s28, 18432
    s_add_u32 s44, s44, 10223616
    s_mul_i32 s45, s28, 18432
    s_mul_i32 s29, s26, 288
    s_add_u32 s45, s45, s29
    s_waitcnt vmcnt(9)
    s_barrier
    ds_read_b64_tr_b16 a[0:1], v3 offset:0
    ds_read_b64_tr_b16 a[2:3], v3 offset:3584
    ds_read_b64_tr_b16 a[4:5], v3 offset:32
    ds_read_b64_tr_b16 a[6:7], v3 offset:3616
    ds_read_b64_tr_b16 a[8:9], v3 offset:64
    ds_read_b64_tr_b16 a[10:11], v3 offset:3648
    ds_read_b64_tr_b16 a[12:13], v3 offset:96
    ds_read_b64_tr_b16 a[14:15], v3 offset:3680
    ds_read_b64_tr_b16 a[16:17], v3 offset:128
    ds_read_b64_tr_b16 a[18:19], v3 offset:3712
    ds_read_b64_tr_b16 a[20:21], v3 offset:160
    ds_read_b64_tr_b16 a[22:23], v3 offset:3744
    ds_read_b64_tr_b16 a[24:25], v3 offset:192
    ds_read_b64_tr_b16 a[26:27], v3 offset:3776
    ds_read_b64_tr_b16 a[28:29], v3 offset:7168
    ds_read_b64_tr_b16 a[30:31], v3 offset:10752
    s_waitcnt vmcnt(8) lgkmcnt(14)
    v_mfma_f32_16x16x32_bf16 v[32:35], a[0:3], a[32:35], 0
    s_waitcnt vmcnt(7)
    v_mfma_f32_16x16x32_bf16 v[36:39], a[0:3], a[36:39], 0
    buffer_load_dwordx4 a[44:47], v1, s[16:19], s39 offen offset:1024
    ds_read_b64_tr_b16 a[0:1], v3 offset:7200
    ds_read_b64_tr_b16 a[2:3], v3 offset:10784
    s_waitcnt lgkmcnt(14)
    v_mfma_f32_16x16x32_bf16 v[40:43], a[4:7], a[32:35], 0
    v_mfma_f32_16x16x32_bf16 v[44:47], a[4:7], a[36:39], 0
    buffer_load_dwordx4 a[48:51], v1, s[16:19], s38 offen offset:2048
    ds_read_b64_tr_b16 a[4:5], v3 offset:7232
    ds_read_b64_tr_b16 a[6:7], v3 offset:10816
    s_waitcnt lgkmcnt(14)
    v_mfma_f32_16x16x32_bf16 v[48:51], a[8:11], a[32:35], 0
    v_mfma_f32_16x16x32_bf16 v[52:55], a[8:11], a[36:39], 0
    buffer_load_dwordx4 a[52:55], v1, s[16:19], s39 offen offset:2048
    ds_read_b64_tr_b16 a[8:9], v3 offset:7264
    ds_read_b64_tr_b16 a[10:11], v3 offset:10848
    s_waitcnt lgkmcnt(14)
    v_mfma_f32_16x16x32_bf16 v[56:59], a[12:15], a[32:35], 0
    v_mfma_f32_16x16x32_bf16 v[60:63], a[12:15], a[36:39], 0
    s_add_u32 m0, s30, 28672
    s_add_u32 s35, s37, 165888
    buffer_load_dwordx4 v9, s[12:15], s35 offen lds
    ds_read_b64_tr_b16 a[12:13], v3 offset:7296
    ds_read_b64_tr_b16 a[14:15], v3 offset:10880
    s_waitcnt lgkmcnt(14)
    v_mfma_f32_16x16x32_bf16 v[64:67], a[16:19], a[32:35], 0
    v_mfma_f32_16x16x32_bf16 v[68:71], a[16:19], a[36:39], 0
    s_add_u32 m0, s30, 29696
    s_bfm_b64 exec, 48, 0
    buffer_load_dwordx4 v10, s[12:15], s35 offen lds
    s_mov_b64 exec, -1
    ds_read_b64_tr_b16 a[16:17], v3 offset:7328
    ds_read_b64_tr_b16 a[18:19], v3 offset:10912
    s_waitcnt lgkmcnt(14)
    v_mfma_f32_16x16x32_bf16 v[72:75], a[20:23], a[32:35], 0
    v_mfma_f32_16x16x32_bf16 v[76:79], a[20:23], a[36:39], 0
    s_add_u32 m0, s31, 8192
    s_mov_b64 exec, 0xffffffff
    buffer_load_dwordx4 v11, s[12:15], s35 offen lds
    s_mov_b64 exec, -1
    ds_read_b64_tr_b16 a[20:21], v3 offset:7360
    ds_read_b64_tr_b16 a[22:23], v3 offset:10944
    s_waitcnt lgkmcnt(14)
    v_mfma_f32_16x16x32_bf16 v[80:83], a[24:27], a[32:35], 0
    v_mfma_f32_16x16x32_bf16 v[84:87], a[24:27], a[36:39], 0
    s_add_u32 m0, s30, 35840
    s_add_u32 s35, s37, 202752
    buffer_load_dwordx4 v9, s[12:15], s35 offen lds
    s_waitcnt vmcnt(8)
    s_barrier
    ds_read_b64_tr_b16 a[24:25], v3 offset:14336
    ds_read_b64_tr_b16 a[26:27], v3 offset:17920
    s_waitcnt vmcnt(7) lgkmcnt(14)
    v_mfma_f32_16x16x32_bf16 v[32:35], a[28:31], a[40:43], v[32:35]
    s_waitcnt vmcnt(6)
    v_mfma_f32_16x16x32_bf16 v[36:39], a[28:31], a[44:47], v[36:39]
    s_add_u32 m0, s30, 36864
    s_bfm_b64 exec, 48, 0
    buffer_load_dwordx4 v10, s[12:15], s35 offen lds
    s_mov_b64 exec, -1
    ds_read_b64_tr_b16 a[28:29], v3 offset:14368
    ds_read_b64_tr_b16 a[30:31], v3 offset:17952
    s_waitcnt lgkmcnt(14)
    v_mfma_f32_16x16x32_bf16 v[40:43], a[0:3], a[40:43], v[40:43]
    v_mfma_f32_16x16x32_bf16 v[44:47], a[0:3], a[44:47], v[44:47]
    s_add_u32 m0, s31, 10240
    s_mov_b64 exec, 0xffffffff
    buffer_load_dwordx4 v11, s[12:15], s35 offen lds
    s_mov_b64 exec, -1
    ds_read_b64_tr_b16 a[0:1], v3 offset:14400
    ds_read_b64_tr_b16 a[2:3], v3 offset:17984
    s_waitcnt lgkmcnt(14)
    v_mfma_f32_16x16x32_bf16 v[48:51], a[4:7], a[40:43], v[48:51]
    v_mfma_f32_16x16x32_bf16 v[52:55], a[4:7], a[44:47], v[52:55]
    buffer_load_dwordx4 a[56:59], v1, s[16:19], s38 offen offset:3072
    ds_read_b64_tr_b16 a[4:5], v3 offset:14432
    ds_read_b64_tr_b16 a[6:7], v3 offset:18016
    s_waitcnt lgkmcnt(14)
    v_mfma_f32_16x16x32_bf16 v[56:59], a[8:11], a[40:43], v[56:59]
    v_mfma_f32_16x16x32_bf16 v[60:63], a[8:11], a[44:47], v[60:63]
    buffer_load_dwordx4 a[60:63], v1, s[16:19], s39 offen offset:3072
    ds_read_b64_tr_b16 a[8:9], v3 offset:14464
    ds_read_b64_tr_b16 a[10:11], v3 offset:18048
    s_waitcnt lgkmcnt(14)
    v_mfma_f32_16x16x32_bf16 v[64:67], a[12:15], a[40:43], v[64:67]
    v_mfma_f32_16x16x32_bf16 v[68:71], a[12:15], a[44:47], v[68:71]
    s_add_u32 s38, s38, 4096
    buffer_load_dwordx4 a[64:67], v1, s[16:19], s38 offen offset:0
    ds_read_b64_tr_b16 a[12:13], v3 offset:14496
    ds_read_b64_tr_b16 a[14:15], v3 offset:18080
    s_waitcnt lgkmcnt(14)
    v_mfma_f32_16x16x32_bf16 v[72:75], a[16:19], a[40:43], v[72:75]
    v_mfma_f32_16x16x32_bf16 v[76:79], a[16:19], a[44:47], v[76:79]
    s_add_u32 s39, s39, 4096
    buffer_load_dwordx4 a[68:71], v1, s[16:19], s39 offen offset:0
    ds_read_b64_tr_b16 a[16:17], v3 offset:14528
    ds_read_b64_tr_b16 a[18:19], v3 offset:18112
    s_waitcnt lgkmcnt(14)
    v_mfma_f32_16x16x32_bf16 v[80:83], a[20:23], a[40:43], v[80:83]
    v_mfma_f32_16x16x32_bf16 v[84:87], a[20:23], a[44:47], v[84:87]
    s_add_u32 m0, s30, 43008
    s_add_u32 s35, s37, 239616
    buffer_load_dwordx4 v9, s[12:15], s35 offen lds
    ds_read_b64_tr_b16 a[20:21], v3 offset:21504
    ds_read_b64_tr_b16 a[22:23], v3 offset:25088
    s_waitcnt vmcnt(12) lgkmcnt(14)
    v_mfma_f32_16x16x32_bf16 v[32:35], a[24:27], a[48:51], v[32:35]
    s_waitcnt vmcnt(11)
    v_mfma_f32_16x16x32_bf16 v[36:39], a[24:27], a[52:55], v[36:39]
    s_add_u32 m0, s30, 44032
    s_bfm_b64 exec, 48, 0
    buffer_load_dwordx4 v10, s[12:15], s35 offen lds
    s_mov_b64 exec, -1
    ds_read_b64_tr_b16 a[24:25], v3 offset:21536
    ds_read_b64_tr_b16 a[26:27], v3 offset:25120
    s_waitcnt lgkmcnt(14)
    v_mfma_f32_16x16x32_bf16 v[40:43], a[28:31], a[48:51], v[40:43]
    v_mfma_f32_16x16x32_bf16 v[44:47], a[28:31], a[52:55], v[44:47]
    s_add_u32 m0, s31, 12288
    s_mov_b64 exec, 0xffffffff
    buffer_load_dwordx4 v11, s[12:15], s35 offen lds
    s_mov_b64 exec, -1
    ds_read_b64_tr_b16 a[28:29], v3 offset:21568
    ds_read_b64_tr_b16 a[30:31], v3 offset:25152
    s_waitcnt lgkmcnt(14)
    v_mfma_f32_16x16x32_bf16 v[48:51], a[0:3], a[48:51], v[48:51]
    v_mfma_f32_16x16x32_bf16 v[52:55], a[0:3], a[52:55], v[52:55]
    buffer_load_dwordx4 a[72:75], v1, s[16:19], s38 offen offset:1024
    ds_read_b64_tr_b16 a[0:1], v3 offset:21600
    ds_read_b64_tr_b16 a[2:3], v3 offset:25184
    s_waitcnt lgkmcnt(14)
    v_mfma_f32_16x16x32_bf16 v[56:59], a[4:7], a[48:51], v[56:59]
    v_mfma_f32_16x16x32_bf16 v[60:63], a[4:7], a[52:55], v[60:63]
    buffer_load_dwordx4 a[76:79], v1, s[16:19], s39 offen offset:1024
    ds_read_b64_tr_b16 a[4:5], v3 offset:21632
    ds_read_b64_tr_b16 a[6:7], v3 offset:25216
    s_waitcnt lgkmcnt(14)
    v_mfma_f32_16x16x32_bf16 v[64:67], a[8:11], a[48:51], v[64:67]
    v_mfma_f32_16x16x32_bf16 v[68:71], a[8:11], a[52:55], v[68:71]
    buffer_load_dwordx4 a[80:83], v1, s[16:19], s38 offen offset:2048
    ds_read_b64_tr_b16 a[8:9], v3 offset:21664
    ds_read_b64_tr_b16 a[10:11], v3 offset:25248
    s_waitcnt lgkmcnt(14)
    v_mfma_f32_16x16x32_bf16 v[72:75], a[12:15], a[48:51], v[72:75]
    v_mfma_f32_16x16x32_bf16 v[76:79], a[12:15], a[52:55], v[76:79]
    buffer_load_dwordx4 a[84:87], v1, s[16:19], s39 offen offset:2048
    ds_read_b64_tr_b16 a[12:13], v3 offset:21696
    ds_read_b64_tr_b16 a[14:15], v3 offset:25280
    s_waitcnt lgkmcnt(14)
    v_mfma_f32_16x16x32_bf16 v[80:83], a[16:19], a[48:51], v[80:83]
    v_mfma_f32_16x16x32_bf16 v[84:87], a[16:19], a[52:55], v[84:87]
    s_add_u32 m0, s30, 50176
    s_add_u32 s35, s37, 276480
    buffer_load_dwordx4 v9, s[12:15], s35 offen lds
    s_waitcnt vmcnt(12)
    s_barrier
    ds_read_b64_tr_b16 a[16:17], v3 offset:28672
    ds_read_b64_tr_b16 a[18:19], v3 offset:32256
    s_waitcnt vmcnt(11) lgkmcnt(14)
    v_mfma_f32_16x16x32_bf16 v[32:35], a[20:23], a[56:59], v[32:35]
    s_waitcnt vmcnt(10)
    v_mfma_f32_16x16x32_bf16 v[36:39], a[20:23], a[60:63], v[36:39]
    s_add_u32 m0, s30, 51200
    s_bfm_b64 exec, 48, 0
    buffer_load_dwordx4 v10, s[12:15], s35 offen lds
    s_mov_b64 exec, -1
    ds_read_b64_tr_b16 a[20:21], v3 offset:28704
    ds_read_b64_tr_b16 a[22:23], v3 offset:32288
    s_waitcnt lgkmcnt(14)
    v_mfma_f32_16x16x32_bf16 v[40:43], a[24:27], a[56:59], v[40:43]
    v_mfma_f32_16x16x32_bf16 v[44:47], a[24:27], a[60:63], v[44:47]
    s_add_u32 m0, s31, 14336
    s_mov_b64 exec, 0xffffffff
    buffer_load_dwordx4 v11, s[12:15], s35 offen lds
    s_mov_b64 exec, -1
    ds_read_b64_tr_b16 a[24:25], v3 offset:28736
    ds_read_b64_tr_b16 a[26:27], v3 offset:32320
    s_waitcnt lgkmcnt(14)
    v_mfma_f32_16x16x32_bf16 v[48:51], a[28:31], a[56:59], v[48:51]
    v_mfma_f32_16x16x32_bf16 v[52:55], a[28:31], a[60:63], v[52:55]
    buffer_load_dwordx4 a[88:91], v1, s[16:19], s38 offen offset:3072
    ds_read_b64_tr_b16 a[28:29], v3 offset:28768
    ds_read_b64_tr_b16 a[30:31], v3 offset:32352
    s_waitcnt lgkmcnt(14)
    v_mfma_f32_16x16x32_bf16 v[56:59], a[0:3], a[56:59], v[56:59]
    v_mfma_f32_16x16x32_bf16 v[60:63], a[0:3], a[60:63], v[60:63]
    buffer_load_dwordx4 a[92:95], v1, s[16:19], s39 offen offset:3072
    ds_read_b64_tr_b16 a[0:1], v3 offset:28800
    ds_read_b64_tr_b16 a[2:3], v3 offset:32384
    s_waitcnt lgkmcnt(14)
    v_mfma_f32_16x16x32_bf16 v[64:67], a[4:7], a[56:59], v[64:67]
    v_mfma_f32_16x16x32_bf16 v[68:71], a[4:7], a[60:63], v[68:71]
    ds_read_b64_tr_b16 a[4:5], v3 offset:28832
    ds_read_b64_tr_b16 a[6:7], v3 offset:32416
    s_waitcnt lgkmcnt(14)
    v_mfma_f32_16x16x32_bf16 v[72:75], a[8:11], a[56:59], v[72:75]
    v_mfma_f32_16x16x32_bf16 v[76:79], a[8:11], a[60:63], v[76:79]
    ds_read_b64_tr_b16 a[8:9], v3 offset:28864
    ds_read_b64_tr_b16 a[10:11], v3 offset:32448
    s_waitcnt lgkmcnt(14)
    v_mfma_f32_16x16x32_bf16 v[80:83], a[12:15], a[56:59], v[80:83]
    v_mfma_f32_16x16x32_bf16 v[84:87], a[12:15], a[60:63], v[84:87]
    s_add_u32 m0, s30, 57344
    s_add_u32 s35, s37, 147456
    buffer_load_dwordx4 v12, s[12:15], s35 offen lds
    ds_read_b64_tr_b16 a[12:13], v3 offset:35840
    ds_read_b64_tr_b16 a[14:15], v3 offset:39424
    s_waitcnt vmcnt(14) lgkmcnt(14)
    v_mfma_f32_16x16x32_bf16 v[32:35], a[16:19], a[64:67], v[32:35]
    s_waitcnt vmcnt(13)
    v_mfma_f32_16x16x32_bf16 v[36:39], a[16:19], a[68:71], v[36:39]
    s_add_u32 m0, s30, 58368
    s_bfm_b64 exec, 48, 0
    buffer_load_dwordx4 v13, s[12:15], s35 offen lds
    s_mov_b64 exec, -1
    ds_read_b64_tr_b16 a[16:17], v3 offset:35872
    ds_read_b64_tr_b16 a[18:19], v3 offset:39456
    s_waitcnt lgkmcnt(14)
    v_mfma_f32_16x16x32_bf16 v[40:43], a[20:23], a[64:67], v[40:43]
    v_mfma_f32_16x16x32_bf16 v[44:47], a[20:23], a[68:71], v[44:47]
    s_add_u32 m0, s31, 16384
    s_mov_b64 exec, 0xffffffff
    buffer_load_dwordx4 v14, s[12:15], s35 offen lds
    s_mov_b64 exec, -1
    ds_read_b64_tr_b16 a[20:21], v3 offset:35904
    ds_read_b64_tr_b16 a[22:23], v3 offset:39488
    s_waitcnt lgkmcnt(14)
    v_mfma_f32_16x16x32_bf16 v[48:51], a[24:27], a[64:67], v[48:51]
    v_mfma_f32_16x16x32_bf16 v[52:55], a[24:27], a[68:71], v[52:55]
    s_add_u32 s38, s38, 4096
    buffer_load_dwordx4 a[96:99], v1, s[16:19], s38 offen offset:0
    ds_read_b64_tr_b16 a[24:25], v3 offset:35936
    ds_read_b64_tr_b16 a[26:27], v3 offset:39520
    s_waitcnt lgkmcnt(14)
    v_mfma_f32_16x16x32_bf16 v[56:59], a[28:31], a[64:67], v[56:59]
    v_mfma_f32_16x16x32_bf16 v[60:63], a[28:31], a[68:71], v[60:63]
    s_add_u32 s39, s39, 4096
    buffer_load_dwordx4 a[100:103], v1, s[16:19], s39 offen offset:0
    ds_read_b64_tr_b16 a[28:29], v3 offset:35968
    ds_read_b64_tr_b16 a[30:31], v3 offset:39552
    s_waitcnt lgkmcnt(14)
    v_mfma_f32_16x16x32_bf16 v[64:67], a[0:3], a[64:67], v[64:67]
    v_mfma_f32_16x16x32_bf16 v[68:71], a[0:3], a[68:71], v[68:71]
    ds_read_b64_tr_b16 a[0:1], v3 offset:36000
    ds_read_b64_tr_b16 a[2:3], v3 offset:39584
    s_waitcnt lgkmcnt(14)
    v_mfma_f32_16x16x32_bf16 v[72:75], a[4:7], a[64:67], v[72:75]
    v_mfma_f32_16x16x32_bf16 v[76:79], a[4:7], a[68:71], v[76:79]
    ds_read_b64_tr_b16 a[4:5], v3 offset:36032
    ds_read_b64_tr_b16 a[6:7], v3 offset:39616
    s_waitcnt lgkmcnt(14)
    v_mfma_f32_16x16x32_bf16 v[80:83], a[8:11], a[64:67], v[80:83]
    v_mfma_f32_16x16x32_bf16 v[84:87], a[8:11], a[68:71], v[84:87]
    s_add_u32 m0, s30, 64512
    s_add_u32 s37, s40, 1
    s_and_b32 s37, s37, 3
    s_mul_i32 s37, s37, 331776
    s_add_u32 s37, s37, s34
    s_add_u32 s35, s37, 0
    buffer_load_dwordx4 v9, s[12:15], s35 offen lds
    s_waitcnt vmcnt(8)
    s_barrier
    ds_read_b64_tr_b16 a[8:9], v4 offset:0
    ds_read_b64_tr_b16 a[10:11], v4 offset:3584
    s_waitcnt lgkmcnt(14)
    v_mfma_f32_16x16x32_bf16 v[32:35], a[12:15], a[72:75], v[32:35]
    v_mfma_f32_16x16x32_bf16 v[36:39], a[12:15], a[76:79], v[36:39]
    s_add_u32 m0, s30, 65536
    s_bfm_b64 exec, 48, 0
    buffer_load_dwordx4 v10, s[12:15], s35 offen lds
    s_mov_b64 exec, -1
    ds_read_b64_tr_b16 a[12:13], v4 offset:32
    ds_read_b64_tr_b16 a[14:15], v4 offset:3616
    s_waitcnt lgkmcnt(14)
    v_mfma_f32_16x16x32_bf16 v[40:43], a[16:19], a[72:75], v[40:43]
    v_mfma_f32_16x16x32_bf16 v[44:47], a[16:19], a[76:79], v[44:47]
    s_add_u32 m0, s31, 18432
    s_mov_b64 exec, 0xffffffff
    buffer_load_dwordx4 v11, s[12:15], s35 offen lds
    s_mov_b64 exec, -1
    ds_read_b64_tr_b16 a[16:17], v4 offset:64
    ds_read_b64_tr_b16 a[18:19], v4 offset:3648
    s_waitcnt lgkmcnt(14)
    v_mfma_f32_16x16x32_bf16 v[48:51], a[20:23], a[72:75], v[48:51]
    v_mfma_f32_16x16x32_bf16 v[52:55], a[20:23], a[76:79], v[52:55]
    s_add_u32 s38, s40, 1
    s_and_b32 s38, s38, 3
    s_mul_i32 s38, s38, 9216
    s_add_u32 s38, s38, s32
    buffer_load_dwordx4 a[104:107], v1, s[16:19], s38 offen offset:0
    ds_read_b64_tr_b16 a[20:21], v4 offset:96
    ds_read_b64_tr_b16 a[22:23], v4 offset:3680
    s_waitcnt lgkmcnt(14)
    v_mfma_f32_16x16x32_bf16 v[56:59], a[24:27], a[72:75], v[56:59]
    v_mfma_f32_16x16x32_bf16 v[60:63], a[24:27], a[76:79], v[60:63]
    s_add_u32 s39, s40, 1
    s_and_b32 s39, s39, 3
    s_mul_i32 s39, s39, 9216
    s_add_u32 s39, s39, s33
    buffer_load_dwordx4 a[108:111], v1, s[16:19], s39 offen offset:0
    ds_read_b64_tr_b16 a[24:25], v4 offset:128
    ds_read_b64_tr_b16 a[26:27], v4 offset:3712
    s_waitcnt lgkmcnt(14)
    v_mfma_f32_16x16x32_bf16 v[64:67], a[28:31], a[72:75], v[64:67]
    v_mfma_f32_16x16x32_bf16 v[68:71], a[28:31], a[76:79], v[68:71]
    ds_read_b64_tr_b16 a[28:29], v4 offset:160
    ds_read_b64_tr_b16 a[30:31], v4 offset:3744
    s_waitcnt lgkmcnt(14)
    v_mfma_f32_16x16x32_bf16 v[72:75], a[0:3], a[72:75], v[72:75]
    v_mfma_f32_16x16x32_bf16 v[76:79], a[0:3], a[76:79], v[76:79]
    ds_read_b64_tr_b16 a[0:1], v4 offset:192
    ds_read_b64_tr_b16 a[2:3], v4 offset:3776
    s_waitcnt lgkmcnt(14)
    v_mfma_f32_16x16x32_bf16 v[80:83], a[4:7], a[72:75], v[80:83]
    v_mfma_f32_16x16x32_bf16 v[84:87], a[4:7], a[76:79], v[84:87]
    s_add_u32 m0, s30, 71680
    s_add_u32 s35, s37, 36864
    buffer_load_dwordx4 v9, s[12:15], s35 offen lds
    ds_read_b64_tr_b16 a[4:5], v4 offset:7168
    ds_read_b64_tr_b16 a[6:7], v4 offset:10752
    s_waitcnt lgkmcnt(14)
    v_mfma_f32_16x16x32_bf16 v[32:35], a[8:11], a[80:83], v[32:35]
    v_mfma_f32_16x16x32_bf16 v[36:39], a[8:11], a[84:87], v[36:39]
    s_add_u32 m0, s30, 72704
    s_bfm_b64 exec, 48, 0
    buffer_load_dwordx4 v10, s[12:15], s35 offen lds
    s_mov_b64 exec, -1
    ds_read_b64_tr_b16 a[8:9], v4 offset:7200
    ds_read_b64_tr_b16 a[10:11], v4 offset:10784
    s_waitcnt lgkmcnt(14)
    v_mfma_f32_16x16x32_bf16 v[40:43], a[12:15], a[80:83], v[40:43]
    v_mfma_f32_16x16x32_bf16 v[44:47], a[12:15], a[84:87], v[44:47]
    s_add_u32 m0, s31, 20480
    s_mov_b64 exec, 0xffffffff
    buffer_load_dwordx4 v11, s[12:15], s35 offen lds
    s_mov_b64 exec, -1
    ds_read_b64_tr_b16 a[12:13], v4 offset:7232
    ds_read_b64_tr_b16 a[14:15], v4 offset:10816
    s_waitcnt lgkmcnt(14)
    v_mfma_f32_16x16x32_bf16 v[48:51], a[16:19], a[80:83], v[48:51]
    v_mfma_f32_16x16x32_bf16 v[52:55], a[16:19], a[84:87], v[52:55]
    buffer_load_dwordx4 a[112:115], v1, s[16:19], s38 offen offset:1024
    ds_read_b64_tr_b16 a[16:17], v4 offset:7264
    ds_read_b64_tr_b16 a[18:19], v4 offset:10848
    s_waitcnt lgkmcnt(14)
    v_mfma_f32_16x16x32_bf16 v[56:59], a[20:23], a[80:83], v[56:59]
    v_mfma_f32_16x16x32_bf16 v[60:63], a[20:23], a[84:87], v[60:63]
    buffer_load_dwordx4 a[116:119], v1, s[16:19], s39 offen offset:1024
    ds_read_b64_tr_b16 a[20:21], v4 offset:7296
    ds_read_b64_tr_b16 a[22:23], v4 offset:10880
    s_waitcnt lgkmcnt(14)
    v_mfma_f32_16x16x32_bf16 v[64:67], a[24:27], a[80:83], v[64:67]
    v_mfma_f32_16x16x32_bf16 v[68:71], a[24:27], a[84:87], v[68:71]
    ds_read_b64_tr_b16 a[24:25], v4 offset:7328
    ds_read_b64_tr_b16 a[26:27], v4 offset:10912
    s_waitcnt lgkmcnt(14)
    v_mfma_f32_16x16x32_bf16 v[72:75], a[28:31], a[80:83], v[72:75]
    v_mfma_f32_16x16x32_bf16 v[76:79], a[28:31], a[84:87], v[76:79]
    ds_read_b64_tr_b16 a[28:29], v4 offset:7360
    ds_read_b64_tr_b16 a[30:31], v4 offset:10944
    s_waitcnt lgkmcnt(14)
    v_mfma_f32_16x16x32_bf16 v[80:83], a[0:3], a[80:83], v[80:83]
    v_mfma_f32_16x16x32_bf16 v[84:87], a[0:3], a[84:87], v[84:87]
    s_add_u32 m0, s30, 78848
    s_add_u32 s35, s37, 73728
    buffer_load_dwordx4 v9, s[12:15], s35 offen lds
    s_waitcnt vmcnt(8)
    s_barrier
    ds_read_b64_tr_b16 a[0:1], v4 offset:14336
    ds_read_b64_tr_b16 a[2:3], v4 offset:17920
    s_waitcnt lgkmcnt(14)
    v_mfma_f32_16x16x32_bf16 v[32:35], a[4:7], a[88:91], v[32:35]
    v_mfma_f32_16x16x32_bf16 v[36:39], a[4:7], a[92:95], v[36:39]
    s_add_u32 m0, s30, 79872
    s_bfm_b64 exec, 48, 0
    buffer_load_dwordx4 v10, s[12:15], s35 offen lds
    s_mov_b64 exec, -1
    ds_read_b64_tr_b16 a[4:5], v4 offset:14368
    ds_read_b64_tr_b16 a[6:7], v4 offset:17952
    s_waitcnt lgkmcnt(14)
    v_mfma_f32_16x16x32_bf16 v[40:43], a[8:11], a[88:91], v[40:43]
    v_mfma_f32_16x16x32_bf16 v[44:47], a[8:11], a[92:95], v[44:47]
    s_add_u32 m0, s31, 22528
    s_mov_b64 exec, 0xffffffff
    buffer_load_dwordx4 v11, s[12:15], s35 offen lds
    s_mov_b64 exec, -1
    ds_read_b64_tr_b16 a[8:9], v4 offset:14400
    ds_read_b64_tr_b16 a[10:11], v4 offset:17984
    s_waitcnt lgkmcnt(14)
    v_mfma_f32_16x16x32_bf16 v[48:51], a[12:15], a[88:91], v[48:51]
    v_mfma_f32_16x16x32_bf16 v[52:55], a[12:15], a[92:95], v[52:55]
    buffer_load_dwordx4 a[120:123], v1, s[16:19], s38 offen offset:2048
    ds_read_b64_tr_b16 a[12:13], v4 offset:14432
    ds_read_b64_tr_b16 a[14:15], v4 offset:18016
    s_waitcnt lgkmcnt(14)
    v_mfma_f32_16x16x32_bf16 v[56:59], a[16:19], a[88:91], v[56:59]
    v_mfma_f32_16x16x32_bf16 v[60:63], a[16:19], a[92:95], v[60:63]
    buffer_load_dwordx4 a[124:127], v1, s[16:19], s39 offen offset:2048
    ds_read_b64_tr_b16 a[16:17], v4 offset:14464
    ds_read_b64_tr_b16 a[18:19], v4 offset:18048
    s_waitcnt lgkmcnt(14)
    v_mfma_f32_16x16x32_bf16 v[64:67], a[20:23], a[88:91], v[64:67]
    v_mfma_f32_16x16x32_bf16 v[68:71], a[20:23], a[92:95], v[68:71]
    ds_read_b64_tr_b16 a[20:21], v4 offset:14496
    ds_read_b64_tr_b16 a[22:23], v4 offset:18080
    s_waitcnt lgkmcnt(14)
    v_mfma_f32_16x16x32_bf16 v[72:75], a[24:27], a[88:91], v[72:75]
    v_mfma_f32_16x16x32_bf16 v[76:79], a[24:27], a[92:95], v[76:79]
    ds_read_b64_tr_b16 a[24:25], v4 offset:14528
    ds_read_b64_tr_b16 a[26:27], v4 offset:18112
    s_waitcnt lgkmcnt(14)
    v_mfma_f32_16x16x32_bf16 v[80:83], a[28:31], a[88:91], v[80:83]
    v_mfma_f32_16x16x32_bf16 v[84:87], a[28:31], a[92:95], v[84:87]
    s_add_u32 m0, s30, 0
    s_add_u32 s35, s37, 110592
    buffer_load_dwordx4 v9, s[12:15], s35 offen lds
    ds_read_b64_tr_b16 a[28:29], v4 offset:21504
    ds_read_b64_tr_b16 a[30:31], v4 offset:25088
    s_waitcnt lgkmcnt(14)
    v_mfma_f32_16x16x32_bf16 v[32:35], a[0:3], a[96:99], v[32:35]
    v_mfma_f32_16x16x32_bf16 v[36:39], a[0:3], a[100:103], v[36:39]
    s_add_u32 m0, s30, 1024
    s_bfm_b64 exec, 48, 0
    buffer_load_dwordx4 v10, s[12:15], s35 offen lds
    s_mov_b64 exec, -1
    ds_read_b64_tr_b16 a[0:1], v4 offset:21536
    ds_read_b64_tr_b16 a[2:3], v4 offset:25120
    s_waitcnt lgkmcnt(14)
    v_mfma_f32_16x16x32_bf16 v[40:43], a[4:7], a[96:99], v[40:43]
    v_mfma_f32_16x16x32_bf16 v[44:47], a[4:7], a[100:103], v[44:47]
    s_add_u32 m0, s31, 24576
    s_mov_b64 exec, 0xffffffff
    buffer_load_dwordx4 v11, s[12:15], s35 offen lds
    s_mov_b64 exec, -1
    ds_read_b64_tr_b16 a[4:5], v4 offset:21568
    ds_read_b64_tr_b16 a[6:7], v4 offset:25152
    s_waitcnt lgkmcnt(14)
    v_mfma_f32_16x16x32_bf16 v[48:51], a[8:11], a[96:99], v[48:51]
    v_mfma_f32_16x16x32_bf16 v[52:55], a[8:11], a[100:103], v[52:55]
    buffer_load_dwordx4 a[128:131], v1, s[16:19], s38 offen offset:3072
    ds_read_b64_tr_b16 a[8:9], v4 offset:21600
    ds_read_b64_tr_b16 a[10:11], v4 offset:25184
    s_waitcnt lgkmcnt(14)
    v_mfma_f32_16x16x32_bf16 v[56:59], a[12:15], a[96:99], v[56:59]
    v_mfma_f32_16x16x32_bf16 v[60:63], a[12:15], a[100:103], v[60:63]
    buffer_load_dwordx4 a[132:135], v1, s[16:19], s39 offen offset:3072
    ds_read_b64_tr_b16 a[12:13], v4 offset:21632
    ds_read_b64_tr_b16 a[14:15], v4 offset:25216
    s_waitcnt lgkmcnt(14)
    v_mfma_f32_16x16x32_bf16 v[64:67], a[16:19], a[96:99], v[64:67]
    v_mfma_f32_16x16x32_bf16 v[68:71], a[16:19], a[100:103], v[68:71]
    ds_read_b64_tr_b16 a[16:17], v4 offset:21664
    ds_read_b64_tr_b16 a[18:19], v4 offset:25248
    s_waitcnt lgkmcnt(14)
    v_mfma_f32_16x16x32_bf16 v[72:75], a[20:23], a[96:99], v[72:75]
    v_mfma_f32_16x16x32_bf16 v[76:79], a[20:23], a[100:103], v[76:79]
    ds_read_b64_tr_b16 a[20:21], v4 offset:21696
    ds_read_b64_tr_b16 a[22:23], v4 offset:25280
    s_waitcnt lgkmcnt(14)
    v_mfma_f32_16x16x32_bf16 v[80:83], a[24:27], a[96:99], v[80:83]
    v_mfma_f32_16x16x32_bf16 v[84:87], a[24:27], a[100:103], v[84:87]
    s_add_u32 m0, s30, 7168
    s_add_u32 s35, s37, 165888
    buffer_load_dwordx4 v9, s[12:15], s35 offen lds
    s_waitcnt vmcnt(8)
    s_barrier
    ds_read_b64_tr_b16 a[24:25], v4 offset:28672
    ds_read_b64_tr_b16 a[26:27], v4 offset:32256
    s_waitcnt lgkmcnt(14)
    v_mfma_f32_16x16x32_bf16 v[32:35], a[28:31], a[104:107], v[32:35]
    v_mfma_f32_16x16x32_bf16 v[36:39], a[28:31], a[108:111], v[36:39]
    s_add_u32 m0, s30, 8192
    s_bfm_b64 exec, 48, 0
    buffer_load_dwordx4 v10, s[12:15], s35 offen lds
    s_mov_b64 exec, -1
    ds_read_b64_tr_b16 a[28:29], v4 offset:28704
    ds_read_b64_tr_b16 a[30:31], v4 offset:32288
    s_waitcnt lgkmcnt(14)
    v_mfma_f32_16x16x32_bf16 v[40:43], a[0:3], a[104:107], v[40:43]
    v_mfma_f32_16x16x32_bf16 v[44:47], a[0:3], a[108:111], v[44:47]
    s_add_u32 m0, s31, 26624
    s_mov_b64 exec, 0xffffffff
    buffer_load_dwordx4 v11, s[12:15], s35 offen lds
    s_mov_b64 exec, -1
    ds_read_b64_tr_b16 a[0:1], v4 offset:28736
    ds_read_b64_tr_b16 a[2:3], v4 offset:32320
    s_waitcnt lgkmcnt(14)
    v_mfma_f32_16x16x32_bf16 v[48:51], a[4:7], a[104:107], v[48:51]
    v_mfma_f32_16x16x32_bf16 v[52:55], a[4:7], a[108:111], v[52:55]
    s_add_u32 s38, s38, 4096
    buffer_load_dwordx4 a[136:139], v1, s[16:19], s38 offen offset:0
    ds_read_b64_tr_b16 a[4:5], v4 offset:28768
    ds_read_b64_tr_b16 a[6:7], v4 offset:32352
    s_waitcnt lgkmcnt(14)
    v_mfma_f32_16x16x32_bf16 v[56:59], a[8:11], a[104:107], v[56:59]
    v_mfma_f32_16x16x32_bf16 v[60:63], a[8:11], a[108:111], v[60:63]
    s_add_u32 s39, s39, 4096
    buffer_load_dwordx4 a[140:143], v1, s[16:19], s39 offen offset:0
    ds_read_b64_tr_b16 a[8:9], v4 offset:28800
    ds_read_b64_tr_b16 a[10:11], v4 offset:32384
    s_waitcnt lgkmcnt(14)
    v_mfma_f32_16x16x32_bf16 v[64:67], a[12:15], a[104:107], v[64:67]
    v_mfma_f32_16x16x32_bf16 v[68:71], a[12:15], a[108:111], v[68:71]
    ds_read_b64_tr_b16 a[12:13], v4 offset:28832
    ds_read_b64_tr_b16 a[14:15], v4 offset:32416
    s_waitcnt lgkmcnt(14)
    v_mfma_f32_16x16x32_bf16 v[72:75], a[16:19], a[104:107], v[72:75]
    v_mfma_f32_16x16x32_bf16 v[76:79], a[16:19], a[108:111], v[76:79]
    ds_read_b64_tr_b16 a[16:17], v4 offset:28864
    ds_read_b64_tr_b16 a[18:19], v4 offset:32448
    s_waitcnt lgkmcnt(14)
    v_mfma_f32_16x16x32_bf16 v[80:83], a[20:23], a[104:107], v[80:83]
    v_mfma_f32_16x16x32_bf16 v[84:87], a[20:23], a[108:111], v[84:87]
    s_add_u32 m0, s30, 14336
    s_add_u32 s35, s37, 202752
    buffer_load_dwordx4 v9, s[12:15], s35 offen lds
    ds_read_b64_tr_b16 a[20:21], v4 offset:35840
    ds_read_b64_tr_b16 a[22:23], v4 offset:39424
    s_waitcnt lgkmcnt(14)
    v_mfma_f32_16x16x32_bf16 v[32:35], a[24:27], a[112:115], v[32:35]
    v_mfma_f32_16x16x32_bf16 v[36:39], a[24:27], a[116:119], v[36:39]
    s_add_u32 m0, s30, 15360
    s_bfm_b64 exec, 48, 0
    buffer_load_dwordx4 v10, s[12:15], s35 offen lds
    s_mov_b64 exec, -1
    ds_read_b64_tr_b16 a[24:25], v4 offset:35872
    ds_read_b64_tr_b16 a[26:27], v4 offset:39456
    s_waitcnt lgkmcnt(14)
    v_mfma_f32_16x16x32_bf16 v[40:43], a[28:31], a[112:115], v[40:43]
    v_mfma_f32_16x16x32_bf16 v[44:47], a[28:31], a[116:119], v[44:47]
    s_add_u32 m0, s31, 28672
    s_mov_b64 exec, 0xffffffff
    buffer_load_dwordx4 v11, s[12:15], s35 offen lds
    s_mov_b64 exec, -1
    ds_read_b64_tr_b16 a[28:29], v4 offset:35904
    ds_read_b64_tr_b16 a[30:31], v4 offset:39488
    s_waitcnt lgkmcnt(14)
    v_mfma_f32_16x16x32_bf16 v[48:51], a[0:3], a[112:115], v[48:51]
    v_mfma_f32_16x16x32_bf16 v[52:55], a[0:3], a[116:119], v[52:55]
    buffer_load_dwordx4 a[144:147], v1, s[16:19], s38 offen offset:1024
    ds_read_b64_tr_b16 a[0:1], v4 offset:35936
    ds_read_b64_tr_b16 a[2:3], v4 offset:39520
    s_waitcnt lgkmcnt(14)
    v_mfma_f32_16x16x32_bf16 v[56:59], a[4:7], a[112:115], v[56:59]
    v_mfma_f32_16x16x32_bf16 v[60:63], a[4:7], a[116:119], v[60:63]
    buffer_load_dwordx4 a[148:151], v1, s[16:19], s39 offen offset:1024
    ds_read_b64_tr_b16 a[4:5], v4 offset:35968
    ds_read_b64_tr_b16 a[6:7], v4 offset:39552
    s_waitcnt lgkmcnt(14)
    v_mfma_f32_16x16x32_bf16 v[64:67], a[8:11], a[112:115], v[64:67]
    v_mfma_f32_16x16x32_bf16 v[68:71], a[8:11], a[116:119], v[68:71]
    ds_read_b64_tr_b16 a[8:9], v4 offset:36000
    ds_read_b64_tr_b16 a[10:11], v4 offset:39584
    s_waitcnt lgkmcnt(14)
    v_mfma_f32_16x16x32_bf16 v[72:75], a[12:15], a[112:115], v[72:75]
    v_mfma_f32_16x16x32_bf16 v[76:79], a[12:15], a[116:119], v[76:79]
    ds_read_b64_tr_b16 a[12:13], v4 offset:36032
    ds_read_b64_tr_b16 a[14:15], v4 offset:39616
    s_waitcnt lgkmcnt(14)
    v_mfma_f32_16x16x32_bf16 v[80:83], a[16:19], a[112:115], v[80:83]
    v_mfma_f32_16x16x32_bf16 v[84:87], a[16:19], a[116:119], v[84:87]
    s_add_u32 m0, s30, 21504
    s_add_u32 s35, s37, 239616
    buffer_load_dwordx4 v9, s[12:15], s35 offen lds
    s_waitcnt vmcnt(8)
    s_barrier
    ds_read_b64_tr_b16 a[16:17], v3 offset:0
    ds_read_b64_tr_b16 a[18:19], v3 offset:3584
    s_waitcnt lgkmcnt(14)
    v_mfma_f32_16x16x32_bf16 v[32:35], a[20:23], a[120:123], v[32:35]
    v_mfma_f32_16x16x32_bf16 v[36:39], a[20:23], a[124:127], v[36:39]
    s_add_u32 m0, s30, 22528
    s_bfm_b64 exec, 48, 0
    buffer_load_dwordx4 v10, s[12:15], s35 offen lds
    s_mov_b64 exec, -1
    ds_read_b64_tr_b16 a[20:21], v3 offset:32
    ds_read_b64_tr_b16 a[22:23], v3 offset:3616
    s_waitcnt lgkmcnt(14)
    v_mfma_f32_16x16x32_bf16 v[40:43], a[24:27], a[120:123], v[40:43]
    v_mfma_f32_16x16x32_bf16 v[44:47], a[24:27], a[124:127], v[44:47]
    s_add_u32 m0, s31, 30720
    s_mov_b64 exec, 0xffffffff
    buffer_load_dwordx4 v11, s[12:15], s35 offen lds
    s_mov_b64 exec, -1
    ds_read_b64_tr_b16 a[24:25], v3 offset:64
    ds_read_b64_tr_b16 a[26:27], v3 offset:3648
    s_waitcnt lgkmcnt(14)
    v_mfma_f32_16x16x32_bf16 v[48:51], a[28:31], a[120:123], v[48:51]
    v_mfma_f32_16x16x32_bf16 v[52:55], a[28:31], a[124:127], v[52:55]
    buffer_load_dwordx4 a[152:155], v1, s[16:19], s38 offen offset:2048
    ds_read_b64_tr_b16 a[28:29], v3 offset:96
    ds_read_b64_tr_b16 a[30:31], v3 offset:3680
    s_waitcnt lgkmcnt(14)
    v_mfma_f32_16x16x32_bf16 v[56:59], a[0:3], a[120:123], v[56:59]
    v_mfma_f32_16x16x32_bf16 v[60:63], a[0:3], a[124:127], v[60:63]
    buffer_load_dwordx4 a[156:159], v1, s[16:19], s39 offen offset:2048
    ds_read_b64_tr_b16 a[0:1], v3 offset:128
    ds_read_b64_tr_b16 a[2:3], v3 offset:3712
    s_waitcnt lgkmcnt(14)
    v_mfma_f32_16x16x32_bf16 v[64:67], a[4:7], a[120:123], v[64:67]
    v_mfma_f32_16x16x32_bf16 v[68:71], a[4:7], a[124:127], v[68:71]
    ds_read_b64_tr_b16 a[4:5], v3 offset:160
    ds_read_b64_tr_b16 a[6:7], v3 offset:3744
    s_waitcnt lgkmcnt(14)
    v_mfma_f32_16x16x32_bf16 v[72:75], a[8:11], a[120:123], v[72:75]
    v_mfma_f32_16x16x32_bf16 v[76:79], a[8:11], a[124:127], v[76:79]
    ds_read_b64_tr_b16 a[8:9], v3 offset:192
    ds_read_b64_tr_b16 a[10:11], v3 offset:3776
    s_waitcnt lgkmcnt(14)
    v_mfma_f32_16x16x32_bf16 v[80:83], a[12:15], a[120:123], v[80:83]
    v_mfma_f32_16x16x32_bf16 v[84:87], a[12:15], a[124:127], v[84:87]
    s_add_u32 m0, s30, 28672
    s_add_u32 s35, s37, 276480
    buffer_load_dwordx4 v9, s[12:15], s35 offen lds
    ds_read_b64_tr_b16 a[12:13], v3 offset:7168
    ds_read_b64_tr_b16 a[14:15], v3 offset:10752
    s_waitcnt lgkmcnt(14)
    v_mfma_f32_16x16x32_bf16 v[32:35], a[16:19], a[128:131], v[32:35]
    v_mfma_f32_16x16x32_bf16 v[36:39], a[16:19], a[132:135], v[36:39]
    s_add_u32 m0, s30, 29696
    s_bfm_b64 exec, 48, 0
    buffer_load_dwordx4 v10, s[12:15], s35 offen lds
    s_mov_b64 exec, -1
    ds_read_b64_tr_b16 a[16:17], v3 offset:7200
    ds_read_b64_tr_b16 a[18:19], v3 offset:10784
    s_waitcnt lgkmcnt(14)
    v_mfma_f32_16x16x32_bf16 v[40:43], a[20:23], a[128:131], v[40:43]
    v_mfma_f32_16x16x32_bf16 v[44:47], a[20:23], a[132:135], v[44:47]
    s_add_u32 m0, s31, 32768
    s_mov_b64 exec, 0xffffffff
    buffer_load_dwordx4 v11, s[12:15], s35 offen lds
    s_mov_b64 exec, -1
    ds_read_b64_tr_b16 a[20:21], v3 offset:7232
    ds_read_b64_tr_b16 a[22:23], v3 offset:10816
    s_waitcnt lgkmcnt(14)
    v_mfma_f32_16x16x32_bf16 v[48:51], a[24:27], a[128:131], v[48:51]
    v_mfma_f32_16x16x32_bf16 v[52:55], a[24:27], a[132:135], v[52:55]
    buffer_load_dwordx4 a[160:163], v1, s[16:19], s38 offen offset:3072
    ds_read_b64_tr_b16 a[24:25], v3 offset:7264
    ds_read_b64_tr_b16 a[26:27], v3 offset:10848
    s_waitcnt lgkmcnt(14)
    v_mfma_f32_16x16x32_bf16 v[56:59], a[28:31], a[128:131], v[56:59]
    v_mfma_f32_16x16x32_bf16 v[60:63], a[28:31], a[132:135], v[60:63]
    buffer_load_dwordx4 a[164:167], v1, s[16:19], s39 offen offset:3072
    ds_read_b64_tr_b16 a[28:29], v3 offset:7296
    ds_read_b64_tr_b16 a[30:31], v3 offset:10880
    s_waitcnt lgkmcnt(14)
    v_mfma_f32_16x16x32_bf16 v[64:67], a[0:3], a[128:131], v[64:67]
    v_mfma_f32_16x16x32_bf16 v[68:71], a[0:3], a[132:135], v[68:71]
    ds_read_b64_tr_b16 a[0:1], v3 offset:7328
    ds_read_b64_tr_b16 a[2:3], v3 offset:10912
    s_waitcnt lgkmcnt(14)
    v_mfma_f32_16x16x32_bf16 v[72:75], a[4:7], a[128:131], v[72:75]
    v_mfma_f32_16x16x32_bf16 v[76:79], a[4:7], a[132:135], v[76:79]
    ds_read_b64_tr_b16 a[4:5], v3 offset:7360
    ds_read_b64_tr_b16 a[6:7], v3 offset:10944
    s_waitcnt lgkmcnt(14)
    v_mfma_f32_16x16x32_bf16 v[80:83], a[8:11], a[128:131], v[80:83]
    v_mfma_f32_16x16x32_bf16 v[84:87], a[8:11], a[132:135], v[84:87]
    s_add_u32 m0, s30, 35840
    s_add_u32 s35, s37, 147456
    buffer_load_dwordx4 v12, s[12:15], s35 offen lds
    s_waitcnt vmcnt(8)
    s_barrier
    ds_read_b64_tr_b16 a[8:9], v3 offset:14336
    ds_read_b64_tr_b16 a[10:11], v3 offset:17920
    s_waitcnt lgkmcnt(14)
    v_mfma_f32_16x16x32_bf16 v[32:35], a[12:15], a[136:139], v[32:35]
    v_mfma_f32_16x16x32_bf16 v[36:39], a[12:15], a[140:143], v[36:39]
    s_add_u32 m0, s30, 36864
    s_bfm_b64 exec, 48, 0
    buffer_load_dwordx4 v13, s[12:15], s35 offen lds
    s_mov_b64 exec, -1
    ds_read_b64_tr_b16 a[12:13], v3 offset:14368
    ds_read_b64_tr_b16 a[14:15], v3 offset:17952
    s_waitcnt lgkmcnt(14)
    v_mfma_f32_16x16x32_bf16 v[40:43], a[16:19], a[136:139], v[40:43]
    v_mfma_f32_16x16x32_bf16 v[44:47], a[16:19], a[140:143], v[44:47]
    s_add_u32 m0, s31, 34816
    s_mov_b64 exec, 0xffffffff
    buffer_load_dwordx4 v14, s[12:15], s35 offen lds
    s_mov_b64 exec, -1
    ds_read_b64_tr_b16 a[16:17], v3 offset:14400
    ds_read_b64_tr_b16 a[18:19], v3 offset:17984
    s_waitcnt lgkmcnt(14)
    v_mfma_f32_16x16x32_bf16 v[48:51], a[20:23], a[136:139], v[48:51]
    v_mfma_f32_16x16x32_bf16 v[52:55], a[20:23], a[140:143], v[52:55]
    s_add_u32 s38, s38, 4096
    buffer_load_dwordx4 a[168:171], v1, s[16:19], s38 offen offset:0
    ds_read_b64_tr_b16 a[20:21], v3 offset:14432
    ds_read_b64_tr_b16 a[22:23], v3 offset:18016
    s_waitcnt lgkmcnt(14)
    v_mfma_f32_16x16x32_bf16 v[56:59], a[24:27], a[136:139], v[56:59]
    v_mfma_f32_16x16x32_bf16 v[60:63], a[24:27], a[140:143], v[60:63]
    s_add_u32 s39, s39, 4096
    buffer_load_dwordx4 a[172:175], v1, s[16:19], s39 offen offset:0
    ds_read_b64_tr_b16 a[24:25], v3 offset:14464
    ds_read_b64_tr_b16 a[26:27], v3 offset:18048
    s_waitcnt lgkmcnt(14)
    v_mfma_f32_16x16x32_bf16 v[64:67], a[28:31], a[136:139], v[64:67]
    v_mfma_f32_16x16x32_bf16 v[68:71], a[28:31], a[140:143], v[68:71]
    ds_read_b64_tr_b16 a[28:29], v3 offset:14496
    ds_read_b64_tr_b16 a[30:31], v3 offset:18080
    s_waitcnt lgkmcnt(14)
    v_mfma_f32_16x16x32_bf16 v[72:75], a[0:3], a[136:139], v[72:75]
    v_mfma_f32_16x16x32_bf16 v[76:79], a[0:3], a[140:143], v[76:79]
    ds_read_b64_tr_b16 a[0:1], v3 offset:14528
    ds_read_b64_tr_b16 a[2:3], v3 offset:18112
    s_waitcnt lgkmcnt(14)
    v_mfma_f32_16x16x32_bf16 v[80:83], a[4:7], a[136:139], v[80:83]
    v_mfma_f32_16x16x32_bf16 v[84:87], a[4:7], a[140:143], v[84:87]
    s_add_u32 m0, s30, 43008
    s_add_u32 s37, s40, 2
    s_and_b32 s37, s37, 3
    s_mul_i32 s37, s37, 331776
    s_add_u32 s37, s37, s34
    s_add_u32 s35, s37, 0
    buffer_load_dwordx4 v9, s[12:15], s35 offen lds
    ds_read_b64_tr_b16 a[4:5], v3 offset:21504
    ds_read_b64_tr_b16 a[6:7], v3 offset:25088
    s_waitcnt lgkmcnt(14)
    v_mfma_f32_16x16x32_bf16 v[32:35], a[8:11], a[144:147], v[32:35]
    v_mfma_f32_16x16x32_bf16 v[36:39], a[8:11], a[148:151], v[36:39]
    s_add_u32 m0, s30, 44032
    s_bfm_b64 exec, 48, 0
    buffer_load_dwordx4 v10, s[12:15], s35 offen lds
    s_mov_b64 exec, -1
    ds_read_b64_tr_b16 a[8:9], v3 offset:21536
    ds_read_b64_tr_b16 a[10:11], v3 offset:25120
    s_waitcnt lgkmcnt(14)
    v_mfma_f32_16x16x32_bf16 v[40:43], a[12:15], a[144:147], v[40:43]
    v_mfma_f32_16x16x32_bf16 v[44:47], a[12:15], a[148:151], v[44:47]
    s_add_u32 m0, s31, 36864
    s_mov_b64 exec, 0xffffffff
    buffer_load_dwordx4 v11, s[12:15], s35 offen lds
    s_mov_b64 exec, -1
    ds_read_b64_tr_b16 a[12:13], v3 offset:21568
    ds_read_b64_tr_b16 a[14:15], v3 offset:25152
    s_waitcnt lgkmcnt(14)
    v_mfma_f32_16x16x32_bf16 v[48:51], a[16:19], a[144:147], v[48:51]
    v_mfma_f32_16x16x32_bf16 v[52:55], a[16:19], a[148:151], v[52:55]
    s_add_u32 s38, s40, 2
    s_and_b32 s38, s38, 3
    s_mul_i32 s38, s38, 9216
    s_add_u32 s38, s38, s32
    buffer_load_dwordx4 a[176:179], v1, s[16:19], s38 offen offset:0
    ds_read_b64_tr_b16 a[16:17], v3 offset:21600
    ds_read_b64_tr_b16 a[18:19], v3 offset:25184
    s_waitcnt lgkmcnt(14)
    v_mfma_f32_16x16x32_bf16 v[56:59], a[20:23], a[144:147], v[56:59]
    v_mfma_f32_16x16x32_bf16 v[60:63], a[20:23], a[148:151], v[60:63]
    s_add_u32 s39, s40, 2
    s_and_b32 s39, s39, 3
    s_mul_i32 s39, s39, 9216
    s_add_u32 s39, s39, s33
    buffer_load_dwordx4 a[180:183], v1, s[16:19], s39 offen offset:0
    ds_read_b64_tr_b16 a[20:21], v3 offset:21632
    ds_read_b64_tr_b16 a[22:23], v3 offset:25216
    s_waitcnt lgkmcnt(14)
    v_mfma_f32_16x16x32_bf16 v[64:67], a[24:27], a[144:147], v[64:67]
    v_mfma_f32_16x16x32_bf16 v[68:71], a[24:27], a[148:151], v[68:71]
    ds_read_b64_tr_b16 a[24:25], v3 offset:21664
    ds_read_b64_tr_b16 a[26:27], v3 offset:25248
    s_waitcnt lgkmcnt(14)
    v_mfma_f32_16x16x32_bf16 v[72:75], a[28:31], a[144:147], v[72:75]
    v_mfma_f32_16x16x32_bf16 v[76:79], a[28:31], a[148:151], v[76:79]
    ds_read_b64_tr_b16 a[28:29], v3 offset:21696
    ds_read_b64_tr_b16 a[30:31], v3 offset:25280
    s_waitcnt lgkmcnt(14)
    v_mfma_f32_16x16x32_bf16 v[80:83], a[0:3], a[144:147], v[80:83]
    v_mfma_f32_16x16x32_bf16 v[84:87], a[0:3], a[148:151], v[84:87]
    s_add_u32 m0, s30, 50176
    s_add_u32 s35, s37, 36864
    buffer_load_dwordx4 v9, s[12:15], s35 offen lds
    s_waitcnt vmcnt(8)
    s_barrier
    ds_read_b64_tr_b16 a[0:1], v3 offset:28672
    ds_read_b64_tr_b16 a[2:3], v3 offset:32256
    s_waitcnt lgkmcnt(14)
    v_mfma_f32_16x16x32_bf16 v[32:35], a[4:7], a[152:155], v[32:35]
    v_mfma_f32_16x16x32_bf16 v[36:39], a[4:7], a[156:159], v[36:39]
    s_add_u32 m0, s30, 51200
    s_bfm_b64 exec, 48, 0
    buffer_load_dwordx4 v10, s[12:15], s35 offen lds
    s_mov_b64 exec, -1
    ds_read_b64_tr_b16 a[4:5], v3 offset:28704
    ds_read_b64_tr_b16 a[6:7], v3 offset:32288
    s_waitcnt lgkmcnt(14)
    v_mfma_f32_16x16x32_bf16 v[40:43], a[8:11], a[152:155], v[40:43]
    v_mfma_f32_16x16x32_bf16 v[44:47], a[8:11], a[156:159], v[44:47]
    s_add_u32 m0, s31, 38912
    s_mov_b64 exec, 0xffffffff
    buffer_load_dwordx4 v11, s[12:15], s35 offen lds
    s_mov_b64 exec, -1
    ds_read_b64_tr_b16 a[8:9], v3 offset:28736
    ds_read_b64_tr_b16 a[10:11], v3 offset:32320
    s_waitcnt lgkmcnt(14)
    v_mfma_f32_16x16x32_bf16 v[48:51], a[12:15], a[152:155], v[48:51]
    v_mfma_f32_16x16x32_bf16 v[52:55], a[12:15], a[156:159], v[52:55]
    buffer_load_dwordx4 a[184:187], v1, s[16:19], s38 offen offset:1024
    ds_read_b64_tr_b16 a[12:13], v3 offset:28768
    ds_read_b64_tr_b16 a[14:15], v3 offset:32352
    s_waitcnt lgkmcnt(14)
    v_mfma_f32_16x16x32_bf16 v[56:59], a[16:19], a[152:155], v[56:59]
    v_mfma_f32_16x16x32_bf16 v[60:63], a[16:19], a[156:159], v[60:63]
    buffer_load_dwordx4 a[188:191], v1, s[16:19], s39 offen offset:1024
    ds_read_b64_tr_b16 a[16:17], v3 offset:28800
    ds_read_b64_tr_b16 a[18:19], v3 offset:32384
    s_waitcnt lgkmcnt(14)
    v_mfma_f32_16x16x32_bf16 v[64:67], a[20:23], a[152:155], v[64:67]
    v_mfma_f32_16x16x32_bf16 v[68:71], a[20:23], a[156:159], v[68:71]
    ds_read_b64_tr_b16 a[20:21], v3 offset:28832
    ds_read_b64_tr_b16 a[22:23], v3 offset:32416
    s_waitcnt lgkmcnt(14)
    v_mfma_f32_16x16x32_bf16 v[72:75], a[24:27], a[152:155], v[72:75]
    v_mfma_f32_16x16x32_bf16 v[76:79], a[24:27], a[156:159], v[76:79]
    ds_read_b64_tr_b16 a[24:25], v3 offset:28864
    ds_read_b64_tr_b16 a[26:27], v3 offset:32448
    s_waitcnt lgkmcnt(14)
    v_mfma_f32_16x16x32_bf16 v[80:83], a[28:31], a[152:155], v[80:83]
    v_mfma_f32_16x16x32_bf16 v[84:87], a[28:31], a[156:159], v[84:87]
    s_add_u32 m0, s30, 57344
    s_add_u32 s35, s37, 73728
    buffer_load_dwordx4 v9, s[12:15], s35 offen lds
    ds_read_b64_tr_b16 a[28:29], v3 offset:35840
    ds_read_b64_tr_b16 a[30:31], v3 offset:39424
    s_waitcnt lgkmcnt(14)
    v_mfma_f32_16x16x32_bf16 v[32:35], a[0:3], a[160:163], v[32:35]
    v_mfma_f32_16x16x32_bf16 v[36:39], a[0:3], a[164:167], v[36:39]
    s_add_u32 m0, s30, 58368
    s_bfm_b64 exec, 48, 0
    buffer_load_dwordx4 v10, s[12:15], s35 offen lds
    s_mov_b64 exec, -1
    ds_read_b64_tr_b16 a[0:1], v3 offset:35872
    ds_read_b64_tr_b16 a[2:3], v3 offset:39456
    s_waitcnt lgkmcnt(14)
    v_mfma_f32_16x16x32_bf16 v[40:43], a[4:7], a[160:163], v[40:43]
    v_mfma_f32_16x16x32_bf16 v[44:47], a[4:7], a[164:167], v[44:47]
    s_add_u32 m0, s31, 40960
    s_mov_b64 exec, 0xffffffff
    buffer_load_dwordx4 v11, s[12:15], s35 offen lds
    s_mov_b64 exec, -1
    ds_read_b64_tr_b16 a[4:5], v3 offset:35904
    ds_read_b64_tr_b16 a[6:7], v3 offset:39488
    s_waitcnt lgkmcnt(14)
    v_mfma_f32_16x16x32_bf16 v[48:51], a[8:11], a[160:163], v[48:51]
    v_mfma_f32_16x16x32_bf16 v[52:55], a[8:11], a[164:167], v[52:55]
    buffer_load_dwordx4 a[192:195], v1, s[16:19], s38 offen offset:2048
    ds_read_b64_tr_b16 a[8:9], v3 offset:35936
    ds_read_b64_tr_b16 a[10:11], v3 offset:39520
    s_waitcnt lgkmcnt(14)
    v_mfma_f32_16x16x32_bf16 v[56:59], a[12:15], a[160:163], v[56:59]
    v_mfma_f32_16x16x32_bf16 v[60:63], a[12:15], a[164:167], v[60:63]
    buffer_load_dwordx4 a[196:199], v1, s[16:19], s39 offen offset:2048
    ds_read_b64_tr_b16 a[12:13], v3 offset:35968
    ds_read_b64_tr_b16 a[14:15], v3 offset:39552
    s_waitcnt lgkmcnt(14)
    v_mfma_f32_16x16x32_bf16 v[64:67], a[16:19], a[160:163], v[64:67]
    v_mfma_f32_16x16x32_bf16 v[68:71], a[16:19], a[164:167], v[68:71]
    ds_read_b64_tr_b16 a[16:17], v3 offset:36000
    ds_read_b64_tr_b16 a[18:19], v3 offset:39584
    s_waitcnt lgkmcnt(14)
    v_mfma_f32_16x16x32_bf16 v[72:75], a[20:23], a[160:163], v[72:75]
    v_mfma_f32_16x16x32_bf16 v[76:79], a[20:23], a[164:167], v[76:79]
    ds_read_b64_tr_b16 a[20:21], v3 offset:36032
    ds_read_b64_tr_b16 a[22:23], v3 offset:39616
    s_waitcnt lgkmcnt(14)
    v_mfma_f32_16x16x32_bf16 v[80:83], a[24:27], a[160:163], v[80:83]
    v_mfma_f32_16x16x32_bf16 v[84:87], a[24:27], a[164:167], v[84:87]
    s_add_u32 m0, s30, 64512
    s_add_u32 s35, s37, 110592
    buffer_load_dwordx4 v9, s[12:15], s35 offen lds
    s_waitcnt vmcnt(8)
    s_barrier
    ds_read_b64_tr_b16 a[24:25], v4 offset:0
    ds_read_b64_tr_b16 a[26:27], v4 offset:3584
    s_waitcnt lgkmcnt(14)
    v_mfma_f32_16x16x32_bf16 v[32:35], a[28:31], a[168:171], v[32:35]
    v_mfma_f32_16x16x32_bf16 v[36:39], a[28:31], a[172:175], v[36:39]
    s_add_u32 m0, s30, 65536
    s_bfm_b64 exec, 48, 0
    buffer_load_dwordx4 v10, s[12:15], s35 offen lds
    s_mov_b64 exec, -1
    ds_read_b64_tr_b16 a[28:29], v4 offset:32
    ds_read_b64_tr_b16 a[30:31], v4 offset:3616
    s_waitcnt lgkmcnt(14)
    v_mfma_f32_16x16x32_bf16 v[40:43], a[0:3], a[168:171], v[40:43]
    v_mfma_f32_16x16x32_bf16 v[44:47], a[0:3], a[172:175], v[44:47]
    s_add_u32 m0, s31, 43008
    s_mov_b64 exec, 0xffffffff
    buffer_load_dwordx4 v11, s[12:15], s35 offen lds
    s_mov_b64 exec, -1
    ds_read_b64_tr_b16 a[0:1], v4 offset:64
    ds_read_b64_tr_b16 a[2:3], v4 offset:3648
    s_waitcnt lgkmcnt(14)
    v_mfma_f32_16x16x32_bf16 v[48:51], a[4:7], a[168:171], v[48:51]
    v_mfma_f32_16x16x32_bf16 v[52:55], a[4:7], a[172:175], v[52:55]
    buffer_load_dwordx4 a[200:203], v1, s[16:19], s38 offen offset:3072
    ds_read_b64_tr_b16 a[4:5], v4 offset:96
    ds_read_b64_tr_b16 a[6:7], v4 offset:3680
    s_waitcnt lgkmcnt(14)
    v_mfma_f32_16x16x32_bf16 v[56:59], a[8:11], a[168:171], v[56:59]
    v_mfma_f32_16x16x32_bf16 v[60:63], a[8:11], a[172:175], v[60:63]
    buffer_load_dwordx4 a[204:207], v1, s[16:19], s39 offen offset:3072
    ds_read_b64_tr_b16 a[8:9], v4 offset:128
    ds_read_b64_tr_b16 a[10:11], v4 offset:3712
    s_waitcnt lgkmcnt(14)
    v_mfma_f32_16x16x32_bf16 v[64:67], a[12:15], a[168:171], v[64:67]
    v_mfma_f32_16x16x32_bf16 v[68:71], a[12:15], a[172:175], v[68:71]
    ds_read_b64_tr_b16 a[12:13], v4 offset:160
    ds_read_b64_tr_b16 a[14:15], v4 offset:3744
    s_waitcnt lgkmcnt(14)
    v_mfma_f32_16x16x32_bf16 v[72:75], a[16:19], a[168:171], v[72:75]
    v_mfma_f32_16x16x32_bf16 v[76:79], a[16:19], a[172:175], v[76:79]
    ds_read_b64_tr_b16 a[16:17], v4 offset:192
    ds_read_b64_tr_b16 a[18:19], v4 offset:3776
    s_waitcnt lgkmcnt(14)
    v_mfma_f32_16x16x32_bf16 v[80:83], a[20:23], a[168:171], v[80:83]
    v_mfma_f32_16x16x32_bf16 v[84:87], a[20:23], a[172:175], v[84:87]
    s_add_u32 m0, s30, 71680
    s_add_u32 s35, s37, 165888
    buffer_load_dwordx4 v9, s[12:15], s35 offen lds
    ds_read_b64_tr_b16 a[20:21], v4 offset:7168
    ds_read_b64_tr_b16 a[22:23], v4 offset:10752
    s_waitcnt lgkmcnt(14)
    v_mfma_f32_16x16x32_bf16 v[32:35], a[24:27], a[176:179], v[32:35]
    v_mfma_f32_16x16x32_bf16 v[36:39], a[24:27], a[180:183], v[36:39]
    s_add_u32 m0, s30, 72704
    s_bfm_b64 exec, 48, 0
    buffer_load_dwordx4 v10, s[12:15], s35 offen lds
    s_mov_b64 exec, -1
    ds_read_b64_tr_b16 a[24:25], v4 offset:7200
    ds_read_b64_tr_b16 a[26:27], v4 offset:10784
    s_waitcnt lgkmcnt(14)
    v_mfma_f32_16x16x32_bf16 v[40:43], a[28:31], a[176:179], v[40:43]
    v_mfma_f32_16x16x32_bf16 v[44:47], a[28:31], a[180:183], v[44:47]
    s_add_u32 m0, s31, 45056
    s_mov_b64 exec, 0xffffffff
    buffer_load_dwordx4 v11, s[12:15], s35 offen lds
    s_mov_b64 exec, -1
    ds_read_b64_tr_b16 a[28:29], v4 offset:7232
    ds_read_b64_tr_b16 a[30:31], v4 offset:10816
    s_waitcnt lgkmcnt(14)
    v_mfma_f32_16x16x32_bf16 v[48:51], a[0:3], a[176:179], v[48:51]
    v_mfma_f32_16x16x32_bf16 v[52:55], a[0:3], a[180:183], v[52:55]
    s_add_u32 s38, s38, 4096
    buffer_load_dwordx4 a[208:211], v1, s[16:19], s38 offen offset:0
    ds_read_b64_tr_b16 a[0:1], v4 offset:7264
    ds_read_b64_tr_b16 a[2:3], v4 offset:10848
    s_waitcnt lgkmcnt(14)
    v_mfma_f32_16x16x32_bf16 v[56:59], a[4:7], a[176:179], v[56:59]
    v_mfma_f32_16x16x32_bf16 v[60:63], a[4:7], a[180:183], v[60:63]
    s_add_u32 s39, s39, 4096
    buffer_load_dwordx4 a[212:215], v1, s[16:19], s39 offen offset:0
    ds_read_b64_tr_b16 a[4:5], v4 offset:7296
    ds_read_b64_tr_b16 a[6:7], v4 offset:10880
    s_waitcnt lgkmcnt(14)
    v_mfma_f32_16x16x32_bf16 v[64:67], a[8:11], a[176:179], v[64:67]
    v_mfma_f32_16x16x32_bf16 v[68:71], a[8:11], a[180:183], v[68:71]
    ds_read_b64_tr_b16 a[8:9], v4 offset:7328
    ds_read_b64_tr_b16 a[10:11], v4 offset:10912
    s_waitcnt lgkmcnt(14)
    v_mfma_f32_16x16x32_bf16 v[72:75], a[12:15], a[176:179], v[72:75]
    v_mfma_f32_16x16x32_bf16 v[76:79], a[12:15], a[180:183], v[76:79]
    ds_read_b64_tr_b16 a[12:13], v4 offset:7360
    ds_read_b64_tr_b16 a[14:15], v4 offset:10944
    s_waitcnt lgkmcnt(14)
    v_mfma_f32_16x16x32_bf16 v[80:83], a[16:19], a[176:179], v[80:83]
    v_mfma_f32_16x16x32_bf16 v[84:87], a[16:19], a[180:183], v[84:87]
    s_add_u32 m0, s30, 78848
    s_add_u32 s35, s37, 202752
    buffer_load_dwordx4 v9, s[12:15], s35 offen lds
    s_waitcnt vmcnt(8)
    s_barrier
    ds_read_b64_tr_b16 a[16:17], v4 offset:14336
    ds_read_b64_tr_b16 a[18:19], v4 offset:17920
    s_waitcnt lgkmcnt(14)
    v_mfma_f32_16x16x32_bf16 v[32:35], a[20:23], a[184:187], v[32:35]
    v_mfma_f32_16x16x32_bf16 v[36:39], a[20:23], a[188:191], v[36:39]
    s_add_u32 m0, s30, 79872
    s_bfm_b64 exec, 48, 0
    buffer_load_dwordx4 v10, s[12:15], s35 offen lds
    s_mov_b64 exec, -1
    ds_read_b64_tr_b16 a[20:21], v4 offset:14368
    ds_read_b64_tr_b16 a[22:23], v4 offset:17952
    s_waitcnt lgkmcnt(14)
    v_mfma_f32_16x16x32_bf16 v[40:43], a[24:27], a[184:187], v[40:43]
    v_mfma_f32_16x16x32_bf16 v[44:47], a[24:27], a[188:191], v[44:47]
    s_add_u32 m0, s31, 47104
    s_mov_b64 exec, 0xffffffff
    buffer_load_dwordx4 v11, s[12:15], s35 offen lds
    s_mov_b64 exec, -1
    ds_read_b64_tr_b16 a[24:25], v4 offset:14400
    ds_read_b64_tr_b16 a[26:27], v4 offset:17984
    s_waitcnt lgkmcnt(14)
    v_mfma_f32_16x16x32_bf16 v[48:51], a[28:31], a[184:187], v[48:51]
    v_mfma_f32_16x16x32_bf16 v[52:55], a[28:31], a[188:191], v[52:55]
    buffer_load_dwordx4 a[216:219], v1, s[16:19], s38 offen offset:1024
    ds_read_b64_tr_b16 a[28:29], v4 offset:14432
    ds_read_b64_tr_b16 a[30:31], v4 offset:18016
    s_waitcnt lgkmcnt(14)
    v_mfma_f32_16x16x32_bf16 v[56:59], a[0:3], a[184:187], v[56:59]
    v_mfma_f32_16x16x32_bf16 v[60:63], a[0:3], a[188:191], v[60:63]
    buffer_load_dwordx4 a[220:223], v1, s[16:19], s39 offen offset:1024
    ds_read_b64_tr_b16 a[0:1], v4 offset:14464
    ds_read_b64_tr_b16 a[2:3], v4 offset:18048
    s_waitcnt lgkmcnt(14)
    v_mfma_f32_16x16x32_bf16 v[64:67], a[4:7], a[184:187], v[64:67]
    v_mfma_f32_16x16x32_bf16 v[68:71], a[4:7], a[188:191], v[68:71]
    ds_read_b64_tr_b16 a[4:5], v4 offset:14496
    ds_read_b64_tr_b16 a[6:7], v4 offset:18080
    s_waitcnt lgkmcnt(14)
    v_mfma_f32_16x16x32_bf16 v[72:75], a[8:11], a[184:187], v[72:75]
    v_mfma_f32_16x16x32_bf16 v[76:79], a[8:11], a[188:191], v[76:79]
    ds_read_b64_tr_b16 a[8:9], v4 offset:14528
    ds_read_b64_tr_b16 a[10:11], v4 offset:18112
    s_waitcnt lgkmcnt(14)
    v_mfma_f32_16x16x32_bf16 v[80:83], a[12:15], a[184:187], v[80:83]
    v_mfma_f32_16x16x32_bf16 v[84:87], a[12:15], a[188:191], v[84:87]
    s_add_u32 m0, s30, 0
    s_add_u32 s35, s37, 239616
    buffer_load_dwordx4 v9, s[12:15], s35 offen lds
    ds_read_b64_tr_b16 a[12:13], v4 offset:21504
    ds_read_b64_tr_b16 a[14:15], v4 offset:25088
    s_waitcnt lgkmcnt(14)
    v_mfma_f32_16x16x32_bf16 v[32:35], a[16:19], a[192:195], v[32:35]
    v_mfma_f32_16x16x32_bf16 v[36:39], a[16:19], a[196:199], v[36:39]
    s_add_u32 m0, s30, 1024
    s_bfm_b64 exec, 48, 0
    buffer_load_dwordx4 v10, s[12:15], s35 offen lds
    s_mov_b64 exec, -1
    ds_read_b64_tr_b16 a[16:17], v4 offset:21536
    ds_read_b64_tr_b16 a[18:19], v4 offset:25120
    s_waitcnt lgkmcnt(14)
    v_mfma_f32_16x16x32_bf16 v[40:43], a[20:23], a[192:195], v[40:43]
    v_mfma_f32_16x16x32_bf16 v[44:47], a[20:23], a[196:199], v[44:47]
    s_add_u32 m0, s31, 49152
    s_mov_b64 exec, 0xffffffff
    buffer_load_dwordx4 v11, s[12:15], s35 offen lds
    s_mov_b64 exec, -1
    ds_read_b64_tr_b16 a[20:21], v4 offset:21568
    ds_read_b64_tr_b16 a[22:23], v4 offset:25152
    s_waitcnt lgkmcnt(14)
    v_mfma_f32_16x16x32_bf16 v[48:51], a[24:27], a[192:195], v[48:51]
    v_mfma_f32_16x16x32_bf16 v[52:55], a[24:27], a[196:199], v[52:55]
    buffer_load_dwordx4 a[224:227], v1, s[16:19], s38 offen offset:2048
    ds_read_b64_tr_b16 a[24:25], v4 offset:21600
    ds_read_b64_tr_b16 a[26:27], v4 offset:25184
    s_waitcnt lgkmcnt(14)
    v_mfma_f32_16x16x32_bf16 v[56:59], a[28:31], a[192:195], v[56:59]
    v_mfma_f32_16x16x32_bf16 v[60:63], a[28:31], a[196:199], v[60:63]
    buffer_load_dwordx4 a[228:231], v1, s[16:19], s39 offen offset:2048
    ds_read_b64_tr_b16 a[28:29], v4 offset:21632
    ds_read_b64_tr_b16 a[30:31], v4 offset:25216
    s_waitcnt lgkmcnt(14)
    v_mfma_f32_16x16x32_bf16 v[64:67], a[0:3], a[192:195], v[64:67]
    v_mfma_f32_16x16x32_bf16 v[68:71], a[0:3], a[196:199], v[68:71]
    ds_read_b64_tr_b16 a[0:1], v4 offset:21664
    ds_read_b64_tr_b16 a[2:3], v4 offset:25248
    s_waitcnt lgkmcnt(14)
    v_mfma_f32_16x16x32_bf16 v[72:75], a[4:7], a[192:195], v[72:75]
    v_mfma_f32_16x16x32_bf16 v[76:79], a[4:7], a[196:199], v[76:79]
    ds_read_b64_tr_b16 a[4:5], v4 offset:21696
    ds_read_b64_tr_b16 a[6:7], v4 offset:25280
    s_waitcnt lgkmcnt(14)
    v_mfma_f32_16x16x32_bf16 v[80:83], a[8:11], a[192:195], v[80:83]
    v_mfma_f32_16x16x32_bf16 v[84:87], a[8:11], a[196:199], v[84:87]
    s_add_u32 m0, s30, 7168
    s_add_u32 s35, s37, 276480
    buffer_load_dwordx4 v9, s[12:15], s35 offen lds
    s_waitcnt vmcnt(8)
    s_barrier
    ds_read_b64_tr_b16 a[8:9], v4 offset:28672
    ds_read_b64_tr_b16 a[10:11], v4 offset:32256
    s_waitcnt lgkmcnt(14)
    v_mfma_f32_16x16x32_bf16 v[32:35], a[12:15], a[200:203], v[32:35]
    v_mfma_f32_16x16x32_bf16 v[36:39], a[12:15], a[204:207], v[36:39]
    s_add_u32 m0, s30, 8192
    s_bfm_b64 exec, 48, 0
    buffer_load_dwordx4 v10, s[12:15], s35 offen lds
    s_mov_b64 exec, -1
    ds_read_b64_tr_b16 a[12:13], v4 offset:28704
    ds_read_b64_tr_b16 a[14:15], v4 offset:32288
    s_waitcnt lgkmcnt(14)
    v_mfma_f32_16x16x32_bf16 v[40:43], a[16:19], a[200:203], v[40:43]
    v_mfma_f32_16x16x32_bf16 v[44:47], a[16:19], a[204:207], v[44:47]
    s_add_u32 m0, s31, 51200
    s_mov_b64 exec, 0xffffffff
    buffer_load_dwordx4 v11, s[12:15], s35 offen lds
    s_mov_b64 exec, -1
    ds_read_b64_tr_b16 a[16:17], v4 offset:28736
    ds_read_b64_tr_b16 a[18:19], v4 offset:32320
    s_waitcnt lgkmcnt(14)
    v_mfma_f32_16x16x32_bf16 v[48:51], a[20:23], a[200:203], v[48:51]
    v_mfma_f32_16x16x32_bf16 v[52:55], a[20:23], a[204:207], v[52:55]
    buffer_load_dwordx4 a[232:235], v1, s[16:19], s38 offen offset:3072
    ds_read_b64_tr_b16 a[20:21], v4 offset:28768
    ds_read_b64_tr_b16 a[22:23], v4 offset:32352
    s_waitcnt lgkmcnt(14)
    v_mfma_f32_16x16x32_bf16 v[56:59], a[24:27], a[200:203], v[56:59]
    v_mfma_f32_16x16x32_bf16 v[60:63], a[24:27], a[204:207], v[60:63]
    buffer_load_dwordx4 a[236:239], v1, s[16:19], s39 offen offset:3072
    ds_read_b64_tr_b16 a[24:25], v4 offset:28800
    ds_read_b64_tr_b16 a[26:27], v4 offset:32384
    s_waitcnt lgkmcnt(14)
    v_mfma_f32_16x16x32_bf16 v[64:67], a[28:31], a[200:203], v[64:67]
    v_mfma_f32_16x16x32_bf16 v[68:71], a[28:31], a[204:207], v[68:71]
    ds_read_b64_tr_b16 a[28:29], v4 offset:28832
    ds_read_b64_tr_b16 a[30:31], v4 offset:32416
    s_waitcnt lgkmcnt(14)
    v_mfma_f32_16x16x32_bf16 v[72:75], a[0:3], a[200:203], v[72:75]
    v_mfma_f32_16x16x32_bf16 v[76:79], a[0:3], a[204:207], v[76:79]
    ds_read_b64_tr_b16 a[0:1], v4 offset:28864
    ds_read_b64_tr_b16 a[2:3], v4 offset:32448
    s_waitcnt lgkmcnt(14)
    v_mfma_f32_16x16x32_bf16 v[80:83], a[4:7], a[200:203], v[80:83]
    v_mfma_f32_16x16x32_bf16 v[84:87], a[4:7], a[204:207], v[84:87]
    s_add_u32 m0, s30, 14336
    s_add_u32 s35, s37, 147456
    buffer_load_dwordx4 v12, s[12:15], s35 offen lds
    ds_read_b64_tr_b16 a[4:5], v4 offset:35840
    ds_read_b64_tr_b16 a[6:7], v4 offset:39424
    s_waitcnt lgkmcnt(14)
    v_mfma_f32_16x16x32_bf16 v[32:35], a[8:11], a[208:211], v[32:35]
    v_mfma_f32_16x16x32_bf16 v[36:39], a[8:11], a[212:215], v[36:39]
    s_add_u32 m0, s30, 15360
    s_bfm_b64 exec, 48, 0
    buffer_load_dwordx4 v13, s[12:15], s35 offen lds
    s_mov_b64 exec, -1
    ds_read_b64_tr_b16 a[8:9], v4 offset:35872
    ds_read_b64_tr_b16 a[10:11], v4 offset:39456
    s_waitcnt lgkmcnt(14)
    v_mfma_f32_16x16x32_bf16 v[40:43], a[12:15], a[208:211], v[40:43]
    v_mfma_f32_16x16x32_bf16 v[44:47], a[12:15], a[212:215], v[44:47]
    s_add_u32 m0, s31, 53248
    s_mov_b64 exec, 0xffffffff
    buffer_load_dwordx4 v14, s[12:15], s35 offen lds
    s_mov_b64 exec, -1
    ds_read_b64_tr_b16 a[12:13], v4 offset:35904
    ds_read_b64_tr_b16 a[14:15], v4 offset:39488
    s_waitcnt lgkmcnt(14)
    v_mfma_f32_16x16x32_bf16 v[48:51], a[16:19], a[208:211], v[48:51]
    v_mfma_f32_16x16x32_bf16 v[52:55], a[16:19], a[212:215], v[52:55]
    s_add_u32 s38, s38, 4096
    buffer_load_dwordx4 a[240:243], v1, s[16:19], s38 offen offset:0
    ds_read_b64_tr_b16 a[16:17], v4 offset:35936
    ds_read_b64_tr_b16 a[18:19], v4 offset:39520
    s_waitcnt lgkmcnt(14)
    v_mfma_f32_16x16x32_bf16 v[56:59], a[20:23], a[208:211], v[56:59]
    v_mfma_f32_16x16x32_bf16 v[60:63], a[20:23], a[212:215], v[60:63]
    s_add_u32 s39, s39, 4096
    buffer_load_dwordx4 a[244:247], v1, s[16:19], s39 offen offset:0
    ds_read_b64_tr_b16 a[20:21], v4 offset:35968
    ds_read_b64_tr_b16 a[22:23], v4 offset:39552
    s_waitcnt lgkmcnt(14)
    v_mfma_f32_16x16x32_bf16 v[64:67], a[24:27], a[208:211], v[64:67]
    v_mfma_f32_16x16x32_bf16 v[68:71], a[24:27], a[212:215], v[68:71]
    ds_read_b64_tr_b16 a[24:25], v4 offset:36000
    ds_read_b64_tr_b16 a[26:27], v4 offset:39584
    s_waitcnt lgkmcnt(14)
    v_mfma_f32_16x16x32_bf16 v[72:75], a[28:31], a[208:211], v[72:75]
    v_mfma_f32_16x16x32_bf16 v[76:79], a[28:31], a[212:215], v[76:79]
    ds_read_b64_tr_b16 a[28:29], v4 offset:36032
    ds_read_b64_tr_b16 a[30:31], v4 offset:39616
    s_waitcnt lgkmcnt(14)
    v_mfma_f32_16x16x32_bf16 v[80:83], a[0:3], a[208:211], v[80:83]
    v_mfma_f32_16x16x32_bf16 v[84:87], a[0:3], a[212:215], v[84:87]
    s_add_u32 m0, s30, 21504
    s_add_u32 s37, s40, 3
    s_and_b32 s37, s37, 3
    s_mul_i32 s37, s37, 331776
    s_add_u32 s37, s37, s34
    s_add_u32 s35, s37, 0
    buffer_load_dwordx4 v9, s[12:15], s35 offen lds
    s_waitcnt vmcnt(8)
    s_barrier
    ds_read_b64_tr_b16 a[0:1], v3 offset:0
    ds_read_b64_tr_b16 a[2:3], v3 offset:3584
    s_waitcnt lgkmcnt(14)
    v_mfma_f32_16x16x32_bf16 v[32:35], a[4:7], a[216:219], v[32:35]
    v_mfma_f32_16x16x32_bf16 v[36:39], a[4:7], a[220:223], v[36:39]
    s_add_u32 m0, s30, 22528
    s_bfm_b64 exec, 48, 0
    buffer_load_dwordx4 v10, s[12:15], s35 offen lds
    s_mov_b64 exec, -1
    ds_read_b64_tr_b16 a[4:5], v3 offset:32
    ds_read_b64_tr_b16 a[6:7], v3 offset:3616
    s_waitcnt lgkmcnt(14)
    v_mfma_f32_16x16x32_bf16 v[40:43], a[8:11], a[216:219], v[40:43]
    v_mfma_f32_16x16x32_bf16 v[44:47], a[8:11], a[220:223], v[44:47]
    s_add_u32 m0, s31, 55296
    s_mov_b64 exec, 0xffffffff
    buffer_load_dwordx4 v11, s[12:15], s35 offen lds
    s_mov_b64 exec, -1
    ds_read_b64_tr_b16 a[8:9], v3 offset:64
    ds_read_b64_tr_b16 a[10:11], v3 offset:3648
    s_waitcnt lgkmcnt(14)
    v_mfma_f32_16x16x32_bf16 v[48:51], a[12:15], a[216:219], v[48:51]
    v_mfma_f32_16x16x32_bf16 v[52:55], a[12:15], a[220:223], v[52:55]
    s_add_u32 s38, s40, 3
    s_and_b32 s38, s38, 3
    s_mul_i32 s38, s38, 9216
    s_add_u32 s38, s38, s32
    buffer_load_dwordx4 a[248:251], v1, s[16:19], s38 offen offset:0
    ds_read_b64_tr_b16 a[12:13], v3 offset:96
    ds_read_b64_tr_b16 a[14:15], v3 offset:3680
    s_waitcnt lgkmcnt(14)
    v_mfma_f32_16x16x32_bf16 v[56:59], a[16:19], a[216:219], v[56:59]
    v_mfma_f32_16x16x32_bf16 v[60:63], a[16:19], a[220:223], v[60:63]
    s_add_u32 s39, s40, 3
    s_and_b32 s39, s39, 3
    s_mul_i32 s39, s39, 9216
    s_add_u32 s39, s39, s33
    buffer_load_dwordx4 a[252:255], v1, s[16:19], s39 offen offset:0
    ds_read_b64_tr_b16 a[16:17], v3 offset:128
    ds_read_b64_tr_b16 a[18:19], v3 offset:3712
    s_waitcnt lgkmcnt(14)
    v_mfma_f32_16x16x32_bf16 v[64:67], a[20:23], a[216:219], v[64:67]
    v_mfma_f32_16x16x32_bf16 v[68:71], a[20:23], a[220:223], v[68:71]
    ds_read_b64_tr_b16 a[20:21], v3 offset:160
    ds_read_b64_tr_b16 a[22:23], v3 offset:3744
    s_waitcnt lgkmcnt(14)
    v_mfma_f32_16x16x32_bf16 v[72:75], a[24:27], a[216:219], v[72:75]
    v_mfma_f32_16x16x32_bf16 v[76:79], a[24:27], a[220:223], v[76:79]
    ds_read_b64_tr_b16 a[24:25], v3 offset:192
    ds_read_b64_tr_b16 a[26:27], v3 offset:3776
    s_waitcnt lgkmcnt(14)
    v_mfma_f32_16x16x32_bf16 v[80:83], a[28:31], a[216:219], v[80:83]
    v_mfma_f32_16x16x32_bf16 v[84:87], a[28:31], a[220:223], v[84:87]
    s_add_u32 m0, s30, 28672
    s_add_u32 s35, s37, 36864
    buffer_load_dwordx4 v9, s[12:15], s35 offen lds
    ds_read_b64_tr_b16 a[28:29], v3 offset:7168
    ds_read_b64_tr_b16 a[30:31], v3 offset:10752
    s_waitcnt lgkmcnt(14)
    v_mfma_f32_16x16x32_bf16 v[32:35], a[0:3], a[224:227], v[32:35]
    v_mfma_f32_16x16x32_bf16 v[36:39], a[0:3], a[228:231], v[36:39]
    s_add_u32 m0, s30, 29696
    s_bfm_b64 exec, 48, 0
    buffer_load_dwordx4 v10, s[12:15], s35 offen lds
    s_mov_b64 exec, -1
    ds_read_b64_tr_b16 a[0:1], v3 offset:7200
    ds_read_b64_tr_b16 a[2:3], v3 offset:10784
    s_waitcnt lgkmcnt(14)
    v_mfma_f32_16x16x32_bf16 v[40:43], a[4:7], a[224:227], v[40:43]
    v_mfma_f32_16x16x32_bf16 v[44:47], a[4:7], a[228:231], v[44:47]
    s_add_u32 m0, s31, 57344
    s_mov_b64 exec, 0xffffffff
    buffer_load_dwordx4 v11, s[12:15], s35 offen lds
    s_mov_b64 exec, -1
    ds_read_b64_tr_b16 a[4:5], v3 offset:7232
    ds_read_b64_tr_b16 a[6:7], v3 offset:10816
    s_waitcnt lgkmcnt(14)
    v_mfma_f32_16x16x32_bf16 v[48:51], a[8:11], a[224:227], v[48:51]
    v_mfma_f32_16x16x32_bf16 v[52:55], a[8:11], a[228:231], v[52:55]
    buffer_load_dwordx4 v[164:167], v1, s[16:19], s38 offen offset:1024
    ds_read_b64_tr_b16 a[8:9], v3 offset:7264
    ds_read_b64_tr_b16 a[10:11], v3 offset:10848
    s_waitcnt lgkmcnt(14)
    v_mfma_f32_16x16x32_bf16 v[56:59], a[12:15], a[224:227], v[56:59]
    v_mfma_f32_16x16x32_bf16 v[60:63], a[12:15], a[228:231], v[60:63]
    buffer_load_dwordx4 v[168:171], v1, s[16:19], s39 offen offset:1024
    ds_read_b64_tr_b16 a[12:13], v3 offset:7296
    ds_read_b64_tr_b16 a[14:15], v3 offset:10880
    s_waitcnt lgkmcnt(14)
    v_mfma_f32_16x16x32_bf16 v[64:67], a[16:19], a[224:227], v[64:67]
    v_mfma_f32_16x16x32_bf16 v[68:71], a[16:19], a[228:231], v[68:71]
    ds_read_b64_tr_b16 a[16:17], v3 offset:7328
    ds_read_b64_tr_b16 a[18:19], v3 offset:10912
    s_waitcnt lgkmcnt(14)
    v_mfma_f32_16x16x32_bf16 v[72:75], a[20:23], a[224:227], v[72:75]
    v_mfma_f32_16x16x32_bf16 v[76:79], a[20:23], a[228:231], v[76:79]
    ds_read_b64_tr_b16 a[20:21], v3 offset:7360
    ds_read_b64_tr_b16 a[22:23], v3 offset:10944
    s_waitcnt lgkmcnt(14)
    v_mfma_f32_16x16x32_bf16 v[80:83], a[24:27], a[224:227], v[80:83]
    v_mfma_f32_16x16x32_bf16 v[84:87], a[24:27], a[228:231], v[84:87]
    s_add_u32 m0, s30, 35840
    s_add_u32 s35, s37, 73728
    buffer_load_dwordx4 v9, s[12:15], s35 offen lds
    s_waitcnt vmcnt(8)
    s_barrier
    ds_read_b64_tr_b16 a[24:25], v3 offset:14336
    ds_read_b64_tr_b16 a[26:27], v3 offset:17920
    s_waitcnt lgkmcnt(14)
    v_mfma_f32_16x16x32_bf16 v[32:35], a[28:31], a[232:235], v[32:35]
    v_mfma_f32_16x16x32_bf16 v[36:39], a[28:31], a[236:239], v[36:39]
    s_add_u32 m0, s30, 36864
    s_bfm_b64 exec, 48, 0
    buffer_load_dwordx4 v10, s[12:15], s35 offen lds
    s_mov_b64 exec, -1
    ds_read_b64_tr_b16 a[28:29], v3 offset:14368
    ds_read_b64_tr_b16 a[30:31], v3 offset:17952
    s_waitcnt lgkmcnt(14)
    v_mfma_f32_16x16x32_bf16 v[40:43], a[0:3], a[232:235], v[40:43]
    v_mfma_f32_16x16x32_bf16 v[44:47], a[0:3], a[236:239], v[44:47]
    s_add_u32 m0, s31, 59392
    s_mov_b64 exec, 0xffffffff
    buffer_load_dwordx4 v11, s[12:15], s35 offen lds
    s_mov_b64 exec, -1
    ds_read_b64_tr_b16 a[0:1], v3 offset:14400
    ds_read_b64_tr_b16 a[2:3], v3 offset:17984
    s_waitcnt lgkmcnt(14)
    v_mfma_f32_16x16x32_bf16 v[48:51], a[4:7], a[232:235], v[48:51]
    v_mfma_f32_16x16x32_bf16 v[52:55], a[4:7], a[236:239], v[52:55]
    buffer_load_dwordx4 v[172:175], v1, s[16:19], s38 offen offset:2048
    ds_read_b64_tr_b16 a[4:5], v3 offset:14432
    ds_read_b64_tr_b16 a[6:7], v3 offset:18016
    s_waitcnt lgkmcnt(14)
    v_mfma_f32_16x16x32_bf16 v[56:59], a[8:11], a[232:235], v[56:59]
    v_mfma_f32_16x16x32_bf16 v[60:63], a[8:11], a[236:239], v[60:63]
    buffer_load_dwordx4 v[176:179], v1, s[16:19], s39 offen offset:2048
    ds_read_b64_tr_b16 a[8:9], v3 offset:14464
    ds_read_b64_tr_b16 a[10:11], v3 offset:18048
    s_waitcnt lgkmcnt(14)
    v_mfma_f32_16x16x32_bf16 v[64:67], a[12:15], a[232:235], v[64:67]
    v_mfma_f32_16x16x32_bf16 v[68:71], a[12:15], a[236:239], v[68:71]
    ds_read_b64_tr_b16 a[12:13], v3 offset:14496
    ds_read_b64_tr_b16 a[14:15], v3 offset:18080
    s_waitcnt lgkmcnt(14)
    v_mfma_f32_16x16x32_bf16 v[72:75], a[16:19], a[232:235], v[72:75]
    v_mfma_f32_16x16x32_bf16 v[76:79], a[16:19], a[236:239], v[76:79]
    ds_read_b64_tr_b16 a[16:17], v3 offset:14528
    ds_read_b64_tr_b16 a[18:19], v3 offset:18112
    s_waitcnt lgkmcnt(14)
    v_mfma_f32_16x16x32_bf16 v[80:83], a[20:23], a[232:235], v[80:83]
    v_mfma_f32_16x16x32_bf16 v[84:87], a[20:23], a[236:239], v[84:87]
    s_add_u32 m0, s30, 43008
    s_add_u32 s35, s37, 110592
    buffer_load_dwordx4 v9, s[12:15], s35 offen lds
    ds_read_b64_tr_b16 a[20:21], v3 offset:21504
    ds_read_b64_tr_b16 a[22:23], v3 offset:25088
    s_waitcnt lgkmcnt(14)
    v_mfma_f32_16x16x32_bf16 v[32:35], a[24:27], a[240:243], v[32:35]
    v_mfma_f32_16x16x32_bf16 v[36:39], a[24:27], a[244:247], v[36:39]
    s_add_u32 m0, s30, 44032
    s_bfm_b64 exec, 48, 0
    buffer_load_dwordx4 v10, s[12:15], s35 offen lds
    s_mov_b64 exec, -1
    ds_read_b64_tr_b16 a[24:25], v3 offset:21536
    ds_read_b64_tr_b16 a[26:27], v3 offset:25120
    s_waitcnt lgkmcnt(14)
    v_mfma_f32_16x16x32_bf16 v[40:43], a[28:31], a[240:243], v[40:43]
    v_mfma_f32_16x16x32_bf16 v[44:47], a[28:31], a[244:247], v[44:47]
    s_add_u32 m0, s31, 61440
    s_mov_b64 exec, 0xffffffff
    buffer_load_dwordx4 v11, s[12:15], s35 offen lds
    s_mov_b64 exec, -1
    ds_read_b64_tr_b16 a[28:29], v3 offset:21568
    ds_read_b64_tr_b16 a[30:31], v3 offset:25152
    s_waitcnt lgkmcnt(14)
    v_mfma_f32_16x16x32_bf16 v[48:51], a[0:3], a[240:243], v[48:51]
    v_mfma_f32_16x16x32_bf16 v[52:55], a[0:3], a[244:247], v[52:55]
    buffer_load_dwordx4 v[180:183], v1, s[16:19], s38 offen offset:3072
    ds_read_b64_tr_b16 a[0:1], v3 offset:21600
    ds_read_b64_tr_b16 a[2:3], v3 offset:25184
    s_waitcnt lgkmcnt(14)
    v_mfma_f32_16x16x32_bf16 v[56:59], a[4:7], a[240:243], v[56:59]
    v_mfma_f32_16x16x32_bf16 v[60:63], a[4:7], a[244:247], v[60:63]
    buffer_load_dwordx4 v[184:187], v1, s[16:19], s39 offen offset:3072
    ds_read_b64_tr_b16 a[4:5], v3 offset:21632
    ds_read_b64_tr_b16 a[6:7], v3 offset:25216
    s_waitcnt lgkmcnt(14)
    v_mfma_f32_16x16x32_bf16 v[64:67], a[8:11], a[240:243], v[64:67]
    v_mfma_f32_16x16x32_bf16 v[68:71], a[8:11], a[244:247], v[68:71]
    ds_read_b64_tr_b16 a[8:9], v3 offset:21664
    ds_read_b64_tr_b16 a[10:11], v3 offset:25248
    s_waitcnt lgkmcnt(14)
    v_mfma_f32_16x16x32_bf16 v[72:75], a[12:15], a[240:243], v[72:75]
    v_mfma_f32_16x16x32_bf16 v[76:79], a[12:15], a[244:247], v[76:79]
    ds_read_b64_tr_b16 a[12:13], v3 offset:21696
    ds_read_b64_tr_b16 a[14:15], v3 offset:25280
    s_waitcnt lgkmcnt(14)
    v_mfma_f32_16x16x32_bf16 v[80:83], a[16:19], a[240:243], v[80:83]
    v_mfma_f32_16x16x32_bf16 v[84:87], a[16:19], a[244:247], v[84:87]
    s_add_u32 m0, s30, 50176
    s_add_u32 s35, s37, 165888
    buffer_load_dwordx4 v9, s[12:15], s35 offen lds
    s_waitcnt vmcnt(8)
    s_barrier
    ds_read_b64_tr_b16 a[16:17], v3 offset:28672
    ds_read_b64_tr_b16 a[18:19], v3 offset:32256
    s_waitcnt lgkmcnt(14)
    v_mfma_f32_16x16x32_bf16 v[32:35], a[20:23], a[248:251], v[32:35]
    v_mfma_f32_16x16x32_bf16 v[36:39], a[20:23], a[252:255], v[36:39]
    s_add_u32 m0, s30, 51200
    s_bfm_b64 exec, 48, 0
    buffer_load_dwordx4 v10, s[12:15], s35 offen lds
    s_mov_b64 exec, -1
    ds_read_b64_tr_b16 a[20:21], v3 offset:28704
    ds_read_b64_tr_b16 a[22:23], v3 offset:32288
    s_waitcnt lgkmcnt(14)
    v_mfma_f32_16x16x32_bf16 v[40:43], a[24:27], a[248:251], v[40:43]
    v_mfma_f32_16x16x32_bf16 v[44:47], a[24:27], a[252:255], v[44:47]
    s_add_u32 m0, s31, 63488
    s_mov_b64 exec, 0xffffffff
    buffer_load_dwordx4 v11, s[12:15], s35 offen lds
    s_mov_b64 exec, -1
    ds_read_b64_tr_b16 a[24:25], v3 offset:28736
    ds_read_b64_tr_b16 a[26:27], v3 offset:32320
    s_waitcnt lgkmcnt(14)
    v_mfma_f32_16x16x32_bf16 v[48:51], a[28:31], a[248:251], v[48:51]
    v_mfma_f32_16x16x32_bf16 v[52:55], a[28:31], a[252:255], v[52:55]
    s_add_u32 s38, s38, 4096
    buffer_load_dwordx4 v[188:191], v1, s[16:19], s38 offen offset:0
    ds_read_b64_tr_b16 a[28:29], v3 offset:28768
    ds_read_b64_tr_b16 a[30:31], v3 offset:32352
    s_waitcnt lgkmcnt(14)
    v_mfma_f32_16x16x32_bf16 v[56:59], a[0:3], a[248:251], v[56:59]
    v_mfma_f32_16x16x32_bf16 v[60:63], a[0:3], a[252:255], v[60:63]
    s_add_u32 s39, s39, 4096
    buffer_load_dwordx4 v[192:195], v1, s[16:19], s39 offen offset:0
    ds_read_b64_tr_b16 a[0:1], v3 offset:28800
    ds_read_b64_tr_b16 a[2:3], v3 offset:32384
    s_waitcnt lgkmcnt(14)
    v_mfma_f32_16x16x32_bf16 v[64:67], a[4:7], a[248:251], v[64:67]
    v_mfma_f32_16x16x32_bf16 v[68:71], a[4:7], a[252:255], v[68:71]
    ds_read_b64_tr_b16 a[4:5], v3 offset:28832
    ds_read_b64_tr_b16 a[6:7], v3 offset:32416
    s_waitcnt lgkmcnt(14)
    v_mfma_f32_16x16x32_bf16 v[72:75], a[8:11], a[248:251], v[72:75]
    v_mfma_f32_16x16x32_bf16 v[76:79], a[8:11], a[252:255], v[76:79]
    ds_read_b64_tr_b16 a[8:9], v3 offset:28864
    ds_read_b64_tr_b16 a[10:11], v3 offset:32448
    s_waitcnt lgkmcnt(14)
    v_mfma_f32_16x16x32_bf16 v[80:83], a[12:15], a[248:251], v[80:83]
    v_mfma_f32_16x16x32_bf16 v[84:87], a[12:15], a[252:255], v[84:87]
    s_add_u32 m0, s30, 57344
    s_add_u32 s35, s37, 202752
    buffer_load_dwordx4 v9, s[12:15], s35 offen lds
    ds_read_b64_tr_b16 a[12:13], v3 offset:35840
    ds_read_b64_tr_b16 a[14:15], v3 offset:39424
    s_waitcnt lgkmcnt(14)
    v_mfma_f32_16x16x32_bf16 v[32:35], a[16:19], v[164:167], v[32:35]
    v_mfma_f32_16x16x32_bf16 v[36:39], a[16:19], v[168:171], v[36:39]
    s_add_u32 m0, s30, 58368
    s_bfm_b64 exec, 48, 0
    buffer_load_dwordx4 v10, s[12:15], s35 offen lds
    s_mov_b64 exec, -1
    ds_read_b64_tr_b16 a[16:17], v3 offset:35872
    ds_read_b64_tr_b16 a[18:19], v3 offset:39456
    s_waitcnt lgkmcnt(14)
    v_mfma_f32_16x16x32_bf16 v[40:43], a[20:23], v[164:167], v[40:43]
    v_mfma_f32_16x16x32_bf16 v[44:47], a[20:23], v[168:171], v[44:47]
    s_add_u32 m0, s31, 65536
    s_mov_b64 exec, 0xffffffff
    buffer_load_dwordx4 v11, s[12:15], s35 offen lds
    s_mov_b64 exec, -1
    ds_read_b64_tr_b16 a[20:21], v3 offset:35904
    ds_read_b64_tr_b16 a[22:23], v3 offset:39488
    s_waitcnt lgkmcnt(14)
    v_mfma_f32_16x16x32_bf16 v[48:51], a[24:27], v[164:167], v[48:51]
    v_mfma_f32_16x16x32_bf16 v[52:55], a[24:27], v[168:171], v[52:55]
    buffer_load_dwordx4 v[196:199], v1, s[16:19], s38 offen offset:1024
    ds_read_b64_tr_b16 a[24:25], v3 offset:35936
    ds_read_b64_tr_b16 a[26:27], v3 offset:39520
    s_waitcnt lgkmcnt(14)
    v_mfma_f32_16x16x32_bf16 v[56:59], a[28:31], v[164:167], v[56:59]
    v_mfma_f32_16x16x32_bf16 v[60:63], a[28:31], v[168:171], v[60:63]
    buffer_load_dwordx4 v[200:203], v1, s[16:19], s39 offen offset:1024
    ds_read_b64_tr_b16 a[28:29], v3 offset:35968
    ds_read_b64_tr_b16 a[30:31], v3 offset:39552
    s_waitcnt lgkmcnt(14)
    v_mfma_f32_16x16x32_bf16 v[64:67], a[0:3], v[164:167], v[64:67]
    v_mfma_f32_16x16x32_bf16 v[68:71], a[0:3], v[168:171], v[68:71]
    ds_read_b64_tr_b16 a[0:1], v3 offset:36000
    ds_read_b64_tr_b16 a[2:3], v3 offset:39584
    s_waitcnt lgkmcnt(14)
    v_mfma_f32_16x16x32_bf16 v[72:75], a[4:7], v[164:167], v[72:75]
    v_mfma_f32_16x16x32_bf16 v[76:79], a[4:7], v[168:171], v[76:79]
    ds_read_b64_tr_b16 a[4:5], v3 offset:36032
    ds_read_b64_tr_b16 a[6:7], v3 offset:39616
    s_waitcnt lgkmcnt(14)
    v_mfma_f32_16x16x32_bf16 v[80:83], a[8:11], v[164:167], v[80:83]
    v_mfma_f32_16x16x32_bf16 v[84:87], a[8:11], v[168:171], v[84:87]
    s_add_u32 m0, s30, 64512
    s_add_u32 s35, s37, 239616
    buffer_load_dwordx4 v9, s[12:15], s35 offen lds
    s_waitcnt vmcnt(8)
    s_barrier
    ds_read_b64_tr_b16 a[8:9], v4 offset:0
    ds_read_b64_tr_b16 a[10:11], v4 offset:3584
    s_waitcnt lgkmcnt(14)
    v_mfma_f32_16x16x32_bf16 v[32:35], a[12:15], v[172:175], v[32:35]
    v_mfma_f32_16x16x32_bf16 v[36:39], a[12:15], v[176:179], v[36:39]
    s_add_u32 m0, s30, 65536
    s_bfm_b64 exec, 48, 0
    buffer_load_dwordx4 v10, s[12:15], s35 offen lds
    s_mov_b64 exec, -1
    ds_read_b64_tr_b16 a[12:13], v4 offset:32
    ds_read_b64_tr_b16 a[14:15], v4 offset:3616
    s_waitcnt lgkmcnt(14)
    v_mfma_f32_16x16x32_bf16 v[40:43], a[16:19], v[172:175], v[40:43]
    v_mfma_f32_16x16x32_bf16 v[44:47], a[16:19], v[176:179], v[44:47]
    s_add_u32 m0, s31, 67584
    s_mov_b64 exec, 0xffffffff
    buffer_load_dwordx4 v11, s[12:15], s35 offen lds
    s_mov_b64 exec, -1
    ds_read_b64_tr_b16 a[16:17], v4 offset:64
    ds_read_b64_tr_b16 a[18:19], v4 offset:3648
    s_waitcnt lgkmcnt(14)
    v_mfma_f32_16x16x32_bf16 v[48:51], a[20:23], v[172:175], v[48:51]
    v_mfma_f32_16x16x32_bf16 v[52:55], a[20:23], v[176:179], v[52:55]
    buffer_load_dwordx4 v[204:207], v1, s[16:19], s38 offen offset:2048
    ds_read_b64_tr_b16 a[20:21], v4 offset:96
    ds_read_b64_tr_b16 a[22:23], v4 offset:3680
    s_waitcnt lgkmcnt(14)
    v_mfma_f32_16x16x32_bf16 v[56:59], a[24:27], v[172:175], v[56:59]
    v_mfma_f32_16x16x32_bf16 v[60:63], a[24:27], v[176:179], v[60:63]
    buffer_load_dwordx4 v[208:211], v1, s[16:19], s39 offen offset:2048
    ds_read_b64_tr_b16 a[24:25], v4 offset:128
    ds_read_b64_tr_b16 a[26:27], v4 offset:3712
    s_waitcnt lgkmcnt(14)
    v_mfma_f32_16x16x32_bf16 v[64:67], a[28:31], v[172:175], v[64:67]
    v_mfma_f32_16x16x32_bf16 v[68:71], a[28:31], v[176:179], v[68:71]
    ds_read_b64_tr_b16 a[28:29], v4 offset:160
    ds_read_b64_tr_b16 a[30:31], v4 offset:3744
    s_waitcnt lgkmcnt(14)
    v_mfma_f32_16x16x32_bf16 v[72:75], a[0:3], v[172:175], v[72:75]
    v_mfma_f32_16x16x32_bf16 v[76:79], a[0:3], v[176:179], v[76:79]
    ds_read_b64_tr_b16 a[0:1], v4 offset:192
    ds_read_b64_tr_b16 a[2:3], v4 offset:3776
    s_waitcnt lgkmcnt(14)
    v_mfma_f32_16x16x32_bf16 v[80:83], a[4:7], v[172:175], v[80:83]
    v_mfma_f32_16x16x32_bf16 v[84:87], a[4:7], v[176:179], v[84:87]
    s_add_u32 m0, s30, 71680
    s_add_u32 s35, s37, 276480
    buffer_load_dwordx4 v9, s[12:15], s35 offen lds
    ds_read_b64_tr_b16 a[4:5], v4 offset:7168
    ds_read_b64_tr_b16 a[6:7], v4 offset:10752
    s_waitcnt lgkmcnt(14)
    v_mfma_f32_16x16x32_bf16 v[32:35], a[8:11], v[180:183], v[32:35]
    v_mfma_f32_16x16x32_bf16 v[36:39], a[8:11], v[184:187], v[36:39]
    s_add_u32 m0, s30, 72704
    s_bfm_b64 exec, 48, 0
    buffer_load_dwordx4 v10, s[12:15], s35 offen lds
    s_mov_b64 exec, -1
    ds_read_b64_tr_b16 a[8:9], v4 offset:7200
    ds_read_b64_tr_b16 a[10:11], v4 offset:10784
    s_waitcnt lgkmcnt(14)
    v_mfma_f32_16x16x32_bf16 v[40:43], a[12:15], v[180:183], v[40:43]
    v_mfma_f32_16x16x32_bf16 v[44:47], a[12:15], v[184:187], v[44:47]
    s_add_u32 m0, s31, 69632
    s_mov_b64 exec, 0xffffffff
    buffer_load_dwordx4 v11, s[12:15], s35 offen lds
    s_mov_b64 exec, -1
    ds_read_b64_tr_b16 a[12:13], v4 offset:7232
    ds_read_b64_tr_b16 a[14:15], v4 offset:10816
    s_waitcnt lgkmcnt(14)
    v_mfma_f32_16x16x32_bf16 v[48:51], a[16:19], v[180:183], v[48:51]
    v_mfma_f32_16x16x32_bf16 v[52:55], a[16:19], v[184:187], v[52:55]
    buffer_load_dwordx4 v[212:215], v1, s[16:19], s38 offen offset:3072
    ds_read_b64_tr_b16 a[16:17], v4 offset:7264
    ds_read_b64_tr_b16 a[18:19], v4 offset:10848
    s_waitcnt lgkmcnt(14)
    v_mfma_f32_16x16x32_bf16 v[56:59], a[20:23], v[180:183], v[56:59]
    v_mfma_f32_16x16x32_bf16 v[60:63], a[20:23], v[184:187], v[60:63]
    buffer_load_dwordx4 v[216:219], v1, s[16:19], s39 offen offset:3072
    ds_read_b64_tr_b16 a[20:21], v4 offset:7296
    ds_read_b64_tr_b16 a[22:23], v4 offset:10880
    s_waitcnt lgkmcnt(14)
    v_mfma_f32_16x16x32_bf16 v[64:67], a[24:27], v[180:183], v[64:67]
    v_mfma_f32_16x16x32_bf16 v[68:71], a[24:27], v[184:187], v[68:71]
    ds_read_b64_tr_b16 a[24:25], v4 offset:7328
    ds_read_b64_tr_b16 a[26:27], v4 offset:10912
    s_waitcnt lgkmcnt(14)
    v_mfma_f32_16x16x32_bf16 v[72:75], a[28:31], v[180:183], v[72:75]
    v_mfma_f32_16x16x32_bf16 v[76:79], a[28:31], v[184:187], v[76:79]
    ds_read_b64_tr_b16 a[28:29], v4 offset:7360
    ds_read_b64_tr_b16 a[30:31], v4 offset:10944
    s_waitcnt lgkmcnt(14)
    v_mfma_f32_16x16x32_bf16 v[80:83], a[0:3], v[180:183], v[80:83]
    v_mfma_f32_16x16x32_bf16 v[84:87], a[0:3], v[184:187], v[84:87]
    s_add_u32 m0, s30, 78848
    s_add_u32 s35, s37, 147456
    buffer_load_dwordx4 v12, s[12:15], s35 offen lds
    s_waitcnt vmcnt(8)
    s_barrier
    ds_read_b64_tr_b16 a[0:1], v4 offset:14336
    ds_read_b64_tr_b16 a[2:3], v4 offset:17920
    s_waitcnt lgkmcnt(14)
    v_mfma_f32_16x16x32_bf16 v[32:35], a[4:7], v[188:191], v[32:35]
    v_mfma_f32_16x16x32_bf16 v[36:39], a[4:7], v[192:195], v[36:39]
    s_add_u32 m0, s30, 79872
    s_bfm_b64 exec, 48, 0
    buffer_load_dwordx4 v13, s[12:15], s35 offen lds
    s_mov_b64 exec, -1
    ds_read_b64_tr_b16 a[4:5], v4 offset:14368
    ds_read_b64_tr_b16 a[6:7], v4 offset:17952
    s_waitcnt lgkmcnt(14)
    v_mfma_f32_16x16x32_bf16 v[40:43], a[8:11], v[188:191], v[40:43]
    v_mfma_f32_16x16x32_bf16 v[44:47], a[8:11], v[192:195], v[44:47]
    s_add_u32 m0, s31, 71680
    s_mov_b64 exec, 0xffffffff
    buffer_load_dwordx4 v14, s[12:15], s35 offen lds
    s_mov_b64 exec, -1
    ds_read_b64_tr_b16 a[8:9], v4 offset:14400
    ds_read_b64_tr_b16 a[10:11], v4 offset:17984
    s_waitcnt lgkmcnt(14)
    v_mfma_f32_16x16x32_bf16 v[48:51], a[12:15], v[188:191], v[48:51]
    v_mfma_f32_16x16x32_bf16 v[52:55], a[12:15], v[192:195], v[52:55]
    s_add_u32 s38, s38, 4096
    buffer_load_dwordx4 v[220:223], v1, s[16:19], s38 offen offset:0
    ds_read_b64_tr_b16 a[12:13], v4 offset:14432
    ds_read_b64_tr_b16 a[14:15], v4 offset:18016
    s_waitcnt lgkmcnt(14)
    v_mfma_f32_16x16x32_bf16 v[56:59], a[16:19], v[188:191], v[56:59]
    v_mfma_f32_16x16x32_bf16 v[60:63], a[16:19], v[192:195], v[60:63]
    s_add_u32 s39, s39, 4096
    buffer_load_dwordx4 v[224:227], v1, s[16:19], s39 offen offset:0
    s_mul_i32 s28, s26, 9
    s_lshl_b32 s29, s27, 1
    s_add_u32 s28, s28, s29
    s_lshr_b32 s29, s28, 1
    s_lshl_b32 s29, s29, 10
    s_and_b32 s28, s28, 1
    s_lshl_b32 s28, s28, 3
    s_add_u32 s28, s28, s29
    s_add_u32 s28, s28, s44
    s_add_u32 s29, s28, 18432
    buffer_load_dwordx2 v[88:89], v1, s[16:19], s28 offen
    buffer_load_dwordx2 v[90:91], v1, s[16:19], s29 offen
    s_mul_i32 s28, s26, 9
    s_lshl_b32 s29, s27, 1
    s_add_u32 s28, s28, s29
    s_add_u32 s28, s28, 1
    s_lshr_b32 s29, s28, 1
    s_lshl_b32 s29, s29, 10
    s_and_b32 s28, s28, 1
    s_lshl_b32 s28, s28, 3
    s_add_u32 s28, s28, s29
    s_add_u32 s28, s28, s44
    s_add_u32 s29, s28, 18432
    buffer_load_dwordx2 v[92:93], v1, s[16:19], s28 offen
    buffer_load_dwordx2 v[94:95], v1, s[16:19], s29 offen
    s_cmp_lg_u32 s24, s27
    s_cbranch_scc1 L_k5_kernel_noh
    s_mul_i32 s28, s26, 9
    s_add_u32 s28, s28, 8
    s_lshr_b32 s29, s28, 1
    s_lshl_b32 s29, s29, 10
    s_and_b32 s28, s28, 1
    s_lshl_b32 s28, s28, 3
    s_add_u32 s28, s28, s29
    s_add_u32 s28, s28, s44
    s_add_u32 s29, s28, 18432
    buffer_load_dwordx2 v[96:97], v1, s[16:19], s28 offen
    buffer_load_dwordx2 v[98:99], v1, s[16:19], s29 offen
L_k5_kernel_noh:
    ds_read_b64_tr_b16 a[16:17], v4 offset:14464
    ds_read_b64_tr_b16 a[18:19], v4 offset:18048
    s_waitcnt lgkmcnt(14)
    v_mfma_f32_16x16x32_bf16 v[64:67], a[20:23], v[188:191], v[64:67]
    v_mfma_f32_16x16x32_bf16 v[68:71], a[20:23], v[192:195], v[68:71]
    ds_read_b64_tr_b16 a[20:21], v4 offset:14496
    ds_read_b64_tr_b16 a[22:23], v4 offset:18080
    s_waitcnt lgkmcnt(14)
    v_mfma_f32_16x16x32_bf16 v[72:75], a[24:27], v[188:191], v[72:75]
    v_mfma_f32_16x16x32_bf16 v[76:79], a[24:27], v[192:195], v[76:79]
    ds_read_b64_tr_b16 a[24:25], v4 offset:14528
    ds_read_b64_tr_b16 a[26:27], v4 offset:18112
    s_waitcnt lgkmcnt(14)
    v_mfma_f32_16x16x32_bf16 v[80:83], a[28:31], v[188:191], v[80:83]
    v_mfma_f32_16x16x32_bf16 v[84:87], a[28:31], v[192:195], v[84:87]
    ds_read_b64_tr_b16 a[28:29], v4 offset:21504
    ds_read_b64_tr_b16 a[30:31], v4 offset:25088
    s_waitcnt lgkmcnt(14)
    v_mfma_f32_16x16x32_bf16 v[32:35], a[0:3], v[196:199], v[32:35]
    v_mfma_f32_16x16x32_bf16 v[36:39], a[0:3], v[200:203], v[36:39]
    ds_read_b64_tr_b16 a[0:1], v4 offset:21536
    ds_read_b64_tr_b16 a[2:3], v4 offset:25120
    s_waitcnt lgkmcnt(14)
    v_mfma_f32_16x16x32_bf16 v[40:43], a[4:7], v[196:199], v[40:43]
    v_mfma_f32_16x16x32_bf16 v[44:47], a[4:7], v[200:203], v[44:47]
    ds_read_b64_tr_b16 a[4:5], v4 offset:21568
    ds_read_b64_tr_b16 a[6:7], v4 offset:25152
    s_waitcnt lgkmcnt(14)
    v_mfma_f32_16x16x32_bf16 v[48:51], a[8:11], v[196:199], v[48:51]
    v_mfma_f32_16x16x32_bf16 v[52:55], a[8:11], v[200:203], v[52:55]
    ds_read_b64_tr_b16 a[8:9], v4 offset:21600
    ds_read_b64_tr_b16 a[10:11], v4 offset:25184
    s_waitcnt lgkmcnt(14)
    v_mfma_f32_16x16x32_bf16 v[56:59], a[12:15], v[196:199], v[56:59]
    v_mfma_f32_16x16x32_bf16 v[60:63], a[12:15], v[200:203], v[60:63]
    ds_read_b64_tr_b16 a[12:13], v4 offset:21632
    ds_read_b64_tr_b16 a[14:15], v4 offset:25216
    s_waitcnt lgkmcnt(14)
    v_mfma_f32_16x16x32_bf16 v[64:67], a[16:19], v[196:199], v[64:67]
    v_mfma_f32_16x16x32_bf16 v[68:71], a[16:19], v[200:203], v[68:71]
    ds_read_b64_tr_b16 a[16:17], v4 offset:21664
    ds_read_b64_tr_b16 a[18:19], v4 offset:25248
    s_waitcnt lgkmcnt(14)
    v_mfma_f32_16x16x32_bf16 v[72:75], a[20:23], v[196:199], v[72:75]
    v_mfma_f32_16x16x32_bf16 v[76:79], a[20:23], v[200:203], v[76:79]
    ds_read_b64_tr_b16 a[20:21], v4 offset:21696
    ds_read_b64_tr_b16 a[22:23], v4 offset:25280
    s_waitcnt lgkmcnt(14)
    v_mfma_f32_16x16x32_bf16 v[80:83], a[24:27], v[196:199], v[80:83]
    v_mfma_f32_16x16x32_bf16 v[84:87], a[24:27], v[200:203], v[84:87]
    s_waitcnt vmcnt(6)
    s_barrier
    ds_read_b64_tr_b16 a[24:25], v4 offset:28672
    ds_read_b64_tr_b16 a[26:27], v4 offset:32256
    s_waitcnt lgkmcnt(14)
    v_mfma_f32_16x16x32_bf16 v[32:35], a[28:31], v[204:207], v[32:35]
    v_mfma_f32_16x16x32_bf16 v[36:39], a[28:31], v[208:211], v[36:39]
    ds_read_b64_tr_b16 a[28:29], v4 offset:28704
    ds_read_b64_tr_b16 a[30:31], v4 offset:32288
    s_waitcnt lgkmcnt(14)
    v_mfma_f32_16x16x32_bf16 v[40:43], a[0:3], v[204:207], v[40:43]
    v_mfma_f32_16x16x32_bf16 v[44:47], a[0:3], v[208:211], v[44:47]
    ds_read_b64_tr_b16 a[0:1], v4 offset:28736
    ds_read_b64_tr_b16 a[2:3], v4 offset:32320
    s_waitcnt lgkmcnt(14)
    v_mfma_f32_16x16x32_bf16 v[48:51], a[4:7], v[204:207], v[48:51]
    v_mfma_f32_16x16x32_bf16 v[52:55], a[4:7], v[208:211], v[52:55]
    ds_read_b64_tr_b16 a[4:5], v4 offset:28768
    ds_read_b64_tr_b16 a[6:7], v4 offset:32352
    s_waitcnt lgkmcnt(14)
    v_mfma_f32_16x16x32_bf16 v[56:59], a[8:11], v[204:207], v[56:59]
    v_mfma_f32_16x16x32_bf16 v[60:63], a[8:11], v[208:211], v[60:63]
    ds_read_b64_tr_b16 a[8:9], v4 offset:28800
    ds_read_b64_tr_b16 a[10:11], v4 offset:32384
    s_waitcnt lgkmcnt(14)
    v_mfma_f32_16x16x32_bf16 v[64:67], a[12:15], v[204:207], v[64:67]
    v_mfma_f32_16x16x32_bf16 v[68:71], a[12:15], v[208:211], v[68:71]
    ds_read_b64_tr_b16 a[12:13], v4 offset:28832
    ds_read_b64_tr_b16 a[14:15], v4 offset:32416
    s_waitcnt lgkmcnt(14)
    v_mfma_f32_16x16x32_bf16 v[72:75], a[16:19], v[204:207], v[72:75]
    v_mfma_f32_16x16x32_bf16 v[76:79], a[16:19], v[208:211], v[76:79]
    ds_read_b64_tr_b16 a[16:17], v4 offset:28864
    ds_read_b64_tr_b16 a[18:19], v4 offset:32448
    s_waitcnt lgkmcnt(14)
    v_mfma_f32_16x16x32_bf16 v[80:83], a[20:23], v[204:207], v[80:83]
    v_mfma_f32_16x16x32_bf16 v[84:87], a[20:23], v[208:211], v[84:87]
    ds_read_b64_tr_b16 a[20:21], v4 offset:35840
    ds_read_b64_tr_b16 a[22:23], v4 offset:39424
    s_waitcnt lgkmcnt(14)
    v_mfma_f32_16x16x32_bf16 v[32:35], a[24:27], v[212:215], v[32:35]
    v_mfma_f32_16x16x32_bf16 v[36:39], a[24:27], v[216:219], v[36:39]
    ds_read_b64_tr_b16 a[24:25], v4 offset:35872
    ds_read_b64_tr_b16 a[26:27], v4 offset:39456
    s_waitcnt lgkmcnt(14)
    v_mfma_f32_16x16x32_bf16 v[40:43], a[28:31], v[212:215], v[40:43]
    v_mfma_f32_16x16x32_bf16 v[44:47], a[28:31], v[216:219], v[44:47]
    ds_read_b64_tr_b16 a[28:29], v4 offset:35904
    ds_read_b64_tr_b16 a[30:31], v4 offset:39488
    s_waitcnt lgkmcnt(14)
    v_mfma_f32_16x16x32_bf16 v[48:51], a[0:3], v[212:215], v[48:51]
    v_mfma_f32_16x16x32_bf16 v[52:55], a[0:3], v[216:219], v[52:55]
    ds_read_b64_tr_b16 a[0:1], v4 offset:35936
    ds_read_b64_tr_b16 a[2:3], v4 offset:39520
    s_waitcnt lgkmcnt(14)
    v_mfma_f32_16x16x32_bf16 v[56:59], a[4:7], v[212:215], v[56:59]
    v_mfma_f32_16x16x32_bf16 v[60:63], a[4:7], v[216:219], v[60:63]
    ds_read_b64_tr_b16 a[4:5], v4 offset:35968
    ds_read_b64_tr_b16 a[6:7], v4 offset:39552
    s_waitcnt lgkmcnt(14)
    v_mfma_f32_16x16x32_bf16 v[64:67], a[8:11], v[212:215], v[64:67]
    v_mfma_f32_16x16x32_bf16 v[68:71], a[8:11], v[216:219], v[68:71]
    ds_read_b64_tr_b16 a[8:9], v4 offset:36000
    ds_read_b64_tr_b16 a[10:11], v4 offset:39584
    s_waitcnt lgkmcnt(14)
    v_mfma_f32_16x16x32_bf16 v[72:75], a[12:15], v[212:215], v[72:75]
    v_mfma_f32_16x16x32_bf16 v[76:79], a[12:15], v[216:219], v[76:79]
    ds_read_b64_tr_b16 a[12:13], v4 offset:36032
    ds_read_b64_tr_b16 a[14:15], v4 offset:39616
    s_waitcnt lgkmcnt(14)
    v_mfma_f32_16x16x32_bf16 v[80:83], a[16:19], v[212:215], v[80:83]
    v_mfma_f32_16x16x32_bf16 v[84:87], a[16:19], v[216:219], v[84:87]
    ds_read_b64_tr_b16 a[16:17], v5 offset:0
    ds_read_b64_tr_b16 a[18:19], v5 offset:1024
    s_waitcnt vmcnt(5) lgkmcnt(14)
    v_mfma_f32_16x16x32_bf16 v[32:35], a[20:23], v[220:223], v[32:35]
    s_waitcnt vmcnt(4)
    v_mfma_f32_16x16x32_bf16 v[36:39], a[20:23], v[224:227], v[36:39]
    ds_read_b64_tr_b16 a[20:21], v7 offset:0
    ds_read_b64_tr_b16 a[22:23], v7 offset:1024
    s_waitcnt lgkmcnt(14)
    v_mfma_f32_16x16x32_bf16 v[40:43], a[24:27], v[220:223], v[40:43]
    v_mfma_f32_16x16x32_bf16 v[44:47], a[24:27], v[224:227], v[44:47]
    ds_read_b64_tr_b16 a[24:25], v5 offset:2048
    ds_read_b64_tr_b16 a[26:27], v5 offset:3072
    s_waitcnt lgkmcnt(14)
    v_mfma_f32_16x16x32_bf16 v[48:51], a[28:31], v[220:223], v[48:51]
    v_mfma_f32_16x16x32_bf16 v[52:55], a[28:31], v[224:227], v[52:55]
    ds_read_b64_tr_b16 a[28:29], v7 offset:2048
    ds_read_b64_tr_b16 a[30:31], v7 offset:3072
    s_waitcnt lgkmcnt(14)
    v_mfma_f32_16x16x32_bf16 v[56:59], a[0:3], v[220:223], v[56:59]
    v_mfma_f32_16x16x32_bf16 v[60:63], a[0:3], v[224:227], v[60:63]
    ds_read_b64_tr_b16 a[0:1], v5 offset:4096
    ds_read_b64_tr_b16 a[2:3], v5 offset:5120
    s_waitcnt lgkmcnt(14)
    v_mfma_f32_16x16x32_bf16 v[64:67], a[4:7], v[220:223], v[64:67]
    v_mfma_f32_16x16x32_bf16 v[68:71], a[4:7], v[224:227], v[68:71]
    ds_read_b64_tr_b16 a[4:5], v7 offset:4096
    ds_read_b64_tr_b16 a[6:7], v7 offset:5120
    s_waitcnt lgkmcnt(14)
    v_mfma_f32_16x16x32_bf16 v[72:75], a[8:11], v[220:223], v[72:75]
    v_mfma_f32_16x16x32_bf16 v[76:79], a[8:11], v[224:227], v[76:79]
    ds_read_b64_tr_b16 a[8:9], v5 offset:6144
    ds_read_b64_tr_b16 a[10:11], v5 offset:7168
    s_waitcnt lgkmcnt(14)
    v_mfma_f32_16x16x32_bf16 v[80:83], a[12:15], v[220:223], v[80:83]
    v_mfma_f32_16x16x32_bf16 v[84:87], a[12:15], v[224:227], v[84:87]
    ds_read_b64_tr_b16 a[12:13], v7 offset:6144
    ds_read_b64_tr_b16 a[14:15], v7 offset:7168
    s_waitcnt lgkmcnt(14)
    v_mfma_f32_16x16x32_bf16 v[16:19], a[16:19], a[32:35], 0
    v_mfma_f32_16x16x32_bf16 v[20:23], a[16:19], a[36:39], 0
    ds_read_b64_tr_b16 a[16:17], v5 offset:8192
    ds_read_b64_tr_b16 a[18:19], v5 offset:9216
    s_waitcnt lgkmcnt(14)
    v_mfma_f32_16x16x32_bf16 v[24:27], a[20:23], a[32:35], 0
    v_mfma_f32_16x16x32_bf16 v[28:31], a[20:23], a[36:39], 0
    s_xor_b32 s28, s27, 1
    s_lshl_b32 s28, s28, 2
    s_add_u32 s28, s28, s27
    s_lshl_b32 s28, s28, 13
    s_add_u32 s28, s28, s41
    v_cvt_pk_bf16_f32 v100, v32, v33
    v_cvt_pk_bf16_f32 v101, v34, v35
    v_cvt_pk_bf16_f32 v102, v40, v41
    v_cvt_pk_bf16_f32 v103, v42, v43
    buffer_store_dwordx4 v[100:103], v1, s[16:19], s28 offen offset:0 sc1
    v_cvt_pk_bf16_f32 v104, v36, v37
    v_cvt_pk_bf16_f32 v105, v38, v39
    v_cvt_pk_bf16_f32 v106, v44, v45
    v_cvt_pk_bf16_f32 v107, v46, v47
    buffer_store_dwordx4 v[104:107], v1, s[16:19], s28 offen offset:1024 sc1
    s_xor_b32 s28, s27, 2
    s_lshl_b32 s28, s28, 2
    s_add_u32 s28, s28, s27
    s_lshl_b32 s28, s28, 13
    s_add_u32 s28, s28, s41
    v_cvt_pk_bf16_f32 v108, v48, v49
    v_cvt_pk_bf16_f32 v109, v50, v51
    v_cvt_pk_bf16_f32 v110, v56, v57
    v_cvt_pk_bf16_f32 v111, v58, v59
    buffer_store_dwordx4 v[108:111], v1, s[16:19], s28 offen offset:0 sc1
    v_cvt_pk_bf16_f32 v112, v52, v53
    v_cvt_pk_bf16_f32 v113, v54, v55
    v_cvt_pk_bf16_f32 v114, v60, v61
    v_cvt_pk_bf16_f32 v115, v62, v63
    buffer_store_dwordx4 v[112:115], v1, s[16:19], s28 offen offset:1024 sc1
    s_xor_b32 s28, s27, 3
    s_lshl_b32 s28, s28, 2
    s_add_u32 s28, s28, s27
    s_lshl_b32 s28, s28, 13
    s_add_u32 s28, s28, s41
    v_cvt_pk_bf16_f32 v116, v64, v65
    v_cvt_pk_bf16_f32 v117, v66, v67
    v_cvt_pk_bf16_f32 v118, v72, v73
    v_cvt_pk_bf16_f32 v119, v74, v75
    buffer_store_dwordx4 v[116:119], v1, s[16:19], s28 offen offset:0 sc1
    v_cvt_pk_bf16_f32 v120, v68, v69
    v_cvt_pk_bf16_f32 v121, v70, v71
    v_cvt_pk_bf16_f32 v122, v76, v77
    v_cvt_pk_bf16_f32 v123, v78, v79
    buffer_store_dwordx4 v[120:123], v1, s[16:19], s28 offen offset:1024 sc1
    s_cmp_eq_u32 s24, s27
    s_cbranch_scc1 L_k5_kernel_np8
    s_lshl_b32 s28, s27, 10
    s_add_u32 s28, s28, s42
    v_cvt_pk_bf16_f32 v124, v80, v81
    v_cvt_pk_bf16_f32 v125, v82, v83
    buffer_store_dwordx2 v[124:125], v2, s[16:19], s28 offen offset:0 sc1
    v_cvt_pk_bf16_f32 v126, v84, v85
    v_cvt_pk_bf16_f32 v127, v86, v87
    buffer_store_dwordx2 v[126:127], v2, s[16:19], s28 offen offset:512 sc1
L_k5_kernel_np8:
    v_and_b32 v148, 15, v0
    v_mul_u32_u24 v148, 112, v148
    v_lshrrev_b32 v149, 4, v0
    v_lshl_add_u32 v148, v149, 3, v148
    s_lshl_b32 s28, s24, 12
    v_add_u32 v148, s28, v148
    v_lshrrev_b32 v149, 2, v0
    v_and_b32 v150, 3, v0
    v_mul_u32_u24 v151, 112, v149
    v_lshl_add_u32 v151, v150, 4, v151
    v_add_u32 v151, s28, v151
    v_mul_u32_u24 v152, 1152, v149
    v_lshl_add_u32 v152, v150, 4, v152
    v_lshrrev_b32 v149, 1, v0
    v_and_b32 v150, 1, v0
    v_mul_u32_u24 v153, 112, v149
    v_lshl_add_u32 v153, v150, 4, v153
    v_add_u32 v153, s28, v153
    v_mul_u32_u24 v154, 1152, v149
    v_lshl_add_u32 v154, v150, 4, v154
    v_mov_b32 v156, 1
    v_mov_b32 v157, 0
    ds_read_b64_tr_b16 a[20:21], v7 offset:8192
    ds_read_b64_tr_b16 a[22:23], v7 offset:9216
    s_waitcnt lgkmcnt(14)
    v_mfma_f32_16x16x32_bf16 v[16:19], a[24:27], a[40:43], v[16:19]
    v_mfma_f32_16x16x32_bf16 v[20:23], a[24:27], a[44:47], v[20:23]
    ds_read_b64_tr_b16 a[24:25], v5 offset:10240
    ds_read_b64_tr_b16 a[26:27], v5 offset:11264
    s_waitcnt lgkmcnt(14)
    v_mfma_f32_16x16x32_bf16 v[24:27], a[28:31], a[40:43], v[24:27]
    v_mfma_f32_16x16x32_bf16 v[28:31], a[28:31], a[44:47], v[28:31]
    ds_read_b64_tr_b16 a[28:29], v7 offset:10240
    ds_read_b64_tr_b16 a[30:31], v7 offset:11264
    s_waitcnt lgkmcnt(14)
    v_mfma_f32_16x16x32_bf16 v[16:19], a[0:3], a[48:51], v[16:19]
    v_mfma_f32_16x16x32_bf16 v[20:23], a[0:3], a[52:55], v[20:23]
    ds_read_b64_tr_b16 a[0:1], v5 offset:12288
    ds_read_b64_tr_b16 a[2:3], v5 offset:13312
    s_waitcnt lgkmcnt(14)
    v_mfma_f32_16x16x32_bf16 v[24:27], a[4:7], a[48:51], v[24:27]
    v_mfma_f32_16x16x32_bf16 v[28:31], a[4:7], a[52:55], v[28:31]
    ds_read_b64_tr_b16 a[4:5], v7 offset:12288
    ds_read_b64_tr_b16 a[6:7], v7 offset:13312
    s_waitcnt lgkmcnt(14)
    v_mfma_f32_16x16x32_bf16 v[16:19], a[8:11], a[56:59], v[16:19]
    v_mfma_f32_16x16x32_bf16 v[20:23], a[8:11], a[60:63], v[20:23]
    ds_read_b64_tr_b16 a[8:9], v5 offset:14336
    ds_read_b64_tr_b16 a[10:11], v5 offset:15360
    s_waitcnt lgkmcnt(14)
    v_mfma_f32_16x16x32_bf16 v[24:27], a[12:15], a[56:59], v[24:27]
    v_mfma_f32_16x16x32_bf16 v[28:31], a[12:15], a[60:63], v[28:31]
    ds_read_b64_tr_b16 a[12:13], v7 offset:14336
    ds_read_b64_tr_b16 a[14:15], v7 offset:15360
    s_waitcnt lgkmcnt(14)
    v_mfma_f32_16x16x32_bf16 v[16:19], a[16:19], a[64:67], v[16:19]
    v_mfma_f32_16x16x32_bf16 v[20:23], a[16:19], a[68:71], v[20:23]
    ds_read_b64_tr_b16 a[16:17], v5 offset:16384
    ds_read_b64_tr_b16 a[18:19], v5 offset:17408
    s_waitcnt lgkmcnt(14)
    v_mfma_f32_16x16x32_bf16 v[24:27], a[20:23], a[64:67], v[24:27]
    v_mfma_f32_16x16x32_bf16 v[28:31], a[20:23], a[68:71], v[28:31]
    ds_read_b64_tr_b16 a[20:21], v7 offset:16384
    ds_read_b64_tr_b16 a[22:23], v7 offset:17408
    s_waitcnt lgkmcnt(14)
    v_mfma_f32_16x16x32_bf16 v[16:19], a[24:27], a[72:75], v[16:19]
    v_mfma_f32_16x16x32_bf16 v[20:23], a[24:27], a[76:79], v[20:23]
    ds_read_b64_tr_b16 a[24:25], v5 offset:18432
    ds_read_b64_tr_b16 a[26:27], v5 offset:19456
    s_waitcnt lgkmcnt(14)
    v_mfma_f32_16x16x32_bf16 v[24:27], a[28:31], a[72:75], v[24:27]
    v_mfma_f32_16x16x32_bf16 v[28:31], a[28:31], a[76:79], v[28:31]
    ds_read_b64_tr_b16 a[28:29], v7 offset:18432
    ds_read_b64_tr_b16 a[30:31], v7 offset:19456
    s_waitcnt lgkmcnt(14)
    v_mfma_f32_16x16x32_bf16 v[16:19], a[0:3], a[80:83], v[16:19]
    v_mfma_f32_16x16x32_bf16 v[20:23], a[0:3], a[84:87], v[20:23]
    ds_read_b64_tr_b16 a[0:1], v5 offset:20480
    ds_read_b64_tr_b16 a[2:3], v5 offset:21504
    s_waitcnt lgkmcnt(14)
    v_mfma_f32_16x16x32_bf16 v[24:27], a[4:7], a[80:83], v[24:27]
    v_mfma_f32_16x16x32_bf16 v[28:31], a[4:7], a[84:87], v[28:31]
    ds_read_b64_tr_b16 a[4:5], v7 offset:20480
    ds_read_b64_tr_b16 a[6:7], v7 offset:21504
    s_waitcnt lgkmcnt(14)
    v_mfma_f32_16x16x32_bf16 v[16:19], a[8:11], a[88:91], v[16:19]
    v_mfma_f32_16x16x32_bf16 v[20:23], a[8:11], a[92:95], v[20:23]
    ds_read_b64_tr_b16 a[8:9], v5 offset:22528
    ds_read_b64_tr_b16 a[10:11], v5 offset:23552
    s_waitcnt lgkmcnt(14)
    v_mfma_f32_16x16x32_bf16 v[24:27], a[12:15], a[88:91], v[24:27]
    v_mfma_f32_16x16x32_bf16 v[28:31], a[12:15], a[92:95], v[28:31]
    ds_read_b64_tr_b16 a[12:13], v7 offset:22528
    ds_read_b64_tr_b16 a[14:15], v7 offset:23552
    s_waitcnt lgkmcnt(14)
    v_mfma_f32_16x16x32_bf16 v[16:19], a[16:19], a[96:99], v[16:19]
    v_mfma_f32_16x16x32_bf16 v[20:23], a[16:19], a[100:103], v[20:23]
    ds_read_b64_tr_b16 a[16:17], v5 offset:24576
    ds_read_b64_tr_b16 a[18:19], v5 offset:25600
    s_waitcnt lgkmcnt(14)
    v_mfma_f32_16x16x32_bf16 v[24:27], a[20:23], a[96:99], v[24:27]
    v_mfma_f32_16x16x32_bf16 v[28:31], a[20:23], a[100:103], v[28:31]
    ds_read_b64_tr_b16 a[20:21], v7 offset:24576
    ds_read_b64_tr_b16 a[22:23], v7 offset:25600
    s_waitcnt lgkmcnt(14)
    v_mfma_f32_16x16x32_bf16 v[16:19], a[24:27], a[104:107], v[16:19]
    v_mfma_f32_16x16x32_bf16 v[20:23], a[24:27], a[108:111], v[20:23]
    ds_read_b64_tr_b16 a[24:25], v5 offset:26624
    ds_read_b64_tr_b16 a[26:27], v5 offset:27648
    s_waitcnt lgkmcnt(14)
    v_mfma_f32_16x16x32_bf16 v[24:27], a[28:31], a[104:107], v[24:27]
    v_mfma_f32_16x16x32_bf16 v[28:31], a[28:31], a[108:111], v[28:31]
    ds_read_b64_tr_b16 a[28:29], v7 offset:26624
    ds_read_b64_tr_b16 a[30:31], v7 offset:27648
    s_waitcnt lgkmcnt(14)
    v_mfma_f32_16x16x32_bf16 v[16:19], a[0:3], a[112:115], v[16:19]
    v_mfma_f32_16x16x32_bf16 v[20:23], a[0:3], a[116:119], v[20:23]
    ds_read_b64_tr_b16 a[0:1], v5 offset:28672
    ds_read_b64_tr_b16 a[2:3], v5 offset:29696
    s_waitcnt lgkmcnt(14)
    v_mfma_f32_16x16x32_bf16 v[24:27], a[4:7], a[112:115], v[24:27]
    v_mfma_f32_16x16x32_bf16 v[28:31], a[4:7], a[116:119], v[28:31]
    ds_read_b64_tr_b16 a[4:5], v7 offset:28672
    ds_read_b64_tr_b16 a[6:7], v7 offset:29696
    s_waitcnt lgkmcnt(14)
    v_mfma_f32_16x16x32_bf16 v[16:19], a[8:11], a[120:123], v[16:19]
    v_mfma_f32_16x16x32_bf16 v[20:23], a[8:11], a[124:127], v[20:23]
    ds_read_b64_tr_b16 a[8:9], v5 offset:30720
    ds_read_b64_tr_b16 a[10:11], v5 offset:31744
    s_waitcnt lgkmcnt(14)
    v_mfma_f32_16x16x32_bf16 v[24:27], a[12:15], a[120:123], v[24:27]
    v_mfma_f32_16x16x32_bf16 v[28:31], a[12:15], a[124:127], v[28:31]
    ds_read_b64_tr_b16 a[12:13], v7 offset:30720
    ds_read_b64_tr_b16 a[14:15], v7 offset:31744
    s_waitcnt lgkmcnt(14)
    v_mfma_f32_16x16x32_bf16 v[16:19], a[16:19], a[128:131], v[16:19]
    v_mfma_f32_16x16x32_bf16 v[20:23], a[16:19], a[132:135], v[20:23]
    ds_read_b64_tr_b16 a[16:17], v5 offset:32768
    ds_read_b64_tr_b16 a[18:19], v5 offset:33792
    s_waitcnt lgkmcnt(14)
    v_mfma_f32_16x16x32_bf16 v[24:27], a[20:23], a[128:131], v[24:27]
    v_mfma_f32_16x16x32_bf16 v[28:31], a[20:23], a[132:135], v[28:31]
    ds_read_b64_tr_b16 a[20:21], v7 offset:32768
    ds_read_b64_tr_b16 a[22:23], v7 offset:33792
    s_waitcnt lgkmcnt(14)
    v_mfma_f32_16x16x32_bf16 v[16:19], a[24:27], a[136:139], v[16:19]
    v_mfma_f32_16x16x32_bf16 v[20:23], a[24:27], a[140:143], v[20:23]
    ds_read_b64_tr_b16 a[24:25], v5 offset:34816
    ds_read_b64_tr_b16 a[26:27], v5 offset:35840
    s_waitcnt lgkmcnt(14)
    v_mfma_f32_16x16x32_bf16 v[24:27], a[28:31], a[136:139], v[24:27]
    v_mfma_f32_16x16x32_bf16 v[28:31], a[28:31], a[140:143], v[28:31]
    ds_read_b64_tr_b16 a[28:29], v7 offset:34816
    ds_read_b64_tr_b16 a[30:31], v7 offset:35840
    s_waitcnt lgkmcnt(14)
    v_mfma_f32_16x16x32_bf16 v[16:19], a[0:3], a[144:147], v[16:19]
    v_mfma_f32_16x16x32_bf16 v[20:23], a[0:3], a[148:151], v[20:23]
    ds_read_b64_tr_b16 a[0:1], v6 offset:0
    ds_read_b64_tr_b16 a[2:3], v6 offset:1024
    s_waitcnt lgkmcnt(14)
    v_mfma_f32_16x16x32_bf16 v[24:27], a[4:7], a[144:147], v[24:27]
    v_mfma_f32_16x16x32_bf16 v[28:31], a[4:7], a[148:151], v[28:31]
    ds_read_b64_tr_b16 a[4:5], v8 offset:0
    ds_read_b64_tr_b16 a[6:7], v8 offset:1024
    s_waitcnt lgkmcnt(14)
    v_mfma_f32_16x16x32_bf16 v[16:19], a[8:11], a[152:155], v[16:19]
    v_mfma_f32_16x16x32_bf16 v[20:23], a[8:11], a[156:159], v[20:23]
    ds_read_b64_tr_b16 a[8:9], v6 offset:2048
    ds_read_b64_tr_b16 a[10:11], v6 offset:3072
    s_waitcnt lgkmcnt(14)
    v_mfma_f32_16x16x32_bf16 v[24:27], a[12:15], a[152:155], v[24:27]
    v_mfma_f32_16x16x32_bf16 v[28:31], a[12:15], a[156:159], v[28:31]
    ds_read_b64_tr_b16 a[12:13], v8 offset:2048
    ds_read_b64_tr_b16 a[14:15], v8 offset:3072
    s_waitcnt lgkmcnt(14)
    v_mfma_f32_16x16x32_bf16 v[16:19], a[16:19], a[160:163], v[16:19]
    v_mfma_f32_16x16x32_bf16 v[20:23], a[16:19], a[164:167], v[20:23]
    ds_read_b64_tr_b16 a[16:17], v6 offset:4096
    ds_read_b64_tr_b16 a[18:19], v6 offset:5120
    s_waitcnt lgkmcnt(14)
    v_mfma_f32_16x16x32_bf16 v[24:27], a[20:23], a[160:163], v[24:27]
    v_mfma_f32_16x16x32_bf16 v[28:31], a[20:23], a[164:167], v[28:31]
    ds_read_b64_tr_b16 a[20:21], v8 offset:4096
    ds_read_b64_tr_b16 a[22:23], v8 offset:5120
    s_waitcnt lgkmcnt(14)
    v_mfma_f32_16x16x32_bf16 v[16:19], a[24:27], a[168:171], v[16:19]
    v_mfma_f32_16x16x32_bf16 v[20:23], a[24:27], a[172:175], v[20:23]
    ds_read_b64_tr_b16 a[24:25], v6 offset:6144
    ds_read_b64_tr_b16 a[26:27], v6 offset:7168
    s_waitcnt lgkmcnt(14)
    v_mfma_f32_16x16x32_bf16 v[24:27], a[28:31], a[168:171], v[24:27]
    v_mfma_f32_16x16x32_bf16 v[28:31], a[28:31], a[172:175], v[28:31]
    ds_read_b64_tr_b16 a[28:29], v8 offset:6144
    ds_read_b64_tr_b16 a[30:31], v8 offset:7168
    s_waitcnt lgkmcnt(14)
    v_mfma_f32_16x16x32_bf16 v[16:19], a[0:3], a[176:179], v[16:19]
    v_mfma_f32_16x16x32_bf16 v[20:23], a[0:3], a[180:183], v[20:23]
    ds_read_b64_tr_b16 a[0:1], v6 offset:8192
    ds_read_b64_tr_b16 a[2:3], v6 offset:9216
    s_waitcnt lgkmcnt(14)
    v_mfma_f32_16x16x32_bf16 v[24:27], a[4:7], a[176:179], v[24:27]
    v_mfma_f32_16x16x32_bf16 v[28:31], a[4:7], a[180:183], v[28:31]
    ds_read_b64_tr_b16 a[4:5], v8 offset:8192
    ds_read_b64_tr_b16 a[6:7], v8 offset:9216
    s_waitcnt lgkmcnt(14)
    v_mfma_f32_16x16x32_bf16 v[16:19], a[8:11], a[184:187], v[16:19]
    v_mfma_f32_16x16x32_bf16 v[20:23], a[8:11], a[188:191], v[20:23]
    ds_read_b64_tr_b16 a[8:9], v6 offset:10240
    ds_read_b64_tr_b16 a[10:11], v6 offset:11264
    s_waitcnt lgkmcnt(14)
    v_mfma_f32_16x16x32_bf16 v[24:27], a[12:15], a[184:187], v[24:27]
    v_mfma_f32_16x16x32_bf16 v[28:31], a[12:15], a[188:191], v[28:31]
    ds_read_b64_tr_b16 a[12:13], v8 offset:10240
    ds_read_b64_tr_b16 a[14:15], v8 offset:11264
    s_waitcnt lgkmcnt(14)
    v_mfma_f32_16x16x32_bf16 v[16:19], a[16:19], a[192:195], v[16:19]
    v_mfma_f32_16x16x32_bf16 v[20:23], a[16:19], a[196:199], v[20:23]
    ds_read_b64_tr_b16 a[16:17], v6 offset:12288
    ds_read_b64_tr_b16 a[18:19], v6 offset:13312
    s_waitcnt lgkmcnt(14)
    v_mfma_f32_16x16x32_bf16 v[24:27], a[20:23], a[192:195], v[24:27]
    v_mfma_f32_16x16x32_bf16 v[28:31], a[20:23], a[196:199], v[28:31]
    ds_read_b64_tr_b16 a[20:21], v8 offset:12288
    ds_read_b64_tr_b16 a[22:23], v8 offset:13312
    s_waitcnt lgkmcnt(14)
    v_mfma_f32_16x16x32_bf16 v[16:19], a[24:27], a[200:203], v[16:19]
    v_mfma_f32_16x16x32_bf16 v[20:23], a[24:27], a[204:207], v[20:23]
    ds_read_b64_tr_b16 a[24:25], v6 offset:14336
    ds_read_b64_tr_b16 a[26:27], v6 offset:15360
    s_waitcnt lgkmcnt(14)
    v_mfma_f32_16x16x32_bf16 v[24:27], a[28:31], a[200:203], v[24:27]
    v_mfma_f32_16x16x32_bf16 v[28:31], a[28:31], a[204:207], v[28:31]
    s_waitcnt vmcnt(0)
    s_barrier
    s_cmp_lg_u32 s24, 0
    s_cbranch_scc1 L_k5_kernel_nofl
    s_lshl_b32 s28, s27, 2
    s_add_u32 s28, s28, s43
    s_mov_b64 exec, 1
    buffer_store_dword v156, v157, s[16:19], s28 offen sc1
    s_mov_b64 exec, -1
L_k5_kernel_nofl:
    ds_read_b64_tr_b16 a[28:29], v8 offset:14336
    ds_read_b64_tr_b16 a[30:31], v8 offset:15360
    s_waitcnt lgkmcnt(14)
    v_mfma_f32_16x16x32_bf16 v[16:19], a[0:3], a[208:211], v[16:19]
    v_mfma_f32_16x16x32_bf16 v[20:23], a[0:3], a[212:215], v[20:23]
    ds_read_b64_tr_b16 a[0:1], v6 offset:16384
    ds_read_b64_tr_b16 a[2:3], v6 offset:17408
    s_waitcnt lgkmcnt(14)
    v_mfma_f32_16x16x32_bf16 v[24:27], a[4:7], a[208:211], v[24:27]
    v_mfma_f32_16x16x32_bf16 v[28:31], a[4:7], a[212:215], v[28:31]
    ds_read_b64_tr_b16 a[4:5], v8 offset:16384
    ds_read_b64_tr_b16 a[6:7], v8 offset:17408
    s_waitcnt lgkmcnt(14)
    v_mfma_f32_16x16x32_bf16 v[16:19], a[8:11], a[216:219], v[16:19]
    v_mfma_f32_16x16x32_bf16 v[20:23], a[8:11], a[220:223], v[20:23]
    ds_read_b64_tr_b16 a[8:9], v6 offset:18432
    ds_read_b64_tr_b16 a[10:11], v6 offset:19456
    s_waitcnt lgkmcnt(14)
    v_mfma_f32_16x16x32_bf16 v[24:27], a[12:15], a[216:219], v[24:27]
    v_mfma_f32_16x16x32_bf16 v[28:31], a[12:15], a[220:223], v[28:31]
    ds_read_b64_tr_b16 a[12:13], v8 offset:18432
    ds_read_b64_tr_b16 a[14:15], v8 offset:19456
    s_waitcnt lgkmcnt(14)
    v_mfma_f32_16x16x32_bf16 v[16:19], a[16:19], a[224:227], v[16:19]
    v_mfma_f32_16x16x32_bf16 v[20:23], a[16:19], a[228:231], v[20:23]
    ds_read_b64_tr_b16 a[16:17], v6 offset:20480
    ds_read_b64_tr_b16 a[18:19], v6 offset:21504
    s_waitcnt lgkmcnt(14)
    v_mfma_f32_16x16x32_bf16 v[24:27], a[20:23], a[224:227], v[24:27]
    v_mfma_f32_16x16x32_bf16 v[28:31], a[20:23], a[228:231], v[28:31]
    ds_read_b64_tr_b16 a[20:21], v8 offset:20480
    ds_read_b64_tr_b16 a[22:23], v8 offset:21504
    s_waitcnt lgkmcnt(14)
    v_mfma_f32_16x16x32_bf16 v[16:19], a[24:27], a[232:235], v[16:19]
    v_mfma_f32_16x16x32_bf16 v[20:23], a[24:27], a[236:239], v[20:23]
    ds_read_b64_tr_b16 a[24:25], v6 offset:22528
    ds_read_b64_tr_b16 a[26:27], v6 offset:23552
    s_waitcnt lgkmcnt(14)
    v_mfma_f32_16x16x32_bf16 v[24:27], a[28:31], a[232:235], v[24:27]
    v_mfma_f32_16x16x32_bf16 v[28:31], a[28:31], a[236:239], v[28:31]
    ds_read_b64_tr_b16 a[28:29], v8 offset:22528
    ds_read_b64_tr_b16 a[30:31], v8 offset:23552
    s_waitcnt lgkmcnt(14)
    v_mfma_f32_16x16x32_bf16 v[16:19], a[0:3], a[240:243], v[16:19]
    v_mfma_f32_16x16x32_bf16 v[20:23], a[0:3], a[244:247], v[20:23]
    ds_read_b64_tr_b16 a[0:1], v6 offset:24576
    ds_read_b64_tr_b16 a[2:3], v6 offset:25600
    s_waitcnt lgkmcnt(14)
    v_mfma_f32_16x16x32_bf16 v[24:27], a[4:7], a[240:243], v[24:27]
    v_mfma_f32_16x16x32_bf16 v[28:31], a[4:7], a[244:247], v[28:31]
    ds_read_b64_tr_b16 a[4:5], v8 offset:24576
    ds_read_b64_tr_b16 a[6:7], v8 offset:25600
    s_waitcnt lgkmcnt(14)
    v_mfma_f32_16x16x32_bf16 v[16:19], a[8:11], a[248:251], v[16:19]
    v_mfma_f32_16x16x32_bf16 v[20:23], a[8:11], a[252:255], v[20:23]
    ds_read_b64_tr_b16 a[8:9], v6 offset:26624
    ds_read_b64_tr_b16 a[10:11], v6 offset:27648
    s_waitcnt lgkmcnt(14)
    v_mfma_f32_16x16x32_bf16 v[24:27], a[12:15], a[248:251], v[24:27]
    v_mfma_f32_16x16x32_bf16 v[28:31], a[12:15], a[252:255], v[28:31]
    ds_read_b64_tr_b16 a[12:13], v8 offset:26624
    ds_read_b64_tr_b16 a[14:15], v8 offset:27648
    s_waitcnt lgkmcnt(14)
    v_mfma_f32_16x16x32_bf16 v[16:19], a[16:19], v[164:167], v[16:19]
    v_mfma_f32_16x16x32_bf16 v[20:23], a[16:19], v[168:171], v[20:23]
    ds_read_b64_tr_b16 a[16:17], v6 offset:28672
    ds_read_b64_tr_b16 a[18:19], v6 offset:29696
    s_waitcnt lgkmcnt(14)
    v_mfma_f32_16x16x32_bf16 v[24:27], a[20:23], v[164:167], v[24:27]
    v_mfma_f32_16x16x32_bf16 v[28:31], a[20:23], v[168:171], v[28:31]
    ds_read_b64_tr_b16 a[20:21], v8 offset:28672
    ds_read_b64_tr_b16 a[22:23], v8 offset:29696
    s_waitcnt lgkmcnt(14)
    v_mfma_f32_16x16x32_bf16 v[16:19], a[24:27], v[172:175], v[16:19]
    v_mfma_f32_16x16x32_bf16 v[20:23], a[24:27], v[176:179], v[20:23]
    ds_read_b64_tr_b16 a[24:25], v6 offset:30720
    ds_read_b64_tr_b16 a[26:27], v6 offset:31744
    s_waitcnt lgkmcnt(14)
    v_mfma_f32_16x16x32_bf16 v[24:27], a[28:31], v[172:175], v[24:27]
    v_mfma_f32_16x16x32_bf16 v[28:31], a[28:31], v[176:179], v[28:31]
    ds_read_b64_tr_b16 a[28:29], v8 offset:30720
    ds_read_b64_tr_b16 a[30:31], v8 offset:31744
    s_waitcnt lgkmcnt(14)
    v_mfma_f32_16x16x32_bf16 v[16:19], a[0:3], v[180:183], v[16:19]
    v_mfma_f32_16x16x32_bf16 v[20:23], a[0:3], v[184:187], v[20:23]
    ds_read_b64_tr_b16 a[0:1], v6 offset:32768
    ds_read_b64_tr_b16 a[2:3], v6 offset:33792
    s_waitcnt lgkmcnt(14)
    v_mfma_f32_16x16x32_bf16 v[24:27], a[4:7], v[180:183], v[24:27]
    v_mfma_f32_16x16x32_bf16 v[28:31], a[4:7], v[184:187], v[28:31]
    ds_read_b64_tr_b16 a[4:5], v8 offset:32768
    ds_read_b64_tr_b16 a[6:7], v8 offset:33792
    s_waitcnt lgkmcnt(14)
    v_mfma_f32_16x16x32_bf16 v[16:19], a[8:11], v[188:191], v[16:19]
    v_mfma_f32_16x16x32_bf16 v[20:23], a[8:11], v[192:195], v[20:23]
    ds_read_b64_tr_b16 a[8:9], v6 offset:34816
    ds_read_b64_tr_b16 a[10:11], v6 offset:35840
    s_waitcnt lgkmcnt(14)
    v_mfma_f32_16x16x32_bf16 v[24:27], a[12:15], v[188:191], v[24:27]
    v_mfma_f32_16x16x32_bf16 v[28:31], a[12:15], v[192:195], v[28:31]
    ds_read_b64_tr_b16 a[12:13], v8 offset:34816
    ds_read_b64_tr_b16 a[14:15], v8 offset:35840
    s_waitcnt lgkmcnt(14)
    v_mfma_f32_16x16x32_bf16 v[16:19], a[16:19], v[196:199], v[16:19]
    v_mfma_f32_16x16x32_bf16 v[20:23], a[16:19], v[200:203], v[20:23]
    s_waitcnt lgkmcnt(12)
    v_mfma_f32_16x16x32_bf16 v[24:27], a[20:23], v[196:199], v[24:27]
    v_mfma_f32_16x16x32_bf16 v[28:31], a[20:23], v[200:203], v[28:31]
    s_waitcnt lgkmcnt(10)
    v_mfma_f32_16x16x32_bf16 v[16:19], a[24:27], v[204:207], v[16:19]
    v_mfma_f32_16x16x32_bf16 v[20:23], a[24:27], v[208:211], v[20:23]
    s_waitcnt lgkmcnt(8)
    v_mfma_f32_16x16x32_bf16 v[24:27], a[28:31], v[204:207], v[24:27]
    v_mfma_f32_16x16x32_bf16 v[28:31], a[28:31], v[208:211], v[28:31]
    s_waitcnt lgkmcnt(6)
    v_mfma_f32_16x16x32_bf16 v[16:19], a[0:3], v[212:215], v[16:19]
    v_mfma_f32_16x16x32_bf16 v[20:23], a[0:3], v[216:219], v[20:23]
    s_waitcnt lgkmcnt(4)
    v_mfma_f32_16x16x32_bf16 v[24:27], a[4:7], v[212:215], v[24:27]
    v_mfma_f32_16x16x32_bf16 v[28:31], a[4:7], v[216:219], v[28:31]
    s_waitcnt lgkmcnt(2)
    v_mfma_f32_16x16x32_bf16 v[16:19], a[8:11], v[220:223], v[16:19]
    v_mfma_f32_16x16x32_bf16 v[20:23], a[8:11], v[224:227], v[20:23]
    s_waitcnt lgkmcnt(0)
    v_mfma_f32_16x16x32_bf16 v[24:27], a[12:15], v[220:223], v[24:27]
    v_mfma_f32_16x16x32_bf16 v[28:31], a[12:15], v[224:227], v[28:31]
    s_cmp_lg_u32 s24, 0
    s_cbranch_scc1 L_k5_kernel_wait
L_k5_kernel_spin:
    buffer_load_dwordx4 v[160:163], v157, s[16:19], s43 offen sc1
    s_waitcnt vmcnt(0)
    v_and_b32 v160, v160, v161
    v_and_b32 v162, v162, v163
    v_and_b32 v160, v160, v162
    s_nop 0
    v_readfirstlane_b32 s28, v160
    s_nop 0
    s_cmp_eq_u32 s28, 1
    s_cbranch_scc0 L_k5_kernel_spin
L_k5_kernel_wait:
    s_barrier
    s_xor_b32 s28, s27, 1
    s_lshl_b32 s29, s27, 2
    s_add_u32 s28, s28, s29
    s_lshl_b32 s28, s28, 13
    s_add_u32 s28, s28, s41
    buffer_load_dwordx4 v[100:103], v1, s[16:19], s28 offen offset:0 sc1
    buffer_load_dwordx4 v[104:107], v1, s[16:19], s28 offen offset:1024 sc1
    s_xor_b32 s28, s27, 2
    s_lshl_b32 s29, s27, 2
    s_add_u32 s28, s28, s29
    s_lshl_b32 s28, s28, 13
    s_add_u32 s28, s28, s41
    buffer_load_dwordx4 v[108:111], v1, s[16:19], s28 offen offset:0 sc1
    buffer_load_dwordx4 v[112:115], v1, s[16:19], s28 offen offset:1024 sc1
    s_xor_b32 s28, s27, 3
    s_lshl_b32 s29, s27, 2
    s_add_u32 s28, s28, s29
    s_lshl_b32 s28, s28, 13
    s_add_u32 s28, s28, s41
    buffer_load_dwordx4 v[116:119], v1, s[16:19], s28 offen offset:0 sc1
    buffer_load_dwordx4 v[120:123], v1, s[16:19], s28 offen offset:1024 sc1
    s_cmp_lg_u32 s24, s27
    s_cbranch_scc1 L_k5_kernel_ng8
    s_xor_b32 s28, s27, 1
    s_lshl_b32 s28, s28, 10
    s_add_u32 s28, s28, s42
    buffer_load_dwordx2 v[124:125], v2, s[16:19], s28 offen offset:0 sc1
    buffer_load_dwordx2 v[126:127], v2, s[16:19], s28 offen offset:512 sc1
    s_xor_b32 s28, s27, 2
    s_lshl_b32 s28, s28, 10
    s_add_u32 s28, s28, s42
    buffer_load_dwordx2 v[128:129], v2, s[16:19], s28 offen offset:0 sc1
    buffer_load_dwordx2 v[130:131], v2, s[16:19], s28 offen offset:512 sc1
    s_xor_b32 s28, s27, 3
    s_lshl_b32 s28, s28, 10
    s_add_u32 s28, s28, s42
    buffer_load_dwordx2 v[132:133], v2, s[16:19], s28 offen offset:0 sc1
    buffer_load_dwordx2 v[134:135], v2, s[16:19], s28 offen offset:512 sc1
L_k5_kernel_ng8:
    s_waitcnt vmcnt(5)
    v_lshlrev_b32 v158, 16, v100
    v_and_b32 v159, 0xffff0000, v100
    v_add_f32 v16, v16, v158
    v_add_f32 v17, v17, v159
    v_lshlrev_b32 v158, 16, v101
    v_and_b32 v159, 0xffff0000, v101
    v_add_f32 v18, v18, v158
    v_add_f32 v19, v19, v159
    s_waitcnt vmcnt(3)
    v_lshlrev_b32 v158, 16, v108
    v_and_b32 v159, 0xffff0000, v108
    v_add_f32 v16, v16, v158
    v_add_f32 v17, v17, v159
    v_lshlrev_b32 v158, 16, v109
    v_and_b32 v159, 0xffff0000, v109
    v_add_f32 v18, v18, v158
    v_add_f32 v19, v19, v159
    s_waitcnt vmcnt(1)
    v_lshlrev_b32 v158, 16, v116
    v_and_b32 v159, 0xffff0000, v116
    v_add_f32 v16, v16, v158
    v_add_f32 v17, v17, v159
    v_lshlrev_b32 v158, 16, v117
    v_and_b32 v159, 0xffff0000, v117
    v_add_f32 v18, v18, v158
    v_add_f32 v19, v19, v159
    v_cvt_pk_bf16_f32 v32, v16, v17
    v_lshlrev_b32 v16, 16, v32
    v_and_b32 v17, 0xffff0000, v32
    v_lshlrev_b32 v158, 16, v88
    v_and_b32 v159, 0xffff0000, v88
    v_add_f32 v16, v16, v158
    v_add_f32 v17, v17, v159
    v_cvt_pk_bf16_f32 v32, v16, v17
    v_cvt_pk_bf16_f32 v33, v18, v19
    v_lshlrev_b32 v18, 16, v33
    v_and_b32 v19, 0xffff0000, v33
    v_lshlrev_b32 v158, 16, v89
    v_and_b32 v159, 0xffff0000, v89
    v_add_f32 v18, v18, v158
    v_add_f32 v19, v19, v159
    v_cvt_pk_bf16_f32 v33, v18, v19
    ds_write_b64 v148, v[32:33] offset:0
    v_lshlrev_b32 v158, 16, v102
    v_and_b32 v159, 0xffff0000, v102
    v_add_f32 v24, v24, v158
    v_add_f32 v25, v25, v159
    v_lshlrev_b32 v158, 16, v103
    v_and_b32 v159, 0xffff0000, v103
    v_add_f32 v26, v26, v158
    v_add_f32 v27, v27, v159
    v_lshlrev_b32 v158, 16, v110
    v_and_b32 v159, 0xffff0000, v110
    v_add_f32 v24, v24, v158
    v_add_f32 v25, v25, v159
    v_lshlrev_b32 v158, 16, v111
    v_and_b32 v159, 0xffff0000, v111
    v_add_f32 v26, v26, v158
    v_add_f32 v27, v27, v159
    v_lshlrev_b32 v158, 16, v118
    v_and_b32 v159, 0xffff0000, v118
    v_add_f32 v24, v24, v158
    v_add_f32 v25, v25, v159
    v_lshlrev_b32 v158, 16, v119
    v_and_b32 v159, 0xffff0000, v119
    v_add_f32 v26, v26, v158
    v_add_f32 v27, v27, v159
    v_cvt_pk_bf16_f32 v34, v24, v25
    v_lshlrev_b32 v24, 16, v34
    v_and_b32 v25, 0xffff0000, v34
    v_lshlrev_b32 v158, 16, v92
    v_and_b32 v159, 0xffff0000, v92
    v_add_f32 v24, v24, v158
    v_add_f32 v25, v25, v159
    v_cvt_pk_bf16_f32 v34, v24, v25
    v_cvt_pk_bf16_f32 v35, v26, v27
    v_lshlrev_b32 v26, 16, v35
    v_and_b32 v27, 0xffff0000, v35
    v_lshlrev_b32 v158, 16, v93
    v_and_b32 v159, 0xffff0000, v93
    v_add_f32 v26, v26, v158
    v_add_f32 v27, v27, v159
    v_cvt_pk_bf16_f32 v35, v26, v27
    ds_write_b64 v148, v[34:35] offset:32
    v_lshlrev_b32 v158, 16, v104
    v_and_b32 v159, 0xffff0000, v104
    v_add_f32 v20, v20, v158
    v_add_f32 v21, v21, v159
    v_lshlrev_b32 v158, 16, v105
    v_and_b32 v159, 0xffff0000, v105
    v_add_f32 v22, v22, v158
    v_add_f32 v23, v23, v159
    v_lshlrev_b32 v158, 16, v112
    v_and_b32 v159, 0xffff0000, v112
    v_add_f32 v20, v20, v158
    v_add_f32 v21, v21, v159
    v_lshlrev_b32 v158, 16, v113
    v_and_b32 v159, 0xffff0000, v113
    v_add_f32 v22, v22, v158
    v_add_f32 v23, v23, v159
    s_waitcnt vmcnt(0)
    v_lshlrev_b32 v158, 16, v120
    v_and_b32 v159, 0xffff0000, v120
    v_add_f32 v20, v20, v158
    v_add_f32 v21, v21, v159
    v_lshlrev_b32 v158, 16, v121
    v_and_b32 v159, 0xffff0000, v121
    v_add_f32 v22, v22, v158
    v_add_f32 v23, v23, v159
    v_cvt_pk_bf16_f32 v36, v20, v21
    v_lshlrev_b32 v20, 16, v36
    v_and_b32 v21, 0xffff0000, v36
    v_lshlrev_b32 v158, 16, v90
    v_and_b32 v159, 0xffff0000, v90
    v_add_f32 v20, v20, v158
    v_add_f32 v21, v21, v159
    v_cvt_pk_bf16_f32 v36, v20, v21
    v_cvt_pk_bf16_f32 v37, v22, v23
    v_lshlrev_b32 v22, 16, v37
    v_and_b32 v23, 0xffff0000, v37
    v_lshlrev_b32 v158, 16, v91
    v_and_b32 v159, 0xffff0000, v91
    v_add_f32 v22, v22, v158
    v_add_f32 v23, v23, v159
    v_cvt_pk_bf16_f32 v37, v22, v23
    ds_write_b64 v148, v[36:37] offset:1792
    v_lshlrev_b32 v158, 16, v106
    v_and_b32 v159, 0xffff0000, v106
    v_add_f32 v28, v28, v158
    v_add_f32 v29, v29, v159
    v_lshlrev_b32 v158, 16, v107
    v_and_b32 v159, 0xffff0000, v107
    v_add_f32 v30, v30, v158
    v_add_f32 v31, v31, v159
    v_lshlrev_b32 v158, 16, v114
    v_and_b32 v159, 0xffff0000, v114
    v_add_f32 v28, v28, v158
    v_add_f32 v29, v29, v159
    v_lshlrev_b32 v158, 16, v115
    v_and_b32 v159, 0xffff0000, v115
    v_add_f32 v30, v30, v158
    v_add_f32 v31, v31, v159
    v_lshlrev_b32 v158, 16, v122
    v_and_b32 v159, 0xffff0000, v122
    v_add_f32 v28, v28, v158
    v_add_f32 v29, v29, v159
    v_lshlrev_b32 v158, 16, v123
    v_and_b32 v159, 0xffff0000, v123
    v_add_f32 v30, v30, v158
    v_add_f32 v31, v31, v159
    v_cvt_pk_bf16_f32 v38, v28, v29
    v_lshlrev_b32 v28, 16, v38
    v_and_b32 v29, 0xffff0000, v38
    v_lshlrev_b32 v158, 16, v94
    v_and_b32 v159, 0xffff0000, v94
    v_add_f32 v28, v28, v158
    v_add_f32 v29, v29, v159
    v_cvt_pk_bf16_f32 v38, v28, v29
    v_cvt_pk_bf16_f32 v39, v30, v31
    v_lshlrev_b32 v30, 16, v39
    v_and_b32 v31, 0xffff0000, v39
    v_lshlrev_b32 v158, 16, v95
    v_and_b32 v159, 0xffff0000, v95
    v_add_f32 v30, v30, v158
    v_add_f32 v31, v31, v159
    v_cvt_pk_bf16_f32 v39, v30, v31
    ds_write_b64 v148, v[38:39] offset:1824
    s_lshl_b32 s28, s27, 6
    s_add_u32 s28, s28, s45
    s_add_u32 s29, s28, 18432
    s_waitcnt lgkmcnt(0)
    ds_read_b128 v[40:43], v151
    ds_read_b128 v[44:47], v151 offset:1792
    s_waitcnt lgkmcnt(1)
    buffer_store_dwordx4 v[40:43], v152, s[20:23], s28 offen
    s_waitcnt lgkmcnt(0)
    buffer_store_dwordx4 v[44:47], v152, s[20:23], s29 offen
    s_cmp_lg_u32 s24, s27
    s_cbranch_scc1 L_k5_kernel_done
    s_waitcnt vmcnt(2)
    v_lshlrev_b32 v158, 16, v124
    v_and_b32 v159, 0xffff0000, v124
    v_add_f32 v80, v80, v158
    v_add_f32 v81, v81, v159
    v_lshlrev_b32 v158, 16, v125
    v_and_b32 v159, 0xffff0000, v125
    v_add_f32 v82, v82, v158
    v_add_f32 v83, v83, v159
    v_lshlrev_b32 v158, 16, v128
    v_and_b32 v159, 0xffff0000, v128
    v_add_f32 v80, v80, v158
    v_add_f32 v81, v81, v159
    v_lshlrev_b32 v158, 16, v129
    v_and_b32 v159, 0xffff0000, v129
    v_add_f32 v82, v82, v158
    v_add_f32 v83, v83, v159
    v_lshlrev_b32 v158, 16, v132
    v_and_b32 v159, 0xffff0000, v132
    v_add_f32 v80, v80, v158
    v_add_f32 v81, v81, v159
    v_lshlrev_b32 v158, 16, v133
    v_and_b32 v159, 0xffff0000, v133
    v_add_f32 v82, v82, v158
    v_add_f32 v83, v83, v159
    v_cvt_pk_bf16_f32 v48, v80, v81
    v_lshlrev_b32 v80, 16, v48
    v_and_b32 v81, 0xffff0000, v48
    v_lshlrev_b32 v158, 16, v96
    v_and_b32 v159, 0xffff0000, v96
    v_add_f32 v80, v80, v158
    v_add_f32 v81, v81, v159
    v_cvt_pk_bf16_f32 v48, v80, v81
    v_cvt_pk_bf16_f32 v49, v82, v83
    v_lshlrev_b32 v82, 16, v49
    v_and_b32 v83, 0xffff0000, v49
    v_lshlrev_b32 v158, 16, v97
    v_and_b32 v159, 0xffff0000, v97
    v_add_f32 v82, v82, v158
    v_add_f32 v83, v83, v159
    v_cvt_pk_bf16_f32 v49, v82, v83
    ds_write_b64 v148, v[48:49] offset:64
    v_lshlrev_b32 v158, 16, v126
    v_and_b32 v159, 0xffff0000, v126
    v_add_f32 v84, v84, v158
    v_add_f32 v85, v85, v159
    v_lshlrev_b32 v158, 16, v127
    v_and_b32 v159, 0xffff0000, v127
    v_add_f32 v86, v86, v158
    v_add_f32 v87, v87, v159
    v_lshlrev_b32 v158, 16, v130
    v_and_b32 v159, 0xffff0000, v130
    v_add_f32 v84, v84, v158
    v_add_f32 v85, v85, v159
    v_lshlrev_b32 v158, 16, v131
    v_and_b32 v159, 0xffff0000, v131
    v_add_f32 v86, v86, v158
    v_add_f32 v87, v87, v159
    v_lshlrev_b32 v158, 16, v134
    v_and_b32 v159, 0xffff0000, v134
    v_add_f32 v84, v84, v158
    v_add_f32 v85, v85, v159
    v_lshlrev_b32 v158, 16, v135
    v_and_b32 v159, 0xffff0000, v135
    v_add_f32 v86, v86, v158
    v_add_f32 v87, v87, v159
    v_cvt_pk_bf16_f32 v50, v84, v85
    v_lshlrev_b32 v84, 16, v50
    v_and_b32 v85, 0xffff0000, v50
    v_lshlrev_b32 v158, 16, v98
    v_and_b32 v159, 0xffff0000, v98
    v_add_f32 v84, v84, v158
    v_add_f32 v85, v85, v159
    v_cvt_pk_bf16_f32 v50, v84, v85
    v_cvt_pk_bf16_f32 v51, v86, v87
    v_lshlrev_b32 v86, 16, v51
    v_and_b32 v87, 0xffff0000, v51
    v_lshlrev_b32 v158, 16, v99
    v_and_b32 v159, 0xffff0000, v99
    v_add_f32 v86, v86, v158
    v_add_f32 v87, v87, v159
    v_cvt_pk_bf16_f32 v51, v86, v87
    ds_write_b64 v148, v[50:51] offset:1856
    s_waitcnt lgkmcnt(0)
    ds_read_b128 v[52:55], v153 offset:64
    s_waitcnt lgkmcnt(0)
    buffer_store_dwordx4 v[52:55], v154, s[20:23], s45 offen offset:256
L_k5_kernel_done:
L_k5_kernel_end:
    s_endpgm
L_code_end:
.section .rodata,"a"
.p2align 6
.amdhsa_kernel sequential_preLN__sliding_block__glu_gated_glu__prompt_kernel
  .amdhsa_next_free_vgpr 244
  .amdhsa_next_free_sgpr 68
  .amdhsa_accum_offset 244
  .amdhsa_group_segment_fixed_size 0
  .amdhsa_kernarg_size 80
  .amdhsa_user_sgpr_count 2
  .amdhsa_user_sgpr_kernarg_segment_ptr 1
  .amdhsa_system_sgpr_workgroup_id_x 1
  .amdhsa_float_denorm_mode_32 3
.end_amdhsa_kernel
.p2align 6
.amdhsa_kernel k2_kernel
  .amdhsa_next_free_vgpr 320
  .amdhsa_next_free_sgpr 64
  .amdhsa_accum_offset 160
  .amdhsa_group_segment_fixed_size 0
  .amdhsa_kernarg_size 80
  .amdhsa_user_sgpr_count 2
  .amdhsa_user_sgpr_kernarg_segment_ptr 1
  .amdhsa_system_sgpr_workgroup_id_x 1
  .amdhsa_float_denorm_mode_32 3
.end_amdhsa_kernel
.p2align 6
.amdhsa_kernel k3_kernel
  .amdhsa_next_free_vgpr 168
  .amdhsa_next_free_sgpr 48
  .amdhsa_accum_offset 168
  .amdhsa_group_segment_fixed_size 0
  .amdhsa_kernarg_size 80
  .amdhsa_user_sgpr_count 2
  .amdhsa_user_sgpr_kernarg_segment_ptr 1
  .amdhsa_system_sgpr_workgroup_id_x 1
  .amdhsa_float_denorm_mode_32 3
.end_amdhsa_kernel
.p2align 6
.amdhsa_kernel k4_kernel
  .amdhsa_next_free_vgpr 252
  .amdhsa_next_free_sgpr 39
  .amdhsa_accum_offset 180
  .amdhsa_group_segment_fixed_size 0
  .amdhsa_kernarg_size 80
  .amdhsa_user_sgpr_count 2
  .amdhsa_user_sgpr_kernarg_segment_ptr 1
  .amdhsa_system_sgpr_workgroup_id_x 1
  .amdhsa_float_denorm_mode_32 3
.end_amdhsa_kernel
.p2align 6
.amdhsa_kernel k5_kernel
  .amdhsa_next_free_vgpr 484
  .amdhsa_next_free_sgpr 46
  .amdhsa_accum_offset 228
  .amdhsa_group_segment_fixed_size 0
  .amdhsa_kernarg_size 80
  .amdhsa_user_sgpr_count 2
  .amdhsa_user_sgpr_kernarg_segment_ptr 1
  .amdhsa_system_sgpr_workgroup_id_x 1
  .amdhsa_float_denorm_mode_32 3
.end_amdhsa_kernel
```
